```python
import torch

def _softmax(x, axis=-1):
    return torch.softmax(x, dim=axis)
def _gelu(x):
    return torch.nn.functional.gelu(x, approximate="tanh")
def _silu(x):
    return torch.nn.functional.silu(x)
def _sigmoid(x):
    return torch.sigmoid(x)
def _layernorm(x, axis=-1, eps=1e-5):
    m = x.mean(dim=axis, keepdim=True)
    v = x.var(dim=axis, keepdim=True, unbiased=False)
    return (x - m) / torch.sqrt(v + eps)
def _scatter_add(tgt, idx, src, axis=0):
    return tgt.clone().index_add_(axis, idx, src)
def _segment_sum(src, seg, n):
    out = torch.zeros((n,) + src.shape[1:], dtype=src.dtype)
    return out.index_add_(0, seg, src)
def _pad(x, pw):
    flat = tuple(v for pair in reversed(pw) for v in pair)
    return torch.nn.functional.pad(x, flat)

kernel_name = 'recurrent_scan__compressed_kv_cla__glu_gated_bilinear__prompt'

def setup_inputs():

    _w = (lambda a: (lambda t: t.to(torch.bfloat16) if t.is_floating_point() else t)(torch.as_tensor(a)))
    def _A_setup():
        B, H, Sq, Sk, D, M = 1, 32, 2048, 2048, 128, 512
        Dc = 4 * D
        return {
            "x": _w((lambda *s: torch.randn(*s, dtype=torch.bfloat16) * 0.05)(B, Sq, M)),
            "c_kv": _w((lambda *s: torch.randn(*s, dtype=torch.bfloat16) * 1.6)(B, Sk, Dc)),
            "w_q": _w((lambda *s: torch.randn(*s, dtype=torch.bfloat16) * 1.6)(M, H, D) * (M ** -0.5)),
            "w_uk": _w((lambda *s: torch.randn(*s, dtype=torch.bfloat16) * 1.6)(Dc, H, D) * (Dc ** -0.5)),
            "w_uv": _w((lambda *s: torch.randn(*s, dtype=torch.bfloat16) * 1.6)(Dc, H, D) * (Dc ** -0.5)),
            "w_o": _w((lambda *s: torch.randn(*s, dtype=torch.bfloat16) * 1.6)(H, D, M) * ((H * D) ** -0.5)),
        }
    _A_in = _A_setup()

    def _B_setup():
        B, S, D, F = 1, 2048, 512, 1792
        return {
            "x": _w((lambda *s: torch.randn(*s, dtype=torch.bfloat16) * 0.05)(B, S, D)),
            "w_gate": _w((lambda *s: torch.randn(*s, dtype=torch.bfloat16) * 0.2)(D, F) * (D ** -0.5)),
            "w_up": _w((lambda *s: torch.randn(*s, dtype=torch.bfloat16) * 0.2)(D, F) * (D ** -0.5)),
            "w_down": _w((lambda *s: torch.randn(*s, dtype=torch.bfloat16) * 0.2)(F, D) * (F ** -0.5)),
        }
    _B_in = _B_setup()

    return {
        "A_x": _A_in["x"],
        "A_c_kv": _A_in["c_kv"],
        "A_w_q": _A_in["w_q"],
        "A_w_uk": _A_in["w_uk"],
        "A_w_uv": _A_in["w_uv"],
        "A_w_o": _A_in["w_o"],
        "B_x": _B_in["x"],
        "B_w_gate": _B_in["w_gate"],
        "B_w_up": _B_in["w_up"],
        "B_w_down": _B_in["w_down"],
    }

def reference(A_x, A_c_kv, A_w_q, A_w_uk, A_w_uv, A_w_o, B_x, B_w_gate, B_w_up, B_w_down):
    def _A_ref(x, c_kv, w_q, w_uk, w_uv, w_o):
        B, Sq, M = x.shape[0], x.shape[1], x.shape[2]
        Sk = c_kv.shape[1]
        H, D = w_q.shape[1], w_q.shape[2]
        q = torch.einsum("bqm,mhd->bhqd", x, w_q)
        k = torch.einsum("bkc,chd->bhkd", c_kv, w_uk)
        v = torch.einsum("bkc,chd->bhkd", c_kv, w_uv)
        scores = torch.einsum("bhqd,bhkd->bhqk", q, k) * (D ** -0.5)
        off = Sk - Sq
        qi = torch.arange(Sq)[:, None]
        kj = torch.arange(Sk)[None, :]
        cmask = kj <= (qi + off)
        scores = torch.where(cmask[None, None], scores, -1e9)
        p = _softmax(scores, axis=-1)
        ctx = torch.einsum("bhqk,bhkd->bhqd", p, v)
        return torch.einsum("bhqd,hdm->bqm", ctx, w_o)

    def _B_ref(x, w_gate, w_up, w_down):
        g = torch.einsum("bsd,df->bsf", x, w_gate)
        u = torch.einsum("bsd,df->bsf", x, w_up)
        h = g * u
        return torch.einsum("bsf,fd->bsd", h, w_down)

    x = A_x
    xn = _layernorm(x, axis=-1)
    s = _A_ref(xn, A_c_kv, A_w_q, A_w_uk, A_w_uv, A_w_o)
    g = _silu(_B_ref(xn, B_w_gate, B_w_up, B_w_down))
    return x + s * g
```

```asm
; @launch grid=(256,1,1) block=(256,1,1) lds=163840
.amdgcn_target "amdgcn-amd-amdhsa--gfx950"
.text
.p2align 12
.fill 832, 4, 0xbf810000
.globl recurrent_scan__compressed_kv_cla__glu_gated_bilinear__prompt_kernel
.p2align 8
.type recurrent_scan__compressed_kv_cla__glu_gated_bilinear__prompt_kernel,@function
recurrent_scan__compressed_kv_cla__glu_gated_bilinear__prompt_kernel:
  s_cmp_ge_u32 s2, 256
  s_cbranch_scc1 L_end
  s_load_dwordx2 s[4:5], s[0:1], 8
  s_load_dwordx2 s[8:9], s[0:1], 24
  s_load_dwordx2 s[48:49], s[0:1], 0
  s_load_dwordx2 s[66:67], s[0:1], 88
  s_load_dwordx2 s[64:65], s[0:1], 96
  s_load_dwordx2 s[12:13], s[0:1], 32
  s_load_dwordx2 s[16:17], s[0:1], 16
  s_load_dwordx2 s[20:21], s[0:1], 56
  s_load_dwordx2 s[24:25], s[0:1], 64
  s_load_dwordx2 s[52:53], s[0:1], 40
  s_load_dwordx2 s[56:57], s[0:1], 72
  s_load_dwordx2 s[60:61], s[0:1], 80
  s_getpc_b64 s[34:35]
L_pc:
  s_lshr_b32 s3, s2, 3
  s_mul_i32 s3, s3, 2560
  v_min_u32 v51, 39, v0
  v_lshlrev_b32 v51, 6, v51
  v_add_u32 v51, s3, v51
  v_min_u32 v51, L_code_end-L_pc-4, v51
  v_lshrrev_b32 v16, 6, v0
  v_and_b32 v1, 63, v0
  global_load_dword v0, v51, s[34:35]
  v_readfirstlane_b32 s68, v16
  s_and_b32 s89, s2, 7
  s_lshl_b32 s75, s89, 2
  s_bfe_u32 s76, s2, 0x20003
  s_lshl_b32 s71, s76, 2
  s_add_u32 s89, s89, s71
  s_and_b32 s89, s89, 7
  s_add_u32 s69, s75, s76
  s_lshr_b32 s70, s2, 5
  s_mov_b32 s71, s89
  s_lshl_b32 s73, s89, 7
  s_lshl_b32 s75, s2, 13
  s_lshl_b32 s76, s68, 8
  s_add_u32 s75, s75, s76
  v_and_b32 v62, 7, v1
  v_lshlrev_b32 v62, 10, v62
  v_lshrrev_b32 v17, 3, v1
  v_lshl_add_u32 v62, v17, 4, v62
  v_add_u32 v62, s75, v62
  s_mov_b32 s6, 0x200000
  s_mov_b32 s7, 0x20000
  s_mov_b32 s10, 0x400000
  s_mov_b32 s11, 0x20000
  s_mov_b32 s50, 0x200000
  s_mov_b32 s51, 0x20000
  v_bfe_u32 v16, v1, 2, 2
  v_lshlrev_b32 v2, 13, v16
  v_lshrrev_b32 v16, 4, v1
  v_lshl_add_u32 v2, v16, 6, v2
  v_and_b32 v16, 3, v1
  v_lshl_add_u32 v2, v16, 4, v2
  s_lshl_b32 s75, s69, 8
  s_lshl_b32 s76, s68, 17
  s_add_u32 s75, s75, s76
  v_add_u32 v2, s75, v2
  v_xor_b32 v16, 32, v2
  v_add_u32 v3, 31744, v2
  v_add_u32 v4, 63488, v16
  v_add_u32 v5, 95232, v16
  s_lshl_b32 s76, s70, 14
  s_add_u32 s75, s75, s76
  v_lshrrev_b32 v16, 3, v1
  v_lshlrev_b32 v56, 19, v16
  v_bfe_u32 v17, v1, 2, 1
  v_lshl_add_u32 v56, v17, 13, v56
  v_and_b32 v17, 3, v1
  v_lshl_add_u32 v56, v17, 6, v56
  v_add_u32 v56, s75, v56
  s_lshl_b32 s75, s70, 18
  s_lshl_b32 s76, s68, 16
  s_add_u32 s75, s75, s76
  v_lshlrev_b32 v16, 10, v16
  v_add_u32 v16, s75, v16
  v_and_b32 v17, 7, v1
  v_lshrrev_b32 v18, 4, v1
  v_xor_b32 v17, v17, v18
  v_lshl_add_u32 v6, v17, 4, v16
  v_xor_b32 v17, 64, v6
  v_add_u32 v7, 7168, v17
  v_add_u32 v8, 14336, v6
  v_add_u32 v9, 21504, v17
  s_lshl_b32 s77, s68, 12
  s_lshl_b32 s78, s68, 13
  s_waitcnt lgkmcnt(0)
  s_or_b32 s75, s2, s68
  s_cmp_lg_u32 s75, 0
  s_cbranch_scc1 L_notoken
  s_memrealtime s[98:99]
  v_mov_b32 v16, 0
  s_waitcnt lgkmcnt(0)
  s_or_b32 s75, s98, 1
  v_mov_b32 v17, s75
  global_store_dword v16, v17, s[66:67] sc1
L_notoken:
  s_add_u32 m0, s77, 98304
  s_lshl_b32 s72, s71, 19
  buffer_load_dwordx4 v2, s[8:11], s72 offen offset:0 lds
  buffer_load_dwordx4 v3, s[8:11], s72 offen offset:1024 lds
  buffer_load_dwordx4 v4, s[8:11], s72 offen offset:2048 lds
  buffer_load_dwordx4 v5, s[8:11], s72 offen offset:3072 lds
  s_add_u32 s71, s71, 1
  s_and_b32 s71, s71, 7
  s_add_u32 m0, s78, 0
  s_add_u32 s74, s73, 0x8000
  buffer_load_dwordx4 v6, s[4:7], s73 offen offset:0 lds
  buffer_load_dwordx4 v7, s[4:7], s73 offen offset:1024 lds
  buffer_load_dwordx4 v8, s[4:7], s73 offen offset:2048 lds
  buffer_load_dwordx4 v9, s[4:7], s73 offen offset:3072 lds
  s_add_u32 m0, s78, 4096
  s_add_u32 s73, s73, 128
  buffer_load_dwordx4 v6, s[4:7], s74 offen offset:0 lds
  buffer_load_dwordx4 v7, s[4:7], s74 offen offset:1024 lds
  buffer_load_dwordx4 v8, s[4:7], s74 offen offset:2048 lds
  buffer_load_dwordx4 v9, s[4:7], s74 offen offset:3072 lds
  s_and_b32 s73, s73, 1023
  s_mov_b32 s95, 32
  s_or_b32 s75, s68, 1
  s_call_b64 s[98:99], Lmask
  v_cmp_gt_u32 vcc, 32, v1
  v_mov_b32 v18, 0xf0000000
  s_nop 0
  v_cndmask_b32 v57, v18, v56, vcc
  s_lshl_b32 s75, s70, 2
  s_add_u32 s75, s75, s68
  s_lshl_b32 s75, s75, 4
  v_lshrrev_b32 v16, 1, v1
  v_add_u32 v16, s75, v16
  v_mul_u32_u24 v16, 3584, v16
  v_and_b32 v17, 1, v1
  v_lshl_add_u32 v16, v17, 6, v16
  s_lshl_b32 s75, s69, 7
  v_add_u32 v16, s75, v16
  v_cndmask_b32 v58, v18, v16, vcc
  v_lshlrev_b32 v17, 6, v1
  v_cndmask_b32 v55, v18, v17, vcc
  s_lshl_b32 s0, s69, 5
  s_lshl_b32 s75, s70, 2
  s_add_u32 s0, s0, s75
  s_add_u32 s0, s0, s68
  s_lshl_b32 s0, s0, 11
  s_mov_b32 s14, 0x400000
  s_mov_b32 s15, 0x20000
  s_mov_b32 s18, 0x400000
  s_mov_b32 s19, 0x20000
  s_mov_b32 s54, 0x400000
  s_mov_b32 s55, 0x20000
  s_mov_b32 s58, 0x1c0000
  s_mov_b32 s59, 0x20000
  s_mov_b32 s62, 0x200000
  s_mov_b32 s63, 0x20000
  s_add_u32 s44, s64, 0x2200000
  s_addc_u32 s45, s65, 0
  s_mov_b32 s46, 0x2800000
  s_mov_b32 s47, 0x20000
  s_add_u32 s28, s64, 0x0
  s_addc_u32 s29, s65, 0
  s_mov_b32 s30, 0x200000
  s_mov_b32 s31, 0x20000
  s_add_u32 s40, s64, 0x3300000
  s_addc_u32 s41, s65, 0
  s_mov_b32 s42, 0x700000
  s_mov_b32 s43, 0x20000
  s_lshl_b32 s76, s69, 20
  s_add_u32 s76, s76, 2097152
  s_add_u32 s36, s64, s76
  s_addc_u32 s37, s65, 0
  s_mov_b32 s38, 0x100000
  s_mov_b32 s39, 0x20000
  s_cmp_lt_u32 s69, 28
  s_cselect_b32 s22, 0x1c0000, 0
  s_cselect_b32 s42, 0x700000, 0
  s_mov_b32 s26, s22
  s_mov_b32 s23, 0x20000
  s_mov_b32 s27, 0x20000
  s_lshl_b32 s85, s2, 7
  s_lshl_b32 s86, s69, 3
  s_add_u32 s86, s86, s70
  s_lshl_b32 s86, s86, 7
  s_add_u32 s86, s86, 32768
  s_lshl_b32 s87, s70, 5
  s_add_u32 s87, s87, s69
  s_lshl_b32 s87, s87, 7
  s_add_u32 s88, s87, 98304
  s_add_u32 s87, s87, 65536
  s_mov_b32 s75, 0xf0000000
  v_mov_b32 v31, s75
  s_cmp_eq_u32 s68, 0
  s_cselect_b32 s75, 0x1000000, s75
  v_writelane_b32 v31, s75, 0
  s_lshr_b32 s75, s2, 1
  s_lshl_b32 s75, s75, 14
  s_and_b32 s76, s2, 1
  s_lshl_b32 s76, s76, 7
  s_add_u32 s75, s75, s76
  s_add_u32 s75, s75, s77
  v_lshrrev_b32 v16, 3, v1
  v_lshlrev_b32 v53, 8, v16
  v_and_b32 v16, 7, v1
  v_lshl_add_u32 v53, v16, 4, v53
  v_add_u32 v53, s75, v53
  v_lshrrev_b32 v16, 4, v1
  v_lshlrev_b32 v59, 10, v16
  v_lshlrev_b32 v12, 11, v16
  v_and_b32 v16, 1, v16
  v_lshl_add_u32 v12, v16, 5, v12
  v_bfe_u32 v16, v1, 2, 2
  v_lshl_add_u32 v12, v16, 6, v12
  v_and_b32 v16, 3, v1
  v_lshl_add_u32 v12, v16, 3, v12
  v_xor_b32 v13, 32, v12
  v_add_u32 v14, 65536, v12
  v_add_u32 v28, 65536, v13
  v_add_u32 v10, 98304, v12
  v_add_u32 v11, 98304, v13
  v_and_b32 v16, 15, v1
  v_lshlrev_b32 v17, 7, v16
  v_add_u32 v17, s78, v17
  v_bfe_u32 v16, v1, 1, 3
  v_lshrrev_b32 v18, 4, v1
  v_xor_b32 v16, v16, v18
  v_lshl_add_u32 v24, v16, 4, v17
  v_xor_b32 v25, 64, v24
  v_add_u32 v26, 0x10000, v24
  v_add_u32 v27, 0x10000, v25
  v_lshlrev_b32 v15, 4, v1
  v_lshrrev_b32 v16, 5, v1
  v_bfe_u32 v17, v1, 2, 2
  v_lshl_add_u32 v16, v16, 2, v17
  s_lshl_b32 s75, s68, 4
  v_add_u32 v16, s75, v16
  v_mul_u32_u24 v29, 3584, v16
  v_bfe_u32 v16, v1, 4, 1
  v_lshl_add_u32 v29, v16, 6, v29
  v_and_b32 v16, 3, v1
  v_lshl_add_u32 v29, v16, 4, v29
  s_lshl_b32 s75, s69, 7
  v_add_u32 v29, s75, v29
  v_xor_b32 v16, 32, v29
  v_add_u32 v30, 27648, v16
  s_lshl_b32 s75, s70, 2
  s_add_u32 s76, s75, s68
  s_lshl_b32 s79, s76, 15
  s_lshl_b32 s75, s75, 1
  s_add_u32 s82, s75, s68
  s_lshl_b32 s82, s82, 14
  s_sub_u32 s75, 120, s75
  s_add_u32 s75, s75, s68
  s_lshl_b32 s81, s75, 14
  s_lshl_b32 s33, s68, 1
  s_sub_u32 s33, 7, s33
  buffer_load_dwordx4 v[64:67], v62, s[48:51], 0 offen offset:0
  buffer_load_dwordx4 v[68:71], v62, s[48:51], 0 offen offset:128
  s_add_u32 m0, s77, 114688
  s_lshl_b32 s72, s71, 19
  buffer_load_dwordx4 v2, s[8:11], s72 offen offset:0 lds
  buffer_load_dwordx4 v3, s[8:11], s72 offen offset:1024 lds
  buffer_load_dwordx4 v4, s[8:11], s72 offen offset:2048 lds
  buffer_load_dwordx4 v5, s[8:11], s72 offen offset:3072 lds
  s_add_u32 s71, s71, 1
  s_and_b32 s71, s71, 7
  s_add_u32 m0, s78, 32768
  s_add_u32 s74, s73, 0x8000
  buffer_load_dwordx4 v6, s[4:7], s73 offen offset:0 lds
  buffer_load_dwordx4 v7, s[4:7], s73 offen offset:1024 lds
  buffer_load_dwordx4 v8, s[4:7], s73 offen offset:2048 lds
  buffer_load_dwordx4 v9, s[4:7], s73 offen offset:3072 lds
  s_add_u32 m0, s78, 36864
  s_add_u32 s73, s73, 128
  buffer_load_dwordx4 v6, s[4:7], s74 offen offset:0 lds
  buffer_load_dwordx4 v7, s[4:7], s74 offen offset:1024 lds
  buffer_load_dwordx4 v8, s[4:7], s74 offen offset:2048 lds
  buffer_load_dwordx4 v9, s[4:7], s74 offen offset:3072 lds
  s_and_b32 s73, s73, 1023
  s_mov_b32 s1, 0
  buffer_load_dword v0, v56, s[8:11], s1 offen
  s_waitcnt vmcnt(15)
  s_waitcnt lgkmcnt(0)
  s_barrier
  ds_read_b128 a[0:3], v24 offset:0
  ds_read_b128 a[4:7], v24 offset:2048
  ds_read_b128 a[8:11], v24 offset:4096
  ds_read_b128 a[12:15], v24 offset:6144
  ds_read_b128 a[16:19], v25 offset:0
  ds_read_b128 a[20:23], v25 offset:2048
  ds_read_b128 a[24:27], v25 offset:4096
  ds_read_b128 a[28:31], v25 offset:6144
  ds_read_b64_tr_b16 v[32:33], v10 offset:0
  ds_read_b64_tr_b16 v[34:35], v10 offset:1024
  ds_read_b64_tr_b16 v[36:37], v10 offset:8192
  ds_read_b64_tr_b16 v[38:39], v10 offset:9216
  ds_read_b64_tr_b16 v[40:41], v11 offset:0
  ds_read_b64_tr_b16 v[42:43], v11 offset:1024
  s_waitcnt lgkmcnt(4)
  v_mfma_f32_16x16x32_bf16 v[128:131], v[32:35], a[0:3], 0
  s_add_u32 m0, s77, 131072
  s_lshl_b32 s72, s71, 19
  ds_read_b64_tr_b16 v[44:45], v11 offset:8192
  v_mfma_f32_16x16x32_bf16 v[132:135], v[32:35], a[4:7], 0
  ds_read_b64_tr_b16 v[46:47], v11 offset:9216
  v_mfma_f32_16x16x32_bf16 v[136:139], v[32:35], a[8:11], 0
  v_mfma_f32_16x16x32_bf16 v[140:143], v[32:35], a[12:15], 0
  s_waitcnt lgkmcnt(4)
  buffer_load_dwordx4 v2, s[8:11], s72 offen offset:0 lds
  v_mfma_f32_16x16x32_bf16 v[128:131], v[36:39], a[16:19], v[128:131]
  ds_read_b64_tr_b16 v[32:33], v10 offset:256
  v_mfma_f32_16x16x32_bf16 v[132:135], v[36:39], a[20:23], v[132:135]
  ds_read_b64_tr_b16 v[34:35], v10 offset:1280
  v_mfma_f32_16x16x32_bf16 v[136:139], v[36:39], a[24:27], v[136:139]
  v_mfma_f32_16x16x32_bf16 v[140:143], v[36:39], a[28:31], v[140:143]
  s_waitcnt lgkmcnt(4)
  buffer_load_dwordx4 v3, s[8:11], s72 offen offset:1024 lds
  v_mfma_f32_16x16x32_bf16 v[144:147], v[40:43], a[0:3], 0
  ds_read_b64_tr_b16 v[36:37], v10 offset:8448
  s_waitcnt vmcnt(16)
  v_lshlrev_b32 v72, 16, v64
  v_mfma_f32_16x16x32_bf16 v[148:151], v[40:43], a[4:7], 0
  ds_read_b64_tr_b16 v[38:39], v10 offset:9472
  v_and_b32 v73, 0xffff0000, v64
  v_mfma_f32_16x16x32_bf16 v[152:155], v[40:43], a[8:11], 0
  v_lshlrev_b32 v74, 16, v65
  v_and_b32 v75, 0xffff0000, v65
  v_mfma_f32_16x16x32_bf16 v[156:159], v[40:43], a[12:15], 0
  s_waitcnt lgkmcnt(4)
  buffer_load_dwordx4 v4, s[8:11], s72 offen offset:2048 lds
  v_lshlrev_b32 v76, 16, v66
  v_mfma_f32_16x16x32_bf16 v[144:147], v[44:47], a[16:19], v[144:147]
  ds_read_b64_tr_b16 v[40:41], v11 offset:256
  v_and_b32 v77, 0xffff0000, v66
  v_mfma_f32_16x16x32_bf16 v[148:151], v[44:47], a[20:23], v[148:151]
  ds_read_b64_tr_b16 v[42:43], v11 offset:1280
  v_lshlrev_b32 v78, 16, v67
  v_mfma_f32_16x16x32_bf16 v[152:155], v[44:47], a[24:27], v[152:155]
  v_and_b32 v79, 0xffff0000, v67
  s_waitcnt vmcnt(16)
  v_lshlrev_b32 v80, 16, v68
  v_mfma_f32_16x16x32_bf16 v[156:159], v[44:47], a[28:31], v[156:159]
  s_waitcnt lgkmcnt(4)
  s_add_u32 s71, s71, 1
  buffer_load_dwordx4 v5, s[8:11], s72 offen offset:3072 lds
  v_mfma_f32_16x16x32_bf16 v[160:163], v[32:35], a[0:3], 0
  s_and_b32 s71, s71, 7
  s_add_u32 m0, s78, 65536
  ds_read_b64_tr_b16 v[44:45], v11 offset:8448
  v_mfma_f32_16x16x32_bf16 v[164:167], v[32:35], a[4:7], 0
  s_add_u32 s74, s73, 0x8000
  ds_read_b64_tr_b16 v[46:47], v11 offset:9472
  v_and_b32 v81, 0xffff0000, v68
  v_mfma_f32_16x16x32_bf16 v[168:171], v[32:35], a[8:11], 0
  v_lshlrev_b32 v82, 16, v69
  v_and_b32 v83, 0xffff0000, v69
  v_mfma_f32_16x16x32_bf16 v[172:175], v[32:35], a[12:15], 0
  s_waitcnt lgkmcnt(4)
  buffer_load_dwordx4 v6, s[4:7], s73 offen offset:0 lds
  v_lshlrev_b32 v84, 16, v70
  v_mfma_f32_16x16x32_bf16 v[160:163], v[36:39], a[16:19], v[160:163]
  ds_read_b64_tr_b16 v[32:33], v10 offset:512
  v_and_b32 v85, 0xffff0000, v70
  v_mfma_f32_16x16x32_bf16 v[164:167], v[36:39], a[20:23], v[164:167]
  ds_read_b64_tr_b16 v[34:35], v10 offset:1536
  v_lshlrev_b32 v86, 16, v71
  v_mfma_f32_16x16x32_bf16 v[168:171], v[36:39], a[24:27], v[168:171]
  v_and_b32 v87, 0xffff0000, v71
  v_add_f32 v88, v72, v73
  v_mfma_f32_16x16x32_bf16 v[172:175], v[36:39], a[28:31], v[172:175]
  s_waitcnt lgkmcnt(4)
  buffer_load_dwordx4 v7, s[4:7], s73 offen offset:1024 lds
  v_mul_f32 v89, v72, v72
  v_mfma_f32_16x16x32_bf16 v[176:179], v[40:43], a[0:3], 0
  ds_read_b64_tr_b16 v[36:37], v10 offset:8704
  v_fmac_f32 v89, v73, v73
  v_mfma_f32_16x16x32_bf16 v[180:183], v[40:43], a[4:7], 0
  ds_read_b64_tr_b16 v[38:39], v10 offset:9728
  s_waitcnt vmcnt(7)
  ds_read_b128 a[32:35], v24 offset:32768
  v_mfma_f32_16x16x32_bf16 v[184:187], v[40:43], a[8:11], 0
  v_add_f32 v88, v88, v74
  v_fmac_f32 v89, v74, v74
  v_mfma_f32_16x16x32_bf16 v[188:191], v[40:43], a[12:15], 0
  s_waitcnt lgkmcnt(5)
  buffer_load_dwordx4 v8, s[4:7], s73 offen offset:2048 lds
  v_add_f32 v88, v88, v75
  v_mfma_f32_16x16x32_bf16 v[176:179], v[44:47], a[16:19], v[176:179]
  ds_read_b64_tr_b16 v[40:41], v11 offset:512
  v_fmac_f32 v89, v75, v75
  v_mfma_f32_16x16x32_bf16 v[180:183], v[44:47], a[20:23], v[180:183]
  ds_read_b64_tr_b16 v[42:43], v11 offset:1536
  ds_read_b128 a[36:39], v24 offset:34816
  v_mfma_f32_16x16x32_bf16 v[184:187], v[44:47], a[24:27], v[184:187]
  v_add_f32 v88, v88, v76
  v_fmac_f32 v89, v76, v76
  v_mfma_f32_16x16x32_bf16 v[188:191], v[44:47], a[28:31], v[188:191]
  s_waitcnt lgkmcnt(6)
  buffer_load_dwordx4 v9, s[4:7], s73 offen offset:3072 lds
  s_add_u32 m0, s78, 69632
  v_mfma_f32_16x16x32_bf16 v[192:195], v[32:35], a[0:3], 0
  s_add_u32 s73, s73, 128
  ds_read_b64_tr_b16 v[44:45], v11 offset:8704
  v_add_f32 v88, v88, v77
  v_mfma_f32_16x16x32_bf16 v[196:199], v[32:35], a[4:7], 0
  ds_read_b64_tr_b16 v[46:47], v11 offset:9728
  ds_read_b128 a[40:43], v24 offset:36864
  v_mfma_f32_16x16x32_bf16 v[200:203], v[32:35], a[8:11], 0
  v_fmac_f32 v89, v77, v77
  v_add_f32 v88, v88, v78
  v_mfma_f32_16x16x32_bf16 v[204:207], v[32:35], a[12:15], 0
  s_waitcnt lgkmcnt(7)
  buffer_load_dwordx4 v6, s[4:7], s74 offen offset:0 lds
  v_fmac_f32 v89, v78, v78
  v_mfma_f32_16x16x32_bf16 v[192:195], v[36:39], a[16:19], v[192:195]
  ds_read_b64_tr_b16 v[32:33], v10 offset:768
  v_add_f32 v88, v88, v79
  v_mfma_f32_16x16x32_bf16 v[196:199], v[36:39], a[20:23], v[196:199]
  ds_read_b64_tr_b16 v[34:35], v10 offset:1792
  ds_read_b128 a[44:47], v24 offset:38912
  v_mfma_f32_16x16x32_bf16 v[200:203], v[36:39], a[24:27], v[200:203]
  v_fmac_f32 v89, v79, v79
  v_add_f32 v88, v88, v80
  v_mfma_f32_16x16x32_bf16 v[204:207], v[36:39], a[28:31], v[204:207]
  s_waitcnt lgkmcnt(7)
  buffer_load_dwordx4 v7, s[4:7], s74 offen offset:1024 lds
  v_fmac_f32 v89, v80, v80
  v_mfma_f32_16x16x32_bf16 v[208:211], v[40:43], a[0:3], 0
  ds_read_b64_tr_b16 v[36:37], v10 offset:8960
  v_add_f32 v88, v88, v81
  v_mfma_f32_16x16x32_bf16 v[212:215], v[40:43], a[4:7], 0
  ds_read_b64_tr_b16 v[38:39], v10 offset:9984
  ds_read_b128 a[48:51], v25 offset:32768
  v_mfma_f32_16x16x32_bf16 v[216:219], v[40:43], a[8:11], 0
  v_fmac_f32 v89, v81, v81
  v_add_f32 v88, v88, v82
  v_mfma_f32_16x16x32_bf16 v[220:223], v[40:43], a[12:15], 0
  s_waitcnt lgkmcnt(7)
  buffer_load_dwordx4 v8, s[4:7], s74 offen offset:2048 lds
  v_fmac_f32 v89, v82, v82
  v_mfma_f32_16x16x32_bf16 v[208:211], v[44:47], a[16:19], v[208:211]
  ds_read_b64_tr_b16 v[40:41], v11 offset:768
  v_add_f32 v88, v88, v83
  v_mfma_f32_16x16x32_bf16 v[212:215], v[44:47], a[20:23], v[212:215]
  ds_read_b64_tr_b16 v[42:43], v11 offset:1792
  ds_read_b128 a[52:55], v25 offset:34816
  v_mfma_f32_16x16x32_bf16 v[216:219], v[44:47], a[24:27], v[216:219]
  s_lshl_b32 s32, s68, 6
  v_fmac_f32 v89, v83, v83
  v_add_f32 v88, v88, v84
  v_fmac_f32 v89, v84, v84
  v_add_f32 v88, v88, v85
  v_fmac_f32 v89, v85, v85
  v_add_f32 v88, v88, v86
  v_fmac_f32 v89, v86, v86
  v_add_f32 v88, v88, v87
  v_fmac_f32 v89, v87, v87
  v_and_b32 v48, 7, v1
  v_lshlrev_b32 v48, 3, v48
  v_add_u32 v48, 147456, v48
  v_add_f32_dpp v88, v88, v88 row_ror:8 row_mask:0xf bank_mask:0xf
  v_add_f32_dpp v89, v89, v89 row_ror:8 row_mask:0xf bank_mask:0xf
  v_mov_b32 v90, v88
  v_mov_b32 v91, v89
  s_nop 0
  v_permlane16_swap_b32 v88, v90
  v_permlane16_swap_b32 v89, v91
  v_add_f32 v88, v88, v90
  v_add_f32 v89, v89, v91
  v_mov_b32 v90, v88
  v_mov_b32 v91, v89
  s_nop 0
  v_permlane32_swap_b32 v88, v90
  v_permlane32_swap_b32 v89, v91
  v_add_f32 v88, v88, v90
  v_add_f32 v89, v89, v91
  v_add_u32 v90, s32, v48
  ds_write_b64 v90, v[88:89]
  v_mfma_f32_16x16x32_bf16 v[220:223], v[44:47], a[28:31], v[220:223]
  s_waitcnt lgkmcnt(8)
  s_and_b32 s73, s73, 1023
  buffer_load_dwordx4 v9, s[4:7], s74 offen offset:3072 lds
  v_mfma_f32_16x16x32_bf16 v[224:227], v[32:35], a[0:3], 0
  s_add_u32 m0, s78, 0
  s_add_u32 s74, s73, 0x8000
  ds_read_b64_tr_b16 v[44:45], v11 offset:8960
  v_mfma_f32_16x16x32_bf16 v[228:231], v[32:35], a[4:7], 0
  ds_read_b64_tr_b16 v[46:47], v11 offset:9984
  ds_read_b128 a[56:59], v25 offset:36864
  v_mfma_f32_16x16x32_bf16 v[232:235], v[32:35], a[8:11], 0
  v_mfma_f32_16x16x32_bf16 v[236:239], v[32:35], a[12:15], 0
  s_waitcnt lgkmcnt(8)
  s_waitcnt lgkmcnt(0)
  s_barrier
  v_mfma_f32_16x16x32_bf16 v[224:227], v[36:39], a[16:19], v[224:227]
  ds_read_b64_tr_b16 v[32:33], v10 offset:16384
  ds_read_b64 v[88:89], v48 offset:0
  v_mfma_f32_16x16x32_bf16 v[228:231], v[36:39], a[20:23], v[228:231]
  ds_read_b64_tr_b16 v[34:35], v10 offset:17408
  ds_read_b128 a[60:63], v25 offset:38912
  v_mfma_f32_16x16x32_bf16 v[232:235], v[36:39], a[24:27], v[232:235]
  ds_read_b64 v[90:91], v48 offset:64
  ds_read_b64 v[92:93], v48 offset:128
  v_mfma_f32_16x16x32_bf16 v[236:239], v[36:39], a[28:31], v[236:239]
  buffer_load_dwordx4 v6, s[4:7], s73 offen offset:0 lds
  ds_read_b64 v[94:95], v48 offset:192
  v_mfma_f32_16x16x32_bf16 v[240:243], v[40:43], a[0:3], 0
  ds_read_b64_tr_b16 v[36:37], v10 offset:24576
  v_mfma_f32_16x16x32_bf16 v[244:247], v[40:43], a[4:7], 0
  ds_read_b64_tr_b16 v[38:39], v10 offset:25600
  v_mfma_f32_16x16x32_bf16 v[248:251], v[40:43], a[8:11], 0
  v_mfma_f32_16x16x32_bf16 v[252:255], v[40:43], a[12:15], 0
  buffer_load_dwordx4 v7, s[4:7], s73 offen offset:1024 lds
  v_mfma_f32_16x16x32_bf16 v[240:243], v[44:47], a[16:19], v[240:243]
  ds_read_b64_tr_b16 v[40:41], v11 offset:16384
  v_mfma_f32_16x16x32_bf16 v[244:247], v[44:47], a[20:23], v[244:247]
  ds_read_b64_tr_b16 v[42:43], v11 offset:17408
  v_mov_b32 v16, 0
  v_mfma_f32_16x16x32_bf16 v[248:251], v[44:47], a[24:27], v[248:251]
  v_mfma_f32_16x16x32_bf16 v[252:255], v[44:47], a[28:31], v[252:255]
  s_waitcnt lgkmcnt(8)
  buffer_load_dwordx4 v8, s[4:7], s73 offen offset:2048 lds
  v_mfma_f32_16x16x32_bf16 v[128:131], v[32:35], a[32:35], v[128:131]
  ds_read_b64_tr_b16 v[44:45], v11 offset:24576
  v_mfma_f32_16x16x32_bf16 v[132:135], v[32:35], a[36:39], v[132:135]
  ds_read_b64_tr_b16 v[46:47], v11 offset:25600
  v_mfma_f32_16x16x32_bf16 v[136:139], v[32:35], a[40:43], v[136:139]
  s_waitcnt lgkmcnt(8)
  v_add_f32 v88, v88, v90
  v_add_f32 v89, v89, v91
  v_mfma_f32_16x16x32_bf16 v[140:143], v[32:35], a[44:47], v[140:143]
  s_waitcnt lgkmcnt(4)
  buffer_load_dwordx4 v9, s[4:7], s73 offen offset:3072 lds
  s_add_u32 m0, s78, 4096
  v_mfma_f32_16x16x32_bf16 v[128:131], v[36:39], a[48:51], v[128:131]
  s_add_u32 s73, s73, 128
  ds_read_b64_tr_b16 v[32:33], v10 offset:16640
  v_add_f32 v92, v92, v94
  v_mfma_f32_16x16x32_bf16 v[132:135], v[36:39], a[52:55], v[132:135]
  ds_read_b64_tr_b16 v[34:35], v10 offset:17664
  v_add_f32 v93, v93, v95
  v_mfma_f32_16x16x32_bf16 v[136:139], v[36:39], a[56:59], v[136:139]
  v_add_f32 v88, v88, v92
  v_add_f32 v89, v89, v93
  v_mfma_f32_16x16x32_bf16 v[140:143], v[36:39], a[60:63], v[140:143]
  s_waitcnt lgkmcnt(4)
  buffer_load_dwordx4 v6, s[4:7], s74 offen offset:0 lds
  v_mul_f32 v88, 0x3b000000, v88
  v_mfma_f32_16x16x32_bf16 v[144:147], v[40:43], a[32:35], v[144:147]
  ds_read_b64_tr_b16 v[36:37], v10 offset:24832
  v_mul_f32 v89, 0x3b000000, v89
  v_mfma_f32_16x16x32_bf16 v[148:151], v[40:43], a[36:39], v[148:151]
  ds_read_b64_tr_b16 v[38:39], v10 offset:25856
  v_fma_f32 v89, -v88, v88, v89
  v_mfma_f32_16x16x32_bf16 v[152:155], v[40:43], a[40:43], v[152:155]
  v_max_f32 v89, 0, v89
  v_cvt_pk_bf16_f32 v89, v89, v89
  v_mfma_f32_16x16x32_bf16 v[156:159], v[40:43], a[44:47], v[156:159]
  s_waitcnt lgkmcnt(4)
  buffer_load_dwordx4 v7, s[4:7], s74 offen offset:1024 lds
  v_lshlrev_b32 v89, 16, v89
  v_mfma_f32_16x16x32_bf16 v[144:147], v[44:47], a[48:51], v[144:147]
  ds_read_b64_tr_b16 v[40:41], v11 offset:16640
  v_add_f32 v89, 0x3727c5ac, v89
  v_mfma_f32_16x16x32_bf16 v[148:151], v[44:47], a[52:55], v[148:151]
  ds_read_b64_tr_b16 v[42:43], v11 offset:17664
  v_cvt_pk_bf16_f32 v89, v89, v89
  v_mfma_f32_16x16x32_bf16 v[152:155], v[44:47], a[56:59], v[152:155]
  v_lshlrev_b32 v89, 16, v89
  v_mfma_f32_16x16x32_bf16 v[156:159], v[44:47], a[60:63], v[156:159]
  s_waitcnt lgkmcnt(4)
  buffer_load_dwordx4 v8, s[4:7], s74 offen offset:2048 lds
  v_mfma_f32_16x16x32_bf16 v[160:163], v[32:35], a[32:35], v[160:163]
  ds_read_b64_tr_b16 v[44:45], v11 offset:24832
  v_mfma_f32_16x16x32_bf16 v[164:167], v[32:35], a[36:39], v[164:167]
  ds_read_b64_tr_b16 v[46:47], v11 offset:25856
  global_load_dword v52, v16, s[66:67] sc1
  v_mfma_f32_16x16x32_bf16 v[168:171], v[32:35], a[40:43], v[168:171]
  v_sqrt_f32 v89, v89
  v_mfma_f32_16x16x32_bf16 v[172:175], v[32:35], a[44:47], v[172:175]
  s_waitcnt lgkmcnt(4)
  v_cvt_pk_bf16_f32 v88, v88, v88
  v_lshlrev_b32 v88, 16, v88
  v_mfma_f32_16x16x32_bf16 v[160:163], v[36:39], a[48:51], v[160:163]
  ds_read_b64_tr_b16 v[32:33], v10 offset:16896
  v_cvt_pk_bf16_f32 v89, v89, v89
  v_mfma_f32_16x16x32_bf16 v[164:167], v[36:39], a[52:55], v[164:167]
  ds_read_b64_tr_b16 v[34:35], v10 offset:17920
  v_lshlrev_b32 v89, 16, v89
  v_mfma_f32_16x16x32_bf16 v[168:171], v[36:39], a[56:59], v[168:171]
  v_rcp_f32 v89, v89
  v_mfma_f32_16x16x32_bf16 v[172:175], v[36:39], a[60:63], v[172:175]
  s_waitcnt lgkmcnt(4)
  s_and_b32 s73, s73, 1023
  buffer_load_dwordx4 v9, s[4:7], s74 offen offset:3072 lds
  v_mfma_f32_16x16x32_bf16 v[176:179], v[40:43], a[32:35], v[176:179]
  s_add_u32 m0, s78, 32768
  s_add_u32 s74, s73, 0x8000
  ds_read_b64_tr_b16 v[36:37], v10 offset:25088
  v_mfma_f32_16x16x32_bf16 v[180:183], v[40:43], a[36:39], v[180:183]
  ds_read_b64_tr_b16 v[38:39], v10 offset:26112
  s_waitcnt vmcnt(9)
  ds_read_b128 a[64:67], v26 offset:0
  v_mfma_f32_16x16x32_bf16 v[184:187], v[40:43], a[40:43], v[184:187]
  v_sub_f32 v72, v72, v88
  v_sub_f32 v73, v73, v88
  v_mfma_f32_16x16x32_bf16 v[188:191], v[40:43], a[44:47], v[188:191]
  s_waitcnt lgkmcnt(5)
  buffer_load_dwordx4 v6, s[4:7], s73 offen offset:0 lds
  v_cvt_pk_bf16_f32 v64, v72, v73
  v_mfma_f32_16x16x32_bf16 v[176:179], v[44:47], a[48:51], v[176:179]
  ds_read_b64_tr_b16 v[40:41], v11 offset:16896
  v_lshlrev_b32 v72, 16, v64
  v_mfma_f32_16x16x32_bf16 v[180:183], v[44:47], a[52:55], v[180:183]
  ds_read_b64_tr_b16 v[42:43], v11 offset:17920
  ds_read_b128 a[68:71], v26 offset:2048
  v_mfma_f32_16x16x32_bf16 v[184:187], v[44:47], a[56:59], v[184:187]
  v_and_b32 v73, 0xffff0000, v64
  v_mul_f32 v72, v72, v89
  v_mfma_f32_16x16x32_bf16 v[188:191], v[44:47], a[60:63], v[188:191]
  s_waitcnt lgkmcnt(6)
  buffer_load_dwordx4 v7, s[4:7], s73 offen offset:1024 lds
  v_mul_f32 v73, v73, v89
  v_mfma_f32_16x16x32_bf16 v[192:195], v[32:35], a[32:35], v[192:195]
  ds_read_b64_tr_b16 v[44:45], v11 offset:25088
  v_cvt_pk_bf16_f32 v64, v72, v73
  v_mfma_f32_16x16x32_bf16 v[196:199], v[32:35], a[36:39], v[196:199]
  ds_read_b64_tr_b16 v[46:47], v11 offset:26112
  ds_read_b128 a[72:75], v26 offset:4096
  v_mfma_f32_16x16x32_bf16 v[200:203], v[32:35], a[40:43], v[200:203]
  v_sub_f32 v74, v74, v88
  v_sub_f32 v75, v75, v88
  v_mfma_f32_16x16x32_bf16 v[204:207], v[32:35], a[44:47], v[204:207]
  s_waitcnt lgkmcnt(7)
  buffer_load_dwordx4 v8, s[4:7], s73 offen offset:2048 lds
  v_cvt_pk_bf16_f32 v65, v74, v75
  v_mfma_f32_16x16x32_bf16 v[192:195], v[36:39], a[48:51], v[192:195]
  ds_read_b64_tr_b16 v[32:33], v10 offset:17152
  v_lshlrev_b32 v74, 16, v65
  v_mfma_f32_16x16x32_bf16 v[196:199], v[36:39], a[52:55], v[196:199]
  ds_read_b64_tr_b16 v[34:35], v10 offset:18176
  ds_read_b128 a[76:79], v26 offset:6144
  v_mfma_f32_16x16x32_bf16 v[200:203], v[36:39], a[56:59], v[200:203]
  v_and_b32 v75, 0xffff0000, v65
  v_mul_f32 v74, v74, v89
  v_mfma_f32_16x16x32_bf16 v[204:207], v[36:39], a[60:63], v[204:207]
  s_waitcnt lgkmcnt(7)
  buffer_load_dwordx4 v9, s[4:7], s73 offen offset:3072 lds
  s_add_u32 m0, s78, 36864
  v_mfma_f32_16x16x32_bf16 v[208:211], v[40:43], a[32:35], v[208:211]
  s_add_u32 s73, s73, 128
  ds_read_b64_tr_b16 v[36:37], v10 offset:25344
  v_mul_f32 v75, v75, v89
  v_mfma_f32_16x16x32_bf16 v[212:215], v[40:43], a[36:39], v[212:215]
  ds_read_b64_tr_b16 v[38:39], v10 offset:26368
  ds_read_b128 a[80:83], v27 offset:0
  v_mfma_f32_16x16x32_bf16 v[216:219], v[40:43], a[40:43], v[216:219]
  v_cvt_pk_bf16_f32 v65, v74, v75
  v_sub_f32 v76, v76, v88
  v_mfma_f32_16x16x32_bf16 v[220:223], v[40:43], a[44:47], v[220:223]
  s_waitcnt lgkmcnt(7)
  buffer_load_dwordx4 v6, s[4:7], s74 offen offset:0 lds
  v_sub_f32 v77, v77, v88
  v_mfma_f32_16x16x32_bf16 v[208:211], v[44:47], a[48:51], v[208:211]
  ds_read_b64_tr_b16 v[40:41], v11 offset:17152
  v_cvt_pk_bf16_f32 v66, v76, v77
  v_mfma_f32_16x16x32_bf16 v[212:215], v[44:47], a[52:55], v[212:215]
  ds_read_b64_tr_b16 v[42:43], v11 offset:18176
  ds_read_b128 a[84:87], v27 offset:2048
  v_mfma_f32_16x16x32_bf16 v[216:219], v[44:47], a[56:59], v[216:219]
  v_lshlrev_b32 v76, 16, v66
  v_and_b32 v77, 0xffff0000, v66
  v_mfma_f32_16x16x32_bf16 v[220:223], v[44:47], a[60:63], v[220:223]
  s_waitcnt lgkmcnt(7)
  buffer_load_dwordx4 v7, s[4:7], s74 offen offset:1024 lds
  v_mul_f32 v76, v76, v89
  v_mfma_f32_16x16x32_bf16 v[224:227], v[32:35], a[32:35], v[224:227]
  ds_read_b64_tr_b16 v[44:45], v11 offset:25344
  v_mul_f32 v77, v77, v89
  v_mfma_f32_16x16x32_bf16 v[228:231], v[32:35], a[36:39], v[228:231]
  ds_read_b64_tr_b16 v[46:47], v11 offset:26368
  ds_read_b128 a[88:91], v27 offset:4096
  v_mfma_f32_16x16x32_bf16 v[232:235], v[32:35], a[40:43], v[232:235]
  v_cvt_pk_bf16_f32 v66, v76, v77
  v_sub_f32 v78, v78, v88
  v_mfma_f32_16x16x32_bf16 v[236:239], v[32:35], a[44:47], v[236:239]
  s_waitcnt lgkmcnt(7)
  s_barrier
  v_mfma_f32_16x16x32_bf16 v[224:227], v[36:39], a[48:51], v[224:227]
  ds_read_b64_tr_b16 v[32:33], v10 offset:32768
  v_sub_f32 v79, v79, v88
  v_mfma_f32_16x16x32_bf16 v[228:231], v[36:39], a[52:55], v[228:231]
  ds_read_b64_tr_b16 v[34:35], v10 offset:33792
  ds_read_b128 a[92:95], v27 offset:6144
  v_mfma_f32_16x16x32_bf16 v[232:235], v[36:39], a[56:59], v[232:235]
  v_cvt_pk_bf16_f32 v67, v78, v79
  v_lshlrev_b32 v78, 16, v67
  v_mfma_f32_16x16x32_bf16 v[236:239], v[36:39], a[60:63], v[236:239]
  s_waitcnt lgkmcnt(7)
  buffer_load_dwordx4 v8, s[4:7], s74 offen offset:2048 lds
  v_and_b32 v79, 0xffff0000, v67
  v_mfma_f32_16x16x32_bf16 v[240:243], v[40:43], a[32:35], v[240:243]
  ds_read_b64_tr_b16 v[36:37], v10 offset:40960
  v_mul_f32 v78, v78, v89
  v_mfma_f32_16x16x32_bf16 v[244:247], v[40:43], a[36:39], v[244:247]
  ds_read_b64_tr_b16 v[38:39], v10 offset:41984
  v_mul_f32 v79, v79, v89
  v_mfma_f32_16x16x32_bf16 v[248:251], v[40:43], a[40:43], v[248:251]
  v_cvt_pk_bf16_f32 v67, v78, v79
  v_sub_f32 v80, v80, v88
  v_mfma_f32_16x16x32_bf16 v[252:255], v[40:43], a[44:47], v[252:255]
  s_waitcnt lgkmcnt(6)
  s_and_b32 s73, s73, 1023
  buffer_load_dwordx4 v9, s[4:7], s74 offen offset:3072 lds
  v_mfma_f32_16x16x32_bf16 v[240:243], v[44:47], a[48:51], v[240:243]
  s_add_u32 m0, s77, 147456
  s_lshl_b32 s72, s71, 19
  ds_read_b64_tr_b16 v[40:41], v11 offset:32768
  v_mfma_f32_16x16x32_bf16 v[244:247], v[44:47], a[52:55], v[244:247]
  ds_read_b64_tr_b16 v[42:43], v11 offset:33792
  v_sub_f32 v81, v81, v88
  v_mfma_f32_16x16x32_bf16 v[248:251], v[44:47], a[56:59], v[248:251]
  v_cvt_pk_bf16_f32 v68, v80, v81
  v_lshlrev_b32 v80, 16, v68
  v_mfma_f32_16x16x32_bf16 v[252:255], v[44:47], a[60:63], v[252:255]
  s_waitcnt lgkmcnt(5)
  buffer_load_dwordx4 v2, s[8:11], s72 offen offset:0 lds
  v_and_b32 v81, 0xffff0000, v68
  v_mfma_f32_16x16x32_bf16 v[128:131], v[32:35], a[64:67], v[128:131]
  ds_read_b64_tr_b16 v[44:45], v11 offset:40960
  v_mul_f32 v80, v80, v89
  v_mfma_f32_16x16x32_bf16 v[132:135], v[32:35], a[68:71], v[132:135]
  ds_read_b64_tr_b16 v[46:47], v11 offset:41984
  v_mul_f32 v81, v81, v89
  v_mfma_f32_16x16x32_bf16 v[136:139], v[32:35], a[72:75], v[136:139]
  v_cvt_pk_bf16_f32 v68, v80, v81
  v_sub_f32 v82, v82, v88
  v_mfma_f32_16x16x32_bf16 v[140:143], v[32:35], a[76:79], v[140:143]
  s_waitcnt lgkmcnt(4)
  buffer_load_dwordx4 v3, s[8:11], s72 offen offset:1024 lds
  v_sub_f32 v83, v83, v88
  v_mfma_f32_16x16x32_bf16 v[128:131], v[36:39], a[80:83], v[128:131]
  ds_read_b64_tr_b16 v[32:33], v10 offset:33024
  v_cvt_pk_bf16_f32 v69, v82, v83
  v_mfma_f32_16x16x32_bf16 v[132:135], v[36:39], a[84:87], v[132:135]
  ds_read_b64_tr_b16 v[34:35], v10 offset:34048
  v_lshlrev_b32 v82, 16, v69
  v_mfma_f32_16x16x32_bf16 v[136:139], v[36:39], a[88:91], v[136:139]
  v_and_b32 v83, 0xffff0000, v69
  v_mul_f32 v82, v82, v89
  v_mfma_f32_16x16x32_bf16 v[140:143], v[36:39], a[92:95], v[140:143]
  s_waitcnt lgkmcnt(4)
  buffer_load_dwordx4 v4, s[8:11], s72 offen offset:2048 lds
  v_mul_f32 v83, v83, v89
  v_mfma_f32_16x16x32_bf16 v[144:147], v[40:43], a[64:67], v[144:147]
  ds_read_b64_tr_b16 v[36:37], v10 offset:41216
  v_cvt_pk_bf16_f32 v69, v82, v83
  v_mfma_f32_16x16x32_bf16 v[148:151], v[40:43], a[68:71], v[148:151]
  ds_read_b64_tr_b16 v[38:39], v10 offset:42240
  v_sub_f32 v84, v84, v88
  v_mfma_f32_16x16x32_bf16 v[152:155], v[40:43], a[72:75], v[152:155]
  v_sub_f32 v85, v85, v88
  v_cvt_pk_bf16_f32 v70, v84, v85
  v_mfma_f32_16x16x32_bf16 v[156:159], v[40:43], a[76:79], v[156:159]
  s_waitcnt lgkmcnt(4)
  s_add_u32 s71, s71, 1
  buffer_load_dwordx4 v5, s[8:11], s72 offen offset:3072 lds
  v_mfma_f32_16x16x32_bf16 v[144:147], v[44:47], a[80:83], v[144:147]
  s_and_b32 s71, s71, 7
  s_add_u32 m0, s77, 98304
  ds_read_b64_tr_b16 v[40:41], v11 offset:33024
  v_mfma_f32_16x16x32_bf16 v[148:151], v[44:47], a[84:87], v[148:151]
  s_lshl_b32 s72, s71, 19
  ds_read_b64_tr_b16 v[42:43], v11 offset:34048
  v_lshlrev_b32 v84, 16, v70
  v_mfma_f32_16x16x32_bf16 v[152:155], v[44:47], a[88:91], v[152:155]
  v_and_b32 v85, 0xffff0000, v70
  v_mul_f32 v84, v84, v89
  v_mfma_f32_16x16x32_bf16 v[156:159], v[44:47], a[92:95], v[156:159]
  s_waitcnt lgkmcnt(4)
  buffer_load_dwordx4 v2, s[8:11], s72 offen offset:0 lds
  v_mul_f32 v85, v85, v89
  v_mfma_f32_16x16x32_bf16 v[160:163], v[32:35], a[64:67], v[160:163]
  ds_read_b64_tr_b16 v[44:45], v11 offset:41216
  v_cvt_pk_bf16_f32 v70, v84, v85
  v_mfma_f32_16x16x32_bf16 v[164:167], v[32:35], a[68:71], v[164:167]
  ds_read_b64_tr_b16 v[46:47], v11 offset:42240
  v_sub_f32 v86, v86, v88
  v_mfma_f32_16x16x32_bf16 v[168:171], v[32:35], a[72:75], v[168:171]
  v_sub_f32 v87, v87, v88
  v_cvt_pk_bf16_f32 v71, v86, v87
  v_mfma_f32_16x16x32_bf16 v[172:175], v[32:35], a[76:79], v[172:175]
  s_waitcnt lgkmcnt(4)
  buffer_load_dwordx4 v3, s[8:11], s72 offen offset:1024 lds
  v_lshlrev_b32 v86, 16, v71
  v_mfma_f32_16x16x32_bf16 v[160:163], v[36:39], a[80:83], v[160:163]
  ds_read_b64_tr_b16 v[32:33], v10 offset:33280
  v_and_b32 v87, 0xffff0000, v71
  v_mfma_f32_16x16x32_bf16 v[164:167], v[36:39], a[84:87], v[164:167]
  ds_read_b64_tr_b16 v[34:35], v10 offset:34304
  v_mul_f32 v86, v86, v89
  v_mfma_f32_16x16x32_bf16 v[168:171], v[36:39], a[88:91], v[168:171]
  v_mul_f32 v87, v87, v89
  v_cvt_pk_bf16_f32 v71, v86, v87
  v_mfma_f32_16x16x32_bf16 v[172:175], v[36:39], a[92:95], v[172:175]
  s_waitcnt lgkmcnt(4)
  buffer_load_dwordx4 v4, s[8:11], s72 offen offset:2048 lds
  v_mfma_f32_16x16x32_bf16 v[176:179], v[40:43], a[64:67], v[176:179]
  ds_read_b64_tr_b16 v[36:37], v10 offset:41472
  v_mfma_f32_16x16x32_bf16 v[180:183], v[40:43], a[68:71], v[180:183]
  ds_read_b64_tr_b16 v[38:39], v10 offset:42496
  s_waitcnt vmcnt(15)
  ds_read_b128 a[96:99], v24 offset:0
  v_mfma_f32_16x16x32_bf16 v[184:187], v[40:43], a[72:75], v[184:187]
  v_mfma_f32_16x16x32_bf16 v[188:191], v[40:43], a[76:79], v[188:191]
  s_waitcnt lgkmcnt(5)
  s_add_u32 s71, s71, 1
  buffer_load_dwordx4 v5, s[8:11], s72 offen offset:3072 lds
  v_mfma_f32_16x16x32_bf16 v[176:179], v[44:47], a[80:83], v[176:179]
  s_and_b32 s71, s71, 7
  s_add_u32 m0, s78, 65536
  ds_read_b64_tr_b16 v[40:41], v11 offset:33280
  v_mfma_f32_16x16x32_bf16 v[180:183], v[44:47], a[84:87], v[180:183]
  s_add_u32 s74, s73, 0x8000
  ds_read_b64_tr_b16 v[42:43], v11 offset:34304
  ds_read_b128 a[100:103], v24 offset:2048
  v_mfma_f32_16x16x32_bf16 v[184:187], v[44:47], a[88:91], v[184:187]
  v_mfma_f32_16x16x32_bf16 v[188:191], v[44:47], a[92:95], v[188:191]
  s_waitcnt lgkmcnt(6)
  buffer_load_dwordx4 v6, s[4:7], s73 offen offset:0 lds
  v_mfma_f32_16x16x32_bf16 v[192:195], v[32:35], a[64:67], v[192:195]
  ds_read_b64_tr_b16 v[44:45], v11 offset:41472
  v_mfma_f32_16x16x32_bf16 v[196:199], v[32:35], a[68:71], v[196:199]
  ds_read_b64_tr_b16 v[46:47], v11 offset:42496
  ds_read_b128 a[104:107], v24 offset:4096
  v_mfma_f32_16x16x32_bf16 v[200:203], v[32:35], a[72:75], v[200:203]
  v_mfma_f32_16x16x32_bf16 v[204:207], v[32:35], a[76:79], v[204:207]
  s_waitcnt lgkmcnt(7)
  buffer_load_dwordx4 v7, s[4:7], s73 offen offset:1024 lds
  v_mfma_f32_16x16x32_bf16 v[192:195], v[36:39], a[80:83], v[192:195]
  ds_read_b64_tr_b16 v[32:33], v10 offset:33536
  v_mfma_f32_16x16x32_bf16 v[196:199], v[36:39], a[84:87], v[196:199]
  ds_read_b64_tr_b16 v[34:35], v10 offset:34560
  ds_read_b128 a[108:111], v24 offset:6144
  v_mfma_f32_16x16x32_bf16 v[200:203], v[36:39], a[88:91], v[200:203]
  v_mfma_f32_16x16x32_bf16 v[204:207], v[36:39], a[92:95], v[204:207]
  s_waitcnt lgkmcnt(7)
  buffer_load_dwordx4 v8, s[4:7], s73 offen offset:2048 lds
  v_mfma_f32_16x16x32_bf16 v[208:211], v[40:43], a[64:67], v[208:211]
  ds_read_b64_tr_b16 v[36:37], v10 offset:41728
  v_mfma_f32_16x16x32_bf16 v[212:215], v[40:43], a[68:71], v[212:215]
  ds_read_b64_tr_b16 v[38:39], v10 offset:42752
  ds_read_b128 a[112:115], v25 offset:0
  v_mfma_f32_16x16x32_bf16 v[216:219], v[40:43], a[72:75], v[216:219]
  v_mfma_f32_16x16x32_bf16 v[220:223], v[40:43], a[76:79], v[220:223]
  s_waitcnt lgkmcnt(7)
  buffer_load_dwordx4 v9, s[4:7], s73 offen offset:3072 lds
  s_add_u32 m0, s78, 69632
  v_mfma_f32_16x16x32_bf16 v[208:211], v[44:47], a[80:83], v[208:211]
  s_add_u32 s73, s73, 128
  ds_read_b64_tr_b16 v[40:41], v11 offset:33536
  v_mfma_f32_16x16x32_bf16 v[212:215], v[44:47], a[84:87], v[212:215]
  ds_read_b64_tr_b16 v[42:43], v11 offset:34560
  ds_read_b128 a[116:119], v25 offset:2048
  v_mfma_f32_16x16x32_bf16 v[216:219], v[44:47], a[88:91], v[216:219]
  v_mfma_f32_16x16x32_bf16 v[220:223], v[44:47], a[92:95], v[220:223]
  s_waitcnt lgkmcnt(7)
  buffer_load_dwordx4 v6, s[4:7], s74 offen offset:0 lds
  v_mfma_f32_16x16x32_bf16 v[224:227], v[32:35], a[64:67], v[224:227]
  ds_read_b64_tr_b16 v[44:45], v11 offset:41728
  v_mfma_f32_16x16x32_bf16 v[228:231], v[32:35], a[68:71], v[228:231]
  ds_read_b64_tr_b16 v[46:47], v11 offset:42752
  ds_read_b128 a[120:123], v25 offset:4096
  v_mfma_f32_16x16x32_bf16 v[232:235], v[32:35], a[72:75], v[232:235]
  v_mfma_f32_16x16x32_bf16 v[236:239], v[32:35], a[76:79], v[236:239]
  s_waitcnt lgkmcnt(7)
  s_waitcnt vmcnt(9)
  s_barrier
  v_mfma_f32_16x16x32_bf16 v[224:227], v[36:39], a[80:83], v[224:227]
  ds_read_b64_tr_b16 v[32:33], v10 offset:49152
  v_mfma_f32_16x16x32_bf16 v[228:231], v[36:39], a[84:87], v[228:231]
  ds_read_b64_tr_b16 v[34:35], v10 offset:50176
  ds_read_b128 a[124:127], v25 offset:6144
  v_mfma_f32_16x16x32_bf16 v[232:235], v[36:39], a[88:91], v[232:235]
  v_mfma_f32_16x16x32_bf16 v[236:239], v[36:39], a[92:95], v[236:239]
  s_waitcnt lgkmcnt(7)
  buffer_load_dwordx4 v7, s[4:7], s74 offen offset:1024 lds
  v_mfma_f32_16x16x32_bf16 v[240:243], v[40:43], a[64:67], v[240:243]
  ds_read_b64_tr_b16 v[36:37], v10 offset:57344
  v_mfma_f32_16x16x32_bf16 v[244:247], v[40:43], a[68:71], v[244:247]
  ds_read_b64_tr_b16 v[38:39], v10 offset:58368
  v_mfma_f32_16x16x32_bf16 v[248:251], v[40:43], a[72:75], v[248:251]
  v_mfma_f32_16x16x32_bf16 v[252:255], v[40:43], a[76:79], v[252:255]
  s_waitcnt lgkmcnt(6)
  buffer_load_dwordx4 v8, s[4:7], s74 offen offset:2048 lds
  v_mfma_f32_16x16x32_bf16 v[240:243], v[44:47], a[80:83], v[240:243]
  ds_read_b64_tr_b16 v[40:41], v11 offset:49152
  v_mfma_f32_16x16x32_bf16 v[244:247], v[44:47], a[84:87], v[244:247]
  ds_read_b64_tr_b16 v[42:43], v11 offset:50176
  v_mfma_f32_16x16x32_bf16 v[248:251], v[44:47], a[88:91], v[248:251]
  v_mfma_f32_16x16x32_bf16 v[252:255], v[44:47], a[92:95], v[252:255]
  s_waitcnt lgkmcnt(5)
  s_and_b32 s73, s73, 1023
  buffer_load_dwordx4 v9, s[4:7], s74 offen offset:3072 lds
  v_mfma_f32_16x16x32_bf16 v[128:131], v[32:35], a[96:99], v[128:131]
  s_add_u32 m0, s77, 114688
  s_lshl_b32 s72, s71, 19
  ds_read_b64_tr_b16 v[44:45], v11 offset:57344
  v_mfma_f32_16x16x32_bf16 v[132:135], v[32:35], a[100:103], v[132:135]
  ds_read_b64_tr_b16 v[46:47], v11 offset:58368
  v_mfma_f32_16x16x32_bf16 v[136:139], v[32:35], a[104:107], v[136:139]
  v_mfma_f32_16x16x32_bf16 v[140:143], v[32:35], a[108:111], v[140:143]
  s_waitcnt lgkmcnt(4)
  buffer_load_dwordx4 v2, s[8:11], s72 offen offset:0 lds
  v_mfma_f32_16x16x32_bf16 v[128:131], v[36:39], a[112:115], v[128:131]
  ds_read_b64_tr_b16 v[32:33], v10 offset:49408
  v_mfma_f32_16x16x32_bf16 v[132:135], v[36:39], a[116:119], v[132:135]
  ds_read_b64_tr_b16 v[34:35], v10 offset:50432
  v_mfma_f32_16x16x32_bf16 v[136:139], v[36:39], a[120:123], v[136:139]
  v_mfma_f32_16x16x32_bf16 v[140:143], v[36:39], a[124:127], v[140:143]
  s_waitcnt lgkmcnt(4)
  buffer_load_dwordx4 v3, s[8:11], s72 offen offset:1024 lds
  v_mfma_f32_16x16x32_bf16 v[144:147], v[40:43], a[96:99], v[144:147]
  s_lshl_b32 s32, s33, 14
  ds_read_b64_tr_b16 v[36:37], v10 offset:57600
  buffer_store_dwordx4 v[64:67], v53, s[28:31], 0 offen offset:0 sc1
  buffer_store_dwordx4 v[68:71], v53, s[28:31], 0 offen offset:2048 sc1
  v_add_u32 v48, s32, v15
  v_mfma_f32_16x16x32_bf16 v[148:151], v[40:43], a[100:103], v[148:151]
  ds_read_b64_tr_b16 v[38:39], v10 offset:58624
  v_mfma_f32_16x16x32_bf16 v[152:155], v[40:43], a[104:107], v[152:155]
  v_mfma_f32_16x16x32_bf16 v[156:159], v[40:43], a[108:111], v[156:159]
  s_waitcnt lgkmcnt(4)
  buffer_load_dwordx4 v4, s[8:11], s72 offen offset:2048 lds
  v_mfma_f32_16x16x32_bf16 v[144:147], v[44:47], a[112:115], v[144:147]
  ds_read_b64_tr_b16 v[40:41], v11 offset:49408
  v_mfma_f32_16x16x32_bf16 v[148:151], v[44:47], a[116:119], v[148:151]
  ds_read_b64_tr_b16 v[42:43], v11 offset:50432
  v_mfma_f32_16x16x32_bf16 v[152:155], v[44:47], a[120:123], v[152:155]
  v_mfma_f32_16x16x32_bf16 v[156:159], v[44:47], a[124:127], v[156:159]
  s_waitcnt lgkmcnt(4)
  s_add_u32 s71, s71, 1
  buffer_load_dwordx4 v5, s[8:11], s72 offen offset:3072 lds
  v_mfma_f32_16x16x32_bf16 v[160:163], v[32:35], a[96:99], v[160:163]
  s_and_b32 s71, s71, 7
  s_add_u32 m0, s78, 0
  ds_read_b64_tr_b16 v[44:45], v11 offset:57600
  v_mfma_f32_16x16x32_bf16 v[164:167], v[32:35], a[100:103], v[164:167]
  s_add_u32 s74, s73, 0x8000
  ds_read_b64_tr_b16 v[46:47], v11 offset:58624
  v_mfma_f32_16x16x32_bf16 v[168:171], v[32:35], a[104:107], v[168:171]
  v_mfma_f32_16x16x32_bf16 v[172:175], v[32:35], a[108:111], v[172:175]
  s_waitcnt lgkmcnt(4)
  buffer_load_dwordx4 v6, s[4:7], s73 offen offset:0 lds
  v_mfma_f32_16x16x32_bf16 v[160:163], v[36:39], a[112:115], v[160:163]
  ds_read_b64_tr_b16 v[32:33], v10 offset:49664
  v_mfma_f32_16x16x32_bf16 v[164:167], v[36:39], a[116:119], v[164:167]
  ds_read_b64_tr_b16 v[34:35], v10 offset:50688
  v_mfma_f32_16x16x32_bf16 v[168:171], v[36:39], a[120:123], v[168:171]
  v_mfma_f32_16x16x32_bf16 v[172:175], v[36:39], a[124:127], v[172:175]
  s_waitcnt lgkmcnt(4)
  buffer_load_dwordx4 v7, s[4:7], s73 offen offset:1024 lds
  v_mfma_f32_16x16x32_bf16 v[176:179], v[40:43], a[96:99], v[176:179]
  ds_read_b64_tr_b16 v[36:37], v10 offset:57856
  v_mfma_f32_16x16x32_bf16 v[180:183], v[40:43], a[100:103], v[180:183]
  ds_read_b64_tr_b16 v[38:39], v10 offset:58880
  ds_read_b128 a[128:131], v24 offset:32768
  v_mfma_f32_16x16x32_bf16 v[184:187], v[40:43], a[104:107], v[184:187]
  v_mfma_f32_16x16x32_bf16 v[188:191], v[40:43], a[108:111], v[188:191]
  s_waitcnt lgkmcnt(5)
  buffer_load_dwordx4 v8, s[4:7], s73 offen offset:2048 lds
  v_mfma_f32_16x16x32_bf16 v[176:179], v[44:47], a[112:115], v[176:179]
  ds_read_b64_tr_b16 v[40:41], v11 offset:49664
  v_mfma_f32_16x16x32_bf16 v[180:183], v[44:47], a[116:119], v[180:183]
  ds_read_b64_tr_b16 v[42:43], v11 offset:50688
  ds_read_b128 a[132:135], v24 offset:34816
  v_mfma_f32_16x16x32_bf16 v[184:187], v[44:47], a[120:123], v[184:187]
  v_cmp_eq_u32 vcc, 0, v52
  s_cbranch_vccnz Lspin1
Lback1:
  v_mfma_f32_16x16x32_bf16 v[188:191], v[44:47], a[124:127], v[188:191]
  s_waitcnt lgkmcnt(6)
  buffer_load_dwordx4 v9, s[4:7], s73 offen offset:3072 lds
  s_add_u32 m0, s78, 4096
  v_mfma_f32_16x16x32_bf16 v[192:195], v[32:35], a[96:99], v[192:195]
  s_add_u32 s73, s73, 128
  ds_read_b64_tr_b16 v[44:45], v11 offset:57856
  v_mfma_f32_16x16x32_bf16 v[196:199], v[32:35], a[100:103], v[196:199]
  ds_read_b64_tr_b16 v[46:47], v11 offset:58880
  ds_read_b128 a[136:139], v24 offset:36864
  v_mfma_f32_16x16x32_bf16 v[200:203], v[32:35], a[104:107], v[200:203]
  v_mfma_f32_16x16x32_bf16 v[204:207], v[32:35], a[108:111], v[204:207]
  s_waitcnt lgkmcnt(7)
  buffer_load_dwordx4 v6, s[4:7], s74 offen offset:0 lds
  v_mfma_f32_16x16x32_bf16 v[192:195], v[36:39], a[112:115], v[192:195]
  ds_read_b64_tr_b16 v[32:33], v10 offset:49920
  v_mfma_f32_16x16x32_bf16 v[196:199], v[36:39], a[116:119], v[196:199]
  ds_read_b64_tr_b16 v[34:35], v10 offset:50944
  ds_read_b128 a[140:143], v24 offset:38912
  v_mfma_f32_16x16x32_bf16 v[200:203], v[36:39], a[120:123], v[200:203]
  v_mfma_f32_16x16x32_bf16 v[204:207], v[36:39], a[124:127], v[204:207]
  s_waitcnt lgkmcnt(7)
  buffer_load_dwordx4 v7, s[4:7], s74 offen offset:1024 lds
  v_mfma_f32_16x16x32_bf16 v[208:211], v[40:43], a[96:99], v[208:211]
  ds_read_b64_tr_b16 v[36:37], v10 offset:58112
  v_mfma_f32_16x16x32_bf16 v[212:215], v[40:43], a[100:103], v[212:215]
  ds_read_b64_tr_b16 v[38:39], v10 offset:59136
  ds_read_b128 a[144:147], v25 offset:32768
  v_mfma_f32_16x16x32_bf16 v[216:219], v[40:43], a[104:107], v[216:219]
  v_mfma_f32_16x16x32_bf16 v[220:223], v[40:43], a[108:111], v[220:223]
  s_waitcnt lgkmcnt(7)
  buffer_load_dwordx4 v8, s[4:7], s74 offen offset:2048 lds
  v_mfma_f32_16x16x32_bf16 v[208:211], v[44:47], a[112:115], v[208:211]
  ds_read_b64_tr_b16 v[40:41], v11 offset:49920
  v_mfma_f32_16x16x32_bf16 v[212:215], v[44:47], a[116:119], v[212:215]
  ds_read_b64_tr_b16 v[42:43], v11 offset:50944
  ds_read_b128 a[148:151], v25 offset:34816
  v_mfma_f32_16x16x32_bf16 v[216:219], v[44:47], a[120:123], v[216:219]
  v_mfma_f32_16x16x32_bf16 v[220:223], v[44:47], a[124:127], v[220:223]
  s_waitcnt lgkmcnt(7)
  s_and_b32 s73, s73, 1023
  buffer_load_dwordx4 v9, s[4:7], s74 offen offset:3072 lds
  v_mfma_f32_16x16x32_bf16 v[224:227], v[32:35], a[96:99], v[224:227]
  ds_read_b64_tr_b16 v[44:45], v11 offset:58112
  v_mfma_f32_16x16x32_bf16 v[228:231], v[32:35], a[100:103], v[228:231]
  ds_read_b64_tr_b16 v[46:47], v11 offset:59136
  ds_read_b128 a[152:155], v25 offset:36864
  v_mfma_f32_16x16x32_bf16 v[232:235], v[32:35], a[104:107], v[232:235]
  v_mfma_f32_16x16x32_bf16 v[236:239], v[32:35], a[108:111], v[236:239]
  s_waitcnt lgkmcnt(7)
  s_waitcnt vmcnt(22)
  s_barrier
  v_mfma_f32_16x16x32_bf16 v[224:227], v[36:39], a[112:115], v[224:227]
  ds_read_b64_tr_b16 v[32:33], v10 offset:0
  v_mfma_f32_16x16x32_bf16 v[228:231], v[36:39], a[116:119], v[228:231]
  s_add_u32 m0, s77, 131072
  ds_read_b64_tr_b16 v[34:35], v10 offset:1024
  ds_read_b128 a[156:159], v25 offset:38912
  v_mfma_f32_16x16x32_bf16 v[232:235], v[36:39], a[120:123], v[232:235]
  s_lshl_b32 s72, s71, 19
  v_mfma_f32_16x16x32_bf16 v[236:239], v[36:39], a[124:127], v[236:239]
  s_waitcnt lgkmcnt(7)
  buffer_load_dwordx4 v2, s[8:11], s72 offen offset:0 lds
  v_mfma_f32_16x16x32_bf16 v[240:243], v[40:43], a[96:99], v[240:243]
  ds_read_b64_tr_b16 v[36:37], v10 offset:8192
  v_mfma_f32_16x16x32_bf16 v[244:247], v[40:43], a[100:103], v[244:247]
  ds_read_b64_tr_b16 v[38:39], v10 offset:9216
  v_mfma_f32_16x16x32_bf16 v[248:251], v[40:43], a[104:107], v[248:251]
  v_mfma_f32_16x16x32_bf16 v[252:255], v[40:43], a[108:111], v[252:255]
  s_waitcnt lgkmcnt(6)
  buffer_load_dwordx4 v3, s[8:11], s72 offen offset:1024 lds
  v_mfma_f32_16x16x32_bf16 v[240:243], v[44:47], a[112:115], v[240:243]
  ds_read_b64_tr_b16 v[40:41], v11 offset:0
  v_mfma_f32_16x16x32_bf16 v[244:247], v[44:47], a[116:119], v[244:247]
  ds_read_b64_tr_b16 v[42:43], v11 offset:1024
  v_mfma_f32_16x16x32_bf16 v[248:251], v[44:47], a[120:123], v[248:251]
  v_mfma_f32_16x16x32_bf16 v[252:255], v[44:47], a[124:127], v[252:255]
  s_waitcnt lgkmcnt(5)
  buffer_load_dwordx4 v4, s[8:11], s72 offen offset:2048 lds
  v_mfma_f32_16x16x32_bf16 v[128:131], v[32:35], a[128:131], v[128:131]
  ds_read_b64_tr_b16 v[44:45], v11 offset:8192
  v_mfma_f32_16x16x32_bf16 v[132:135], v[32:35], a[132:135], v[132:135]
  ds_read_b64_tr_b16 v[46:47], v11 offset:9216
  v_mfma_f32_16x16x32_bf16 v[136:139], v[32:35], a[136:139], v[136:139]
  v_mfma_f32_16x16x32_bf16 v[140:143], v[32:35], a[140:143], v[140:143]
  s_waitcnt lgkmcnt(4)
  buffer_load_dwordx4 v5, s[8:11], s72 offen offset:3072 lds
  v_mfma_f32_16x16x32_bf16 v[128:131], v[36:39], a[144:147], v[128:131]
  ds_read_b64_tr_b16 v[32:33], v10 offset:256
  v_mfma_f32_16x16x32_bf16 v[132:135], v[36:39], a[148:151], v[132:135]
  s_add_u32 s71, s71, 1
  s_and_b32 s71, s71, 7
  ds_read_b64_tr_b16 v[34:35], v10 offset:1280
  v_mfma_f32_16x16x32_bf16 v[136:139], v[36:39], a[152:155], v[136:139]
  v_mfma_f32_16x16x32_bf16 v[140:143], v[36:39], a[156:159], v[140:143]
  s_waitcnt lgkmcnt(4)
  v_mfma_f32_16x16x32_bf16 v[144:147], v[40:43], a[128:131], v[144:147]
  ds_read_b64_tr_b16 v[36:37], v10 offset:8448
  v_mfma_f32_16x16x32_bf16 v[148:151], v[40:43], a[132:135], v[148:151]
  ds_read_b64_tr_b16 v[38:39], v10 offset:9472
  v_mfma_f32_16x16x32_bf16 v[152:155], v[40:43], a[136:139], v[152:155]
  s_add_u32 m0, s78, 32768
  s_add_u32 s74, s73, 0x8000
  v_mfma_f32_16x16x32_bf16 v[156:159], v[40:43], a[140:143], v[156:159]
  s_waitcnt lgkmcnt(4)
  buffer_load_dwordx4 v6, s[4:7], s73 offen offset:0 lds
  v_mfma_f32_16x16x32_bf16 v[144:147], v[44:47], a[144:147], v[144:147]
  ds_read_b64_tr_b16 v[40:41], v11 offset:256
  v_mfma_f32_16x16x32_bf16 v[148:151], v[44:47], a[148:151], v[148:151]
  ds_read_b64_tr_b16 v[42:43], v11 offset:1280
  v_mfma_f32_16x16x32_bf16 v[152:155], v[44:47], a[152:155], v[152:155]
  v_mfma_f32_16x16x32_bf16 v[156:159], v[44:47], a[156:159], v[156:159]
  s_waitcnt lgkmcnt(4)
  buffer_load_dwordx4 v7, s[4:7], s73 offen offset:1024 lds
  v_mfma_f32_16x16x32_bf16 v[160:163], v[32:35], a[128:131], v[160:163]
  ds_read_b64_tr_b16 v[44:45], v11 offset:8448
  v_mfma_f32_16x16x32_bf16 v[164:167], v[32:35], a[132:135], v[164:167]
  ds_read_b64_tr_b16 v[46:47], v11 offset:9472
  v_mfma_f32_16x16x32_bf16 v[168:171], v[32:35], a[136:139], v[168:171]
  v_mfma_f32_16x16x32_bf16 v[172:175], v[32:35], a[140:143], v[172:175]
  s_waitcnt lgkmcnt(4)
  buffer_load_dwordx4 v8, s[4:7], s73 offen offset:2048 lds
  v_mfma_f32_16x16x32_bf16 v[160:163], v[36:39], a[144:147], v[160:163]
  ds_read_b64_tr_b16 v[32:33], v10 offset:512
  v_mfma_f32_16x16x32_bf16 v[164:167], v[36:39], a[148:151], v[164:167]
  ds_read_b64_tr_b16 v[34:35], v10 offset:1536
  v_mfma_f32_16x16x32_bf16 v[168:171], v[36:39], a[152:155], v[168:171]
  v_mfma_f32_16x16x32_bf16 v[172:175], v[36:39], a[156:159], v[172:175]
  s_waitcnt lgkmcnt(4)
  buffer_load_dwordx4 v9, s[4:7], s73 offen offset:3072 lds
  v_mfma_f32_16x16x32_bf16 v[176:179], v[40:43], a[128:131], v[176:179]
  ds_read_b64_tr_b16 v[36:37], v10 offset:8704
  v_mfma_f32_16x16x32_bf16 v[180:183], v[40:43], a[132:135], v[180:183]
  ds_read_b64_tr_b16 v[38:39], v10 offset:9728
  s_waitcnt vmcnt(22)
  ds_read_b128 a[160:163], v26 offset:0
  v_mfma_f32_16x16x32_bf16 v[184:187], v[40:43], a[136:139], v[184:187]
  s_add_u32 m0, s78, 36864
  s_add_u32 s73, s73, 128
  v_mfma_f32_16x16x32_bf16 v[188:191], v[40:43], a[140:143], v[188:191]
  s_waitcnt lgkmcnt(5)
  buffer_load_dwordx4 v6, s[4:7], s74 offen offset:0 lds
  v_mfma_f32_16x16x32_bf16 v[176:179], v[44:47], a[144:147], v[176:179]
  ds_read_b64_tr_b16 v[40:41], v11 offset:512
  v_mfma_f32_16x16x32_bf16 v[180:183], v[44:47], a[148:151], v[180:183]
  ds_read_b64_tr_b16 v[42:43], v11 offset:1536
  ds_read_b128 a[164:167], v26 offset:2048
  v_mfma_f32_16x16x32_bf16 v[184:187], v[44:47], a[152:155], v[184:187]
  v_mfma_f32_16x16x32_bf16 v[188:191], v[44:47], a[156:159], v[188:191]
  s_waitcnt lgkmcnt(6)
  buffer_load_dwordx4 v7, s[4:7], s74 offen offset:1024 lds
  v_mfma_f32_16x16x32_bf16 v[192:195], v[32:35], a[128:131], v[192:195]
  ds_read_b64_tr_b16 v[44:45], v11 offset:8704
  v_mfma_f32_16x16x32_bf16 v[196:199], v[32:35], a[132:135], v[196:199]
  ds_read_b64_tr_b16 v[46:47], v11 offset:9728
  ds_read_b128 a[168:171], v26 offset:4096
  v_mfma_f32_16x16x32_bf16 v[200:203], v[32:35], a[136:139], v[200:203]
  v_mfma_f32_16x16x32_bf16 v[204:207], v[32:35], a[140:143], v[204:207]
  s_waitcnt lgkmcnt(7)
  buffer_load_dwordx4 v8, s[4:7], s74 offen offset:2048 lds
  v_mfma_f32_16x16x32_bf16 v[192:195], v[36:39], a[144:147], v[192:195]
  ds_read_b64_tr_b16 v[32:33], v10 offset:768
  v_mfma_f32_16x16x32_bf16 v[196:199], v[36:39], a[148:151], v[196:199]
  ds_read_b64_tr_b16 v[34:35], v10 offset:1792
  ds_read_b128 a[172:175], v26 offset:6144
  v_mfma_f32_16x16x32_bf16 v[200:203], v[36:39], a[152:155], v[200:203]
  v_mfma_f32_16x16x32_bf16 v[204:207], v[36:39], a[156:159], v[204:207]
  s_waitcnt lgkmcnt(7)
  buffer_load_dwordx4 v9, s[4:7], s74 offen offset:3072 lds
  v_mfma_f32_16x16x32_bf16 v[208:211], v[40:43], a[128:131], v[208:211]
  ds_read_b64_tr_b16 v[36:37], v10 offset:8960
  v_mfma_f32_16x16x32_bf16 v[212:215], v[40:43], a[132:135], v[212:215]
  ds_read_b64_tr_b16 v[38:39], v10 offset:9984
  ds_read_b128 a[176:179], v27 offset:0
  v_mfma_f32_16x16x32_bf16 v[216:219], v[40:43], a[136:139], v[216:219]
  s_and_b32 s73, s73, 1023
  v_mfma_f32_16x16x32_bf16 v[220:223], v[40:43], a[140:143], v[220:223]
  s_waitcnt lgkmcnt(7)
  v_mfma_f32_16x16x32_bf16 v[208:211], v[44:47], a[144:147], v[208:211]
  ds_read_b64_tr_b16 v[40:41], v11 offset:768
  v_mfma_f32_16x16x32_bf16 v[212:215], v[44:47], a[148:151], v[212:215]
  ds_read_b64_tr_b16 v[42:43], v11 offset:1792
  ds_read_b128 a[180:183], v27 offset:2048
  v_mfma_f32_16x16x32_bf16 v[216:219], v[44:47], a[152:155], v[216:219]
  v_mfma_f32_16x16x32_bf16 v[220:223], v[44:47], a[156:159], v[220:223]
  s_waitcnt lgkmcnt(7)
  v_mfma_f32_16x16x32_bf16 v[224:227], v[32:35], a[128:131], v[224:227]
  ds_read_b64_tr_b16 v[44:45], v11 offset:8960
  v_mfma_f32_16x16x32_bf16 v[228:231], v[32:35], a[132:135], v[228:231]
  ds_read_b64_tr_b16 v[46:47], v11 offset:9984
  ds_read_b128 a[184:187], v27 offset:4096
  v_mfma_f32_16x16x32_bf16 v[232:235], v[32:35], a[136:139], v[232:235]
  v_mfma_f32_16x16x32_bf16 v[236:239], v[32:35], a[140:143], v[236:239]
  s_waitcnt lgkmcnt(7)
  s_waitcnt vmcnt(20)
  s_barrier
  v_mfma_f32_16x16x32_bf16 v[224:227], v[36:39], a[144:147], v[224:227]
  ds_read_b64_tr_b16 v[32:33], v10 offset:16384
  v_mfma_f32_16x16x32_bf16 v[228:231], v[36:39], a[148:151], v[228:231]
  s_add_u32 m0, s77, 147456
  ds_read_b64_tr_b16 v[34:35], v10 offset:17408
  ds_read_b128 a[188:191], v27 offset:6144
  v_mfma_f32_16x16x32_bf16 v[232:235], v[36:39], a[152:155], v[232:235]
  s_lshl_b32 s72, s71, 19
  v_mfma_f32_16x16x32_bf16 v[236:239], v[36:39], a[156:159], v[236:239]
  s_waitcnt lgkmcnt(7)
  buffer_load_dwordx4 v2, s[8:11], s72 offen offset:0 lds
  v_mfma_f32_16x16x32_bf16 v[240:243], v[40:43], a[128:131], v[240:243]
  ds_read_b64_tr_b16 v[36:37], v10 offset:24576
  v_mfma_f32_16x16x32_bf16 v[244:247], v[40:43], a[132:135], v[244:247]
  ds_read_b64_tr_b16 v[38:39], v10 offset:25600
  v_mfma_f32_16x16x32_bf16 v[248:251], v[40:43], a[136:139], v[248:251]
  v_mfma_f32_16x16x32_bf16 v[252:255], v[40:43], a[140:143], v[252:255]
  s_waitcnt lgkmcnt(6)
  buffer_load_dwordx4 v3, s[8:11], s72 offen offset:1024 lds
  v_mfma_f32_16x16x32_bf16 v[240:243], v[44:47], a[144:147], v[240:243]
  ds_read_b64_tr_b16 v[40:41], v11 offset:16384
  v_mfma_f32_16x16x32_bf16 v[244:247], v[44:47], a[148:151], v[244:247]
  s_getreg_b32 s32, hwreg(HW_REG_XCC_ID, 0, 4)
  ds_read_b64_tr_b16 v[42:43], v11 offset:17408
  buffer_store_dword v52, v31, s[44:47], s85 offen sc1
  v_mfma_f32_16x16x32_bf16 v[248:251], v[44:47], a[152:155], v[248:251]
  v_mov_b32 v60, v52
  v_mov_b32 v61, s32
  v_mfma_f32_16x16x32_bf16 v[252:255], v[44:47], a[156:159], v[252:255]
  s_waitcnt lgkmcnt(5)
  s_add_u32 s32, s86, 131072
  v_mfma_f32_16x16x32_bf16 v[128:131], v[32:35], a[160:163], v[128:131]
  ds_read_b64_tr_b16 v[44:45], v11 offset:24576
  v_mfma_f32_16x16x32_bf16 v[132:135], v[32:35], a[164:167], v[132:135]
  ds_read_b64_tr_b16 v[46:47], v11 offset:25600
  v_mfma_f32_16x16x32_bf16 v[136:139], v[32:35], a[168:171], v[136:139]
  v_mfma_f32_16x16x32_bf16 v[140:143], v[32:35], a[172:175], v[140:143]
  s_waitcnt lgkmcnt(4)
  buffer_load_dwordx4 v4, s[8:11], s72 offen offset:2048 lds
  v_mfma_f32_16x16x32_bf16 v[128:131], v[36:39], a[176:179], v[128:131]
  ds_read_b64_tr_b16 v[32:33], v10 offset:16640
  v_mfma_f32_16x16x32_bf16 v[132:135], v[36:39], a[180:183], v[132:135]
  ds_read_b64_tr_b16 v[34:35], v10 offset:17664
  v_mfma_f32_16x16x32_bf16 v[136:139], v[36:39], a[184:187], v[136:139]
  v_mfma_f32_16x16x32_bf16 v[140:143], v[36:39], a[188:191], v[140:143]
  s_waitcnt lgkmcnt(4)
  s_add_u32 s71, s71, 1
  buffer_load_dwordx4 v5, s[8:11], s72 offen offset:3072 lds
  v_mfma_f32_16x16x32_bf16 v[144:147], v[40:43], a[160:163], v[144:147]
  s_and_b32 s71, s71, 7
  s_mov_b32 s1, 0
  ds_read_b64_tr_b16 v[36:37], v10 offset:24832
  v_mfma_f32_16x16x32_bf16 v[148:151], v[40:43], a[164:167], v[148:151]
  ds_read_b64_tr_b16 v[38:39], v10 offset:25856
  v_mfma_f32_16x16x32_bf16 v[152:155], v[40:43], a[168:171], v[152:155]
  v_mfma_f32_16x16x32_bf16 v[156:159], v[40:43], a[172:175], v[156:159]
  s_waitcnt lgkmcnt(4)
  buffer_load_dword v0, v56, s[12:15], s1 offen
  v_mfma_f32_16x16x32_bf16 v[144:147], v[44:47], a[176:179], v[144:147]
  ds_read_b64_tr_b16 v[40:41], v11 offset:16640
  v_mfma_f32_16x16x32_bf16 v[148:151], v[44:47], a[180:183], v[148:151]
  ds_read_b64_tr_b16 v[42:43], v11 offset:17664
  v_mfma_f32_16x16x32_bf16 v[152:155], v[44:47], a[184:187], v[152:155]
  v_mfma_f32_16x16x32_bf16 v[156:159], v[44:47], a[188:191], v[156:159]
  s_waitcnt lgkmcnt(4)
  buffer_store_dwordx2 v[60:61], v31, s[44:47], s32 offen sc1
  v_mfma_f32_16x16x32_bf16 v[160:163], v[32:35], a[160:163], v[160:163]
  ds_read_b64_tr_b16 v[44:45], v11 offset:24832
  v_mfma_f32_16x16x32_bf16 v[164:167], v[32:35], a[164:167], v[164:167]
  ds_read_b64_tr_b16 v[46:47], v11 offset:25856
  v_mfma_f32_16x16x32_bf16 v[168:171], v[32:35], a[168:171], v[168:171]
  v_mfma_f32_16x16x32_bf16 v[172:175], v[32:35], a[172:175], v[172:175]
  s_waitcnt lgkmcnt(4)
  v_mfma_f32_16x16x32_bf16 v[160:163], v[36:39], a[176:179], v[160:163]
  ds_read_b64_tr_b16 v[32:33], v10 offset:16896
  v_mfma_f32_16x16x32_bf16 v[164:167], v[36:39], a[180:183], v[164:167]
  ds_read_b64_tr_b16 v[34:35], v10 offset:17920
  v_mfma_f32_16x16x32_bf16 v[168:171], v[36:39], a[184:187], v[168:171]
  v_mfma_f32_16x16x32_bf16 v[172:175], v[36:39], a[188:191], v[172:175]
  s_waitcnt lgkmcnt(4)
  v_mfma_f32_16x16x32_bf16 v[176:179], v[40:43], a[160:163], v[176:179]
  ds_read_b64_tr_b16 v[36:37], v10 offset:25088
  v_mfma_f32_16x16x32_bf16 v[180:183], v[40:43], a[164:167], v[180:183]
  ds_read_b64_tr_b16 v[38:39], v10 offset:26112
  s_waitcnt vmcnt(19)
  ds_read_b128 a[192:195], v24 offset:0
  v_mfma_f32_16x16x32_bf16 v[184:187], v[40:43], a[168:171], v[184:187]
  v_mfma_f32_16x16x32_bf16 v[188:191], v[40:43], a[172:175], v[188:191]
  s_waitcnt lgkmcnt(5)
  v_mfma_f32_16x16x32_bf16 v[176:179], v[44:47], a[176:179], v[176:179]
  ds_read_b64_tr_b16 v[40:41], v11 offset:16896
  v_mfma_f32_16x16x32_bf16 v[180:183], v[44:47], a[180:183], v[180:183]
  ds_read_b64_tr_b16 v[42:43], v11 offset:17920
  ds_read_b128 a[196:199], v24 offset:2048
  v_mfma_f32_16x16x32_bf16 v[184:187], v[44:47], a[184:187], v[184:187]
  v_mfma_f32_16x16x32_bf16 v[188:191], v[44:47], a[188:191], v[188:191]
  s_waitcnt lgkmcnt(6)
  v_mfma_f32_16x16x32_bf16 v[192:195], v[32:35], a[160:163], v[192:195]
  ds_read_b64_tr_b16 v[44:45], v11 offset:25088
  v_mfma_f32_16x16x32_bf16 v[196:199], v[32:35], a[164:167], v[196:199]
  ds_read_b64_tr_b16 v[46:47], v11 offset:26112
  ds_read_b128 a[200:203], v24 offset:4096
  v_mfma_f32_16x16x32_bf16 v[200:203], v[32:35], a[168:171], v[200:203]
  v_mfma_f32_16x16x32_bf16 v[204:207], v[32:35], a[172:175], v[204:207]
  s_waitcnt lgkmcnt(7)
  v_mfma_f32_16x16x32_bf16 v[192:195], v[36:39], a[176:179], v[192:195]
  ds_read_b64_tr_b16 v[32:33], v10 offset:17152
  v_mfma_f32_16x16x32_bf16 v[196:199], v[36:39], a[180:183], v[196:199]
  ds_read_b64_tr_b16 v[34:35], v10 offset:18176
  ds_read_b128 a[204:207], v24 offset:6144
  v_mfma_f32_16x16x32_bf16 v[200:203], v[36:39], a[184:187], v[200:203]
  v_mfma_f32_16x16x32_bf16 v[204:207], v[36:39], a[188:191], v[204:207]
  s_waitcnt lgkmcnt(7)
  v_mfma_f32_16x16x32_bf16 v[208:211], v[40:43], a[160:163], v[208:211]
  ds_read_b64_tr_b16 v[36:37], v10 offset:25344
  v_mfma_f32_16x16x32_bf16 v[212:215], v[40:43], a[164:167], v[212:215]
  ds_read_b64_tr_b16 v[38:39], v10 offset:26368
  ds_read_b128 a[208:211], v25 offset:0
  v_mfma_f32_16x16x32_bf16 v[216:219], v[40:43], a[168:171], v[216:219]
  v_mfma_f32_16x16x32_bf16 v[220:223], v[40:43], a[172:175], v[220:223]
  s_waitcnt lgkmcnt(7)
  v_mfma_f32_16x16x32_bf16 v[208:211], v[44:47], a[176:179], v[208:211]
  ds_read_b64_tr_b16 v[40:41], v11 offset:17152
  v_mfma_f32_16x16x32_bf16 v[212:215], v[44:47], a[180:183], v[212:215]
  ds_read_b64_tr_b16 v[42:43], v11 offset:18176
  ds_read_b128 a[212:215], v25 offset:2048
  v_mfma_f32_16x16x32_bf16 v[216:219], v[44:47], a[184:187], v[216:219]
  v_mfma_f32_16x16x32_bf16 v[220:223], v[44:47], a[188:191], v[220:223]
  s_waitcnt lgkmcnt(7)
  v_mfma_f32_16x16x32_bf16 v[224:227], v[32:35], a[160:163], v[224:227]
  ds_read_b64_tr_b16 v[44:45], v11 offset:25344
  v_mfma_f32_16x16x32_bf16 v[228:231], v[32:35], a[164:167], v[228:231]
  ds_read_b64_tr_b16 v[46:47], v11 offset:26368
  ds_read_b128 a[216:219], v25 offset:4096
  v_mfma_f32_16x16x32_bf16 v[232:235], v[32:35], a[168:171], v[232:235]
  v_mfma_f32_16x16x32_bf16 v[236:239], v[32:35], a[172:175], v[236:239]
  s_waitcnt lgkmcnt(7)
  s_waitcnt vmcnt(15)
  s_barrier
  v_mfma_f32_16x16x32_bf16 v[224:227], v[36:39], a[176:179], v[224:227]
  ds_read_b64_tr_b16 v[32:33], v10 offset:32768
  v_mfma_f32_16x16x32_bf16 v[228:231], v[36:39], a[180:183], v[228:231]
  s_add_u32 m0, s77, 98304
  ds_read_b64_tr_b16 v[34:35], v10 offset:33792
  ds_read_b128 a[220:223], v25 offset:6144
  v_mfma_f32_16x16x32_bf16 v[232:235], v[36:39], a[184:187], v[232:235]
  s_lshl_b32 s72, s71, 19
  v_mfma_f32_16x16x32_bf16 v[236:239], v[36:39], a[188:191], v[236:239]
  s_waitcnt lgkmcnt(7)
  buffer_load_dwordx4 v2, s[12:15], s72 offen offset:0 lds
  v_mfma_f32_16x16x32_bf16 v[240:243], v[40:43], a[160:163], v[240:243]
  ds_read_b64_tr_b16 v[36:37], v10 offset:40960
  v_mfma_f32_16x16x32_bf16 v[244:247], v[40:43], a[164:167], v[244:247]
  ds_read_b64_tr_b16 v[38:39], v10 offset:41984
  v_mfma_f32_16x16x32_bf16 v[248:251], v[40:43], a[168:171], v[248:251]
  v_mfma_f32_16x16x32_bf16 v[252:255], v[40:43], a[172:175], v[252:255]
  s_waitcnt lgkmcnt(6)
  v_mfma_f32_16x16x32_bf16 v[240:243], v[44:47], a[176:179], v[240:243]
  ds_read_b64_tr_b16 v[40:41], v11 offset:32768
  v_mfma_f32_16x16x32_bf16 v[244:247], v[44:47], a[180:183], v[244:247]
  ds_read_b64_tr_b16 v[42:43], v11 offset:33792
  v_mfma_f32_16x16x32_bf16 v[248:251], v[44:47], a[184:187], v[248:251]
  v_mfma_f32_16x16x32_bf16 v[252:255], v[44:47], a[188:191], v[252:255]
  s_waitcnt lgkmcnt(5)
  buffer_load_dwordx4 v3, s[12:15], s72 offen offset:1024 lds
  v_mfma_f32_16x16x32_bf16 v[128:131], v[32:35], a[192:195], v[128:131]
  ds_read_b64_tr_b16 v[44:45], v11 offset:40960
  v_mfma_f32_16x16x32_bf16 v[132:135], v[32:35], a[196:199], v[132:135]
  ds_read_b64_tr_b16 v[46:47], v11 offset:41984
  v_mfma_f32_16x16x32_bf16 v[136:139], v[32:35], a[200:203], v[136:139]
  v_mfma_f32_16x16x32_bf16 v[140:143], v[32:35], a[204:207], v[140:143]
  s_waitcnt lgkmcnt(4)
  v_mfma_f32_16x16x32_bf16 v[128:131], v[36:39], a[208:211], v[128:131]
  ds_read_b64_tr_b16 v[32:33], v10 offset:33024
  v_mfma_f32_16x16x32_bf16 v[132:135], v[36:39], a[212:215], v[132:135]
  ds_read_b64_tr_b16 v[34:35], v10 offset:34048
  v_mfma_f32_16x16x32_bf16 v[136:139], v[36:39], a[216:219], v[136:139]
  v_mfma_f32_16x16x32_bf16 v[140:143], v[36:39], a[220:223], v[140:143]
  s_waitcnt lgkmcnt(4)
  buffer_load_dwordx4 v4, s[12:15], s72 offen offset:2048 lds
  v_mfma_f32_16x16x32_bf16 v[144:147], v[40:43], a[192:195], v[144:147]
  ds_read_b64_tr_b16 v[36:37], v10 offset:41216
  v_mfma_f32_16x16x32_bf16 v[148:151], v[40:43], a[196:199], v[148:151]
  ds_read_b64_tr_b16 v[38:39], v10 offset:42240
  v_mfma_f32_16x16x32_bf16 v[152:155], v[40:43], a[200:203], v[152:155]
  v_mfma_f32_16x16x32_bf16 v[156:159], v[40:43], a[204:207], v[156:159]
  s_waitcnt lgkmcnt(4)
  v_mfma_f32_16x16x32_bf16 v[144:147], v[44:47], a[208:211], v[144:147]
  ds_read_b64_tr_b16 v[40:41], v11 offset:33024
  v_mfma_f32_16x16x32_bf16 v[148:151], v[44:47], a[212:215], v[148:151]
  ds_read_b64_tr_b16 v[42:43], v11 offset:34048
  v_mfma_f32_16x16x32_bf16 v[152:155], v[44:47], a[216:219], v[152:155]
  v_mfma_f32_16x16x32_bf16 v[156:159], v[44:47], a[220:223], v[156:159]
  s_waitcnt lgkmcnt(4)
  buffer_load_dwordx4 v5, s[12:15], s72 offen offset:3072 lds
  v_mfma_f32_16x16x32_bf16 v[160:163], v[32:35], a[192:195], v[160:163]
  ds_read_b64_tr_b16 v[44:45], v11 offset:41216
  v_mfma_f32_16x16x32_bf16 v[164:167], v[32:35], a[196:199], v[164:167]
  ds_read_b64_tr_b16 v[46:47], v11 offset:42240
  v_mfma_f32_16x16x32_bf16 v[168:171], v[32:35], a[200:203], v[168:171]
  v_mfma_f32_16x16x32_bf16 v[172:175], v[32:35], a[204:207], v[172:175]
  s_waitcnt lgkmcnt(4)
  v_mfma_f32_16x16x32_bf16 v[160:163], v[36:39], a[208:211], v[160:163]
  ds_read_b64_tr_b16 v[32:33], v10 offset:33280
  v_mfma_f32_16x16x32_bf16 v[164:167], v[36:39], a[212:215], v[164:167]
  s_add_u32 s71, s71, 1
  s_and_b32 s71, s71, 7
  ds_read_b64_tr_b16 v[34:35], v10 offset:34304
  v_mfma_f32_16x16x32_bf16 v[168:171], v[36:39], a[216:219], v[168:171]
  s_add_u32 m0, s77, 65536
  s_lshl_b32 s72, s71, 19
  v_mfma_f32_16x16x32_bf16 v[172:175], v[36:39], a[220:223], v[172:175]
  s_waitcnt lgkmcnt(4)
  buffer_load_dwordx4 v2, s[12:15], s72 offen offset:0 lds
  v_mfma_f32_16x16x32_bf16 v[176:179], v[40:43], a[192:195], v[176:179]
  ds_read_b64_tr_b16 v[36:37], v10 offset:41472
  v_mfma_f32_16x16x32_bf16 v[180:183], v[40:43], a[196:199], v[180:183]
  ds_read_b64_tr_b16 v[38:39], v10 offset:42496
  s_waitcnt vmcnt(12)
  ds_read_b128 a[224:227], v24 offset:32768
  v_mfma_f32_16x16x32_bf16 v[184:187], v[40:43], a[200:203], v[184:187]
  v_mfma_f32_16x16x32_bf16 v[188:191], v[40:43], a[204:207], v[188:191]
  s_waitcnt lgkmcnt(5)
  v_mfma_f32_16x16x32_bf16 v[176:179], v[44:47], a[208:211], v[176:179]
  ds_read_b64_tr_b16 v[40:41], v11 offset:33280
  v_mfma_f32_16x16x32_bf16 v[180:183], v[44:47], a[212:215], v[180:183]
  ds_read_b64_tr_b16 v[42:43], v11 offset:34304
  ds_read_b128 a[228:231], v24 offset:34816
  v_mfma_f32_16x16x32_bf16 v[184:187], v[44:47], a[216:219], v[184:187]
  v_mfma_f32_16x16x32_bf16 v[188:191], v[44:47], a[220:223], v[188:191]
  s_waitcnt lgkmcnt(6)
  buffer_load_dwordx4 v3, s[12:15], s72 offen offset:1024 lds
  v_mfma_f32_16x16x32_bf16 v[192:195], v[32:35], a[192:195], v[192:195]
  ds_read_b64_tr_b16 v[44:45], v11 offset:41472
  v_mfma_f32_16x16x32_bf16 v[196:199], v[32:35], a[196:199], v[196:199]
  ds_read_b64_tr_b16 v[46:47], v11 offset:42496
  ds_read_b128 a[232:235], v24 offset:36864
  v_mfma_f32_16x16x32_bf16 v[200:203], v[32:35], a[200:203], v[200:203]
  v_mfma_f32_16x16x32_bf16 v[204:207], v[32:35], a[204:207], v[204:207]
  s_waitcnt lgkmcnt(7)
  v_mfma_f32_16x16x32_bf16 v[192:195], v[36:39], a[208:211], v[192:195]
  ds_read_b64_tr_b16 v[32:33], v10 offset:33536
  v_mfma_f32_16x16x32_bf16 v[196:199], v[36:39], a[212:215], v[196:199]
  ds_read_b64_tr_b16 v[34:35], v10 offset:34560
  ds_read_b128 a[236:239], v24 offset:38912
  v_mfma_f32_16x16x32_bf16 v[200:203], v[36:39], a[216:219], v[200:203]
  s_lshl_b32 s32, s70, 11
  s_sub_u32 s35, 30720, s32
  v_and_b32 v50, 15, v1
  v_mfma_f32_16x16x32_bf16 v[204:207], v[36:39], a[220:223], v[204:207]
  s_waitcnt lgkmcnt(7)
  buffer_load_dwordx4 v4, s[12:15], s72 offen offset:2048 lds
  v_lshlrev_b32 v50, 7, v50
  v_mfma_f32_16x16x32_bf16 v[208:211], v[40:43], a[192:195], v[208:211]
  ds_read_b64_tr_b16 v[36:37], v10 offset:41728
  v_add_u32 v50, s32, v50
  v_mfma_f32_16x16x32_bf16 v[212:215], v[40:43], a[196:199], v[212:215]
  ds_read_b64_tr_b16 v[38:39], v10 offset:42752
  ds_read_b128 a[240:243], v25 offset:32768
  v_mfma_f32_16x16x32_bf16 v[216:219], v[40:43], a[200:203], v[216:219]
  s_sub_u32 s35, s35, s32
  v_add_u32 v50, 0x1000000, v50
  v_bfe_u32 v62, v1, 4, 1
  v_mfma_f32_16x16x32_bf16 v[220:223], v[40:43], a[204:207], v[220:223]
  s_waitcnt lgkmcnt(7)
  v_mul_lo_u32 v62, v62, s35
  v_add_u32 v50, v50, v62
  v_mfma_f32_16x16x32_bf16 v[208:211], v[44:47], a[208:211], v[208:211]
  ds_read_b64_tr_b16 v[40:41], v11 offset:33536
  v_mfma_f32_16x16x32_bf16 v[212:215], v[44:47], a[212:215], v[212:215]
  ds_read_b64_tr_b16 v[42:43], v11 offset:34560
  ds_read_b128 a[244:247], v25 offset:34816
  v_mfma_f32_16x16x32_bf16 v[216:219], v[44:47], a[216:219], v[216:219]
  v_mfma_f32_16x16x32_bf16 v[220:223], v[44:47], a[220:223], v[220:223]
  s_waitcnt lgkmcnt(7)
  buffer_load_dwordx4 v5, s[12:15], s72 offen offset:3072 lds
  v_mfma_f32_16x16x32_bf16 v[224:227], v[32:35], a[192:195], v[224:227]
  ds_read_b64_tr_b16 v[44:45], v11 offset:41728
  v_mfma_f32_16x16x32_bf16 v[228:231], v[32:35], a[196:199], v[228:231]
  ds_read_b64_tr_b16 v[46:47], v11 offset:42752
  ds_read_b128 a[248:251], v25 offset:36864
  v_mfma_f32_16x16x32_bf16 v[232:235], v[32:35], a[200:203], v[232:235]
  v_mfma_f32_16x16x32_bf16 v[236:239], v[32:35], a[204:207], v[236:239]
  s_waitcnt lgkmcnt(7)
  s_waitcnt vmcnt(10)
  s_barrier
  v_mfma_f32_16x16x32_bf16 v[224:227], v[36:39], a[208:211], v[224:227]
  ds_read_b64_tr_b16 v[32:33], v10 offset:49152
  v_mfma_f32_16x16x32_bf16 v[228:231], v[36:39], a[212:215], v[228:231]
  s_add_u32 s71, s71, 1
  ds_read_b64_tr_b16 v[34:35], v10 offset:50176
  ds_read_b128 a[252:255], v25 offset:38912
  v_mfma_f32_16x16x32_bf16 v[232:235], v[36:39], a[216:219], v[232:235]
  s_and_b32 s71, s71, 7
  v_mfma_f32_16x16x32_bf16 v[236:239], v[36:39], a[220:223], v[236:239]
  s_waitcnt lgkmcnt(7)
  buffer_load_dword v49, v50, s[44:47], 0 offen sc1
  v_mfma_f32_16x16x32_bf16 v[240:243], v[40:43], a[192:195], v[240:243]
  ds_read_b64_tr_b16 v[36:37], v10 offset:57344
  v_mfma_f32_16x16x32_bf16 v[244:247], v[40:43], a[196:199], v[244:247]
  ds_read_b64_tr_b16 v[38:39], v10 offset:58368
  v_mfma_f32_16x16x32_bf16 v[248:251], v[40:43], a[200:203], v[248:251]
  v_mfma_f32_16x16x32_bf16 v[252:255], v[40:43], a[204:207], v[252:255]
  s_waitcnt lgkmcnt(6)
  v_mfma_f32_16x16x32_bf16 v[240:243], v[44:47], a[208:211], v[240:243]
  ds_read_b64_tr_b16 v[40:41], v11 offset:49152
  v_mfma_f32_16x16x32_bf16 v[244:247], v[44:47], a[212:215], v[244:247]
  ds_read_b64_tr_b16 v[42:43], v11 offset:50176
  v_mfma_f32_16x16x32_bf16 v[248:251], v[44:47], a[216:219], v[248:251]
  v_mfma_f32_16x16x32_bf16 v[252:255], v[44:47], a[220:223], v[252:255]
  s_waitcnt lgkmcnt(5)
  v_mfma_f32_16x16x32_bf16 v[128:131], v[32:35], a[224:227], v[128:131]
  ds_read_b64_tr_b16 v[44:45], v11 offset:57344
  v_mfma_f32_16x16x32_bf16 v[132:135], v[32:35], a[228:231], v[132:135]
  ds_read_b64_tr_b16 v[46:47], v11 offset:58368
  v_mfma_f32_16x16x32_bf16 v[136:139], v[32:35], a[232:235], v[136:139]
  v_mfma_f32_16x16x32_bf16 v[140:143], v[32:35], a[236:239], v[140:143]
  s_waitcnt lgkmcnt(4)
  v_mfma_f32_16x16x32_bf16 v[128:131], v[36:39], a[240:243], v[128:131]
  ds_read_b64_tr_b16 v[32:33], v10 offset:49408
  v_mfma_f32_16x16x32_bf16 v[132:135], v[36:39], a[244:247], v[132:135]
  ds_read_b64_tr_b16 v[34:35], v10 offset:50432
  v_mfma_f32_16x16x32_bf16 v[136:139], v[36:39], a[248:251], v[136:139]
  v_mfma_f32_16x16x32_bf16 v[140:143], v[36:39], a[252:255], v[140:143]
  s_waitcnt lgkmcnt(4)
  v_mfma_f32_16x16x32_bf16 v[144:147], v[40:43], a[224:227], v[144:147]
  ds_read_b64_tr_b16 v[36:37], v10 offset:57600
  v_mfma_f32_16x16x32_bf16 v[148:151], v[40:43], a[228:231], v[148:151]
  ds_read_b64_tr_b16 v[38:39], v10 offset:58624
  v_mfma_f32_16x16x32_bf16 v[152:155], v[40:43], a[232:235], v[152:155]
  v_mfma_f32_16x16x32_bf16 v[156:159], v[40:43], a[236:239], v[156:159]
  s_waitcnt lgkmcnt(4)
  v_mfma_f32_16x16x32_bf16 v[144:147], v[44:47], a[240:243], v[144:147]
  ds_read_b64_tr_b16 v[40:41], v11 offset:49408
  v_mfma_f32_16x16x32_bf16 v[148:151], v[44:47], a[244:247], v[148:151]
  ds_read_b64_tr_b16 v[42:43], v11 offset:50432
  v_mfma_f32_16x16x32_bf16 v[152:155], v[44:47], a[248:251], v[152:155]
  v_mfma_f32_16x16x32_bf16 v[156:159], v[44:47], a[252:255], v[156:159]
  s_waitcnt lgkmcnt(4)
  v_mfma_f32_16x16x32_bf16 v[160:163], v[32:35], a[224:227], v[160:163]
  ds_read_b64_tr_b16 v[44:45], v11 offset:57600
  v_mfma_f32_16x16x32_bf16 v[164:167], v[32:35], a[228:231], v[164:167]
  s_add_u32 m0, s77, 0
  ds_read_b64_tr_b16 v[46:47], v11 offset:58624
  v_cvt_pk_bf16_f32 v64, v128, v129
  v_mfma_f32_16x16x32_bf16 v[168:171], v[32:35], a[232:235], v[168:171]
  s_lshl_b32 s72, s71, 19
  v_cvt_pk_bf16_f32 v65, v130, v131
  v_cvt_pk_bf16_f32 v66, v144, v145
  v_mfma_f32_16x16x32_bf16 v[172:175], v[32:35], a[236:239], v[172:175]
  s_waitcnt lgkmcnt(4)
  v_cvt_pk_bf16_f32 v67, v146, v147
  v_cvt_pk_bf16_f32 v80, v132, v133
  v_mfma_f32_16x16x32_bf16 v[160:163], v[36:39], a[240:243], v[160:163]
  ds_read_b64_tr_b16 v[32:33], v10 offset:49664
  v_cvt_pk_bf16_f32 v81, v134, v135
  v_mfma_f32_16x16x32_bf16 v[164:167], v[36:39], a[244:247], v[164:167]
  ds_read_b64_tr_b16 v[34:35], v10 offset:50688
  v_cvt_pk_bf16_f32 v82, v148, v149
  v_mfma_f32_16x16x32_bf16 v[168:171], v[36:39], a[248:251], v[168:171]
  v_cvt_pk_bf16_f32 v83, v150, v151
  v_cvt_pk_bf16_f32 v96, v136, v137
  v_mfma_f32_16x16x32_bf16 v[172:175], v[36:39], a[252:255], v[172:175]
  s_waitcnt lgkmcnt(4)
  v_cvt_pk_bf16_f32 v97, v138, v139
  v_cvt_pk_bf16_f32 v98, v152, v153
  v_mfma_f32_16x16x32_bf16 v[176:179], v[40:43], a[224:227], v[176:179]
  ds_read_b64_tr_b16 v[36:37], v10 offset:57856
  v_cvt_pk_bf16_f32 v99, v154, v155
  v_mfma_f32_16x16x32_bf16 v[180:183], v[40:43], a[228:231], v[180:183]
  ds_read_b64_tr_b16 v[38:39], v10 offset:58880
  v_cvt_pk_bf16_f32 v112, v140, v141
  v_mfma_f32_16x16x32_bf16 v[184:187], v[40:43], a[232:235], v[184:187]
  v_cvt_pk_bf16_f32 v113, v142, v143
  v_cvt_pk_bf16_f32 v114, v156, v157
  v_mfma_f32_16x16x32_bf16 v[188:191], v[40:43], a[236:239], v[188:191]
  s_waitcnt lgkmcnt(4)
  buffer_load_dwordx4 v2, s[12:15], s72 offen offset:0 lds
  v_cvt_pk_bf16_f32 v115, v158, v159
  v_mfma_f32_16x16x32_bf16 v[176:179], v[44:47], a[240:243], v[176:179]
  ds_read_b64_tr_b16 v[40:41], v11 offset:49664
  v_mfma_f32_16x16x32_bf16 v[180:183], v[44:47], a[244:247], v[180:183]
  ds_read_b64_tr_b16 v[42:43], v11 offset:50688
  v_mfma_f32_16x16x32_bf16 v[184:187], v[44:47], a[248:251], v[184:187]
  v_mfma_f32_16x16x32_bf16 v[188:191], v[44:47], a[252:255], v[188:191]
  s_waitcnt lgkmcnt(4)
  buffer_load_dwordx4 v3, s[12:15], s72 offen offset:1024 lds
  v_mfma_f32_16x16x32_bf16 v[192:195], v[32:35], a[224:227], v[192:195]
  ds_read_b64_tr_b16 v[44:45], v11 offset:57856
  v_mfma_f32_16x16x32_bf16 v[196:199], v[32:35], a[228:231], v[196:199]
  ds_read_b64_tr_b16 v[46:47], v11 offset:58880
  v_cvt_pk_bf16_f32 v68, v160, v161
  v_mfma_f32_16x16x32_bf16 v[200:203], v[32:35], a[232:235], v[200:203]
  v_cvt_pk_bf16_f32 v69, v162, v163
  v_cvt_pk_bf16_f32 v70, v176, v177
  v_mfma_f32_16x16x32_bf16 v[204:207], v[32:35], a[236:239], v[204:207]
  s_waitcnt lgkmcnt(4)
  v_cvt_pk_bf16_f32 v71, v178, v179
  v_cvt_pk_bf16_f32 v84, v164, v165
  v_mfma_f32_16x16x32_bf16 v[192:195], v[36:39], a[240:243], v[192:195]
  ds_read_b64_tr_b16 v[32:33], v10 offset:49920
  v_cvt_pk_bf16_f32 v85, v166, v167
  v_mfma_f32_16x16x32_bf16 v[196:199], v[36:39], a[244:247], v[196:199]
  ds_read_b64_tr_b16 v[34:35], v10 offset:50944
  v_cvt_pk_bf16_f32 v86, v180, v181
  v_mfma_f32_16x16x32_bf16 v[200:203], v[36:39], a[248:251], v[200:203]
  v_cvt_pk_bf16_f32 v87, v182, v183
  v_cvt_pk_bf16_f32 v100, v168, v169
  v_mfma_f32_16x16x32_bf16 v[204:207], v[36:39], a[252:255], v[204:207]
  s_waitcnt lgkmcnt(4)
  v_cvt_pk_bf16_f32 v101, v170, v171
  v_cvt_pk_bf16_f32 v102, v184, v185
  v_mfma_f32_16x16x32_bf16 v[208:211], v[40:43], a[224:227], v[208:211]
  ds_read_b64_tr_b16 v[36:37], v10 offset:58112
  v_cvt_pk_bf16_f32 v103, v186, v187
  v_mfma_f32_16x16x32_bf16 v[212:215], v[40:43], a[228:231], v[212:215]
  ds_read_b64_tr_b16 v[38:39], v10 offset:59136
  v_cvt_pk_bf16_f32 v116, v172, v173
  v_mfma_f32_16x16x32_bf16 v[216:219], v[40:43], a[232:235], v[216:219]
  v_cvt_pk_bf16_f32 v117, v174, v175
  v_cvt_pk_bf16_f32 v118, v188, v189
  v_mfma_f32_16x16x32_bf16 v[220:223], v[40:43], a[236:239], v[220:223]
  s_waitcnt lgkmcnt(4)
  buffer_load_dwordx4 v4, s[12:15], s72 offen offset:2048 lds
  v_cvt_pk_bf16_f32 v119, v190, v191
  v_mfma_f32_16x16x32_bf16 v[208:211], v[44:47], a[240:243], v[208:211]
  ds_read_b64_tr_b16 v[40:41], v11 offset:49920
  v_mfma_f32_16x16x32_bf16 v[212:215], v[44:47], a[244:247], v[212:215]
  ds_read_b64_tr_b16 v[42:43], v11 offset:50944
  v_mfma_f32_16x16x32_bf16 v[216:219], v[44:47], a[248:251], v[216:219]
  v_mfma_f32_16x16x32_bf16 v[220:223], v[44:47], a[252:255], v[220:223]
  s_waitcnt lgkmcnt(4)
  s_add_u32 s71, s71, 1
  buffer_load_dwordx4 v5, s[12:15], s72 offen offset:3072 lds
  v_mfma_f32_16x16x32_bf16 v[224:227], v[32:35], a[224:227], v[224:227]
  s_and_b32 s71, s71, 7
  s_add_u32 m0, s77, 114688
  ds_read_b64_tr_b16 v[44:45], v11 offset:58112
  v_mfma_f32_16x16x32_bf16 v[228:231], v[32:35], a[228:231], v[228:231]
  s_lshl_b32 s72, s71, 19
  ds_read_b64_tr_b16 v[46:47], v11 offset:59136
  v_cvt_pk_bf16_f32 v72, v192, v193
  v_mfma_f32_16x16x32_bf16 v[232:235], v[32:35], a[232:235], v[232:235]
  v_cvt_pk_bf16_f32 v73, v194, v195
  v_cvt_pk_bf16_f32 v74, v208, v209
  v_mfma_f32_16x16x32_bf16 v[236:239], v[32:35], a[236:239], v[236:239]
  s_waitcnt lgkmcnt(4)
  s_waitcnt vmcnt(9)
  s_barrier
  v_mfma_f32_16x16x32_bf16 v[224:227], v[36:39], a[240:243], v[224:227]
  ds_read_b64_tr_b16 v[32:33], v10 offset:0
  v_cvt_pk_bf16_f32 v75, v210, v211
  v_mfma_f32_16x16x32_bf16 v[228:231], v[36:39], a[244:247], v[228:231]
  ds_read_b64_tr_b16 v[34:35], v10 offset:1024
  v_cvt_pk_bf16_f32 v88, v196, v197
  v_mfma_f32_16x16x32_bf16 v[232:235], v[36:39], a[248:251], v[232:235]
  v_cvt_pk_bf16_f32 v89, v198, v199
  v_cvt_pk_bf16_f32 v90, v212, v213
  v_mfma_f32_16x16x32_bf16 v[236:239], v[36:39], a[252:255], v[236:239]
  s_waitcnt lgkmcnt(4)
  v_cvt_pk_bf16_f32 v91, v214, v215
  v_cvt_pk_bf16_f32 v104, v200, v201
  v_mfma_f32_16x16x32_bf16 v[240:243], v[40:43], a[224:227], v[240:243]
  ds_read_b64_tr_b16 v[36:37], v10 offset:8192
  v_cvt_pk_bf16_f32 v105, v202, v203
  v_mfma_f32_16x16x32_bf16 v[244:247], v[40:43], a[228:231], v[244:247]
  ds_read_b64_tr_b16 v[38:39], v10 offset:9216
  v_cvt_pk_bf16_f32 v106, v216, v217
  v_mfma_f32_16x16x32_bf16 v[248:251], v[40:43], a[232:235], v[248:251]
  v_cvt_pk_bf16_f32 v107, v218, v219
  v_cvt_pk_bf16_f32 v120, v204, v205
  v_mfma_f32_16x16x32_bf16 v[252:255], v[40:43], a[236:239], v[252:255]
  s_waitcnt lgkmcnt(4)
  v_cvt_pk_bf16_f32 v121, v206, v207
  v_cvt_pk_bf16_f32 v122, v220, v221
  v_mfma_f32_16x16x32_bf16 v[240:243], v[44:47], a[240:243], v[240:243]
  ds_read_b64_tr_b16 v[40:41], v11 offset:0
  v_cvt_pk_bf16_f32 v123, v222, v223
  v_mfma_f32_16x16x32_bf16 v[244:247], v[44:47], a[244:247], v[244:247]
  ds_read_b64_tr_b16 v[42:43], v11 offset:1024
  v_mfma_f32_16x16x32_bf16 v[248:251], v[44:47], a[248:251], v[248:251]
  v_mfma_f32_16x16x32_bf16 v[252:255], v[44:47], a[252:255], v[252:255]
  s_waitcnt lgkmcnt(4)
  buffer_load_dwordx4 v2, s[12:15], s72 offen offset:0 lds
  s_getpc_b64 s[98:99]
L_pc2:
  s_sub_u32 s98, s98, L_pc2-L_pc
  s_subb_u32 s99, s99, 0
  global_load_dword v0, v51, s[98:99]
  v_mfma_f32_16x16x32_bf16 v[128:131], a[0:3], v[32:35], 0
  ds_read_b64_tr_b16 v[44:45], v11 offset:8192
  v_mfma_f32_16x16x32_bf16 v[132:135], a[4:7], v[32:35], 0
  ds_read_b64_tr_b16 v[46:47], v11 offset:9216
  v_cvt_pk_bf16_f32 v76, v224, v225
  v_mfma_f32_16x16x32_bf16 v[136:139], a[8:11], v[32:35], 0
  v_cvt_pk_bf16_f32 v77, v226, v227
  v_cvt_pk_bf16_f32 v78, v240, v241
  v_mfma_f32_16x16x32_bf16 v[140:143], a[12:15], v[32:35], 0
  s_waitcnt lgkmcnt(4)
  v_cvt_pk_bf16_f32 v79, v242, v243
  v_cvt_pk_bf16_f32 v92, v228, v229
  v_mfma_f32_16x16x32_bf16 v[128:131], a[16:19], v[36:39], v[128:131]
  ds_read_b64_tr_b16 v[32:33], v10 offset:256
  v_cvt_pk_bf16_f32 v93, v230, v231
  v_mfma_f32_16x16x32_bf16 v[132:135], a[20:23], v[36:39], v[132:135]
  ds_read_b64_tr_b16 v[34:35], v10 offset:1280
  v_cvt_pk_bf16_f32 v94, v244, v245
  v_mfma_f32_16x16x32_bf16 v[136:139], a[24:27], v[36:39], v[136:139]
  v_cvt_pk_bf16_f32 v95, v246, v247
  v_cvt_pk_bf16_f32 v108, v232, v233
  v_mfma_f32_16x16x32_bf16 v[140:143], a[28:31], v[36:39], v[140:143]
  s_waitcnt lgkmcnt(4)
  v_cvt_pk_bf16_f32 v109, v234, v235
  v_cvt_pk_bf16_f32 v110, v248, v249
  v_mfma_f32_16x16x32_bf16 v[144:147], a[0:3], v[40:43], 0
  ds_read_b64_tr_b16 v[36:37], v10 offset:8448
  v_cvt_pk_bf16_f32 v111, v250, v251
  v_mfma_f32_16x16x32_bf16 v[148:151], a[4:7], v[40:43], 0
  ds_read_b64_tr_b16 v[38:39], v10 offset:9472
  v_cvt_pk_bf16_f32 v124, v236, v237
  v_mfma_f32_16x16x32_bf16 v[152:155], a[8:11], v[40:43], 0
  v_cvt_pk_bf16_f32 v125, v238, v239
  v_cvt_pk_bf16_f32 v126, v252, v253
  v_mfma_f32_16x16x32_bf16 v[156:159], a[12:15], v[40:43], 0
  s_waitcnt lgkmcnt(4)
  buffer_load_dwordx4 v3, s[12:15], s72 offen offset:1024 lds
  v_cvt_pk_bf16_f32 v127, v254, v255
  v_mfma_f32_16x16x32_bf16 v[144:147], a[16:19], v[44:47], v[144:147]
  ds_read_b64_tr_b16 v[40:41], v11 offset:256
  v_mfma_f32_16x16x32_bf16 v[148:151], a[20:23], v[44:47], v[148:151]
  ds_read_b64_tr_b16 v[42:43], v11 offset:1280
  v_mfma_f32_16x16x32_bf16 v[152:155], a[24:27], v[44:47], v[152:155]
  v_mfma_f32_16x16x32_bf16 v[156:159], a[28:31], v[44:47], v[156:159]
  s_waitcnt lgkmcnt(4)
  buffer_load_dwordx4 v4, s[12:15], s72 offen offset:2048 lds
  v_mfma_f32_16x16x32_bf16 v[160:163], a[0:3], v[32:35], 0
  ds_read_b64_tr_b16 v[44:45], v11 offset:8448
  v_mfma_f32_16x16x32_bf16 v[164:167], a[4:7], v[32:35], 0
  ds_read_b64_tr_b16 v[46:47], v11 offset:9472
  v_mfma_f32_16x16x32_bf16 v[168:171], a[8:11], v[32:35], 0
  v_mfma_f32_16x16x32_bf16 v[172:175], a[12:15], v[32:35], 0
  s_waitcnt lgkmcnt(4)
  s_add_u32 s71, s71, 1
  buffer_load_dwordx4 v5, s[12:15], s72 offen offset:3072 lds
  v_mfma_f32_16x16x32_bf16 v[160:163], a[16:19], v[36:39], v[160:163]
  s_and_b32 s71, s71, 7
  s_add_u32 m0, s77, 16384
  ds_read_b64_tr_b16 v[32:33], v10 offset:512
  v_mfma_f32_16x16x32_bf16 v[164:167], a[20:23], v[36:39], v[164:167]
  s_lshl_b32 s72, s71, 19
  ds_read_b64_tr_b16 v[34:35], v10 offset:1536
  v_mfma_f32_16x16x32_bf16 v[168:171], a[24:27], v[36:39], v[168:171]
  v_mfma_f32_16x16x32_bf16 v[172:175], a[28:31], v[36:39], v[172:175]
  s_waitcnt lgkmcnt(4)
  buffer_load_dwordx4 v2, s[12:15], s72 offen offset:0 lds
  v_mfma_f32_16x16x32_bf16 v[176:179], a[0:3], v[40:43], 0
  ds_read_b64_tr_b16 v[36:37], v10 offset:8704
  v_mfma_f32_16x16x32_bf16 v[180:183], a[4:7], v[40:43], 0
  ds_read_b64_tr_b16 v[38:39], v10 offset:9728
  v_mfma_f32_16x16x32_bf16 v[184:187], a[8:11], v[40:43], 0
  v_mfma_f32_16x16x32_bf16 v[188:191], a[12:15], v[40:43], 0
  s_waitcnt lgkmcnt(4)
  buffer_load_dwordx4 v3, s[12:15], s72 offen offset:1024 lds
  v_mfma_f32_16x16x32_bf16 v[176:179], a[16:19], v[44:47], v[176:179]
  s_mov_b32 s1, 0
  ds_read_b64_tr_b16 v[40:41], v11 offset:512
  v_mfma_f32_16x16x32_bf16 v[180:183], a[20:23], v[44:47], v[180:183]
  ds_read_b64_tr_b16 v[42:43], v11 offset:1536
  v_mfma_f32_16x16x32_bf16 v[184:187], a[24:27], v[44:47], v[184:187]
  v_mfma_f32_16x16x32_bf16 v[188:191], a[28:31], v[44:47], v[188:191]
  s_waitcnt lgkmcnt(4)
  buffer_load_dwordx4 v4, s[12:15], s72 offen offset:2048 lds
  v_mfma_f32_16x16x32_bf16 v[192:195], a[0:3], v[32:35], 0
  ds_read_b64_tr_b16 v[44:45], v11 offset:8704
  v_mfma_f32_16x16x32_bf16 v[196:199], a[4:7], v[32:35], 0
  ds_read_b64_tr_b16 v[46:47], v11 offset:9728
  v_mfma_f32_16x16x32_bf16 v[200:203], a[8:11], v[32:35], 0
  v_mfma_f32_16x16x32_bf16 v[204:207], a[12:15], v[32:35], 0
  s_waitcnt lgkmcnt(4)
  s_add_u32 s71, s71, 1
  buffer_load_dwordx4 v5, s[12:15], s72 offen offset:3072 lds
  v_mfma_f32_16x16x32_bf16 v[192:195], a[16:19], v[36:39], v[192:195]
  s_and_b32 s71, s71, 7
  s_add_u32 m0, s77, 131072
  ds_read_b64_tr_b16 v[32:33], v10 offset:768
  v_mfma_f32_16x16x32_bf16 v[196:199], a[20:23], v[36:39], v[196:199]
  s_lshl_b32 s72, s71, 19
  ds_read_b64_tr_b16 v[34:35], v10 offset:1792
  v_mfma_f32_16x16x32_bf16 v[200:203], a[24:27], v[36:39], v[200:203]
  v_mfma_f32_16x16x32_bf16 v[204:207], a[28:31], v[36:39], v[204:207]
  s_waitcnt lgkmcnt(4)
  buffer_load_dwordx4 v2, s[12:15], s72 offen offset:0 lds
  v_mfma_f32_16x16x32_bf16 v[208:211], a[0:3], v[40:43], 0
  ds_read_b64_tr_b16 v[36:37], v10 offset:8960
  v_mfma_f32_16x16x32_bf16 v[212:215], a[4:7], v[40:43], 0
  ds_read_b64_tr_b16 v[38:39], v10 offset:9984
  v_mfma_f32_16x16x32_bf16 v[216:219], a[8:11], v[40:43], 0
  v_mfma_f32_16x16x32_bf16 v[220:223], a[12:15], v[40:43], 0
  s_waitcnt lgkmcnt(4)
  buffer_load_dwordx4 v3, s[12:15], s72 offen offset:1024 lds
  v_mfma_f32_16x16x32_bf16 v[208:211], a[16:19], v[44:47], v[208:211]
  ds_read_b64_tr_b16 v[40:41], v11 offset:768
  v_mfma_f32_16x16x32_bf16 v[212:215], a[20:23], v[44:47], v[212:215]
  ds_read_b64_tr_b16 v[42:43], v11 offset:1792
  v_mfma_f32_16x16x32_bf16 v[216:219], a[24:27], v[44:47], v[216:219]
  v_mfma_f32_16x16x32_bf16 v[220:223], a[28:31], v[44:47], v[220:223]
  s_waitcnt lgkmcnt(4)
  buffer_load_dwordx4 v4, s[12:15], s72 offen offset:2048 lds
  v_mfma_f32_16x16x32_bf16 v[224:227], a[0:3], v[32:35], 0
  ds_read_b64_tr_b16 v[44:45], v11 offset:8960
  v_mfma_f32_16x16x32_bf16 v[228:231], a[4:7], v[32:35], 0
  ds_read_b64_tr_b16 v[46:47], v11 offset:9984
  v_mfma_f32_16x16x32_bf16 v[232:235], a[8:11], v[32:35], 0
  v_mfma_f32_16x16x32_bf16 v[236:239], a[12:15], v[32:35], 0
  s_waitcnt lgkmcnt(4)
  s_waitcnt vmcnt(17)
  s_barrier
  v_mfma_f32_16x16x32_bf16 v[224:227], a[16:19], v[36:39], v[224:227]
  ds_read_b64_tr_b16 v[32:33], v14 offset:0
  v_mfma_f32_16x16x32_bf16 v[228:231], a[20:23], v[36:39], v[228:231]
  ds_read_b64_tr_b16 v[34:35], v14 offset:1024
  v_mfma_f32_16x16x32_bf16 v[232:235], a[24:27], v[36:39], v[232:235]
  v_mfma_f32_16x16x32_bf16 v[236:239], a[28:31], v[36:39], v[236:239]
  s_waitcnt lgkmcnt(4)
  s_add_u32 s71, s71, 1
  buffer_load_dwordx4 v5, s[12:15], s72 offen offset:3072 lds
  v_mfma_f32_16x16x32_bf16 v[240:243], a[0:3], v[40:43], 0
  s_and_b32 s71, s71, 7
  ds_read_b64_tr_b16 v[36:37], v14 offset:8192
  v_mfma_f32_16x16x32_bf16 v[244:247], a[4:7], v[40:43], 0
  ds_read_b64_tr_b16 v[38:39], v14 offset:9216
  v_mfma_f32_16x16x32_bf16 v[248:251], a[8:11], v[40:43], 0
  buffer_load_dword v0, v58, s[20:23], s1 offen
  s_mov_b32 s1, 0
  buffer_load_dword v0, v58, s[24:27], s1 offen
  s_mov_b32 s1, 0
  buffer_load_dword v0, v56, s[16:19], s1 offen
  v_mfma_f32_16x16x32_bf16 v[252:255], a[12:15], v[40:43], 0
  s_waitcnt lgkmcnt(4)
  v_mfma_f32_16x16x32_bf16 v[240:243], a[16:19], v[44:47], v[240:243]
  ds_read_b64_tr_b16 v[40:41], v28 offset:0
  v_mfma_f32_16x16x32_bf16 v[244:247], a[20:23], v[44:47], v[244:247]
  ds_read_b64_tr_b16 v[42:43], v28 offset:1024
  v_mfma_f32_16x16x32_bf16 v[248:251], a[24:27], v[44:47], v[248:251]
  v_mfma_f32_16x16x32_bf16 v[252:255], a[28:31], v[44:47], v[252:255]
  s_waitcnt lgkmcnt(4)
  v_mfma_f32_16x16x32_bf16 v[128:131], a[32:35], v[32:35], v[128:131]
  ds_read_b64_tr_b16 v[44:45], v28 offset:8192
  v_mfma_f32_16x16x32_bf16 v[132:135], a[36:39], v[32:35], v[132:135]
  ds_read_b64_tr_b16 v[46:47], v28 offset:9216
  v_mfma_f32_16x16x32_bf16 v[136:139], a[40:43], v[32:35], v[136:139]
  v_mfma_f32_16x16x32_bf16 v[140:143], a[44:47], v[32:35], v[140:143]
  s_waitcnt lgkmcnt(4)
  v_mfma_f32_16x16x32_bf16 v[128:131], a[48:51], v[36:39], v[128:131]
  ds_read_b64_tr_b16 v[32:33], v14 offset:256
  v_mfma_f32_16x16x32_bf16 v[132:135], a[52:55], v[36:39], v[132:135]
  ds_read_b64_tr_b16 v[34:35], v14 offset:1280
  v_mfma_f32_16x16x32_bf16 v[136:139], a[56:59], v[36:39], v[136:139]
  v_mfma_f32_16x16x32_bf16 v[140:143], a[60:63], v[36:39], v[140:143]
  s_waitcnt lgkmcnt(4)
  v_mfma_f32_16x16x32_bf16 v[144:147], a[32:35], v[40:43], v[144:147]
  ds_read_b64_tr_b16 v[36:37], v14 offset:8448
  v_mfma_f32_16x16x32_bf16 v[148:151], a[36:39], v[40:43], v[148:151]
  ds_read_b64_tr_b16 v[38:39], v14 offset:9472
  v_mfma_f32_16x16x32_bf16 v[152:155], a[40:43], v[40:43], v[152:155]
  v_mfma_f32_16x16x32_bf16 v[156:159], a[44:47], v[40:43], v[156:159]
  s_waitcnt lgkmcnt(4)
  v_mfma_f32_16x16x32_bf16 v[144:147], a[48:51], v[44:47], v[144:147]
  ds_read_b64_tr_b16 v[40:41], v28 offset:256
  v_mfma_f32_16x16x32_bf16 v[148:151], a[52:55], v[44:47], v[148:151]
  ds_read_b64_tr_b16 v[42:43], v28 offset:1280
  v_mfma_f32_16x16x32_bf16 v[152:155], a[56:59], v[44:47], v[152:155]
  v_mfma_f32_16x16x32_bf16 v[156:159], a[60:63], v[44:47], v[156:159]
  s_waitcnt lgkmcnt(4)
  v_mfma_f32_16x16x32_bf16 v[160:163], a[32:35], v[32:35], v[160:163]
  ds_read_b64_tr_b16 v[44:45], v28 offset:8448
  v_mfma_f32_16x16x32_bf16 v[164:167], a[36:39], v[32:35], v[164:167]
  ds_read_b64_tr_b16 v[46:47], v28 offset:9472
  v_mfma_f32_16x16x32_bf16 v[168:171], a[40:43], v[32:35], v[168:171]
  v_mfma_f32_16x16x32_bf16 v[172:175], a[44:47], v[32:35], v[172:175]
  s_waitcnt lgkmcnt(4)
  v_mfma_f32_16x16x32_bf16 v[160:163], a[48:51], v[36:39], v[160:163]
  ds_read_b64_tr_b16 v[32:33], v14 offset:512
  v_mfma_f32_16x16x32_bf16 v[164:167], a[52:55], v[36:39], v[164:167]
  ds_read_b64_tr_b16 v[34:35], v14 offset:1536
  v_mfma_f32_16x16x32_bf16 v[168:171], a[56:59], v[36:39], v[168:171]
  v_mfma_f32_16x16x32_bf16 v[172:175], a[60:63], v[36:39], v[172:175]
  s_waitcnt lgkmcnt(4)
  v_mfma_f32_16x16x32_bf16 v[176:179], a[32:35], v[40:43], v[176:179]
  ds_read_b64_tr_b16 v[36:37], v14 offset:8704
  v_mfma_f32_16x16x32_bf16 v[180:183], a[36:39], v[40:43], v[180:183]
  ds_read_b64_tr_b16 v[38:39], v14 offset:9728
  v_mfma_f32_16x16x32_bf16 v[184:187], a[40:43], v[40:43], v[184:187]
  v_mfma_f32_16x16x32_bf16 v[188:191], a[44:47], v[40:43], v[188:191]
  s_waitcnt lgkmcnt(4)
  v_mfma_f32_16x16x32_bf16 v[176:179], a[48:51], v[44:47], v[176:179]
  ds_read_b64_tr_b16 v[40:41], v28 offset:512
  v_mfma_f32_16x16x32_bf16 v[180:183], a[52:55], v[44:47], v[180:183]
  ds_read_b64_tr_b16 v[42:43], v28 offset:1536
  v_mfma_f32_16x16x32_bf16 v[184:187], a[56:59], v[44:47], v[184:187]
  v_mfma_f32_16x16x32_bf16 v[188:191], a[60:63], v[44:47], v[188:191]
  s_waitcnt lgkmcnt(4)
  v_mfma_f32_16x16x32_bf16 v[192:195], a[32:35], v[32:35], v[192:195]
  ds_read_b64_tr_b16 v[44:45], v28 offset:8704
  v_mfma_f32_16x16x32_bf16 v[196:199], a[36:39], v[32:35], v[196:199]
  ds_read_b64_tr_b16 v[46:47], v28 offset:9728
  v_mfma_f32_16x16x32_bf16 v[200:203], a[40:43], v[32:35], v[200:203]
  v_mfma_f32_16x16x32_bf16 v[204:207], a[44:47], v[32:35], v[204:207]
  s_waitcnt lgkmcnt(4)
  v_mfma_f32_16x16x32_bf16 v[192:195], a[48:51], v[36:39], v[192:195]
  ds_read_b64_tr_b16 v[32:33], v14 offset:768
  v_mfma_f32_16x16x32_bf16 v[196:199], a[52:55], v[36:39], v[196:199]
  ds_read_b64_tr_b16 v[34:35], v14 offset:1792
  v_mfma_f32_16x16x32_bf16 v[200:203], a[56:59], v[36:39], v[200:203]
  v_mfma_f32_16x16x32_bf16 v[204:207], a[60:63], v[36:39], v[204:207]
  s_waitcnt lgkmcnt(4)
  v_mfma_f32_16x16x32_bf16 v[208:211], a[32:35], v[40:43], v[208:211]
  ds_read_b64_tr_b16 v[36:37], v14 offset:8960
  v_mfma_f32_16x16x32_bf16 v[212:215], a[36:39], v[40:43], v[212:215]
  ds_read_b64_tr_b16 v[38:39], v14 offset:9984
  v_mfma_f32_16x16x32_bf16 v[216:219], a[40:43], v[40:43], v[216:219]
  v_mfma_f32_16x16x32_bf16 v[220:223], a[44:47], v[40:43], v[220:223]
  s_waitcnt lgkmcnt(4)
  v_mfma_f32_16x16x32_bf16 v[208:211], a[48:51], v[44:47], v[208:211]
  ds_read_b64_tr_b16 v[40:41], v28 offset:768
  v_mfma_f32_16x16x32_bf16 v[212:215], a[52:55], v[44:47], v[212:215]
  ds_read_b64_tr_b16 v[42:43], v28 offset:1792
  v_mfma_f32_16x16x32_bf16 v[216:219], a[56:59], v[44:47], v[216:219]
  v_mfma_f32_16x16x32_bf16 v[220:223], a[60:63], v[44:47], v[220:223]
  s_waitcnt lgkmcnt(4)
  v_mfma_f32_16x16x32_bf16 v[224:227], a[32:35], v[32:35], v[224:227]
  ds_read_b64_tr_b16 v[44:45], v28 offset:8960
  v_mfma_f32_16x16x32_bf16 v[228:231], a[36:39], v[32:35], v[228:231]
  ds_read_b64_tr_b16 v[46:47], v28 offset:9984
  v_mfma_f32_16x16x32_bf16 v[232:235], a[40:43], v[32:35], v[232:235]
  v_mfma_f32_16x16x32_bf16 v[236:239], a[44:47], v[32:35], v[236:239]
  s_waitcnt lgkmcnt(4)
  s_waitcnt vmcnt(16)
  s_barrier
  v_mfma_f32_16x16x32_bf16 v[224:227], a[48:51], v[36:39], v[224:227]
  ds_read_b64_tr_b16 v[32:33], v12 offset:0
  v_mfma_f32_16x16x32_bf16 v[228:231], a[52:55], v[36:39], v[228:231]
  ds_read_b64_tr_b16 v[34:35], v12 offset:1024
  v_mfma_f32_16x16x32_bf16 v[232:235], a[56:59], v[36:39], v[232:235]
  v_mfma_f32_16x16x32_bf16 v[236:239], a[60:63], v[36:39], v[236:239]
  s_waitcnt lgkmcnt(4)
  v_mfma_f32_16x16x32_bf16 v[240:243], a[32:35], v[40:43], v[240:243]
  ds_read_b64_tr_b16 v[36:37], v12 offset:8192
  v_mfma_f32_16x16x32_bf16 v[244:247], a[36:39], v[40:43], v[244:247]
  ds_read_b64_tr_b16 v[38:39], v12 offset:9216
  v_mfma_f32_16x16x32_bf16 v[248:251], a[40:43], v[40:43], v[248:251]
  v_mfma_f32_16x16x32_bf16 v[252:255], a[44:47], v[40:43], v[252:255]
  s_waitcnt lgkmcnt(4)
  v_mfma_f32_16x16x32_bf16 v[240:243], a[48:51], v[44:47], v[240:243]
  ds_read_b64_tr_b16 v[40:41], v13 offset:0
  v_mfma_f32_16x16x32_bf16 v[244:247], a[52:55], v[44:47], v[244:247]
  ds_read_b64_tr_b16 v[42:43], v13 offset:1024
  v_mfma_f32_16x16x32_bf16 v[248:251], a[56:59], v[44:47], v[248:251]
  v_mfma_f32_16x16x32_bf16 v[252:255], a[60:63], v[44:47], v[252:255]
  s_waitcnt lgkmcnt(4)
  v_mfma_f32_16x16x32_bf16 v[128:131], a[64:67], v[32:35], v[128:131]
  ds_read_b64_tr_b16 v[44:45], v13 offset:8192
  v_mfma_f32_16x16x32_bf16 v[132:135], a[68:71], v[32:35], v[132:135]
  ds_read_b64_tr_b16 v[46:47], v13 offset:9216
  v_mfma_f32_16x16x32_bf16 v[136:139], a[72:75], v[32:35], v[136:139]
  v_mfma_f32_16x16x32_bf16 v[140:143], a[76:79], v[32:35], v[140:143]
  s_waitcnt lgkmcnt(4)
  v_mfma_f32_16x16x32_bf16 v[128:131], a[80:83], v[36:39], v[128:131]
  ds_read_b64_tr_b16 v[32:33], v12 offset:256
  v_mfma_f32_16x16x32_bf16 v[132:135], a[84:87], v[36:39], v[132:135]
  ds_read_b64_tr_b16 v[34:35], v12 offset:1280
  v_mfma_f32_16x16x32_bf16 v[136:139], a[88:91], v[36:39], v[136:139]
  v_mfma_f32_16x16x32_bf16 v[140:143], a[92:95], v[36:39], v[140:143]
  s_waitcnt lgkmcnt(4)
  v_mfma_f32_16x16x32_bf16 v[144:147], a[64:67], v[40:43], v[144:147]
  ds_read_b64_tr_b16 v[36:37], v12 offset:8448
  v_mfma_f32_16x16x32_bf16 v[148:151], a[68:71], v[40:43], v[148:151]
  ds_read_b64_tr_b16 v[38:39], v12 offset:9472
  v_mfma_f32_16x16x32_bf16 v[152:155], a[72:75], v[40:43], v[152:155]
  v_mfma_f32_16x16x32_bf16 v[156:159], a[76:79], v[40:43], v[156:159]
  s_waitcnt lgkmcnt(4)
  v_mfma_f32_16x16x32_bf16 v[144:147], a[80:83], v[44:47], v[144:147]
  ds_read_b64_tr_b16 v[40:41], v13 offset:256
  v_mfma_f32_16x16x32_bf16 v[148:151], a[84:87], v[44:47], v[148:151]
  ds_read_b64_tr_b16 v[42:43], v13 offset:1280
  v_mfma_f32_16x16x32_bf16 v[152:155], a[88:91], v[44:47], v[152:155]
  v_mfma_f32_16x16x32_bf16 v[156:159], a[92:95], v[44:47], v[156:159]
  s_waitcnt lgkmcnt(4)
  v_mfma_f32_16x16x32_bf16 v[160:163], a[64:67], v[32:35], v[160:163]
  ds_read_b64_tr_b16 v[44:45], v13 offset:8448
  v_mfma_f32_16x16x32_bf16 v[164:167], a[68:71], v[32:35], v[164:167]
  ds_read_b64_tr_b16 v[46:47], v13 offset:9472
  v_mfma_f32_16x16x32_bf16 v[168:171], a[72:75], v[32:35], v[168:171]
  v_mfma_f32_16x16x32_bf16 v[172:175], a[76:79], v[32:35], v[172:175]
  s_waitcnt lgkmcnt(4)
  v_mfma_f32_16x16x32_bf16 v[160:163], a[80:83], v[36:39], v[160:163]
  ds_read_b64_tr_b16 v[32:33], v12 offset:512
  v_mfma_f32_16x16x32_bf16 v[164:167], a[84:87], v[36:39], v[164:167]
  ds_read_b64_tr_b16 v[34:35], v12 offset:1536
  v_mfma_f32_16x16x32_bf16 v[168:171], a[88:91], v[36:39], v[168:171]
  v_mfma_f32_16x16x32_bf16 v[172:175], a[92:95], v[36:39], v[172:175]
  s_waitcnt lgkmcnt(4)
  v_mfma_f32_16x16x32_bf16 v[176:179], a[64:67], v[40:43], v[176:179]
  ds_read_b64_tr_b16 v[36:37], v12 offset:8704
  v_mfma_f32_16x16x32_bf16 v[180:183], a[68:71], v[40:43], v[180:183]
  ds_read_b64_tr_b16 v[38:39], v12 offset:9728
  v_mfma_f32_16x16x32_bf16 v[184:187], a[72:75], v[40:43], v[184:187]
  v_mfma_f32_16x16x32_bf16 v[188:191], a[76:79], v[40:43], v[188:191]
  s_waitcnt lgkmcnt(4)
  v_mfma_f32_16x16x32_bf16 v[176:179], a[80:83], v[44:47], v[176:179]
  ds_read_b64_tr_b16 v[40:41], v13 offset:512
  v_mfma_f32_16x16x32_bf16 v[180:183], a[84:87], v[44:47], v[180:183]
  ds_read_b64_tr_b16 v[42:43], v13 offset:1536
  v_mfma_f32_16x16x32_bf16 v[184:187], a[88:91], v[44:47], v[184:187]
  v_mfma_f32_16x16x32_bf16 v[188:191], a[92:95], v[44:47], v[188:191]
  s_waitcnt lgkmcnt(4)
  v_mfma_f32_16x16x32_bf16 v[192:195], a[64:67], v[32:35], v[192:195]
  ds_read_b64_tr_b16 v[44:45], v13 offset:8704
  v_mfma_f32_16x16x32_bf16 v[196:199], a[68:71], v[32:35], v[196:199]
  ds_read_b64_tr_b16 v[46:47], v13 offset:9728
  v_mfma_f32_16x16x32_bf16 v[200:203], a[72:75], v[32:35], v[200:203]
  v_mfma_f32_16x16x32_bf16 v[204:207], a[76:79], v[32:35], v[204:207]
  s_waitcnt lgkmcnt(4)
  v_mfma_f32_16x16x32_bf16 v[192:195], a[80:83], v[36:39], v[192:195]
  ds_read_b64_tr_b16 v[32:33], v12 offset:768
  v_mfma_f32_16x16x32_bf16 v[196:199], a[84:87], v[36:39], v[196:199]
  ds_read_b64_tr_b16 v[34:35], v12 offset:1792
  v_mfma_f32_16x16x32_bf16 v[200:203], a[88:91], v[36:39], v[200:203]
  v_mfma_f32_16x16x32_bf16 v[204:207], a[92:95], v[36:39], v[204:207]
  s_waitcnt lgkmcnt(4)
  v_mfma_f32_16x16x32_bf16 v[208:211], a[64:67], v[40:43], v[208:211]
  ds_read_b64_tr_b16 v[36:37], v12 offset:8960
  v_mfma_f32_16x16x32_bf16 v[212:215], a[68:71], v[40:43], v[212:215]
  ds_read_b64_tr_b16 v[38:39], v12 offset:9984
  v_mfma_f32_16x16x32_bf16 v[216:219], a[72:75], v[40:43], v[216:219]
  v_mfma_f32_16x16x32_bf16 v[220:223], a[76:79], v[40:43], v[220:223]
  s_waitcnt lgkmcnt(4)
  v_mfma_f32_16x16x32_bf16 v[208:211], a[80:83], v[44:47], v[208:211]
  ds_read_b64_tr_b16 v[40:41], v13 offset:768
  v_mfma_f32_16x16x32_bf16 v[212:215], a[84:87], v[44:47], v[212:215]
  ds_read_b64_tr_b16 v[42:43], v13 offset:1792
  v_mfma_f32_16x16x32_bf16 v[216:219], a[88:91], v[44:47], v[216:219]
  v_mfma_f32_16x16x32_bf16 v[220:223], a[92:95], v[44:47], v[220:223]
  s_waitcnt lgkmcnt(4)
  v_mfma_f32_16x16x32_bf16 v[224:227], a[64:67], v[32:35], v[224:227]
  ds_read_b64_tr_b16 v[44:45], v13 offset:8960
  v_mfma_f32_16x16x32_bf16 v[228:231], a[68:71], v[32:35], v[228:231]
  ds_read_b64_tr_b16 v[46:47], v13 offset:9984
  v_mfma_f32_16x16x32_bf16 v[232:235], a[72:75], v[32:35], v[232:235]
  v_mfma_f32_16x16x32_bf16 v[236:239], a[76:79], v[32:35], v[236:239]
  s_waitcnt lgkmcnt(4)
  s_waitcnt vmcnt(11)
  s_barrier
  v_mfma_f32_16x16x32_bf16 v[224:227], a[80:83], v[36:39], v[224:227]
  ds_read_b64_tr_b16 v[32:33], v10 offset:16384
  v_mfma_f32_16x16x32_bf16 v[228:231], a[84:87], v[36:39], v[228:231]
  ds_read_b64_tr_b16 v[34:35], v10 offset:17408
  v_mfma_f32_16x16x32_bf16 v[232:235], a[88:91], v[36:39], v[232:235]
  v_mfma_f32_16x16x32_bf16 v[236:239], a[92:95], v[36:39], v[236:239]
  s_waitcnt lgkmcnt(4)
  v_mfma_f32_16x16x32_bf16 v[240:243], a[64:67], v[40:43], v[240:243]
  ds_read_b64_tr_b16 v[36:37], v10 offset:24576
  v_mfma_f32_16x16x32_bf16 v[244:247], a[68:71], v[40:43], v[244:247]
  ds_read_b64_tr_b16 v[38:39], v10 offset:25600
  v_mfma_f32_16x16x32_bf16 v[248:251], a[72:75], v[40:43], v[248:251]
  v_mfma_f32_16x16x32_bf16 v[252:255], a[76:79], v[40:43], v[252:255]
  s_waitcnt lgkmcnt(4)
  v_mfma_f32_16x16x32_bf16 v[240:243], a[80:83], v[44:47], v[240:243]
  ds_read_b64_tr_b16 v[40:41], v11 offset:16384
  v_mfma_f32_16x16x32_bf16 v[244:247], a[84:87], v[44:47], v[244:247]
  ds_read_b64_tr_b16 v[42:43], v11 offset:17408
  v_mfma_f32_16x16x32_bf16 v[248:251], a[88:91], v[44:47], v[248:251]
  v_mfma_f32_16x16x32_bf16 v[252:255], a[92:95], v[44:47], v[252:255]
  s_waitcnt lgkmcnt(4)
  v_mfma_f32_16x16x32_bf16 v[128:131], a[96:99], v[32:35], v[128:131]
  ds_read_b64_tr_b16 v[44:45], v11 offset:24576
  v_mfma_f32_16x16x32_bf16 v[132:135], a[100:103], v[32:35], v[132:135]
  ds_read_b64_tr_b16 v[46:47], v11 offset:25600
  v_mfma_f32_16x16x32_bf16 v[136:139], a[104:107], v[32:35], v[136:139]
  v_mfma_f32_16x16x32_bf16 v[140:143], a[108:111], v[32:35], v[140:143]
  s_waitcnt lgkmcnt(4)
  v_mfma_f32_16x16x32_bf16 v[128:131], a[112:115], v[36:39], v[128:131]
  ds_read_b64_tr_b16 v[32:33], v10 offset:16640
  v_mfma_f32_16x16x32_bf16 v[132:135], a[116:119], v[36:39], v[132:135]
  ds_read_b64_tr_b16 v[34:35], v10 offset:17664
  v_mfma_f32_16x16x32_bf16 v[136:139], a[120:123], v[36:39], v[136:139]
  v_mfma_f32_16x16x32_bf16 v[140:143], a[124:127], v[36:39], v[140:143]
  s_waitcnt lgkmcnt(4)
  v_mfma_f32_16x16x32_bf16 v[144:147], a[96:99], v[40:43], v[144:147]
  ds_read_b64_tr_b16 v[36:37], v10 offset:24832
  v_mfma_f32_16x16x32_bf16 v[148:151], a[100:103], v[40:43], v[148:151]
  ds_read_b64_tr_b16 v[38:39], v10 offset:25856
  v_mfma_f32_16x16x32_bf16 v[152:155], a[104:107], v[40:43], v[152:155]
  v_mfma_f32_16x16x32_bf16 v[156:159], a[108:111], v[40:43], v[156:159]
  s_waitcnt lgkmcnt(4)
  v_mfma_f32_16x16x32_bf16 v[144:147], a[112:115], v[44:47], v[144:147]
  ds_read_b64_tr_b16 v[40:41], v11 offset:16640
  v_mfma_f32_16x16x32_bf16 v[148:151], a[116:119], v[44:47], v[148:151]
  ds_read_b64_tr_b16 v[42:43], v11 offset:17664
  v_mfma_f32_16x16x32_bf16 v[152:155], a[120:123], v[44:47], v[152:155]
  s_add_u32 s83, s79, 0
  v_mfma_f32_16x16x32_bf16 v[156:159], a[124:127], v[44:47], v[156:159]
  s_waitcnt lgkmcnt(4)
  buffer_store_dwordx4 v[64:67], v15, s[36:39], s83 offen offset:0
  v_mfma_f32_16x16x32_bf16 v[160:163], a[96:99], v[32:35], v[160:163]
  ds_read_b64_tr_b16 v[44:45], v11 offset:24832
  v_mfma_f32_16x16x32_bf16 v[164:167], a[100:103], v[32:35], v[164:167]
  ds_read_b64_tr_b16 v[46:47], v11 offset:25856
  v_mfma_f32_16x16x32_bf16 v[168:171], a[104:107], v[32:35], v[168:171]
  v_mfma_f32_16x16x32_bf16 v[172:175], a[108:111], v[32:35], v[172:175]
  s_waitcnt lgkmcnt(4)
  v_mfma_f32_16x16x32_bf16 v[160:163], a[112:115], v[36:39], v[160:163]
  ds_read_b64_tr_b16 v[32:33], v10 offset:16896
  v_mfma_f32_16x16x32_bf16 v[164:167], a[116:119], v[36:39], v[164:167]
  ds_read_b64_tr_b16 v[34:35], v10 offset:17920
  v_mfma_f32_16x16x32_bf16 v[168:171], a[120:123], v[36:39], v[168:171]
  v_mfma_f32_16x16x32_bf16 v[172:175], a[124:127], v[36:39], v[172:175]
  s_waitcnt lgkmcnt(4)
  v_mfma_f32_16x16x32_bf16 v[176:179], a[96:99], v[40:43], v[176:179]
  ds_read_b64_tr_b16 v[36:37], v10 offset:25088
  v_mfma_f32_16x16x32_bf16 v[180:183], a[100:103], v[40:43], v[180:183]
  ds_read_b64_tr_b16 v[38:39], v10 offset:26112
  v_mfma_f32_16x16x32_bf16 v[184:187], a[104:107], v[40:43], v[184:187]
  v_mfma_f32_16x16x32_bf16 v[188:191], a[108:111], v[40:43], v[188:191]
  s_waitcnt lgkmcnt(4)
  v_mfma_f32_16x16x32_bf16 v[176:179], a[112:115], v[44:47], v[176:179]
  ds_read_b64_tr_b16 v[40:41], v11 offset:16896
  v_mfma_f32_16x16x32_bf16 v[180:183], a[116:119], v[44:47], v[180:183]
  ds_read_b64_tr_b16 v[42:43], v11 offset:17920
  v_mfma_f32_16x16x32_bf16 v[184:187], a[120:123], v[44:47], v[184:187]
  v_mfma_f32_16x16x32_bf16 v[188:191], a[124:127], v[44:47], v[188:191]
  s_waitcnt lgkmcnt(4)
  buffer_store_dwordx4 v[68:71], v15, s[36:39], s83 offen offset:1024
  v_mfma_f32_16x16x32_bf16 v[192:195], a[96:99], v[32:35], v[192:195]
  ds_read_b64_tr_b16 v[44:45], v11 offset:25088
  v_cmp_ne_u32 vcc, v52, v49
  s_cbranch_vccnz Lspin8
Lback8:
  v_mfma_f32_16x16x32_bf16 v[196:199], a[100:103], v[32:35], v[196:199]
  ds_read_b64_tr_b16 v[46:47], v11 offset:26112
  v_mfma_f32_16x16x32_bf16 v[200:203], a[104:107], v[32:35], v[200:203]
  v_mfma_f32_16x16x32_bf16 v[204:207], a[108:111], v[32:35], v[204:207]
  s_waitcnt lgkmcnt(4)
  v_mfma_f32_16x16x32_bf16 v[192:195], a[112:115], v[36:39], v[192:195]
  ds_read_b64_tr_b16 v[32:33], v10 offset:17152
  v_mfma_f32_16x16x32_bf16 v[196:199], a[116:119], v[36:39], v[196:199]
  ds_read_b64_tr_b16 v[34:35], v10 offset:18176
  v_mfma_f32_16x16x32_bf16 v[200:203], a[120:123], v[36:39], v[200:203]
  v_mfma_f32_16x16x32_bf16 v[204:207], a[124:127], v[36:39], v[204:207]
  s_waitcnt lgkmcnt(4)
  v_mfma_f32_16x16x32_bf16 v[208:211], a[96:99], v[40:43], v[208:211]
  ds_read_b64_tr_b16 v[36:37], v10 offset:25344
  v_mfma_f32_16x16x32_bf16 v[212:215], a[100:103], v[40:43], v[212:215]
  ds_read_b64_tr_b16 v[38:39], v10 offset:26368
  v_mfma_f32_16x16x32_bf16 v[216:219], a[104:107], v[40:43], v[216:219]
  v_mfma_f32_16x16x32_bf16 v[220:223], a[108:111], v[40:43], v[220:223]
  s_waitcnt lgkmcnt(4)
  v_mfma_f32_16x16x32_bf16 v[208:211], a[112:115], v[44:47], v[208:211]
  s_add_u32 s76, s89, 0
  s_and_b32 s76, s76, 7
  ds_read_b64_tr_b16 v[40:41], v11 offset:17152
  v_mfma_f32_16x16x32_bf16 v[212:215], a[116:119], v[44:47], v[212:215]
  s_lshl_b32 s76, s76, 11
  s_add_u32 s75, s76, s81
  ds_read_b64_tr_b16 v[42:43], v11 offset:18176
  v_mfma_f32_16x16x32_bf16 v[216:219], a[120:123], v[44:47], v[216:219]
  s_add_u32 s76, s76, s82
  v_mfma_f32_16x16x32_bf16 v[220:223], a[124:127], v[44:47], v[220:223]
  s_waitcnt lgkmcnt(4)
  buffer_load_dwordx4 a[0:3], v15, s[28:31], s75 offen offset:0 sc1
  v_mfma_f32_16x16x32_bf16 v[224:227], a[96:99], v[32:35], v[224:227]
  ds_read_b64_tr_b16 v[44:45], v11 offset:25344
  v_mfma_f32_16x16x32_bf16 v[228:231], a[100:103], v[32:35], v[228:231]
  ds_read_b64_tr_b16 v[46:47], v11 offset:26368
  v_mfma_f32_16x16x32_bf16 v[232:235], a[104:107], v[32:35], v[232:235]
  v_mfma_f32_16x16x32_bf16 v[236:239], a[108:111], v[32:35], v[236:239]
  s_waitcnt lgkmcnt(4)
  s_waitcnt vmcnt(10)
  s_barrier
  v_mfma_f32_16x16x32_bf16 v[224:227], a[112:115], v[36:39], v[224:227]
  ds_read_b64_tr_b16 v[32:33], v12 offset:16384
  v_mfma_f32_16x16x32_bf16 v[228:231], a[116:119], v[36:39], v[228:231]
  s_add_u32 m0, s77, 147456
  s_lshl_b32 s72, s71, 19
  ds_read_b64_tr_b16 v[34:35], v12 offset:17408
  v_mfma_f32_16x16x32_bf16 v[232:235], a[120:123], v[36:39], v[232:235]
  v_mfma_f32_16x16x32_bf16 v[236:239], a[124:127], v[36:39], v[236:239]
  s_waitcnt lgkmcnt(4)
  buffer_load_dwordx4 v2, s[12:15], s72 offen offset:0 lds
  v_mfma_f32_16x16x32_bf16 v[240:243], a[96:99], v[40:43], v[240:243]
  ds_read_b64_tr_b16 v[36:37], v12 offset:24576
  v_mfma_f32_16x16x32_bf16 v[244:247], a[100:103], v[40:43], v[244:247]
  ds_read_b64_tr_b16 v[38:39], v12 offset:25600
  v_mfma_f32_16x16x32_bf16 v[248:251], a[104:107], v[40:43], v[248:251]
  v_mfma_f32_16x16x32_bf16 v[252:255], a[108:111], v[40:43], v[252:255]
  s_waitcnt lgkmcnt(4)
  buffer_load_dwordx4 a[4:7], v48, s[28:31], s75 offen offset:0 sc1
  v_mfma_f32_16x16x32_bf16 v[240:243], a[112:115], v[44:47], v[240:243]
  ds_read_b64_tr_b16 v[40:41], v13 offset:16384
  v_mfma_f32_16x16x32_bf16 v[244:247], a[116:119], v[44:47], v[244:247]
  ds_read_b64_tr_b16 v[42:43], v13 offset:17408
  v_mfma_f32_16x16x32_bf16 v[248:251], a[120:123], v[44:47], v[248:251]
  v_mfma_f32_16x16x32_bf16 v[252:255], a[124:127], v[44:47], v[252:255]
  s_waitcnt lgkmcnt(4)
  buffer_store_dwordx4 v[72:75], v15, s[36:39], s83 offen offset:2048
  v_mfma_f32_16x16x32_bf16 v[128:131], a[128:131], v[32:35], v[128:131]
  ds_read_b64_tr_b16 v[44:45], v13 offset:24576
  v_mfma_f32_16x16x32_bf16 v[132:135], a[132:135], v[32:35], v[132:135]
  ds_read_b64_tr_b16 v[46:47], v13 offset:25600
  v_mfma_f32_16x16x32_bf16 v[136:139], a[136:139], v[32:35], v[136:139]
  v_mfma_f32_16x16x32_bf16 v[140:143], a[140:143], v[32:35], v[140:143]
  s_waitcnt lgkmcnt(4)
  buffer_load_dwordx4 a[8:11], v15, s[28:31], s76 offen offset:0 sc1
  v_mfma_f32_16x16x32_bf16 v[128:131], a[144:147], v[36:39], v[128:131]
  ds_read_b64_tr_b16 v[32:33], v12 offset:16640
  v_mfma_f32_16x16x32_bf16 v[132:135], a[148:151], v[36:39], v[132:135]
  ds_read_b64_tr_b16 v[34:35], v12 offset:17664
  v_mfma_f32_16x16x32_bf16 v[136:139], a[152:155], v[36:39], v[136:139]
  v_mfma_f32_16x16x32_bf16 v[140:143], a[156:159], v[36:39], v[140:143]
  s_waitcnt lgkmcnt(4)
  buffer_load_dwordx4 v3, s[12:15], s72 offen offset:1024 lds
  v_mfma_f32_16x16x32_bf16 v[144:147], a[128:131], v[40:43], v[144:147]
  ds_read_b64_tr_b16 v[36:37], v12 offset:24832
  v_mfma_f32_16x16x32_bf16 v[148:151], a[132:135], v[40:43], v[148:151]
  ds_read_b64_tr_b16 v[38:39], v12 offset:25856
  v_mfma_f32_16x16x32_bf16 v[152:155], a[136:139], v[40:43], v[152:155]
  v_mfma_f32_16x16x32_bf16 v[156:159], a[140:143], v[40:43], v[156:159]
  s_waitcnt lgkmcnt(4)
  buffer_load_dwordx4 a[12:15], v48, s[28:31], s76 offen offset:0 sc1
  v_mfma_f32_16x16x32_bf16 v[144:147], a[144:147], v[44:47], v[144:147]
  ds_read_b64_tr_b16 v[40:41], v13 offset:16640
  v_mfma_f32_16x16x32_bf16 v[148:151], a[148:151], v[44:47], v[148:151]
  ds_read_b64_tr_b16 v[42:43], v13 offset:17664
  v_mfma_f32_16x16x32_bf16 v[152:155], a[152:155], v[44:47], v[152:155]
  v_mfma_f32_16x16x32_bf16 v[156:159], a[156:159], v[44:47], v[156:159]
  s_waitcnt lgkmcnt(4)
  buffer_store_dwordx4 v[76:79], v15, s[36:39], s83 offen offset:3072
  s_add_u32 s83, s79, 8192
  v_mfma_f32_16x16x32_bf16 v[160:163], a[128:131], v[32:35], v[160:163]
  ds_read_b64_tr_b16 v[44:45], v13 offset:24832
  v_mfma_f32_16x16x32_bf16 v[164:167], a[132:135], v[32:35], v[164:167]
  ds_read_b64_tr_b16 v[46:47], v13 offset:25856
  v_mfma_f32_16x16x32_bf16 v[168:171], a[136:139], v[32:35], v[168:171]
  v_mfma_f32_16x16x32_bf16 v[172:175], a[140:143], v[32:35], v[172:175]
  s_waitcnt lgkmcnt(4)
  buffer_store_dwordx4 v[96:99], v15, s[36:39], s83 offen offset:0
  v_mfma_f32_16x16x32_bf16 v[160:163], a[144:147], v[36:39], v[160:163]
  ds_read_b64_tr_b16 v[32:33], v12 offset:16896
  v_mfma_f32_16x16x32_bf16 v[164:167], a[148:151], v[36:39], v[164:167]
  ds_read_b64_tr_b16 v[34:35], v12 offset:17920
  v_mfma_f32_16x16x32_bf16 v[168:171], a[152:155], v[36:39], v[168:171]
  v_mfma_f32_16x16x32_bf16 v[172:175], a[156:159], v[36:39], v[172:175]
  s_waitcnt lgkmcnt(4)
  buffer_load_dwordx4 v4, s[12:15], s72 offen offset:2048 lds
  v_mfma_f32_16x16x32_bf16 v[176:179], a[128:131], v[40:43], v[176:179]
  ds_read_b64_tr_b16 v[36:37], v12 offset:25088
  v_mfma_f32_16x16x32_bf16 v[180:183], a[132:135], v[40:43], v[180:183]
  ds_read_b64_tr_b16 v[38:39], v12 offset:26112
  v_mfma_f32_16x16x32_bf16 v[184:187], a[136:139], v[40:43], v[184:187]
  v_mfma_f32_16x16x32_bf16 v[188:191], a[140:143], v[40:43], v[188:191]
  s_waitcnt lgkmcnt(4)
  buffer_load_dwordx4 a[16:19], v15, s[28:31], s75 offen offset:1024 sc1
  v_mfma_f32_16x16x32_bf16 v[176:179], a[144:147], v[44:47], v[176:179]
  ds_read_b64_tr_b16 v[40:41], v13 offset:16896
  v_mfma_f32_16x16x32_bf16 v[180:183], a[148:151], v[44:47], v[180:183]
  ds_read_b64_tr_b16 v[42:43], v13 offset:17920
  v_mfma_f32_16x16x32_bf16 v[184:187], a[152:155], v[44:47], v[184:187]
  v_mfma_f32_16x16x32_bf16 v[188:191], a[156:159], v[44:47], v[188:191]
  s_waitcnt lgkmcnt(4)
  buffer_load_dwordx4 a[20:23], v48, s[28:31], s75 offen offset:1024 sc1
  v_mfma_f32_16x16x32_bf16 v[192:195], a[128:131], v[32:35], v[192:195]
  ds_read_b64_tr_b16 v[44:45], v13 offset:25088
  v_mfma_f32_16x16x32_bf16 v[196:199], a[132:135], v[32:35], v[196:199]
  ds_read_b64_tr_b16 v[46:47], v13 offset:26112
  v_mfma_f32_16x16x32_bf16 v[200:203], a[136:139], v[32:35], v[200:203]
  v_mfma_f32_16x16x32_bf16 v[204:207], a[140:143], v[32:35], v[204:207]
  s_waitcnt lgkmcnt(4)
  buffer_store_dwordx4 v[100:103], v15, s[36:39], s83 offen offset:1024
  v_mfma_f32_16x16x32_bf16 v[192:195], a[144:147], v[36:39], v[192:195]
  ds_read_b64_tr_b16 v[32:33], v12 offset:17152
  v_mfma_f32_16x16x32_bf16 v[196:199], a[148:151], v[36:39], v[196:199]
  ds_read_b64_tr_b16 v[34:35], v12 offset:18176
  v_mfma_f32_16x16x32_bf16 v[200:203], a[152:155], v[36:39], v[200:203]
  v_mfma_f32_16x16x32_bf16 v[204:207], a[156:159], v[36:39], v[204:207]
  s_waitcnt lgkmcnt(4)
  buffer_load_dwordx4 v5, s[12:15], s72 offen offset:3072 lds
  v_mfma_f32_16x16x32_bf16 v[208:211], a[128:131], v[40:43], v[208:211]
  ds_read_b64_tr_b16 v[36:37], v12 offset:25344
  v_mfma_f32_16x16x32_bf16 v[212:215], a[132:135], v[40:43], v[212:215]
  ds_read_b64_tr_b16 v[38:39], v12 offset:26368
  v_mfma_f32_16x16x32_bf16 v[216:219], a[136:139], v[40:43], v[216:219]
  v_mfma_f32_16x16x32_bf16 v[220:223], a[140:143], v[40:43], v[220:223]
  s_waitcnt lgkmcnt(4)
  buffer_load_dwordx4 a[24:27], v15, s[28:31], s76 offen offset:1024 sc1
  v_mfma_f32_16x16x32_bf16 v[208:211], a[144:147], v[44:47], v[208:211]
  ds_read_b64_tr_b16 v[40:41], v13 offset:17152
  v_mfma_f32_16x16x32_bf16 v[212:215], a[148:151], v[44:47], v[212:215]
  ds_read_b64_tr_b16 v[42:43], v13 offset:18176
  v_mfma_f32_16x16x32_bf16 v[216:219], a[152:155], v[44:47], v[216:219]
  v_mfma_f32_16x16x32_bf16 v[220:223], a[156:159], v[44:47], v[220:223]
  s_waitcnt lgkmcnt(4)
  buffer_store_dwordx4 v[104:107], v15, s[36:39], s83 offen offset:2048
  v_mfma_f32_16x16x32_bf16 v[224:227], a[128:131], v[32:35], v[224:227]
  ds_read_b64_tr_b16 v[44:45], v13 offset:25344
  v_mfma_f32_16x16x32_bf16 v[228:231], a[132:135], v[32:35], v[228:231]
  ds_read_b64_tr_b16 v[46:47], v13 offset:26368
  v_mfma_f32_16x16x32_bf16 v[232:235], a[136:139], v[32:35], v[232:235]
  v_mfma_f32_16x16x32_bf16 v[236:239], a[140:143], v[32:35], v[236:239]
  s_waitcnt lgkmcnt(4)
  s_waitcnt vmcnt(21)
  s_barrier
  v_mfma_f32_16x16x32_bf16 v[224:227], a[144:147], v[36:39], v[224:227]
  ds_read_b64_tr_b16 v[32:33], v10 offset:32768
  v_mfma_f32_16x16x32_bf16 v[228:231], a[148:151], v[36:39], v[228:231]
  s_add_u32 s71, s71, 1
  s_and_b32 s71, s71, 7
  ds_read_b64_tr_b16 v[34:35], v10 offset:33792
  v_mfma_f32_16x16x32_bf16 v[232:235], a[152:155], v[36:39], v[232:235]
  s_add_u32 m0, s77, 81920
  s_lshl_b32 s72, s71, 19
  v_mfma_f32_16x16x32_bf16 v[236:239], a[156:159], v[36:39], v[236:239]
  s_waitcnt lgkmcnt(4)
  buffer_load_dwordx4 v2, s[12:15], s72 offen offset:0 lds
  v_mfma_f32_16x16x32_bf16 v[240:243], a[128:131], v[40:43], v[240:243]
  ds_read_b64_tr_b16 v[36:37], v10 offset:40960
  v_mfma_f32_16x16x32_bf16 v[244:247], a[132:135], v[40:43], v[244:247]
  ds_read_b64_tr_b16 v[38:39], v10 offset:41984
  v_mfma_f32_16x16x32_bf16 v[248:251], a[136:139], v[40:43], v[248:251]
  v_mfma_f32_16x16x32_bf16 v[252:255], a[140:143], v[40:43], v[252:255]
  s_waitcnt lgkmcnt(4)
  buffer_load_dwordx4 a[28:31], v48, s[28:31], s76 offen offset:1024 sc1
  v_mfma_f32_16x16x32_bf16 v[240:243], a[144:147], v[44:47], v[240:243]
  s_add_u32 s76, s89, 1
  s_and_b32 s76, s76, 7
  ds_read_b64_tr_b16 v[40:41], v11 offset:32768
  v_mfma_f32_16x16x32_bf16 v[244:247], a[148:151], v[44:47], v[244:247]
  s_lshl_b32 s76, s76, 11
  s_add_u32 s75, s76, s81
  ds_read_b64_tr_b16 v[42:43], v11 offset:33792
  v_mfma_f32_16x16x32_bf16 v[248:251], a[152:155], v[44:47], v[248:251]
  s_add_u32 s76, s76, s82
  v_mfma_f32_16x16x32_bf16 v[252:255], a[156:159], v[44:47], v[252:255]
  s_waitcnt lgkmcnt(4)
  buffer_load_dwordx4 v3, s[12:15], s72 offen offset:1024 lds
  s_getpc_b64 s[98:99]
L_pc3:
  s_sub_u32 s98, s98, L_pc3-L_pc
  s_subb_u32 s99, s99, 0
  global_load_dword v0, v51, s[98:99]
  v_mfma_f32_16x16x32_bf16 v[128:131], a[160:163], v[32:35], v[128:131]
  ds_read_b64_tr_b16 v[44:45], v11 offset:40960
  v_mfma_f32_16x16x32_bf16 v[132:135], a[164:167], v[32:35], v[132:135]
  ds_read_b64_tr_b16 v[46:47], v11 offset:41984
  v_mfma_f32_16x16x32_bf16 v[136:139], a[168:171], v[32:35], v[136:139]
  v_mfma_f32_16x16x32_bf16 v[140:143], a[172:175], v[32:35], v[140:143]
  s_waitcnt lgkmcnt(4)
  buffer_load_dwordx4 a[32:35], v15, s[28:31], s75 offen offset:0 sc1
  v_mfma_f32_16x16x32_bf16 v[128:131], a[176:179], v[36:39], v[128:131]
  ds_read_b64_tr_b16 v[32:33], v10 offset:33024
  v_mfma_f32_16x16x32_bf16 v[132:135], a[180:183], v[36:39], v[132:135]
  ds_read_b64_tr_b16 v[34:35], v10 offset:34048
  v_mfma_f32_16x16x32_bf16 v[136:139], a[184:187], v[36:39], v[136:139]
  v_mfma_f32_16x16x32_bf16 v[140:143], a[188:191], v[36:39], v[140:143]
  s_waitcnt lgkmcnt(4)
  buffer_load_dwordx4 v4, s[12:15], s72 offen offset:2048 lds
  v_mfma_f32_16x16x32_bf16 v[144:147], a[160:163], v[40:43], v[144:147]
  ds_read_b64_tr_b16 v[36:37], v10 offset:41216
  v_mfma_f32_16x16x32_bf16 v[148:151], a[164:167], v[40:43], v[148:151]
  ds_read_b64_tr_b16 v[38:39], v10 offset:42240
  v_mfma_f32_16x16x32_bf16 v[152:155], a[168:171], v[40:43], v[152:155]
  v_mfma_f32_16x16x32_bf16 v[156:159], a[172:175], v[40:43], v[156:159]
  s_waitcnt lgkmcnt(4)
  buffer_load_dwordx4 a[36:39], v48, s[28:31], s75 offen offset:0 sc1
  v_mfma_f32_16x16x32_bf16 v[144:147], a[176:179], v[44:47], v[144:147]
  ds_read_b64_tr_b16 v[40:41], v11 offset:33024
  v_mfma_f32_16x16x32_bf16 v[148:151], a[180:183], v[44:47], v[148:151]
  ds_read_b64_tr_b16 v[42:43], v11 offset:34048
  v_mfma_f32_16x16x32_bf16 v[152:155], a[184:187], v[44:47], v[152:155]
  v_mfma_f32_16x16x32_bf16 v[156:159], a[188:191], v[44:47], v[156:159]
  s_waitcnt lgkmcnt(4)
  buffer_load_dwordx4 v5, s[12:15], s72 offen offset:3072 lds
  v_mfma_f32_16x16x32_bf16 v[160:163], a[160:163], v[32:35], v[160:163]
  ds_read_b64_tr_b16 v[44:45], v11 offset:41216
  v_mfma_f32_16x16x32_bf16 v[164:167], a[164:167], v[32:35], v[164:167]
  ds_read_b64_tr_b16 v[46:47], v11 offset:42240
  v_mfma_f32_16x16x32_bf16 v[168:171], a[168:171], v[32:35], v[168:171]
  v_mfma_f32_16x16x32_bf16 v[172:175], a[172:175], v[32:35], v[172:175]
  s_waitcnt lgkmcnt(4)
  buffer_load_dwordx4 a[40:43], v15, s[28:31], s76 offen offset:0 sc1
  v_mfma_f32_16x16x32_bf16 v[160:163], a[176:179], v[36:39], v[160:163]
  ds_read_b64_tr_b16 v[32:33], v10 offset:33280
  v_mfma_f32_16x16x32_bf16 v[164:167], a[180:183], v[36:39], v[164:167]
  s_add_u32 s71, s71, 1
  s_and_b32 s71, s71, 7
  ds_read_b64_tr_b16 v[34:35], v10 offset:34304
  v_mfma_f32_16x16x32_bf16 v[168:171], a[184:187], v[36:39], v[168:171]
  s_lshr_b32 s72, s77, 1
  s_add_u32 m0, s72, 32768
  s_mul_i32 s72, s71, 229376
  v_mfma_f32_16x16x32_bf16 v[172:175], a[188:191], v[36:39], v[172:175]
  s_waitcnt lgkmcnt(4)
  buffer_load_dwordx4 v29, s[20:23], s72 offen offset:0 lds
  v_mfma_f32_16x16x32_bf16 v[176:179], a[160:163], v[40:43], v[176:179]
  ds_read_b64_tr_b16 v[36:37], v10 offset:41472
  v_mfma_f32_16x16x32_bf16 v[180:183], a[164:167], v[40:43], v[180:183]
  ds_read_b64_tr_b16 v[38:39], v10 offset:42496
  v_mfma_f32_16x16x32_bf16 v[184:187], a[168:171], v[40:43], v[184:187]
  v_mfma_f32_16x16x32_bf16 v[188:191], a[172:175], v[40:43], v[188:191]
  s_waitcnt lgkmcnt(4)
  buffer_load_dwordx4 a[44:47], v48, s[28:31], s76 offen offset:0 sc1
  v_mfma_f32_16x16x32_bf16 v[176:179], a[176:179], v[44:47], v[176:179]
  ds_read_b64_tr_b16 v[40:41], v11 offset:33280
  v_mfma_f32_16x16x32_bf16 v[180:183], a[180:183], v[44:47], v[180:183]
  ds_read_b64_tr_b16 v[42:43], v11 offset:34304
  v_mfma_f32_16x16x32_bf16 v[184:187], a[184:187], v[44:47], v[184:187]
  v_mfma_f32_16x16x32_bf16 v[188:191], a[188:191], v[44:47], v[188:191]
  s_waitcnt lgkmcnt(4)
  buffer_load_dwordx4 v30, s[20:23], s72 offen offset:1024 lds
  v_mfma_f32_16x16x32_bf16 v[192:195], a[160:163], v[32:35], v[192:195]
  ds_read_b64_tr_b16 v[44:45], v11 offset:41472
  v_mfma_f32_16x16x32_bf16 v[196:199], a[164:167], v[32:35], v[196:199]
  ds_read_b64_tr_b16 v[46:47], v11 offset:42496
  v_mfma_f32_16x16x32_bf16 v[200:203], a[168:171], v[32:35], v[200:203]
  v_mfma_f32_16x16x32_bf16 v[204:207], a[172:175], v[32:35], v[204:207]
  s_waitcnt lgkmcnt(4)
  buffer_store_dwordx4 v[108:111], v15, s[36:39], s83 offen offset:3072
  s_add_u32 s83, s79, 4096
  v_mfma_f32_16x16x32_bf16 v[192:195], a[176:179], v[36:39], v[192:195]
  ds_read_b64_tr_b16 v[32:33], v10 offset:33536
  v_mfma_f32_16x16x32_bf16 v[196:199], a[180:183], v[36:39], v[196:199]
  s_add_u32 m0, m0, 8192
  s_add_u32 s71, s71, 1
  ds_read_b64_tr_b16 v[34:35], v10 offset:34560
  v_mfma_f32_16x16x32_bf16 v[200:203], a[184:187], v[36:39], v[200:203]
  v_mfma_f32_16x16x32_bf16 v[204:207], a[188:191], v[36:39], v[204:207]
  s_waitcnt lgkmcnt(4)
  buffer_load_dwordx4 v29, s[24:27], s72 offen offset:0 lds
  v_mfma_f32_16x16x32_bf16 v[208:211], a[160:163], v[40:43], v[208:211]
  ds_read_b64_tr_b16 v[36:37], v10 offset:41728
  v_mfma_f32_16x16x32_bf16 v[212:215], a[164:167], v[40:43], v[212:215]
  ds_read_b64_tr_b16 v[38:39], v10 offset:42752
  v_mfma_f32_16x16x32_bf16 v[216:219], a[168:171], v[40:43], v[216:219]
  v_mfma_f32_16x16x32_bf16 v[220:223], a[172:175], v[40:43], v[220:223]
  s_waitcnt lgkmcnt(4)
  buffer_load_dwordx4 a[48:51], v15, s[28:31], s75 offen offset:1024 sc1
  v_mfma_f32_16x16x32_bf16 v[208:211], a[176:179], v[44:47], v[208:211]
  ds_read_b64_tr_b16 v[40:41], v11 offset:33536
  v_mfma_f32_16x16x32_bf16 v[212:215], a[180:183], v[44:47], v[212:215]
  ds_read_b64_tr_b16 v[42:43], v11 offset:34560
  v_mfma_f32_16x16x32_bf16 v[216:219], a[184:187], v[44:47], v[216:219]
  v_mfma_f32_16x16x32_bf16 v[220:223], a[188:191], v[44:47], v[220:223]
  s_waitcnt lgkmcnt(4)
  buffer_load_dwordx4 v30, s[24:27], s72 offen offset:1024 lds
  v_mfma_f32_16x16x32_bf16 v[224:227], a[160:163], v[32:35], v[224:227]
  ds_read_b64_tr_b16 v[44:45], v11 offset:41728
  v_mfma_f32_16x16x32_bf16 v[228:231], a[164:167], v[32:35], v[228:231]
  ds_read_b64_tr_b16 v[46:47], v11 offset:42752
  v_mfma_f32_16x16x32_bf16 v[232:235], a[168:171], v[32:35], v[232:235]
  v_mfma_f32_16x16x32_bf16 v[236:239], a[172:175], v[32:35], v[236:239]
  s_waitcnt lgkmcnt(4)
  s_waitcnt vmcnt(18)
  s_barrier
  v_mfma_f32_16x16x32_bf16 v[224:227], a[176:179], v[36:39], v[224:227]
  ds_read_b64_tr_b16 v[32:33], v10 offset:49152
  v_mfma_f32_16x16x32_bf16 v[228:231], a[180:183], v[36:39], v[228:231]
  s_and_b32 s71, s71, 7
  s_lshr_b32 s72, s77, 1
  ds_read_b64_tr_b16 v[34:35], v10 offset:50176
  v_mfma_f32_16x16x32_bf16 v[232:235], a[184:187], v[36:39], v[232:235]
  s_add_u32 m0, s72, 98304
  s_mul_i32 s72, s71, 229376
  v_mfma_f32_16x16x32_bf16 v[236:239], a[188:191], v[36:39], v[236:239]
  s_waitcnt lgkmcnt(4)
  buffer_load_dwordx4 v29, s[20:23], s72 offen offset:0 lds
  v_mfma_f32_16x16x32_bf16 v[240:243], a[160:163], v[40:43], v[240:243]
  ds_read_b64_tr_b16 v[36:37], v10 offset:57344
  v_mfma_f32_16x16x32_bf16 v[244:247], a[164:167], v[40:43], v[244:247]
  ds_read_b64_tr_b16 v[38:39], v10 offset:58368
  v_mfma_f32_16x16x32_bf16 v[248:251], a[168:171], v[40:43], v[248:251]
  v_mfma_f32_16x16x32_bf16 v[252:255], a[172:175], v[40:43], v[252:255]
  s_waitcnt lgkmcnt(4)
  buffer_load_dwordx4 a[52:55], v48, s[28:31], s75 offen offset:1024 sc1
  v_mfma_f32_16x16x32_bf16 v[240:243], a[176:179], v[44:47], v[240:243]
  ds_read_b64_tr_b16 v[40:41], v11 offset:49152
  v_mfma_f32_16x16x32_bf16 v[244:247], a[180:183], v[44:47], v[244:247]
  ds_read_b64_tr_b16 v[42:43], v11 offset:50176
  v_mfma_f32_16x16x32_bf16 v[248:251], a[184:187], v[44:47], v[248:251]
  v_mfma_f32_16x16x32_bf16 v[252:255], a[188:191], v[44:47], v[252:255]
  s_waitcnt lgkmcnt(4)
  buffer_load_dwordx4 v30, s[20:23], s72 offen offset:1024 lds
  v_mfma_f32_16x16x32_bf16 v[128:131], a[192:195], v[32:35], v[128:131]
  ds_read_b64_tr_b16 v[44:45], v11 offset:57344
  v_mfma_f32_16x16x32_bf16 v[132:135], a[196:199], v[32:35], v[132:135]
  ds_read_b64_tr_b16 v[46:47], v11 offset:58368
  v_mfma_f32_16x16x32_bf16 v[136:139], a[200:203], v[32:35], v[136:139]
  v_mfma_f32_16x16x32_bf16 v[140:143], a[204:207], v[32:35], v[140:143]
  s_waitcnt lgkmcnt(4)
  buffer_load_dwordx4 a[56:59], v15, s[28:31], s76 offen offset:1024 sc1
  v_mfma_f32_16x16x32_bf16 v[128:131], a[208:211], v[36:39], v[128:131]
  ds_read_b64_tr_b16 v[32:33], v10 offset:49408
  v_mfma_f32_16x16x32_bf16 v[132:135], a[212:215], v[36:39], v[132:135]
  s_add_u32 m0, m0, 8192
  s_add_u32 s71, s71, 1
  ds_read_b64_tr_b16 v[34:35], v10 offset:50432
  v_mfma_f32_16x16x32_bf16 v[136:139], a[216:219], v[36:39], v[136:139]
  v_mfma_f32_16x16x32_bf16 v[140:143], a[220:223], v[36:39], v[140:143]
  s_waitcnt lgkmcnt(4)
  buffer_load_dwordx4 v29, s[24:27], s72 offen offset:0 lds
  v_mfma_f32_16x16x32_bf16 v[144:147], a[192:195], v[40:43], v[144:147]
  ds_read_b64_tr_b16 v[36:37], v10 offset:57600
  v_mfma_f32_16x16x32_bf16 v[148:151], a[196:199], v[40:43], v[148:151]
  ds_read_b64_tr_b16 v[38:39], v10 offset:58624
  v_mfma_f32_16x16x32_bf16 v[152:155], a[200:203], v[40:43], v[152:155]
  v_mfma_f32_16x16x32_bf16 v[156:159], a[204:207], v[40:43], v[156:159]
  s_waitcnt lgkmcnt(4)
  buffer_load_dwordx4 a[60:63], v48, s[28:31], s76 offen offset:1024 sc1
  v_mfma_f32_16x16x32_bf16 v[144:147], a[208:211], v[44:47], v[144:147]
  s_add_u32 s76, s89, 2
  s_and_b32 s76, s76, 7
  ds_read_b64_tr_b16 v[40:41], v11 offset:49408
  v_mfma_f32_16x16x32_bf16 v[148:151], a[212:215], v[44:47], v[148:151]
  s_lshl_b32 s76, s76, 11
  s_add_u32 s75, s76, s81
  ds_read_b64_tr_b16 v[42:43], v11 offset:50432
  v_mfma_f32_16x16x32_bf16 v[152:155], a[216:219], v[44:47], v[152:155]
  s_add_u32 s76, s76, s82
  v_mfma_f32_16x16x32_bf16 v[156:159], a[220:223], v[44:47], v[156:159]
  s_waitcnt lgkmcnt(4)
  buffer_load_dwordx4 v30, s[24:27], s72 offen offset:1024 lds
  v_mfma_f32_16x16x32_bf16 v[160:163], a[192:195], v[32:35], v[160:163]
  ds_read_b64_tr_b16 v[44:45], v11 offset:57600
  v_mfma_f32_16x16x32_bf16 v[164:167], a[196:199], v[32:35], v[164:167]
  ds_read_b64_tr_b16 v[46:47], v11 offset:58624
  v_mfma_f32_16x16x32_bf16 v[168:171], a[200:203], v[32:35], v[168:171]
  v_mfma_f32_16x16x32_bf16 v[172:175], a[204:207], v[32:35], v[172:175]
  s_waitcnt lgkmcnt(4)
  buffer_load_dwordx4 a[64:67], v15, s[28:31], s75 offen offset:0 sc1
  v_mfma_f32_16x16x32_bf16 v[160:163], a[208:211], v[36:39], v[160:163]
  ds_read_b64_tr_b16 v[32:33], v10 offset:49664
  v_mfma_f32_16x16x32_bf16 v[164:167], a[212:215], v[36:39], v[164:167]
  s_and_b32 s71, s71, 7
  s_lshr_b32 s72, s77, 1
  ds_read_b64_tr_b16 v[34:35], v10 offset:50688
  v_mfma_f32_16x16x32_bf16 v[168:171], a[216:219], v[36:39], v[168:171]
  s_add_u32 m0, s72, 49152
  s_mul_i32 s72, s71, 229376
  v_mfma_f32_16x16x32_bf16 v[172:175], a[220:223], v[36:39], v[172:175]
  s_waitcnt lgkmcnt(4)
  buffer_load_dwordx4 v29, s[20:23], s72 offen offset:0 lds
  v_mfma_f32_16x16x32_bf16 v[176:179], a[192:195], v[40:43], v[176:179]
  ds_read_b64_tr_b16 v[36:37], v10 offset:57856
  v_mfma_f32_16x16x32_bf16 v[180:183], a[196:199], v[40:43], v[180:183]
  ds_read_b64_tr_b16 v[38:39], v10 offset:58880
  v_mfma_f32_16x16x32_bf16 v[184:187], a[200:203], v[40:43], v[184:187]
  v_mfma_f32_16x16x32_bf16 v[188:191], a[204:207], v[40:43], v[188:191]
  s_waitcnt lgkmcnt(4)
  buffer_load_dwordx4 a[68:71], v48, s[28:31], s75 offen offset:0 sc1
  v_mfma_f32_16x16x32_bf16 v[176:179], a[208:211], v[44:47], v[176:179]
  ds_read_b64_tr_b16 v[40:41], v11 offset:49664
  v_mfma_f32_16x16x32_bf16 v[180:183], a[212:215], v[44:47], v[180:183]
  ds_read_b64_tr_b16 v[42:43], v11 offset:50688
  v_mfma_f32_16x16x32_bf16 v[184:187], a[216:219], v[44:47], v[184:187]
  v_mfma_f32_16x16x32_bf16 v[188:191], a[220:223], v[44:47], v[188:191]
  s_waitcnt lgkmcnt(4)
  buffer_load_dwordx4 v30, s[20:23], s72 offen offset:1024 lds
  v_mfma_f32_16x16x32_bf16 v[192:195], a[192:195], v[32:35], v[192:195]
  ds_read_b64_tr_b16 v[44:45], v11 offset:57856
  v_mfma_f32_16x16x32_bf16 v[196:199], a[196:199], v[32:35], v[196:199]
  ds_read_b64_tr_b16 v[46:47], v11 offset:58880
  v_mfma_f32_16x16x32_bf16 v[200:203], a[200:203], v[32:35], v[200:203]
  v_mfma_f32_16x16x32_bf16 v[204:207], a[204:207], v[32:35], v[204:207]
  s_waitcnt lgkmcnt(4)
  buffer_load_dwordx4 a[72:75], v15, s[28:31], s76 offen offset:0 sc1
  v_mfma_f32_16x16x32_bf16 v[192:195], a[208:211], v[36:39], v[192:195]
  ds_read_b64_tr_b16 v[32:33], v10 offset:49920
  v_mfma_f32_16x16x32_bf16 v[196:199], a[212:215], v[36:39], v[196:199]
  s_add_u32 m0, m0, 8192
  s_add_u32 s71, s71, 1
  ds_read_b64_tr_b16 v[34:35], v10 offset:50944
  v_mfma_f32_16x16x32_bf16 v[200:203], a[216:219], v[36:39], v[200:203]
  v_mfma_f32_16x16x32_bf16 v[204:207], a[220:223], v[36:39], v[204:207]
  s_waitcnt lgkmcnt(4)
  buffer_load_dwordx4 v29, s[24:27], s72 offen offset:0 lds
  v_mfma_f32_16x16x32_bf16 v[208:211], a[192:195], v[40:43], v[208:211]
  ds_read_b64_tr_b16 v[36:37], v10 offset:58112
  v_mfma_f32_16x16x32_bf16 v[212:215], a[196:199], v[40:43], v[212:215]
  ds_read_b64_tr_b16 v[38:39], v10 offset:59136
  v_mfma_f32_16x16x32_bf16 v[216:219], a[200:203], v[40:43], v[216:219]
  v_mfma_f32_16x16x32_bf16 v[220:223], a[204:207], v[40:43], v[220:223]
  s_waitcnt lgkmcnt(4)
  buffer_load_dwordx4 a[76:79], v48, s[28:31], s76 offen offset:0 sc1
  v_mfma_f32_16x16x32_bf16 v[208:211], a[208:211], v[44:47], v[208:211]
  ds_read_b64_tr_b16 v[40:41], v11 offset:49920
  v_mfma_f32_16x16x32_bf16 v[212:215], a[212:215], v[44:47], v[212:215]
  ds_read_b64_tr_b16 v[42:43], v11 offset:50944
  v_mfma_f32_16x16x32_bf16 v[216:219], a[216:219], v[44:47], v[216:219]
  v_mfma_f32_16x16x32_bf16 v[220:223], a[220:223], v[44:47], v[220:223]
  s_waitcnt lgkmcnt(4)
  buffer_load_dwordx4 v30, s[24:27], s72 offen offset:1024 lds
  v_mfma_f32_16x16x32_bf16 v[224:227], a[192:195], v[32:35], v[224:227]
  ds_read_b64_tr_b16 v[44:45], v11 offset:58112
  v_mfma_f32_16x16x32_bf16 v[228:231], a[196:199], v[32:35], v[228:231]
  ds_read_b64_tr_b16 v[46:47], v11 offset:59136
  v_mfma_f32_16x16x32_bf16 v[232:235], a[200:203], v[32:35], v[232:235]
  v_mfma_f32_16x16x32_bf16 v[236:239], a[204:207], v[32:35], v[236:239]
  s_waitcnt lgkmcnt(4)
  s_waitcnt vmcnt(23)
  s_barrier
  v_mfma_f32_16x16x32_bf16 v[224:227], a[208:211], v[36:39], v[224:227]
  ds_read_b64_tr_b16 v[32:33], v14 offset:16384
  v_mfma_f32_16x16x32_bf16 v[228:231], a[212:215], v[36:39], v[228:231]
  s_and_b32 s71, s71, 7
  s_lshr_b32 s72, s77, 1
  ds_read_b64_tr_b16 v[34:35], v14 offset:17408
  v_mfma_f32_16x16x32_bf16 v[232:235], a[216:219], v[36:39], v[232:235]
  s_add_u32 m0, s72, 114688
  s_mul_i32 s72, s71, 229376
  v_mfma_f32_16x16x32_bf16 v[236:239], a[220:223], v[36:39], v[236:239]
  s_waitcnt lgkmcnt(4)
  buffer_load_dwordx4 v29, s[20:23], s72 offen offset:0 lds
  v_mfma_f32_16x16x32_bf16 v[240:243], a[192:195], v[40:43], v[240:243]
  ds_read_b64_tr_b16 v[36:37], v14 offset:24576
  v_mfma_f32_16x16x32_bf16 v[244:247], a[196:199], v[40:43], v[244:247]
  ds_read_b64_tr_b16 v[38:39], v14 offset:25600
  v_mfma_f32_16x16x32_bf16 v[248:251], a[200:203], v[40:43], v[248:251]
  v_mfma_f32_16x16x32_bf16 v[252:255], a[204:207], v[40:43], v[252:255]
  s_waitcnt lgkmcnt(4)
  buffer_load_dwordx4 a[80:83], v15, s[28:31], s75 offen offset:1024 sc1
  v_mfma_f32_16x16x32_bf16 v[240:243], a[208:211], v[44:47], v[240:243]
  ds_read_b64_tr_b16 v[40:41], v28 offset:16384
  v_mfma_f32_16x16x32_bf16 v[244:247], a[212:215], v[44:47], v[244:247]
  ds_read_b64_tr_b16 v[42:43], v28 offset:17408
  v_mfma_f32_16x16x32_bf16 v[248:251], a[216:219], v[44:47], v[248:251]
  v_mfma_f32_16x16x32_bf16 v[252:255], a[220:223], v[44:47], v[252:255]
  s_waitcnt lgkmcnt(4)
  buffer_load_dwordx4 a[84:87], v48, s[28:31], s75 offen offset:1024 sc1
  v_mfma_f32_16x16x32_bf16 v[128:131], a[224:227], v[32:35], v[128:131]
  ds_read_b64_tr_b16 v[44:45], v28 offset:24576
  v_mfma_f32_16x16x32_bf16 v[132:135], a[228:231], v[32:35], v[132:135]
  ds_read_b64_tr_b16 v[46:47], v28 offset:25600
  v_mfma_f32_16x16x32_bf16 v[136:139], a[232:235], v[32:35], v[136:139]
  v_mfma_f32_16x16x32_bf16 v[140:143], a[236:239], v[32:35], v[140:143]
  s_waitcnt lgkmcnt(4)
  buffer_store_dwordx4 v[80:83], v15, s[36:39], s83 offen offset:0
  v_mfma_f32_16x16x32_bf16 v[128:131], a[240:243], v[36:39], v[128:131]
  ds_read_b64_tr_b16 v[32:33], v14 offset:16640
  v_mfma_f32_16x16x32_bf16 v[132:135], a[244:247], v[36:39], v[132:135]
  ds_read_b64_tr_b16 v[34:35], v14 offset:17664
  v_mfma_f32_16x16x32_bf16 v[136:139], a[248:251], v[36:39], v[136:139]
  v_mfma_f32_16x16x32_bf16 v[140:143], a[252:255], v[36:39], v[140:143]
  s_waitcnt lgkmcnt(4)
  buffer_load_dwordx4 v30, s[20:23], s72 offen offset:1024 lds
  v_mfma_f32_16x16x32_bf16 v[144:147], a[224:227], v[40:43], v[144:147]
  ds_read_b64_tr_b16 v[36:37], v14 offset:24832
  v_mfma_f32_16x16x32_bf16 v[148:151], a[228:231], v[40:43], v[148:151]
  ds_read_b64_tr_b16 v[38:39], v14 offset:25856
  v_mfma_f32_16x16x32_bf16 v[152:155], a[232:235], v[40:43], v[152:155]
  v_cvt_pk_bf16_f32 v64, v128, v129
  v_cvt_pk_bf16_f32 v65, v130, v131
  v_mfma_f32_16x16x32_bf16 v[156:159], a[236:239], v[40:43], v[156:159]
  s_waitcnt lgkmcnt(4)
  v_cvt_pk_bf16_f32 v66, v132, v133
  v_cvt_pk_bf16_f32 v67, v134, v135
  v_mfma_f32_16x16x32_bf16 v[144:147], a[240:243], v[44:47], v[144:147]
  ds_read_b64_tr_b16 v[40:41], v28 offset:16640
  v_cvt_pk_bf16_f32 v96, v136, v137
  v_mfma_f32_16x16x32_bf16 v[148:151], a[244:247], v[44:47], v[148:151]
  ds_read_b64_tr_b16 v[42:43], v28 offset:17664
  v_cvt_pk_bf16_f32 v97, v138, v139
  v_mfma_f32_16x16x32_bf16 v[152:155], a[248:251], v[44:47], v[152:155]
  v_cvt_pk_bf16_f32 v98, v140, v141
  v_cvt_pk_bf16_f32 v99, v142, v143
  v_mfma_f32_16x16x32_bf16 v[156:159], a[252:255], v[44:47], v[156:159]
  s_waitcnt lgkmcnt(4)
  buffer_load_dwordx4 a[88:91], v15, s[28:31], s76 offen offset:1024 sc1
  v_mfma_f32_16x16x32_bf16 v[160:163], a[224:227], v[32:35], v[160:163]
  ds_read_b64_tr_b16 v[44:45], v28 offset:24832
  v_mfma_f32_16x16x32_bf16 v[164:167], a[228:231], v[32:35], v[164:167]
  ds_read_b64_tr_b16 v[46:47], v28 offset:25856
  v_mfma_f32_16x16x32_bf16 v[168:171], a[232:235], v[32:35], v[168:171]
  v_cvt_pk_bf16_f32 v68, v144, v145
  v_cvt_pk_bf16_f32 v69, v146, v147
  v_mfma_f32_16x16x32_bf16 v[172:175], a[236:239], v[32:35], v[172:175]
  s_waitcnt lgkmcnt(4)
  v_cvt_pk_bf16_f32 v70, v148, v149
  v_cvt_pk_bf16_f32 v71, v150, v151
  v_mfma_f32_16x16x32_bf16 v[160:163], a[240:243], v[36:39], v[160:163]
  ds_read_b64_tr_b16 v[32:33], v14 offset:16896
  v_cvt_pk_bf16_f32 v100, v152, v153
  v_mfma_f32_16x16x32_bf16 v[164:167], a[244:247], v[36:39], v[164:167]
  s_add_u32 m0, m0, 8192
  ds_read_b64_tr_b16 v[34:35], v14 offset:17920
  v_cvt_pk_bf16_f32 v101, v154, v155
  v_mfma_f32_16x16x32_bf16 v[168:171], a[248:251], v[36:39], v[168:171]
  s_add_u32 s71, s71, 1
  v_cvt_pk_bf16_f32 v102, v156, v157
  v_cvt_pk_bf16_f32 v103, v158, v159
  v_mfma_f32_16x16x32_bf16 v[172:175], a[252:255], v[36:39], v[172:175]
  s_waitcnt lgkmcnt(4)
  buffer_load_dwordx4 v29, s[24:27], s72 offen offset:0 lds
  v_mfma_f32_16x16x32_bf16 v[176:179], a[224:227], v[40:43], v[176:179]
  ds_read_b64_tr_b16 v[36:37], v14 offset:25088
  v_mfma_f32_16x16x32_bf16 v[180:183], a[228:231], v[40:43], v[180:183]
  ds_read_b64_tr_b16 v[38:39], v14 offset:26112
  v_mfma_f32_16x16x32_bf16 v[184:187], a[232:235], v[40:43], v[184:187]
  v_cvt_pk_bf16_f32 v72, v160, v161
  v_cvt_pk_bf16_f32 v73, v162, v163
  v_mfma_f32_16x16x32_bf16 v[188:191], a[236:239], v[40:43], v[188:191]
  s_waitcnt lgkmcnt(4)
  v_cvt_pk_bf16_f32 v74, v164, v165
  v_cvt_pk_bf16_f32 v75, v166, v167
  v_mfma_f32_16x16x32_bf16 v[176:179], a[240:243], v[44:47], v[176:179]
  ds_read_b64_tr_b16 v[40:41], v28 offset:16896
  v_cvt_pk_bf16_f32 v104, v168, v169
  v_mfma_f32_16x16x32_bf16 v[180:183], a[244:247], v[44:47], v[180:183]
  ds_read_b64_tr_b16 v[42:43], v28 offset:17920
  v_cvt_pk_bf16_f32 v105, v170, v171
  v_mfma_f32_16x16x32_bf16 v[184:187], a[248:251], v[44:47], v[184:187]
  buffer_store_dwordx4 v[84:87], v15, s[36:39], s83 offen offset:1024
  buffer_store_dwordx4 v[88:91], v15, s[36:39], s83 offen offset:2048
  buffer_store_dwordx4 v[92:95], v15, s[36:39], s83 offen offset:3072
  s_add_u32 s83, s79, 12288
  buffer_store_dwordx4 v[112:115], v15, s[36:39], s83 offen offset:0
  buffer_store_dwordx4 v[116:119], v15, s[36:39], s83 offen offset:1024
  buffer_store_dwordx4 v[120:123], v15, s[36:39], s83 offen offset:2048
  buffer_store_dwordx4 v[124:127], v15, s[36:39], s83 offen offset:3072
  v_cvt_pk_bf16_f32 v106, v172, v173
  v_cvt_pk_bf16_f32 v107, v174, v175
  v_mfma_f32_16x16x32_bf16 v[188:191], a[252:255], v[44:47], v[188:191]
  s_waitcnt lgkmcnt(4)
  v_mfma_f32_16x16x32_bf16 v[192:195], a[224:227], v[32:35], v[192:195]
  ds_read_b64_tr_b16 v[44:45], v28 offset:25088
  v_mfma_f32_16x16x32_bf16 v[196:199], a[228:231], v[32:35], v[196:199]
  ds_read_b64_tr_b16 v[46:47], v28 offset:26112
  v_mfma_f32_16x16x32_bf16 v[200:203], a[232:235], v[32:35], v[200:203]
  v_cvt_pk_bf16_f32 v76, v176, v177
  v_cvt_pk_bf16_f32 v77, v178, v179
  v_mfma_f32_16x16x32_bf16 v[204:207], a[236:239], v[32:35], v[204:207]
  s_waitcnt lgkmcnt(4)
  v_cvt_pk_bf16_f32 v78, v180, v181
  v_cvt_pk_bf16_f32 v79, v182, v183
  v_mfma_f32_16x16x32_bf16 v[192:195], a[240:243], v[36:39], v[192:195]
  ds_read_b64_tr_b16 v[32:33], v14 offset:17152
  v_cvt_pk_bf16_f32 v108, v184, v185
  v_mfma_f32_16x16x32_bf16 v[196:199], a[244:247], v[36:39], v[196:199]
  ds_read_b64_tr_b16 v[34:35], v14 offset:18176
  v_cvt_pk_bf16_f32 v109, v186, v187
  v_mfma_f32_16x16x32_bf16 v[200:203], a[248:251], v[36:39], v[200:203]
  v_cvt_pk_bf16_f32 v110, v188, v189
  v_cvt_pk_bf16_f32 v111, v190, v191
  v_mfma_f32_16x16x32_bf16 v[204:207], a[252:255], v[36:39], v[204:207]
  s_waitcnt lgkmcnt(4)
  buffer_load_dwordx4 v30, s[24:27], s72 offen offset:1024 lds
  v_mfma_f32_16x16x32_bf16 v[208:211], a[224:227], v[40:43], v[208:211]
  ds_read_b64_tr_b16 v[36:37], v14 offset:25344
  v_mfma_f32_16x16x32_bf16 v[212:215], a[228:231], v[40:43], v[212:215]
  ds_read_b64_tr_b16 v[38:39], v14 offset:26368
  v_mfma_f32_16x16x32_bf16 v[216:219], a[232:235], v[40:43], v[216:219]
  v_cvt_pk_bf16_f32 v80, v192, v193
  v_cvt_pk_bf16_f32 v81, v194, v195
  v_mfma_f32_16x16x32_bf16 v[220:223], a[236:239], v[40:43], v[220:223]
  s_waitcnt lgkmcnt(4)
  v_cvt_pk_bf16_f32 v82, v196, v197
  v_cvt_pk_bf16_f32 v83, v198, v199
  v_mfma_f32_16x16x32_bf16 v[208:211], a[240:243], v[44:47], v[208:211]
  ds_read_b64_tr_b16 v[40:41], v28 offset:17152
  v_cvt_pk_bf16_f32 v112, v200, v201
  v_mfma_f32_16x16x32_bf16 v[212:215], a[244:247], v[44:47], v[212:215]
  ds_read_b64_tr_b16 v[42:43], v28 offset:18176
  v_cvt_pk_bf16_f32 v113, v202, v203
  v_mfma_f32_16x16x32_bf16 v[216:219], a[248:251], v[44:47], v[216:219]
  v_cvt_pk_bf16_f32 v114, v204, v205
  v_cvt_pk_bf16_f32 v115, v206, v207
  v_mfma_f32_16x16x32_bf16 v[220:223], a[252:255], v[44:47], v[220:223]
  s_waitcnt lgkmcnt(4)
  buffer_load_dwordx4 a[92:95], v48, s[28:31], s76 offen offset:1024 sc1
  s_add_u32 s76, s89, 3
  v_mfma_f32_16x16x32_bf16 v[224:227], a[224:227], v[32:35], v[224:227]
  s_and_b32 s76, s76, 7
  s_lshl_b32 s76, s76, 11
  ds_read_b64_tr_b16 v[44:45], v28 offset:25344
  v_mfma_f32_16x16x32_bf16 v[228:231], a[228:231], v[32:35], v[228:231]
  s_add_u32 s75, s76, s81
  s_add_u32 s76, s76, s82
  ds_read_b64_tr_b16 v[46:47], v28 offset:26368
  v_mfma_f32_16x16x32_bf16 v[232:235], a[232:235], v[32:35], v[232:235]
  v_cvt_pk_bf16_f32 v84, v208, v209
  v_cvt_pk_bf16_f32 v85, v210, v211
  v_mfma_f32_16x16x32_bf16 v[236:239], a[236:239], v[32:35], v[236:239]
  s_waitcnt lgkmcnt(4)
  s_waitcnt vmcnt(31)
  s_barrier
  v_sub_u32 v12, v12, v59
  v_sub_u32 v13, v13, v59
  v_mfma_f32_16x16x32_bf16 v[224:227], a[240:243], v[36:39], v[224:227]
  ds_read_b64_tr_b16 v[32:33], v12 offset:32768
  v_cvt_pk_bf16_f32 v86, v212, v213
  v_mfma_f32_16x16x32_bf16 v[228:231], a[244:247], v[36:39], v[228:231]
  s_and_b32 s71, s71, 7
  ds_read_b64_tr_b16 v[34:35], v12 offset:33280
  v_cvt_pk_bf16_f32 v87, v214, v215
  v_mfma_f32_16x16x32_bf16 v[232:235], a[248:251], v[36:39], v[232:235]
  s_lshr_b32 s72, s77, 1
  v_cvt_pk_bf16_f32 v116, v216, v217
  v_cvt_pk_bf16_f32 v117, v218, v219
  v_mfma_f32_16x16x32_bf16 v[236:239], a[252:255], v[36:39], v[236:239]
  s_waitcnt lgkmcnt(4)
  v_cvt_pk_bf16_f32 v118, v220, v221
  v_cvt_pk_bf16_f32 v119, v222, v223
  v_mfma_f32_16x16x32_bf16 v[240:243], a[224:227], v[40:43], v[240:243]
  s_add_u32 m0, s72, 131072
  s_mul_i32 s72, s71, 229376
  ds_read_b64_tr_b16 v[36:37], v12 offset:36864
  v_mfma_f32_16x16x32_bf16 v[244:247], a[228:231], v[40:43], v[244:247]
  ds_read_b64_tr_b16 v[38:39], v12 offset:37376
  v_sub_u32 v10, v10, v59
  v_mfma_f32_16x16x32_bf16 v[248:251], a[232:235], v[40:43], v[248:251]
  v_cvt_pk_bf16_f32 v88, v224, v225
  v_cvt_pk_bf16_f32 v89, v226, v227
  v_mfma_f32_16x16x32_bf16 v[252:255], a[236:239], v[40:43], v[252:255]
  s_waitcnt lgkmcnt(4)
  v_cvt_pk_bf16_f32 v90, v228, v229
  v_cvt_pk_bf16_f32 v91, v230, v231
  v_mfma_f32_16x16x32_bf16 v[240:243], a[240:243], v[44:47], v[240:243]
  ds_read_b64_tr_b16 v[40:41], v12 offset:40960
  v_cvt_pk_bf16_f32 v120, v232, v233
  v_mfma_f32_16x16x32_bf16 v[244:247], a[244:247], v[44:47], v[244:247]
  ds_read_b64_tr_b16 v[42:43], v12 offset:41472
  v_cvt_pk_bf16_f32 v121, v234, v235
  v_mfma_f32_16x16x32_bf16 v[248:251], a[248:251], v[44:47], v[248:251]
  v_cvt_pk_bf16_f32 v122, v236, v237
  v_cvt_pk_bf16_f32 v123, v238, v239
  v_mfma_f32_16x16x32_bf16 v[252:255], a[252:255], v[44:47], v[252:255]
  s_waitcnt lgkmcnt(4)
  buffer_load_dwordx4 v29, s[20:23], s72 offen offset:0 lds
  v_sub_u32 v11, v11, v59
  v_mfma_f32_16x16x32_bf16 v[128:131], v[32:35], a[0:3], 0
  ds_read_b64_tr_b16 v[44:45], v12 offset:45056
  v_sub_u32 v14, v14, v59
  v_mfma_f32_16x16x32_bf16 v[132:135], v[32:35], a[4:7], 0
  ds_read_b64_tr_b16 v[46:47], v12 offset:45568
  v_sub_u32 v28, v28, v59
  v_mfma_f32_16x16x32_bf16 v[136:139], v[32:35], a[8:11], 0
  v_cvt_pk_bf16_f32 v92, v240, v241
  v_cvt_pk_bf16_f32 v93, v242, v243
  v_mfma_f32_16x16x32_bf16 v[140:143], v[32:35], a[12:15], 0
  s_waitcnt lgkmcnt(4)
  v_cvt_pk_bf16_f32 v94, v244, v245
  v_cvt_pk_bf16_f32 v95, v246, v247
  v_mfma_f32_16x16x32_bf16 v[128:131], v[36:39], a[16:19], v[128:131]
  ds_read_b64_tr_b16 v[32:33], v13 offset:32768
  v_cvt_pk_bf16_f32 v124, v248, v249
  v_mfma_f32_16x16x32_bf16 v[132:135], v[36:39], a[20:23], v[132:135]
  ds_read_b64_tr_b16 v[34:35], v13 offset:33280
  v_cvt_pk_bf16_f32 v125, v250, v251
  v_mfma_f32_16x16x32_bf16 v[136:139], v[36:39], a[24:27], v[136:139]
  v_cvt_pk_bf16_f32 v126, v252, v253
  v_cvt_pk_bf16_f32 v127, v254, v255
  v_mfma_f32_16x16x32_bf16 v[140:143], v[36:39], a[28:31], v[140:143]
  s_waitcnt lgkmcnt(4)
  buffer_load_dwordx4 v30, s[20:23], s72 offen offset:1024 lds
  v_mfma_f32_16x16x32_bf16 v[144:147], v[40:43], a[0:3], 0
  ds_read_b64_tr_b16 v[36:37], v13 offset:36864
  v_mfma_f32_16x16x32_bf16 v[148:151], v[40:43], a[4:7], 0
  ds_read_b64_tr_b16 v[38:39], v13 offset:37376
  v_mfma_f32_16x16x32_bf16 v[152:155], v[40:43], a[8:11], 0
  v_mfma_f32_16x16x32_bf16 v[156:159], v[40:43], a[12:15], 0
  s_waitcnt lgkmcnt(4)
  buffer_load_dwordx4 a[96:99], v15, s[28:31], s75 offen offset:0 sc1
  v_mfma_f32_16x16x32_bf16 v[144:147], v[44:47], a[16:19], v[144:147]
  ds_read_b64_tr_b16 v[40:41], v13 offset:40960
  v_mfma_f32_16x16x32_bf16 v[148:151], v[44:47], a[20:23], v[148:151]
  ds_read_b64_tr_b16 v[42:43], v13 offset:41472
  v_mfma_f32_16x16x32_bf16 v[152:155], v[44:47], a[24:27], v[152:155]
  v_mfma_f32_16x16x32_bf16 v[156:159], v[44:47], a[28:31], v[156:159]
  s_waitcnt lgkmcnt(4)
  buffer_load_dwordx4 a[100:103], v48, s[28:31], s75 offen offset:0 sc1
  v_mfma_f32_16x16x32_bf16 v[160:163], v[32:35], a[0:3], 0
  ds_read_b64_tr_b16 v[44:45], v13 offset:45056
  v_mfma_f32_16x16x32_bf16 v[164:167], v[32:35], a[4:7], 0
  ds_read_b64_tr_b16 v[46:47], v13 offset:45568
  v_mfma_f32_16x16x32_bf16 v[168:171], v[32:35], a[8:11], 0
  v_mfma_f32_16x16x32_bf16 v[172:175], v[32:35], a[12:15], 0
  s_waitcnt lgkmcnt(4)
  buffer_load_dwordx4 a[104:107], v15, s[28:31], s76 offen offset:0 sc1
  v_mfma_f32_16x16x32_bf16 v[160:163], v[36:39], a[16:19], v[160:163]
  ds_read_b64_tr_b16 v[32:33], v12 offset:33024
  v_mfma_f32_16x16x32_bf16 v[164:167], v[36:39], a[20:23], v[164:167]
  s_add_u32 m0, m0, 8192
  s_add_u32 s71, s71, 1
  ds_read_b64_tr_b16 v[34:35], v12 offset:33536
  v_mfma_f32_16x16x32_bf16 v[168:171], v[36:39], a[24:27], v[168:171]
  v_mfma_f32_16x16x32_bf16 v[172:175], v[36:39], a[28:31], v[172:175]
  s_waitcnt lgkmcnt(4)
  buffer_load_dwordx4 v29, s[24:27], s72 offen offset:0 lds
  v_mfma_f32_16x16x32_bf16 v[176:179], v[40:43], a[0:3], 0
  ds_read_b64_tr_b16 v[36:37], v12 offset:37120
  v_mfma_f32_16x16x32_bf16 v[180:183], v[40:43], a[4:7], 0
  ds_read_b64_tr_b16 v[38:39], v12 offset:37632
  v_mfma_f32_16x16x32_bf16 v[184:187], v[40:43], a[8:11], 0
  v_mfma_f32_16x16x32_bf16 v[188:191], v[40:43], a[12:15], 0
  s_waitcnt lgkmcnt(4)
  buffer_load_dwordx4 a[108:111], v48, s[28:31], s76 offen offset:0 sc1
  v_mfma_f32_16x16x32_bf16 v[176:179], v[44:47], a[16:19], v[176:179]
  ds_read_b64_tr_b16 v[40:41], v12 offset:41216
  v_mfma_f32_16x16x32_bf16 v[180:183], v[44:47], a[20:23], v[180:183]
  ds_read_b64_tr_b16 v[42:43], v12 offset:41728
  v_mfma_f32_16x16x32_bf16 v[184:187], v[44:47], a[24:27], v[184:187]
  v_mfma_f32_16x16x32_bf16 v[188:191], v[44:47], a[28:31], v[188:191]
  s_waitcnt lgkmcnt(4)
  buffer_load_dwordx4 a[112:115], v15, s[28:31], s75 offen offset:1024 sc1
  v_mfma_f32_16x16x32_bf16 v[192:195], v[32:35], a[0:3], 0
  ds_read_b64_tr_b16 v[44:45], v12 offset:45312
  v_mfma_f32_16x16x32_bf16 v[196:199], v[32:35], a[4:7], 0
  ds_read_b64_tr_b16 v[46:47], v12 offset:45824
  v_mfma_f32_16x16x32_bf16 v[200:203], v[32:35], a[8:11], 0
  v_mfma_f32_16x16x32_bf16 v[204:207], v[32:35], a[12:15], 0
  s_waitcnt lgkmcnt(4)
  buffer_load_dwordx4 a[116:119], v48, s[28:31], s75 offen offset:1024 sc1
  v_mfma_f32_16x16x32_bf16 v[192:195], v[36:39], a[16:19], v[192:195]
  ds_read_b64_tr_b16 v[32:33], v13 offset:33024
  v_mfma_f32_16x16x32_bf16 v[196:199], v[36:39], a[20:23], v[196:199]
  ds_read_b64_tr_b16 v[34:35], v13 offset:33536
  v_mfma_f32_16x16x32_bf16 v[200:203], v[36:39], a[24:27], v[200:203]
  v_mfma_f32_16x16x32_bf16 v[204:207], v[36:39], a[28:31], v[204:207]
  s_waitcnt lgkmcnt(4)
  buffer_load_dwordx4 v30, s[24:27], s72 offen offset:1024 lds
  v_mfma_f32_16x16x32_bf16 v[208:211], v[40:43], a[0:3], 0
  ds_read_b64_tr_b16 v[36:37], v13 offset:37120
  v_mfma_f32_16x16x32_bf16 v[212:215], v[40:43], a[4:7], 0
  ds_read_b64_tr_b16 v[38:39], v13 offset:37632
  v_mfma_f32_16x16x32_bf16 v[216:219], v[40:43], a[8:11], 0
  v_mfma_f32_16x16x32_bf16 v[220:223], v[40:43], a[12:15], 0
  s_waitcnt lgkmcnt(4)
  buffer_load_dwordx4 a[120:123], v15, s[28:31], s76 offen offset:1024 sc1
  v_mfma_f32_16x16x32_bf16 v[208:211], v[44:47], a[16:19], v[208:211]
  ds_read_b64_tr_b16 v[40:41], v13 offset:41216
  v_mfma_f32_16x16x32_bf16 v[212:215], v[44:47], a[20:23], v[212:215]
  ds_read_b64_tr_b16 v[42:43], v13 offset:41728
  v_mfma_f32_16x16x32_bf16 v[216:219], v[44:47], a[24:27], v[216:219]
  v_mfma_f32_16x16x32_bf16 v[220:223], v[44:47], a[28:31], v[220:223]
  s_waitcnt lgkmcnt(4)
  buffer_load_dwordx4 a[124:127], v48, s[28:31], s76 offen offset:1024 sc1
  s_add_u32 s76, s89, 4
  v_mfma_f32_16x16x32_bf16 v[224:227], v[32:35], a[0:3], 0
  s_and_b32 s76, s76, 7
  s_lshl_b32 s76, s76, 11
  ds_read_b64_tr_b16 v[44:45], v13 offset:45312
  v_mfma_f32_16x16x32_bf16 v[228:231], v[32:35], a[4:7], 0
  s_add_u32 s75, s76, s81
  s_add_u32 s76, s76, s82
  ds_read_b64_tr_b16 v[46:47], v13 offset:45824
  v_mfma_f32_16x16x32_bf16 v[232:235], v[32:35], a[8:11], 0
  v_mfma_f32_16x16x32_bf16 v[236:239], v[32:35], a[12:15], 0
  s_waitcnt lgkmcnt(4)
  s_waitcnt vmcnt(36)
  s_barrier
  v_mfma_f32_16x16x32_bf16 v[224:227], v[36:39], a[16:19], v[224:227]
  ds_read_b64_tr_b16 v[32:33], v10 offset:0
  v_mfma_f32_16x16x32_bf16 v[228:231], v[36:39], a[20:23], v[228:231]
  s_and_b32 s71, s71, 7
  s_lshr_b32 s72, s77, 1
  ds_read_b64_tr_b16 v[34:35], v10 offset:512
  v_mfma_f32_16x16x32_bf16 v[232:235], v[36:39], a[24:27], v[232:235]
  s_add_u32 m0, s72, 147456
  s_mul_i32 s72, s71, 229376
  v_mfma_f32_16x16x32_bf16 v[236:239], v[36:39], a[28:31], v[236:239]
  s_waitcnt lgkmcnt(4)
  buffer_load_dwordx4 v29, s[20:23], s72 offen offset:0 lds
  v_mfma_f32_16x16x32_bf16 v[240:243], v[40:43], a[0:3], 0
  ds_read_b64_tr_b16 v[36:37], v10 offset:4096
  v_mfma_f32_16x16x32_bf16 v[244:247], v[40:43], a[4:7], 0
  ds_read_b64_tr_b16 v[38:39], v10 offset:4608
  v_mfma_f32_16x16x32_bf16 v[248:251], v[40:43], a[8:11], 0
  v_mfma_f32_16x16x32_bf16 v[252:255], v[40:43], a[12:15], 0
  s_waitcnt lgkmcnt(4)
  buffer_load_dwordx4 a[128:131], v15, s[28:31], s75 offen offset:0 sc1
  v_mfma_f32_16x16x32_bf16 v[240:243], v[44:47], a[16:19], v[240:243]
  ds_read_b64_tr_b16 v[40:41], v10 offset:8192
  v_mfma_f32_16x16x32_bf16 v[244:247], v[44:47], a[20:23], v[244:247]
  ds_read_b64_tr_b16 v[42:43], v10 offset:8704
  v_mfma_f32_16x16x32_bf16 v[248:251], v[44:47], a[24:27], v[248:251]
  v_mfma_f32_16x16x32_bf16 v[252:255], v[44:47], a[28:31], v[252:255]
  s_waitcnt lgkmcnt(4)
  buffer_load_dwordx4 a[132:135], v48, s[28:31], s75 offen offset:0 sc1
  s_getpc_b64 s[98:99]
L_pc4:
  s_sub_u32 s98, s98, L_pc4-L_pc
  s_subb_u32 s99, s99, 0
  global_load_dword v0, v51, s[98:99]
  v_mfma_f32_16x16x32_bf16 v[128:131], v[32:35], a[32:35], v[128:131]
  ds_read_b64_tr_b16 v[44:45], v10 offset:12288
  v_mfma_f32_16x16x32_bf16 v[132:135], v[32:35], a[36:39], v[132:135]
  ds_read_b64_tr_b16 v[46:47], v10 offset:12800
  v_mfma_f32_16x16x32_bf16 v[136:139], v[32:35], a[40:43], v[136:139]
  v_mfma_f32_16x16x32_bf16 v[140:143], v[32:35], a[44:47], v[140:143]
  s_waitcnt lgkmcnt(4)
  buffer_load_dwordx4 a[136:139], v15, s[28:31], s76 offen offset:0 sc1
  v_mfma_f32_16x16x32_bf16 v[128:131], v[36:39], a[48:51], v[128:131]
  ds_read_b64_tr_b16 v[32:33], v11 offset:0
  v_mfma_f32_16x16x32_bf16 v[132:135], v[36:39], a[52:55], v[132:135]
  ds_read_b64_tr_b16 v[34:35], v11 offset:512
  v_mfma_f32_16x16x32_bf16 v[136:139], v[36:39], a[56:59], v[136:139]
  v_mfma_f32_16x16x32_bf16 v[140:143], v[36:39], a[60:63], v[140:143]
  s_waitcnt lgkmcnt(4)
  buffer_load_dwordx4 v30, s[20:23], s72 offen offset:1024 lds
  v_mfma_f32_16x16x32_bf16 v[144:147], v[40:43], a[32:35], v[144:147]
  ds_read_b64_tr_b16 v[36:37], v11 offset:4096
  v_mfma_f32_16x16x32_bf16 v[148:151], v[40:43], a[36:39], v[148:151]
  ds_read_b64_tr_b16 v[38:39], v11 offset:4608
  v_mfma_f32_16x16x32_bf16 v[152:155], v[40:43], a[40:43], v[152:155]
  v_mfma_f32_16x16x32_bf16 v[156:159], v[40:43], a[44:47], v[156:159]
  s_waitcnt lgkmcnt(4)
  buffer_load_dwordx4 a[140:143], v48, s[28:31], s76 offen offset:0 sc1
  v_mfma_f32_16x16x32_bf16 v[144:147], v[44:47], a[48:51], v[144:147]
  ds_read_b64_tr_b16 v[40:41], v11 offset:8192
  v_mfma_f32_16x16x32_bf16 v[148:151], v[44:47], a[52:55], v[148:151]
  ds_read_b64_tr_b16 v[42:43], v11 offset:8704
  v_mfma_f32_16x16x32_bf16 v[152:155], v[44:47], a[56:59], v[152:155]
  v_mfma_f32_16x16x32_bf16 v[156:159], v[44:47], a[60:63], v[156:159]
  s_waitcnt lgkmcnt(4)
  v_mfma_f32_16x16x32_bf16 v[160:163], v[32:35], a[32:35], v[160:163]
  ds_read_b64_tr_b16 v[44:45], v11 offset:12288
  v_mfma_f32_16x16x32_bf16 v[164:167], v[32:35], a[36:39], v[164:167]
  ds_read_b64_tr_b16 v[46:47], v11 offset:12800
  v_mfma_f32_16x16x32_bf16 v[168:171], v[32:35], a[40:43], v[168:171]
  v_mfma_f32_16x16x32_bf16 v[172:175], v[32:35], a[44:47], v[172:175]
  s_waitcnt lgkmcnt(4)
  v_mfma_f32_16x16x32_bf16 v[160:163], v[36:39], a[48:51], v[160:163]
  ds_read_b64_tr_b16 v[32:33], v10 offset:256
  v_mfma_f32_16x16x32_bf16 v[164:167], v[36:39], a[52:55], v[164:167]
  s_add_u32 m0, m0, 8192
  s_add_u32 s71, s71, 1
  ds_read_b64_tr_b16 v[34:35], v10 offset:768
  v_mfma_f32_16x16x32_bf16 v[168:171], v[36:39], a[56:59], v[168:171]
  v_mfma_f32_16x16x32_bf16 v[172:175], v[36:39], a[60:63], v[172:175]
  s_waitcnt lgkmcnt(4)
  buffer_load_dwordx4 v29, s[24:27], s72 offen offset:0 lds
  v_mfma_f32_16x16x32_bf16 v[176:179], v[40:43], a[32:35], v[176:179]
  ds_read_b64_tr_b16 v[36:37], v10 offset:4352
  v_mfma_f32_16x16x32_bf16 v[180:183], v[40:43], a[36:39], v[180:183]
  ds_read_b64_tr_b16 v[38:39], v10 offset:4864
  v_mfma_f32_16x16x32_bf16 v[184:187], v[40:43], a[40:43], v[184:187]
  v_mfma_f32_16x16x32_bf16 v[188:191], v[40:43], a[44:47], v[188:191]
  s_waitcnt lgkmcnt(4)
  buffer_load_dwordx4 a[144:147], v15, s[28:31], s75 offen offset:1024 sc1
  v_mfma_f32_16x16x32_bf16 v[176:179], v[44:47], a[48:51], v[176:179]
  ds_read_b64_tr_b16 v[40:41], v10 offset:8448
  v_mfma_f32_16x16x32_bf16 v[180:183], v[44:47], a[52:55], v[180:183]
  ds_read_b64_tr_b16 v[42:43], v10 offset:8960
  v_mfma_f32_16x16x32_bf16 v[184:187], v[44:47], a[56:59], v[184:187]
  v_mfma_f32_16x16x32_bf16 v[188:191], v[44:47], a[60:63], v[188:191]
  s_waitcnt lgkmcnt(4)
  buffer_load_dwordx4 a[148:151], v48, s[28:31], s75 offen offset:1024 sc1
  v_mfma_f32_16x16x32_bf16 v[192:195], v[32:35], a[32:35], v[192:195]
  ds_read_b64_tr_b16 v[44:45], v10 offset:12544
  v_mfma_f32_16x16x32_bf16 v[196:199], v[32:35], a[36:39], v[196:199]
  ds_read_b64_tr_b16 v[46:47], v10 offset:13056
  v_mfma_f32_16x16x32_bf16 v[200:203], v[32:35], a[40:43], v[200:203]
  v_mfma_f32_16x16x32_bf16 v[204:207], v[32:35], a[44:47], v[204:207]
  s_waitcnt lgkmcnt(4)
  v_mfma_f32_16x16x32_bf16 v[192:195], v[36:39], a[48:51], v[192:195]
  ds_read_b64_tr_b16 v[32:33], v11 offset:256
  v_mfma_f32_16x16x32_bf16 v[196:199], v[36:39], a[52:55], v[196:199]
  ds_read_b64_tr_b16 v[34:35], v11 offset:768
  v_mfma_f32_16x16x32_bf16 v[200:203], v[36:39], a[56:59], v[200:203]
  v_mfma_f32_16x16x32_bf16 v[204:207], v[36:39], a[60:63], v[204:207]
  s_waitcnt lgkmcnt(4)
  buffer_load_dwordx4 v30, s[24:27], s72 offen offset:1024 lds
  v_mfma_f32_16x16x32_bf16 v[208:211], v[40:43], a[32:35], v[208:211]
  ds_read_b64_tr_b16 v[36:37], v11 offset:4352
  v_mfma_f32_16x16x32_bf16 v[212:215], v[40:43], a[36:39], v[212:215]
  ds_read_b64_tr_b16 v[38:39], v11 offset:4864
  v_mfma_f32_16x16x32_bf16 v[216:219], v[40:43], a[40:43], v[216:219]
  v_mfma_f32_16x16x32_bf16 v[220:223], v[40:43], a[44:47], v[220:223]
  s_waitcnt lgkmcnt(4)
  buffer_load_dwordx4 a[152:155], v15, s[28:31], s76 offen offset:1024 sc1
  v_mfma_f32_16x16x32_bf16 v[208:211], v[44:47], a[48:51], v[208:211]
  ds_read_b64_tr_b16 v[40:41], v11 offset:8448
  v_mfma_f32_16x16x32_bf16 v[212:215], v[44:47], a[52:55], v[212:215]
  ds_read_b64_tr_b16 v[42:43], v11 offset:8960
  v_mfma_f32_16x16x32_bf16 v[216:219], v[44:47], a[56:59], v[216:219]
  v_mfma_f32_16x16x32_bf16 v[220:223], v[44:47], a[60:63], v[220:223]
  s_waitcnt lgkmcnt(4)
  v_mfma_f32_16x16x32_bf16 v[224:227], v[32:35], a[32:35], v[224:227]
  ds_read_b64_tr_b16 v[44:45], v11 offset:12544
  v_mfma_f32_16x16x32_bf16 v[228:231], v[32:35], a[36:39], v[228:231]
  ds_read_b64_tr_b16 v[46:47], v11 offset:13056
  v_mfma_f32_16x16x32_bf16 v[232:235], v[32:35], a[40:43], v[232:235]
  v_mfma_f32_16x16x32_bf16 v[236:239], v[32:35], a[44:47], v[236:239]
  s_waitcnt lgkmcnt(4)
  s_waitcnt vmcnt(40)
  s_barrier
  v_mfma_f32_16x16x32_bf16 v[224:227], v[36:39], a[48:51], v[224:227]
  ds_read_b64_tr_b16 v[32:33], v12 offset:49152
  v_mfma_f32_16x16x32_bf16 v[228:231], v[36:39], a[52:55], v[228:231]
  s_and_b32 s71, s71, 7
  s_lshr_b32 s72, s77, 1
  ds_read_b64_tr_b16 v[34:35], v12 offset:49664
  v_mfma_f32_16x16x32_bf16 v[232:235], v[36:39], a[56:59], v[232:235]
  s_add_u32 m0, s72, 0
  s_mul_i32 s72, s71, 229376
  v_mfma_f32_16x16x32_bf16 v[236:239], v[36:39], a[60:63], v[236:239]
  s_waitcnt lgkmcnt(4)
  buffer_load_dwordx4 v29, s[20:23], s72 offen offset:0 lds
  v_mfma_f32_16x16x32_bf16 v[240:243], v[40:43], a[32:35], v[240:243]
  ds_read_b64_tr_b16 v[36:37], v12 offset:53248
  v_mfma_f32_16x16x32_bf16 v[244:247], v[40:43], a[36:39], v[244:247]
  ds_read_b64_tr_b16 v[38:39], v12 offset:53760
  v_mfma_f32_16x16x32_bf16 v[248:251], v[40:43], a[40:43], v[248:251]
  v_mfma_f32_16x16x32_bf16 v[252:255], v[40:43], a[44:47], v[252:255]
  s_waitcnt lgkmcnt(4)
  buffer_load_dwordx4 a[156:159], v48, s[28:31], s76 offen offset:1024 sc1
  v_mfma_f32_16x16x32_bf16 v[240:243], v[44:47], a[48:51], v[240:243]
  s_add_u32 s76, s89, 5
  s_and_b32 s76, s76, 7
  ds_read_b64_tr_b16 v[40:41], v12 offset:57344
  v_mfma_f32_16x16x32_bf16 v[244:247], v[44:47], a[52:55], v[244:247]
  s_lshl_b32 s76, s76, 11
  s_add_u32 s75, s76, s81
  ds_read_b64_tr_b16 v[42:43], v12 offset:57856
  v_mfma_f32_16x16x32_bf16 v[248:251], v[44:47], a[56:59], v[248:251]
  s_add_u32 s76, s76, s82
  v_mfma_f32_16x16x32_bf16 v[252:255], v[44:47], a[60:63], v[252:255]
  s_waitcnt lgkmcnt(4)
  buffer_load_dwordx4 a[160:163], v15, s[28:31], s75 offen offset:0 sc1
  v_mfma_f32_16x16x32_bf16 v[128:131], v[32:35], a[64:67], v[128:131]
  ds_read_b64_tr_b16 v[44:45], v12 offset:61440
  v_mfma_f32_16x16x32_bf16 v[132:135], v[32:35], a[68:71], v[132:135]
  ds_read_b64_tr_b16 v[46:47], v12 offset:61952
  v_mfma_f32_16x16x32_bf16 v[136:139], v[32:35], a[72:75], v[136:139]
  v_mfma_f32_16x16x32_bf16 v[140:143], v[32:35], a[76:79], v[140:143]
  s_waitcnt vmcnt(27) lgkmcnt(4)
  v_mfma_f32_16x16x32_bf16 v[128:131], v[36:39], a[80:83], v[128:131]
  ds_read_b64_tr_b16 v[32:33], v13 offset:49152
  v_mfma_f32_16x16x32_bf16 v[132:135], v[36:39], a[84:87], v[132:135]
  ds_read_b64_tr_b16 v[34:35], v13 offset:49664
  v_mfma_f32_16x16x32_bf16 v[136:139], v[36:39], a[88:91], v[136:139]
  v_mfma_f32_16x16x32_bf16 v[140:143], v[36:39], a[92:95], v[140:143]
  s_waitcnt lgkmcnt(4)
  buffer_load_dwordx4 v30, s[20:23], s72 offen offset:1024 lds
  v_mfma_f32_16x16x32_bf16 v[144:147], v[40:43], a[64:67], v[144:147]
  ds_read_b64_tr_b16 v[36:37], v13 offset:53248
  v_mfma_f32_16x16x32_bf16 v[148:151], v[40:43], a[68:71], v[148:151]
  ds_read_b64_tr_b16 v[38:39], v13 offset:53760
  v_mfma_f32_16x16x32_bf16 v[152:155], v[40:43], a[72:75], v[152:155]
  v_mfma_f32_16x16x32_bf16 v[156:159], v[40:43], a[76:79], v[156:159]
  s_waitcnt lgkmcnt(4)
  buffer_load_dwordx4 a[164:167], v48, s[28:31], s75 offen offset:0 sc1
  v_mfma_f32_16x16x32_bf16 v[144:147], v[44:47], a[80:83], v[144:147]
  ds_read_b64_tr_b16 v[40:41], v13 offset:57344
  v_mfma_f32_16x16x32_bf16 v[148:151], v[44:47], a[84:87], v[148:151]
  ds_read_b64_tr_b16 v[42:43], v13 offset:57856
  v_mfma_f32_16x16x32_bf16 v[152:155], v[44:47], a[88:91], v[152:155]
  v_mfma_f32_16x16x32_bf16 v[156:159], v[44:47], a[92:95], v[156:159]
  s_waitcnt lgkmcnt(4)
  v_mfma_f32_16x16x32_bf16 v[160:163], v[32:35], a[64:67], v[160:163]
  ds_read_b64_tr_b16 v[44:45], v13 offset:61440
  v_mfma_f32_16x16x32_bf16 v[164:167], v[32:35], a[68:71], v[164:167]
  ds_read_b64_tr_b16 v[46:47], v13 offset:61952
  v_mfma_f32_16x16x32_bf16 v[168:171], v[32:35], a[72:75], v[168:171]
  v_mfma_f32_16x16x32_bf16 v[172:175], v[32:35], a[76:79], v[172:175]
  s_waitcnt lgkmcnt(4)
  buffer_load_dwordx4 a[168:171], v15, s[28:31], s76 offen offset:0 sc1
  v_mfma_f32_16x16x32_bf16 v[160:163], v[36:39], a[80:83], v[160:163]
  ds_read_b64_tr_b16 v[32:33], v12 offset:49408
  v_mfma_f32_16x16x32_bf16 v[164:167], v[36:39], a[84:87], v[164:167]
  s_add_u32 m0, m0, 8192
  s_add_u32 s71, s71, 1
  ds_read_b64_tr_b16 v[34:35], v12 offset:49920
  v_mfma_f32_16x16x32_bf16 v[168:171], v[36:39], a[88:91], v[168:171]
  v_mfma_f32_16x16x32_bf16 v[172:175], v[36:39], a[92:95], v[172:175]
  s_waitcnt lgkmcnt(4)
  buffer_load_dwordx4 v29, s[24:27], s72 offen offset:0 lds
  v_mfma_f32_16x16x32_bf16 v[176:179], v[40:43], a[64:67], v[176:179]
  ds_read_b64_tr_b16 v[36:37], v12 offset:53504
  v_mfma_f32_16x16x32_bf16 v[180:183], v[40:43], a[68:71], v[180:183]
  ds_read_b64_tr_b16 v[38:39], v12 offset:54016
  v_mfma_f32_16x16x32_bf16 v[184:187], v[40:43], a[72:75], v[184:187]
  v_mfma_f32_16x16x32_bf16 v[188:191], v[40:43], a[76:79], v[188:191]
  s_waitcnt lgkmcnt(4)
  buffer_load_dwordx4 a[172:175], v48, s[28:31], s76 offen offset:0 sc1
  v_mfma_f32_16x16x32_bf16 v[176:179], v[44:47], a[80:83], v[176:179]
  ds_read_b64_tr_b16 v[40:41], v12 offset:57600
  v_mfma_f32_16x16x32_bf16 v[180:183], v[44:47], a[84:87], v[180:183]
  ds_read_b64_tr_b16 v[42:43], v12 offset:58112
  v_mfma_f32_16x16x32_bf16 v[184:187], v[44:47], a[88:91], v[184:187]
  v_mfma_f32_16x16x32_bf16 v[188:191], v[44:47], a[92:95], v[188:191]
  s_waitcnt lgkmcnt(4)
  v_mfma_f32_16x16x32_bf16 v[192:195], v[32:35], a[64:67], v[192:195]
  ds_read_b64_tr_b16 v[44:45], v12 offset:61696
  v_mfma_f32_16x16x32_bf16 v[196:199], v[32:35], a[68:71], v[196:199]
  ds_read_b64_tr_b16 v[46:47], v12 offset:62208
  v_mfma_f32_16x16x32_bf16 v[200:203], v[32:35], a[72:75], v[200:203]
  v_mfma_f32_16x16x32_bf16 v[204:207], v[32:35], a[76:79], v[204:207]
  s_waitcnt lgkmcnt(4)
  v_mfma_f32_16x16x32_bf16 v[192:195], v[36:39], a[80:83], v[192:195]
  ds_read_b64_tr_b16 v[32:33], v13 offset:49408
  v_mfma_f32_16x16x32_bf16 v[196:199], v[36:39], a[84:87], v[196:199]
  ds_read_b64_tr_b16 v[34:35], v13 offset:49920
  v_mfma_f32_16x16x32_bf16 v[200:203], v[36:39], a[88:91], v[200:203]
  v_mfma_f32_16x16x32_bf16 v[204:207], v[36:39], a[92:95], v[204:207]
  s_waitcnt lgkmcnt(4)
  buffer_load_dwordx4 v30, s[24:27], s72 offen offset:1024 lds
  v_mfma_f32_16x16x32_bf16 v[208:211], v[40:43], a[64:67], v[208:211]
  ds_read_b64_tr_b16 v[36:37], v13 offset:53504
  v_mfma_f32_16x16x32_bf16 v[212:215], v[40:43], a[68:71], v[212:215]
  ds_read_b64_tr_b16 v[38:39], v13 offset:54016
  v_mfma_f32_16x16x32_bf16 v[216:219], v[40:43], a[72:75], v[216:219]
  v_mfma_f32_16x16x32_bf16 v[220:223], v[40:43], a[76:79], v[220:223]
  s_waitcnt lgkmcnt(4)
  buffer_load_dwordx4 a[176:179], v15, s[28:31], s75 offen offset:1024 sc1
  v_mfma_f32_16x16x32_bf16 v[208:211], v[44:47], a[80:83], v[208:211]
  ds_read_b64_tr_b16 v[40:41], v13 offset:57600
  v_mfma_f32_16x16x32_bf16 v[212:215], v[44:47], a[84:87], v[212:215]
  ds_read_b64_tr_b16 v[42:43], v13 offset:58112
  v_mfma_f32_16x16x32_bf16 v[216:219], v[44:47], a[88:91], v[216:219]
  v_mfma_f32_16x16x32_bf16 v[220:223], v[44:47], a[92:95], v[220:223]
  s_waitcnt lgkmcnt(4)
  buffer_load_dwordx4 a[180:183], v48, s[28:31], s75 offen offset:1024 sc1
  v_mfma_f32_16x16x32_bf16 v[224:227], v[32:35], a[64:67], v[224:227]
  ds_read_b64_tr_b16 v[44:45], v13 offset:61696
  v_mfma_f32_16x16x32_bf16 v[228:231], v[32:35], a[68:71], v[228:231]
  ds_read_b64_tr_b16 v[46:47], v13 offset:62208
  v_mfma_f32_16x16x32_bf16 v[232:235], v[32:35], a[72:75], v[232:235]
  v_mfma_f32_16x16x32_bf16 v[236:239], v[32:35], a[76:79], v[236:239]
  s_waitcnt lgkmcnt(4)
  s_barrier
  v_mfma_f32_16x16x32_bf16 v[224:227], v[36:39], a[80:83], v[224:227]
  ds_read_b64_tr_b16 v[32:33], v10 offset:16384
  v_mfma_f32_16x16x32_bf16 v[228:231], v[36:39], a[84:87], v[228:231]
  s_and_b32 s71, s71, 7
  s_lshr_b32 s72, s77, 1
  ds_read_b64_tr_b16 v[34:35], v10 offset:16896
  v_mfma_f32_16x16x32_bf16 v[232:235], v[36:39], a[88:91], v[232:235]
  s_add_u32 m0, s72, 65536
  s_mul_i32 s72, s71, 229376
  v_mfma_f32_16x16x32_bf16 v[236:239], v[36:39], a[92:95], v[236:239]
  s_waitcnt lgkmcnt(4)
  buffer_load_dwordx4 v29, s[20:23], s72 offen offset:0 lds
  v_mfma_f32_16x16x32_bf16 v[240:243], v[40:43], a[64:67], v[240:243]
  ds_read_b64_tr_b16 v[36:37], v10 offset:20480
  v_mfma_f32_16x16x32_bf16 v[244:247], v[40:43], a[68:71], v[244:247]
  ds_read_b64_tr_b16 v[38:39], v10 offset:20992
  v_mfma_f32_16x16x32_bf16 v[248:251], v[40:43], a[72:75], v[248:251]
  v_mfma_f32_16x16x32_bf16 v[252:255], v[40:43], a[76:79], v[252:255]
  s_waitcnt lgkmcnt(4)
  buffer_load_dwordx4 a[184:187], v15, s[28:31], s76 offen offset:1024 sc1
  v_mfma_f32_16x16x32_bf16 v[240:243], v[44:47], a[80:83], v[240:243]
  ds_read_b64_tr_b16 v[40:41], v10 offset:24576
  v_mfma_f32_16x16x32_bf16 v[244:247], v[44:47], a[84:87], v[244:247]
  ds_read_b64_tr_b16 v[42:43], v10 offset:25088
  v_mfma_f32_16x16x32_bf16 v[248:251], v[44:47], a[88:91], v[248:251]
  v_mfma_f32_16x16x32_bf16 v[252:255], v[44:47], a[92:95], v[252:255]
  s_waitcnt vmcnt(30) lgkmcnt(4)
  v_mfma_f32_16x16x32_bf16 v[128:131], v[32:35], a[96:99], v[128:131]
  ds_read_b64_tr_b16 v[44:45], v10 offset:28672
  v_mfma_f32_16x16x32_bf16 v[132:135], v[32:35], a[100:103], v[132:135]
  ds_read_b64_tr_b16 v[46:47], v10 offset:29184
  v_mfma_f32_16x16x32_bf16 v[136:139], v[32:35], a[104:107], v[136:139]
  v_mfma_f32_16x16x32_bf16 v[140:143], v[32:35], a[108:111], v[140:143]
  s_waitcnt vmcnt(25) lgkmcnt(4)
  buffer_load_dwordx4 a[188:191], v48, s[28:31], s76 offen offset:1024 sc1
  v_mfma_f32_16x16x32_bf16 v[128:131], v[36:39], a[112:115], v[128:131]
  ds_read_b64_tr_b16 v[32:33], v11 offset:16384
  v_mfma_f32_16x16x32_bf16 v[132:135], v[36:39], a[116:119], v[132:135]
  ds_read_b64_tr_b16 v[34:35], v11 offset:16896
  v_mfma_f32_16x16x32_bf16 v[136:139], v[36:39], a[120:123], v[136:139]
  v_mfma_f32_16x16x32_bf16 v[140:143], v[36:39], a[124:127], v[140:143]
  s_waitcnt lgkmcnt(4)
  buffer_load_dwordx4 v30, s[20:23], s72 offen offset:1024 lds
  v_mfma_f32_16x16x32_bf16 v[144:147], v[40:43], a[96:99], v[144:147]
  ds_read_b64_tr_b16 v[36:37], v11 offset:20480
  v_mfma_f32_16x16x32_bf16 v[148:151], v[40:43], a[100:103], v[148:151]
  ds_read_b64_tr_b16 v[38:39], v11 offset:20992
  v_mfma_f32_16x16x32_bf16 v[152:155], v[40:43], a[104:107], v[152:155]
  v_mfma_f32_16x16x32_bf16 v[156:159], v[40:43], a[108:111], v[156:159]
  s_waitcnt lgkmcnt(4)
  v_mfma_f32_16x16x32_bf16 v[144:147], v[44:47], a[112:115], v[144:147]
  s_add_u32 s76, s89, 6
  s_and_b32 s76, s76, 7
  ds_read_b64_tr_b16 v[40:41], v11 offset:24576
  v_mfma_f32_16x16x32_bf16 v[148:151], v[44:47], a[116:119], v[148:151]
  s_lshl_b32 s76, s76, 11
  s_add_u32 s75, s76, s81
  ds_read_b64_tr_b16 v[42:43], v11 offset:25088
  v_mfma_f32_16x16x32_bf16 v[152:155], v[44:47], a[120:123], v[152:155]
  s_add_u32 s76, s76, s82
  v_mfma_f32_16x16x32_bf16 v[156:159], v[44:47], a[124:127], v[156:159]
  s_waitcnt lgkmcnt(4)
  buffer_load_dwordx4 a[192:195], v15, s[28:31], s75 offen offset:0 sc1
  v_mfma_f32_16x16x32_bf16 v[160:163], v[32:35], a[96:99], v[160:163]
  ds_read_b64_tr_b16 v[44:45], v11 offset:28672
  v_mfma_f32_16x16x32_bf16 v[164:167], v[32:35], a[100:103], v[164:167]
  ds_read_b64_tr_b16 v[46:47], v11 offset:29184
  v_mfma_f32_16x16x32_bf16 v[168:171], v[32:35], a[104:107], v[168:171]
  v_mfma_f32_16x16x32_bf16 v[172:175], v[32:35], a[108:111], v[172:175]
  s_waitcnt lgkmcnt(4)
  v_mfma_f32_16x16x32_bf16 v[160:163], v[36:39], a[112:115], v[160:163]
  ds_read_b64_tr_b16 v[32:33], v10 offset:16640
  v_mfma_f32_16x16x32_bf16 v[164:167], v[36:39], a[116:119], v[164:167]
  s_add_u32 m0, m0, 8192
  s_add_u32 s71, s71, 1
  ds_read_b64_tr_b16 v[34:35], v10 offset:17152
  v_mfma_f32_16x16x32_bf16 v[168:171], v[36:39], a[120:123], v[168:171]
  v_mfma_f32_16x16x32_bf16 v[172:175], v[36:39], a[124:127], v[172:175]
  s_waitcnt lgkmcnt(4)
  buffer_load_dwordx4 v29, s[24:27], s72 offen offset:0 lds
  v_mfma_f32_16x16x32_bf16 v[176:179], v[40:43], a[96:99], v[176:179]
  ds_read_b64_tr_b16 v[36:37], v10 offset:20736
  v_mfma_f32_16x16x32_bf16 v[180:183], v[40:43], a[100:103], v[180:183]
  ds_read_b64_tr_b16 v[38:39], v10 offset:21248
  v_mfma_f32_16x16x32_bf16 v[184:187], v[40:43], a[104:107], v[184:187]
  v_mfma_f32_16x16x32_bf16 v[188:191], v[40:43], a[108:111], v[188:191]
  s_waitcnt lgkmcnt(4)
  buffer_load_dwordx4 a[196:199], v48, s[28:31], s75 offen offset:0 sc1
  v_mfma_f32_16x16x32_bf16 v[176:179], v[44:47], a[112:115], v[176:179]
  ds_read_b64_tr_b16 v[40:41], v10 offset:24832
  v_mfma_f32_16x16x32_bf16 v[180:183], v[44:47], a[116:119], v[180:183]
  ds_read_b64_tr_b16 v[42:43], v10 offset:25344
  v_mfma_f32_16x16x32_bf16 v[184:187], v[44:47], a[120:123], v[184:187]
  v_mfma_f32_16x16x32_bf16 v[188:191], v[44:47], a[124:127], v[188:191]
  s_waitcnt lgkmcnt(4)
  v_mfma_f32_16x16x32_bf16 v[192:195], v[32:35], a[96:99], v[192:195]
  ds_read_b64_tr_b16 v[44:45], v10 offset:28928
  v_mfma_f32_16x16x32_bf16 v[196:199], v[32:35], a[100:103], v[196:199]
  ds_read_b64_tr_b16 v[46:47], v10 offset:29440
  v_mfma_f32_16x16x32_bf16 v[200:203], v[32:35], a[104:107], v[200:203]
  v_mfma_f32_16x16x32_bf16 v[204:207], v[32:35], a[108:111], v[204:207]
  s_waitcnt lgkmcnt(4)
  buffer_load_dwordx4 a[200:203], v15, s[28:31], s76 offen offset:0 sc1
  v_mfma_f32_16x16x32_bf16 v[192:195], v[36:39], a[112:115], v[192:195]
  ds_read_b64_tr_b16 v[32:33], v11 offset:16640
  v_mfma_f32_16x16x32_bf16 v[196:199], v[36:39], a[116:119], v[196:199]
  ds_read_b64_tr_b16 v[34:35], v11 offset:17152
  v_mfma_f32_16x16x32_bf16 v[200:203], v[36:39], a[120:123], v[200:203]
  v_mfma_f32_16x16x32_bf16 v[204:207], v[36:39], a[124:127], v[204:207]
  s_waitcnt lgkmcnt(4)
  buffer_load_dwordx4 v30, s[24:27], s72 offen offset:1024 lds
  v_mfma_f32_16x16x32_bf16 v[208:211], v[40:43], a[96:99], v[208:211]
  ds_read_b64_tr_b16 v[36:37], v11 offset:20736
  v_mfma_f32_16x16x32_bf16 v[212:215], v[40:43], a[100:103], v[212:215]
  ds_read_b64_tr_b16 v[38:39], v11 offset:21248
  v_mfma_f32_16x16x32_bf16 v[216:219], v[40:43], a[104:107], v[216:219]
  v_mfma_f32_16x16x32_bf16 v[220:223], v[40:43], a[108:111], v[220:223]
  s_waitcnt lgkmcnt(4)
  buffer_load_dwordx4 a[204:207], v48, s[28:31], s76 offen offset:0 sc1
  v_mfma_f32_16x16x32_bf16 v[208:211], v[44:47], a[112:115], v[208:211]
  ds_read_b64_tr_b16 v[40:41], v11 offset:24832
  v_mfma_f32_16x16x32_bf16 v[212:215], v[44:47], a[116:119], v[212:215]
  ds_read_b64_tr_b16 v[42:43], v11 offset:25344
  v_mfma_f32_16x16x32_bf16 v[216:219], v[44:47], a[120:123], v[216:219]
  v_mfma_f32_16x16x32_bf16 v[220:223], v[44:47], a[124:127], v[220:223]
  s_waitcnt lgkmcnt(4)
  v_mfma_f32_16x16x32_bf16 v[224:227], v[32:35], a[96:99], v[224:227]
  ds_read_b64_tr_b16 v[44:45], v11 offset:28928
  v_mfma_f32_16x16x32_bf16 v[228:231], v[32:35], a[100:103], v[228:231]
  ds_read_b64_tr_b16 v[46:47], v11 offset:29440
  v_mfma_f32_16x16x32_bf16 v[232:235], v[32:35], a[104:107], v[232:235]
  v_mfma_f32_16x16x32_bf16 v[236:239], v[32:35], a[108:111], v[236:239]
  s_waitcnt lgkmcnt(4)
  s_barrier
  v_mfma_f32_16x16x32_bf16 v[224:227], v[36:39], a[112:115], v[224:227]
  ds_read_b64_tr_b16 v[32:33], v10 offset:32768
  v_mfma_f32_16x16x32_bf16 v[228:231], v[36:39], a[116:119], v[228:231]
  s_and_b32 s71, s71, 7
  s_add_u32 m0, s77, 16384
  ds_read_b64_tr_b16 v[34:35], v10 offset:33280
  v_mfma_f32_16x16x32_bf16 v[232:235], v[36:39], a[120:123], v[232:235]
  s_lshl_b32 s72, s71, 19
  v_mfma_f32_16x16x32_bf16 v[236:239], v[36:39], a[124:127], v[236:239]
  s_waitcnt lgkmcnt(4)
  buffer_load_dwordx4 v2, s[16:19], s72 offen offset:0 lds
  v_mfma_f32_16x16x32_bf16 v[240:243], v[40:43], a[96:99], v[240:243]
  ds_read_b64_tr_b16 v[36:37], v10 offset:36864
  v_mfma_f32_16x16x32_bf16 v[244:247], v[40:43], a[100:103], v[244:247]
  ds_read_b64_tr_b16 v[38:39], v10 offset:37376
  v_mfma_f32_16x16x32_bf16 v[248:251], v[40:43], a[104:107], v[248:251]
  v_mfma_f32_16x16x32_bf16 v[252:255], v[40:43], a[108:111], v[252:255]
  s_waitcnt lgkmcnt(4)
  buffer_load_dwordx4 a[208:211], v15, s[28:31], s75 offen offset:1024 sc1
  v_mfma_f32_16x16x32_bf16 v[240:243], v[44:47], a[112:115], v[240:243]
  ds_read_b64_tr_b16 v[40:41], v10 offset:40960
  v_mfma_f32_16x16x32_bf16 v[244:247], v[44:47], a[116:119], v[244:247]
  ds_read_b64_tr_b16 v[42:43], v10 offset:41472
  v_mfma_f32_16x16x32_bf16 v[248:251], v[44:47], a[120:123], v[248:251]
  v_mfma_f32_16x16x32_bf16 v[252:255], v[44:47], a[124:127], v[252:255]
  s_waitcnt vmcnt(28) lgkmcnt(4)
  buffer_load_dwordx4 a[212:215], v48, s[28:31], s75 offen offset:1024 sc1
  v_mfma_f32_16x16x32_bf16 v[128:131], v[32:35], a[128:131], v[128:131]
  ds_read_b64_tr_b16 v[44:45], v10 offset:45056
  v_mfma_f32_16x16x32_bf16 v[132:135], v[32:35], a[132:135], v[132:135]
  ds_read_b64_tr_b16 v[46:47], v10 offset:45568
  v_mfma_f32_16x16x32_bf16 v[136:139], v[32:35], a[136:139], v[136:139]
  v_mfma_f32_16x16x32_bf16 v[140:143], v[32:35], a[140:143], v[140:143]
  s_waitcnt vmcnt(22) lgkmcnt(4)
  v_mfma_f32_16x16x32_bf16 v[128:131], v[36:39], a[144:147], v[128:131]
  ds_read_b64_tr_b16 v[32:33], v11 offset:32768
  v_mfma_f32_16x16x32_bf16 v[132:135], v[36:39], a[148:151], v[132:135]
  ds_read_b64_tr_b16 v[34:35], v11 offset:33280
  v_mfma_f32_16x16x32_bf16 v[136:139], v[36:39], a[152:155], v[136:139]
  v_mfma_f32_16x16x32_bf16 v[140:143], v[36:39], a[156:159], v[140:143]
  s_waitcnt lgkmcnt(4)
  buffer_load_dwordx4 v3, s[16:19], s72 offen offset:1024 lds
  v_mfma_f32_16x16x32_bf16 v[144:147], v[40:43], a[128:131], v[144:147]
  ds_read_b64_tr_b16 v[36:37], v11 offset:36864
  v_mfma_f32_16x16x32_bf16 v[148:151], v[40:43], a[132:135], v[148:151]
  ds_read_b64_tr_b16 v[38:39], v11 offset:37376
  v_mfma_f32_16x16x32_bf16 v[152:155], v[40:43], a[136:139], v[152:155]
  s_add_u32 s83, s79, 24576
  v_mfma_f32_16x16x32_bf16 v[156:159], v[40:43], a[140:143], v[156:159]
  s_waitcnt lgkmcnt(4)
  buffer_load_dwordx4 a[216:219], v15, s[28:31], s76 offen offset:1024 sc1
  v_mfma_f32_16x16x32_bf16 v[144:147], v[44:47], a[144:147], v[144:147]
  ds_read_b64_tr_b16 v[40:41], v11 offset:40960
  v_mfma_f32_16x16x32_bf16 v[148:151], v[44:47], a[148:151], v[148:151]
  ds_read_b64_tr_b16 v[42:43], v11 offset:41472
  v_mfma_f32_16x16x32_bf16 v[152:155], v[44:47], a[152:155], v[152:155]
  v_mfma_f32_16x16x32_bf16 v[156:159], v[44:47], a[156:159], v[156:159]
  s_waitcnt lgkmcnt(4)
  buffer_store_dwordx4 v[96:99], v15, s[36:39], s83 offen offset:0
  v_mfma_f32_16x16x32_bf16 v[160:163], v[32:35], a[128:131], v[160:163]
  ds_read_b64_tr_b16 v[44:45], v11 offset:45056
  v_mfma_f32_16x16x32_bf16 v[164:167], v[32:35], a[132:135], v[164:167]
  ds_read_b64_tr_b16 v[46:47], v11 offset:45568
  v_mfma_f32_16x16x32_bf16 v[168:171], v[32:35], a[136:139], v[168:171]
  v_mfma_f32_16x16x32_bf16 v[172:175], v[32:35], a[140:143], v[172:175]
  s_waitcnt lgkmcnt(4)
  buffer_load_dwordx4 a[220:223], v48, s[28:31], s76 offen offset:1024 sc1
  v_mfma_f32_16x16x32_bf16 v[160:163], v[36:39], a[144:147], v[160:163]
  ds_read_b64_tr_b16 v[32:33], v10 offset:33024
  v_mfma_f32_16x16x32_bf16 v[164:167], v[36:39], a[148:151], v[164:167]
  ds_read_b64_tr_b16 v[34:35], v10 offset:33536
  v_mfma_f32_16x16x32_bf16 v[168:171], v[36:39], a[152:155], v[168:171]
  v_mfma_f32_16x16x32_bf16 v[172:175], v[36:39], a[156:159], v[172:175]
  s_waitcnt lgkmcnt(4)
  buffer_load_dwordx4 v4, s[16:19], s72 offen offset:2048 lds
  v_mfma_f32_16x16x32_bf16 v[176:179], v[40:43], a[128:131], v[176:179]
  ds_read_b64_tr_b16 v[36:37], v10 offset:37120
  v_mfma_f32_16x16x32_bf16 v[180:183], v[40:43], a[132:135], v[180:183]
  ds_read_b64_tr_b16 v[38:39], v10 offset:37632
  v_mfma_f32_16x16x32_bf16 v[184:187], v[40:43], a[136:139], v[184:187]
  v_mfma_f32_16x16x32_bf16 v[188:191], v[40:43], a[140:143], v[188:191]
  s_waitcnt lgkmcnt(4)
  v_mfma_f32_16x16x32_bf16 v[176:179], v[44:47], a[144:147], v[176:179]
  s_add_u32 s76, s89, 7
  s_and_b32 s76, s76, 7
  ds_read_b64_tr_b16 v[40:41], v10 offset:41216
  v_mfma_f32_16x16x32_bf16 v[180:183], v[44:47], a[148:151], v[180:183]
  s_lshl_b32 s76, s76, 11
  s_add_u32 s75, s76, s81
  ds_read_b64_tr_b16 v[42:43], v10 offset:41728
  v_mfma_f32_16x16x32_bf16 v[184:187], v[44:47], a[152:155], v[184:187]
  s_add_u32 s76, s76, s82
  v_mfma_f32_16x16x32_bf16 v[188:191], v[44:47], a[156:159], v[188:191]
  s_waitcnt lgkmcnt(4)
  buffer_load_dwordx4 a[224:227], v15, s[28:31], s75 offen offset:0 sc1
  v_mfma_f32_16x16x32_bf16 v[192:195], v[32:35], a[128:131], v[192:195]
  ds_read_b64_tr_b16 v[44:45], v10 offset:45312
  v_mfma_f32_16x16x32_bf16 v[196:199], v[32:35], a[132:135], v[196:199]
  ds_read_b64_tr_b16 v[46:47], v10 offset:45824
  v_mfma_f32_16x16x32_bf16 v[200:203], v[32:35], a[136:139], v[200:203]
  v_mfma_f32_16x16x32_bf16 v[204:207], v[32:35], a[140:143], v[204:207]
  s_waitcnt lgkmcnt(4)
  buffer_store_dwordx4 v[100:103], v15, s[36:39], s83 offen offset:1024
  v_mfma_f32_16x16x32_bf16 v[192:195], v[36:39], a[144:147], v[192:195]
  ds_read_b64_tr_b16 v[32:33], v11 offset:33024
  v_mfma_f32_16x16x32_bf16 v[196:199], v[36:39], a[148:151], v[196:199]
  ds_read_b64_tr_b16 v[34:35], v11 offset:33536
  v_mfma_f32_16x16x32_bf16 v[200:203], v[36:39], a[152:155], v[200:203]
  v_mfma_f32_16x16x32_bf16 v[204:207], v[36:39], a[156:159], v[204:207]
  s_waitcnt lgkmcnt(4)
  buffer_load_dwordx4 v5, s[16:19], s72 offen offset:3072 lds
  v_mfma_f32_16x16x32_bf16 v[208:211], v[40:43], a[128:131], v[208:211]
  ds_read_b64_tr_b16 v[36:37], v11 offset:37120
  v_mfma_f32_16x16x32_bf16 v[212:215], v[40:43], a[132:135], v[212:215]
  ds_read_b64_tr_b16 v[38:39], v11 offset:37632
  v_mfma_f32_16x16x32_bf16 v[216:219], v[40:43], a[136:139], v[216:219]
  v_mfma_f32_16x16x32_bf16 v[220:223], v[40:43], a[140:143], v[220:223]
  s_waitcnt lgkmcnt(4)
  buffer_load_dwordx4 a[228:231], v48, s[28:31], s75 offen offset:0 sc1
  v_mfma_f32_16x16x32_bf16 v[208:211], v[44:47], a[144:147], v[208:211]
  ds_read_b64_tr_b16 v[40:41], v11 offset:41216
  v_mfma_f32_16x16x32_bf16 v[212:215], v[44:47], a[148:151], v[212:215]
  ds_read_b64_tr_b16 v[42:43], v11 offset:41728
  v_mfma_f32_16x16x32_bf16 v[216:219], v[44:47], a[152:155], v[216:219]
  v_mfma_f32_16x16x32_bf16 v[220:223], v[44:47], a[156:159], v[220:223]
  s_waitcnt lgkmcnt(4)
  v_mfma_f32_16x16x32_bf16 v[224:227], v[32:35], a[128:131], v[224:227]
  ds_read_b64_tr_b16 v[44:45], v11 offset:45312
  v_mfma_f32_16x16x32_bf16 v[228:231], v[32:35], a[132:135], v[228:231]
  ds_read_b64_tr_b16 v[46:47], v11 offset:45824
  v_mfma_f32_16x16x32_bf16 v[232:235], v[32:35], a[136:139], v[232:235]
  v_mfma_f32_16x16x32_bf16 v[236:239], v[32:35], a[140:143], v[236:239]
  s_waitcnt lgkmcnt(4)
  s_barrier
  v_mfma_f32_16x16x32_bf16 v[224:227], v[36:39], a[144:147], v[224:227]
  ds_read_b64_tr_b16 v[32:33], v10 offset:49152
  v_mfma_f32_16x16x32_bf16 v[228:231], v[36:39], a[148:151], v[228:231]
  s_add_u32 s71, s71, 1
  s_and_b32 s71, s71, 7
  ds_read_b64_tr_b16 v[34:35], v10 offset:49664
  v_mfma_f32_16x16x32_bf16 v[232:235], v[36:39], a[152:155], v[232:235]
  s_add_u32 m0, s77, 81920
  s_lshl_b32 s72, s71, 19
  v_mfma_f32_16x16x32_bf16 v[236:239], v[36:39], a[156:159], v[236:239]
  s_waitcnt lgkmcnt(4)
  buffer_load_dwordx4 v2, s[16:19], s72 offen offset:0 lds
  v_mfma_f32_16x16x32_bf16 v[240:243], v[40:43], a[128:131], v[240:243]
  ds_read_b64_tr_b16 v[36:37], v10 offset:53248
  v_mfma_f32_16x16x32_bf16 v[244:247], v[40:43], a[132:135], v[244:247]
  ds_read_b64_tr_b16 v[38:39], v10 offset:53760
  v_mfma_f32_16x16x32_bf16 v[248:251], v[40:43], a[136:139], v[248:251]
  v_mfma_f32_16x16x32_bf16 v[252:255], v[40:43], a[140:143], v[252:255]
  s_waitcnt lgkmcnt(4)
  buffer_load_dwordx4 a[232:235], v15, s[28:31], s76 offen offset:0 sc1
  v_mfma_f32_16x16x32_bf16 v[240:243], v[44:47], a[144:147], v[240:243]
  ds_read_b64_tr_b16 v[40:41], v10 offset:57344
  v_mfma_f32_16x16x32_bf16 v[244:247], v[44:47], a[148:151], v[244:247]
  ds_read_b64_tr_b16 v[42:43], v10 offset:57856
  v_mfma_f32_16x16x32_bf16 v[248:251], v[44:47], a[152:155], v[248:251]
  v_mfma_f32_16x16x32_bf16 v[252:255], v[44:47], a[156:159], v[252:255]
  s_waitcnt vmcnt(27) lgkmcnt(4)
  buffer_load_dwordx4 a[236:239], v48, s[28:31], s76 offen offset:0 sc1
  s_getpc_b64 s[98:99]
L_pc5:
  s_sub_u32 s98, s98, L_pc5-L_pc
  s_subb_u32 s99, s99, 0
  global_load_dword v0, v51, s[98:99]
  v_mfma_f32_16x16x32_bf16 v[128:131], v[32:35], a[160:163], v[128:131]
  s_lshl_b32 s32, s69, 10
  ds_read_b64_tr_b16 v[44:45], v10 offset:61440
  v_and_b32 v50, 7, v1
  v_mfma_f32_16x16x32_bf16 v[132:135], v[32:35], a[164:167], v[132:135]
  ds_read_b64_tr_b16 v[46:47], v10 offset:61952
  v_lshlrev_b32 v50, 7, v50
  v_mfma_f32_16x16x32_bf16 v[136:139], v[32:35], a[168:171], v[136:139]
  v_add_u32 v50, s32, v50
  v_add_u32 v50, 0x1028000, v50
  v_mfma_f32_16x16x32_bf16 v[140:143], v[32:35], a[172:175], v[140:143]
  s_waitcnt vmcnt(23) lgkmcnt(4)
  buffer_store_dwordx4 v[104:107], v15, s[36:39], s83 offen offset:2048
  v_mfma_f32_16x16x32_bf16 v[128:131], v[36:39], a[176:179], v[128:131]
  ds_read_b64_tr_b16 v[32:33], v11 offset:49152
  v_mfma_f32_16x16x32_bf16 v[132:135], v[36:39], a[180:183], v[132:135]
  ds_read_b64_tr_b16 v[34:35], v11 offset:49664
  v_mfma_f32_16x16x32_bf16 v[136:139], v[36:39], a[184:187], v[136:139]
  v_mfma_f32_16x16x32_bf16 v[140:143], v[36:39], a[188:191], v[140:143]
  s_waitcnt lgkmcnt(4)
  buffer_load_dwordx4 v3, s[16:19], s72 offen offset:1024 lds
  v_mfma_f32_16x16x32_bf16 v[144:147], v[40:43], a[160:163], v[144:147]
  ds_read_b64_tr_b16 v[36:37], v11 offset:53248
  v_mfma_f32_16x16x32_bf16 v[148:151], v[40:43], a[164:167], v[148:151]
  ds_read_b64_tr_b16 v[38:39], v11 offset:53760
  v_mfma_f32_16x16x32_bf16 v[152:155], v[40:43], a[168:171], v[152:155]
  v_mfma_f32_16x16x32_bf16 v[156:159], v[40:43], a[172:175], v[156:159]
  s_waitcnt lgkmcnt(4)
  buffer_load_dwordx4 a[240:243], v15, s[28:31], s75 offen offset:1024 sc1
  v_mfma_f32_16x16x32_bf16 v[144:147], v[44:47], a[176:179], v[144:147]
  ds_read_b64_tr_b16 v[40:41], v11 offset:57344
  v_mfma_f32_16x16x32_bf16 v[148:151], v[44:47], a[180:183], v[148:151]
  ds_read_b64_tr_b16 v[42:43], v11 offset:57856
  v_mfma_f32_16x16x32_bf16 v[152:155], v[44:47], a[184:187], v[152:155]
  v_mfma_f32_16x16x32_bf16 v[156:159], v[44:47], a[188:191], v[156:159]
  s_waitcnt lgkmcnt(4)
  buffer_load_dwordx4 a[244:247], v48, s[28:31], s75 offen offset:1024 sc1
  v_mfma_f32_16x16x32_bf16 v[160:163], v[32:35], a[160:163], v[160:163]
  ds_read_b64_tr_b16 v[44:45], v11 offset:61440
  v_mfma_f32_16x16x32_bf16 v[164:167], v[32:35], a[164:167], v[164:167]
  ds_read_b64_tr_b16 v[46:47], v11 offset:61952
  v_mfma_f32_16x16x32_bf16 v[168:171], v[32:35], a[168:171], v[168:171]
  v_mfma_f32_16x16x32_bf16 v[172:175], v[32:35], a[172:175], v[172:175]
  s_waitcnt lgkmcnt(4)
  buffer_store_dwordx4 v[108:111], v15, s[36:39], s83 offen offset:3072
  v_mfma_f32_16x16x32_bf16 v[160:163], v[36:39], a[176:179], v[160:163]
  ds_read_b64_tr_b16 v[32:33], v10 offset:49408
  v_mfma_f32_16x16x32_bf16 v[164:167], v[36:39], a[180:183], v[164:167]
  ds_read_b64_tr_b16 v[34:35], v10 offset:49920
  v_mfma_f32_16x16x32_bf16 v[168:171], v[36:39], a[184:187], v[168:171]
  v_mfma_f32_16x16x32_bf16 v[172:175], v[36:39], a[188:191], v[172:175]
  s_waitcnt lgkmcnt(4)
  buffer_load_dwordx4 v4, s[16:19], s72 offen offset:2048 lds
  v_mfma_f32_16x16x32_bf16 v[176:179], v[40:43], a[160:163], v[176:179]
  ds_read_b64_tr_b16 v[36:37], v10 offset:53504
  v_mfma_f32_16x16x32_bf16 v[180:183], v[40:43], a[164:167], v[180:183]
  ds_read_b64_tr_b16 v[38:39], v10 offset:54016
  v_mfma_f32_16x16x32_bf16 v[184:187], v[40:43], a[168:171], v[184:187]
  v_mfma_f32_16x16x32_bf16 v[188:191], v[40:43], a[172:175], v[188:191]
  s_waitcnt lgkmcnt(4)
  buffer_load_dwordx4 a[248:251], v15, s[28:31], s76 offen offset:1024 sc1
  v_mfma_f32_16x16x32_bf16 v[176:179], v[44:47], a[176:179], v[176:179]
  ds_read_b64_tr_b16 v[40:41], v10 offset:57600
  v_mfma_f32_16x16x32_bf16 v[180:183], v[44:47], a[180:183], v[180:183]
  ds_read_b64_tr_b16 v[42:43], v10 offset:58112
  v_mfma_f32_16x16x32_bf16 v[184:187], v[44:47], a[184:187], v[184:187]
  v_mfma_f32_16x16x32_bf16 v[188:191], v[44:47], a[188:191], v[188:191]
  s_waitcnt lgkmcnt(4)
  buffer_load_dwordx2 v[16:17], v50, s[44:47], 0 offen sc1
  v_mfma_f32_16x16x32_bf16 v[192:195], v[32:35], a[160:163], v[192:195]
  ds_read_b64_tr_b16 v[44:45], v10 offset:61696
  v_mfma_f32_16x16x32_bf16 v[196:199], v[32:35], a[164:167], v[196:199]
  ds_read_b64_tr_b16 v[46:47], v10 offset:62208
  v_mfma_f32_16x16x32_bf16 v[200:203], v[32:35], a[168:171], v[200:203]
  s_add_u32 s83, s79, 28672
  v_mfma_f32_16x16x32_bf16 v[204:207], v[32:35], a[172:175], v[204:207]
  s_waitcnt lgkmcnt(4)
  buffer_load_dwordx4 a[252:255], v48, s[28:31], s76 offen offset:1024 sc1
  v_mfma_f32_16x16x32_bf16 v[192:195], v[36:39], a[176:179], v[192:195]
  ds_read_b64_tr_b16 v[32:33], v11 offset:49408
  v_mfma_f32_16x16x32_bf16 v[196:199], v[36:39], a[180:183], v[196:199]
  ds_read_b64_tr_b16 v[34:35], v11 offset:49920
  v_mfma_f32_16x16x32_bf16 v[200:203], v[36:39], a[184:187], v[200:203]
  v_mfma_f32_16x16x32_bf16 v[204:207], v[36:39], a[188:191], v[204:207]
  s_waitcnt lgkmcnt(4)
  buffer_load_dwordx4 v5, s[16:19], s72 offen offset:3072 lds
  v_mfma_f32_16x16x32_bf16 v[208:211], v[40:43], a[160:163], v[208:211]
  ds_read_b64_tr_b16 v[36:37], v11 offset:53504
  v_mfma_f32_16x16x32_bf16 v[212:215], v[40:43], a[164:167], v[212:215]
  ds_read_b64_tr_b16 v[38:39], v11 offset:54016
  v_mfma_f32_16x16x32_bf16 v[216:219], v[40:43], a[168:171], v[216:219]
  v_mfma_f32_16x16x32_bf16 v[220:223], v[40:43], a[172:175], v[220:223]
  s_waitcnt lgkmcnt(4)
  buffer_store_dwordx4 v[112:115], v15, s[36:39], s83 offen offset:0
  v_mfma_f32_16x16x32_bf16 v[208:211], v[44:47], a[176:179], v[208:211]
  ds_read_b64_tr_b16 v[40:41], v11 offset:57600
  v_mfma_f32_16x16x32_bf16 v[212:215], v[44:47], a[180:183], v[212:215]
  ds_read_b64_tr_b16 v[42:43], v11 offset:58112
  v_mfma_f32_16x16x32_bf16 v[216:219], v[44:47], a[184:187], v[216:219]
  v_mfma_f32_16x16x32_bf16 v[220:223], v[44:47], a[188:191], v[220:223]
  s_waitcnt lgkmcnt(4)
  v_mfma_f32_16x16x32_bf16 v[224:227], v[32:35], a[160:163], v[224:227]
  ds_read_b64_tr_b16 v[44:45], v11 offset:61696
  v_mfma_f32_16x16x32_bf16 v[228:231], v[32:35], a[164:167], v[228:231]
  ds_read_b64_tr_b16 v[46:47], v11 offset:62208
  v_mfma_f32_16x16x32_bf16 v[232:235], v[32:35], a[168:171], v[232:235]
  v_mfma_f32_16x16x32_bf16 v[236:239], v[32:35], a[172:175], v[236:239]
  s_waitcnt lgkmcnt(4)
  s_barrier
  v_mfma_f32_16x16x32_bf16 v[224:227], v[36:39], a[176:179], v[224:227]
  ds_read_b64_tr_b16 v[32:33], v12 offset:0
  v_mfma_f32_16x16x32_bf16 v[228:231], v[36:39], a[180:183], v[228:231]
  s_add_u32 s71, s71, 1
  s_and_b32 s71, s71, 7
  ds_read_b64_tr_b16 v[34:35], v12 offset:512
  v_mfma_f32_16x16x32_bf16 v[232:235], v[36:39], a[184:187], v[232:235]
  s_add_u32 m0, s77, 32768
  s_lshl_b32 s72, s71, 19
  v_mfma_f32_16x16x32_bf16 v[236:239], v[36:39], a[188:191], v[236:239]
  s_waitcnt lgkmcnt(4)
  buffer_load_dwordx4 v2, s[16:19], s72 offen offset:0 lds
  v_mfma_f32_16x16x32_bf16 v[240:243], v[40:43], a[160:163], v[240:243]
  ds_read_b64_tr_b16 v[36:37], v12 offset:4096
  v_mfma_f32_16x16x32_bf16 v[244:247], v[40:43], a[164:167], v[244:247]
  ds_read_b64_tr_b16 v[38:39], v12 offset:4608
  v_mfma_f32_16x16x32_bf16 v[248:251], v[40:43], a[168:171], v[248:251]
  v_mfma_f32_16x16x32_bf16 v[252:255], v[40:43], a[172:175], v[252:255]
  s_waitcnt lgkmcnt(4)
  buffer_store_dwordx4 v[116:119], v15, s[36:39], s83 offen offset:1024
  v_mfma_f32_16x16x32_bf16 v[240:243], v[44:47], a[176:179], v[240:243]
  ds_read_b64_tr_b16 v[40:41], v12 offset:8192
  v_mfma_f32_16x16x32_bf16 v[244:247], v[44:47], a[180:183], v[244:247]
  ds_read_b64_tr_b16 v[42:43], v12 offset:8704
  v_mfma_f32_16x16x32_bf16 v[248:251], v[44:47], a[184:187], v[248:251]
  v_mfma_f32_16x16x32_bf16 v[252:255], v[44:47], a[188:191], v[252:255]
  s_waitcnt vmcnt(29) lgkmcnt(4)
  v_mfma_f32_16x16x32_bf16 v[128:131], v[32:35], a[192:195], v[128:131]
  ds_read_b64_tr_b16 v[44:45], v12 offset:12288
  v_mfma_f32_16x16x32_bf16 v[132:135], v[32:35], a[196:199], v[132:135]
  ds_read_b64_tr_b16 v[46:47], v12 offset:12800
  v_mfma_f32_16x16x32_bf16 v[136:139], v[32:35], a[200:203], v[136:139]
  v_mfma_f32_16x16x32_bf16 v[140:143], v[32:35], a[204:207], v[140:143]
  s_waitcnt vmcnt(22) lgkmcnt(4)
  v_mfma_f32_16x16x32_bf16 v[128:131], v[36:39], a[208:211], v[128:131]
  ds_read_b64_tr_b16 v[32:33], v13 offset:0
  v_mfma_f32_16x16x32_bf16 v[132:135], v[36:39], a[212:215], v[132:135]
  ds_read_b64_tr_b16 v[34:35], v13 offset:512
  v_mfma_f32_16x16x32_bf16 v[136:139], v[36:39], a[216:219], v[136:139]
  v_mfma_f32_16x16x32_bf16 v[140:143], v[36:39], a[220:223], v[140:143]
  s_waitcnt lgkmcnt(4)
  buffer_load_dwordx4 v3, s[16:19], s72 offen offset:1024 lds
  v_mfma_f32_16x16x32_bf16 v[144:147], v[40:43], a[192:195], v[144:147]
  ds_read_b64_tr_b16 v[36:37], v13 offset:4096
  v_mfma_f32_16x16x32_bf16 v[148:151], v[40:43], a[196:199], v[148:151]
  ds_read_b64_tr_b16 v[38:39], v13 offset:4608
  v_mfma_f32_16x16x32_bf16 v[152:155], v[40:43], a[200:203], v[152:155]
  v_mfma_f32_16x16x32_bf16 v[156:159], v[40:43], a[204:207], v[156:159]
  s_waitcnt lgkmcnt(4)
  v_mfma_f32_16x16x32_bf16 v[144:147], v[44:47], a[208:211], v[144:147]
  ds_read_b64_tr_b16 v[40:41], v13 offset:8192
  v_mfma_f32_16x16x32_bf16 v[148:151], v[44:47], a[212:215], v[148:151]
  ds_read_b64_tr_b16 v[42:43], v13 offset:8704
  v_mfma_f32_16x16x32_bf16 v[152:155], v[44:47], a[216:219], v[152:155]
  v_mfma_f32_16x16x32_bf16 v[156:159], v[44:47], a[220:223], v[156:159]
  s_waitcnt lgkmcnt(4)
  buffer_store_dwordx4 v[120:123], v15, s[36:39], s83 offen offset:2048
  v_mfma_f32_16x16x32_bf16 v[160:163], v[32:35], a[192:195], v[160:163]
  ds_read_b64_tr_b16 v[44:45], v13 offset:12288
  v_mfma_f32_16x16x32_bf16 v[164:167], v[32:35], a[196:199], v[164:167]
  ds_read_b64_tr_b16 v[46:47], v13 offset:12800
  v_mfma_f32_16x16x32_bf16 v[168:171], v[32:35], a[200:203], v[168:171]
  v_mfma_f32_16x16x32_bf16 v[172:175], v[32:35], a[204:207], v[172:175]
  s_waitcnt lgkmcnt(4)
  v_mfma_f32_16x16x32_bf16 v[160:163], v[36:39], a[208:211], v[160:163]
  ds_read_b64_tr_b16 v[32:33], v12 offset:256
  v_mfma_f32_16x16x32_bf16 v[164:167], v[36:39], a[212:215], v[164:167]
  ds_read_b64_tr_b16 v[34:35], v12 offset:768
  v_mfma_f32_16x16x32_bf16 v[168:171], v[36:39], a[216:219], v[168:171]
  v_mfma_f32_16x16x32_bf16 v[172:175], v[36:39], a[220:223], v[172:175]
  s_waitcnt lgkmcnt(4)
  buffer_load_dwordx4 v4, s[16:19], s72 offen offset:2048 lds
  v_mfma_f32_16x16x32_bf16 v[176:179], v[40:43], a[192:195], v[176:179]
  ds_read_b64_tr_b16 v[36:37], v12 offset:4352
  v_mfma_f32_16x16x32_bf16 v[180:183], v[40:43], a[196:199], v[180:183]
  ds_read_b64_tr_b16 v[38:39], v12 offset:4864
  v_mfma_f32_16x16x32_bf16 v[184:187], v[40:43], a[200:203], v[184:187]
  v_mfma_f32_16x16x32_bf16 v[188:191], v[40:43], a[204:207], v[188:191]
  s_waitcnt lgkmcnt(4)
  v_mfma_f32_16x16x32_bf16 v[176:179], v[44:47], a[208:211], v[176:179]
  ds_read_b64_tr_b16 v[40:41], v12 offset:8448
  v_mfma_f32_16x16x32_bf16 v[180:183], v[44:47], a[212:215], v[180:183]
  ds_read_b64_tr_b16 v[42:43], v12 offset:8960
  v_mfma_f32_16x16x32_bf16 v[184:187], v[44:47], a[216:219], v[184:187]
  v_mfma_f32_16x16x32_bf16 v[188:191], v[44:47], a[220:223], v[188:191]
  s_waitcnt lgkmcnt(4)
  v_mfma_f32_16x16x32_bf16 v[192:195], v[32:35], a[192:195], v[192:195]
  ds_read_b64_tr_b16 v[44:45], v12 offset:12544
  v_mfma_f32_16x16x32_bf16 v[196:199], v[32:35], a[196:199], v[196:199]
  ds_read_b64_tr_b16 v[46:47], v12 offset:13056
  v_mfma_f32_16x16x32_bf16 v[200:203], v[32:35], a[200:203], v[200:203]
  v_mfma_f32_16x16x32_bf16 v[204:207], v[32:35], a[204:207], v[204:207]
  s_waitcnt lgkmcnt(4)
  v_mfma_f32_16x16x32_bf16 v[192:195], v[36:39], a[208:211], v[192:195]
  ds_read_b64_tr_b16 v[32:33], v13 offset:256
  v_mfma_f32_16x16x32_bf16 v[196:199], v[36:39], a[212:215], v[196:199]
  ds_read_b64_tr_b16 v[34:35], v13 offset:768
  v_mfma_f32_16x16x32_bf16 v[200:203], v[36:39], a[216:219], v[200:203]
  v_mfma_f32_16x16x32_bf16 v[204:207], v[36:39], a[220:223], v[204:207]
  s_waitcnt lgkmcnt(4)
  buffer_load_dwordx4 v5, s[16:19], s72 offen offset:3072 lds
  v_mfma_f32_16x16x32_bf16 v[208:211], v[40:43], a[192:195], v[208:211]
  ds_read_b64_tr_b16 v[36:37], v13 offset:4352
  v_mfma_f32_16x16x32_bf16 v[212:215], v[40:43], a[196:199], v[212:215]
  ds_read_b64_tr_b16 v[38:39], v13 offset:4864
  v_mfma_f32_16x16x32_bf16 v[216:219], v[40:43], a[200:203], v[216:219]
  v_mfma_f32_16x16x32_bf16 v[220:223], v[40:43], a[204:207], v[220:223]
  s_waitcnt lgkmcnt(4)
  buffer_store_dwordx4 v[124:127], v15, s[36:39], s83 offen offset:3072
  v_mfma_f32_16x16x32_bf16 v[208:211], v[44:47], a[208:211], v[208:211]
  ds_read_b64_tr_b16 v[40:41], v13 offset:8448
  v_mfma_f32_16x16x32_bf16 v[212:215], v[44:47], a[212:215], v[212:215]
  ds_read_b64_tr_b16 v[42:43], v13 offset:8960
  v_mfma_f32_16x16x32_bf16 v[216:219], v[44:47], a[216:219], v[216:219]
  v_mfma_f32_16x16x32_bf16 v[220:223], v[44:47], a[220:223], v[220:223]
  s_waitcnt lgkmcnt(4)
  v_mfma_f32_16x16x32_bf16 v[224:227], v[32:35], a[192:195], v[224:227]
  ds_read_b64_tr_b16 v[44:45], v13 offset:12544
  v_mfma_f32_16x16x32_bf16 v[228:231], v[32:35], a[196:199], v[228:231]
  ds_read_b64_tr_b16 v[46:47], v13 offset:13056
  v_mfma_f32_16x16x32_bf16 v[232:235], v[32:35], a[200:203], v[232:235]
  v_mfma_f32_16x16x32_bf16 v[236:239], v[32:35], a[204:207], v[236:239]
  s_waitcnt lgkmcnt(4)
  s_barrier
  v_mfma_f32_16x16x32_bf16 v[224:227], v[36:39], a[208:211], v[224:227]
  ds_read_b64_tr_b16 v[32:33], v14 offset:0
  v_mfma_f32_16x16x32_bf16 v[228:231], v[36:39], a[212:215], v[228:231]
  s_add_u32 s71, s71, 1
  s_and_b32 s71, s71, 7
  ds_read_b64_tr_b16 v[34:35], v14 offset:512
  v_mfma_f32_16x16x32_bf16 v[232:235], v[36:39], a[216:219], v[232:235]
  s_add_u32 m0, s77, 98304
  s_lshl_b32 s72, s71, 19
  v_mfma_f32_16x16x32_bf16 v[236:239], v[36:39], a[220:223], v[236:239]
  s_waitcnt lgkmcnt(4)
  buffer_load_dwordx4 v2, s[16:19], s72 offen offset:0 lds
  v_mfma_f32_16x16x32_bf16 v[240:243], v[40:43], a[192:195], v[240:243]
  ds_read_b64_tr_b16 v[36:37], v14 offset:4096
  v_mfma_f32_16x16x32_bf16 v[244:247], v[40:43], a[196:199], v[244:247]
  ds_read_b64_tr_b16 v[38:39], v14 offset:4608
  v_mfma_f32_16x16x32_bf16 v[248:251], v[40:43], a[200:203], v[248:251]
  s_add_u32 s83, s79, 16384
  v_mfma_f32_16x16x32_bf16 v[252:255], v[40:43], a[204:207], v[252:255]
  s_waitcnt lgkmcnt(4)
  buffer_store_dwordx4 v[64:67], v15, s[36:39], s83 offen offset:0
  v_mfma_f32_16x16x32_bf16 v[240:243], v[44:47], a[208:211], v[240:243]
  ds_read_b64_tr_b16 v[40:41], v14 offset:8192
  v_mfma_f32_16x16x32_bf16 v[244:247], v[44:47], a[212:215], v[244:247]
  ds_read_b64_tr_b16 v[42:43], v14 offset:8704
  v_mfma_f32_16x16x32_bf16 v[248:251], v[44:47], a[216:219], v[248:251]
  v_mfma_f32_16x16x32_bf16 v[252:255], v[44:47], a[220:223], v[252:255]
  s_waitcnt vmcnt(21) lgkmcnt(4)
  v_mfma_f32_16x16x32_bf16 v[128:131], v[32:35], a[224:227], v[128:131]
  ds_read_b64_tr_b16 v[44:45], v14 offset:12288
  v_mfma_f32_16x16x32_bf16 v[132:135], v[32:35], a[228:231], v[132:135]
  ds_read_b64_tr_b16 v[46:47], v14 offset:12800
  v_mfma_f32_16x16x32_bf16 v[136:139], v[32:35], a[232:235], v[136:139]
  v_mfma_f32_16x16x32_bf16 v[140:143], v[32:35], a[236:239], v[140:143]
  s_waitcnt vmcnt(11) lgkmcnt(4)
  v_mfma_f32_16x16x32_bf16 v[128:131], v[36:39], a[240:243], v[128:131]
  ds_read_b64_tr_b16 v[32:33], v28 offset:0
  v_mfma_f32_16x16x32_bf16 v[132:135], v[36:39], a[244:247], v[132:135]
  ds_read_b64_tr_b16 v[34:35], v28 offset:512
  v_mfma_f32_16x16x32_bf16 v[136:139], v[36:39], a[248:251], v[136:139]
  v_mfma_f32_16x16x32_bf16 v[140:143], v[36:39], a[252:255], v[140:143]
  s_waitcnt lgkmcnt(4)
  buffer_load_dwordx4 v3, s[16:19], s72 offen offset:1024 lds
  v_mfma_f32_16x16x32_bf16 v[144:147], v[40:43], a[224:227], v[144:147]
  ds_read_b64_tr_b16 v[36:37], v28 offset:4096
  v_mfma_f32_16x16x32_bf16 v[148:151], v[40:43], a[228:231], v[148:151]
  ds_read_b64_tr_b16 v[38:39], v28 offset:4608
  v_mfma_f32_16x16x32_bf16 v[152:155], v[40:43], a[232:235], v[152:155]
  v_mfma_f32_16x16x32_bf16 v[156:159], v[40:43], a[236:239], v[156:159]
  s_waitcnt lgkmcnt(4)
  v_mfma_f32_16x16x32_bf16 v[144:147], v[44:47], a[240:243], v[144:147]
  ds_read_b64_tr_b16 v[40:41], v28 offset:8192
  v_cmp_ne_u64 vcc, v[16:17], v[60:61]
  s_nop 0
  s_or_b32 s73, vcc_lo, vcc_hi
  s_cmp_eq_u32 s68, 0
  s_cselect_b32 s73, s73, 0
  v_mfma_f32_16x16x32_bf16 v[148:151], v[44:47], a[244:247], v[148:151]
  ds_read_b64_tr_b16 v[42:43], v28 offset:8704
  v_mfma_f32_16x16x32_bf16 v[152:155], v[44:47], a[248:251], v[152:155]
  v_mfma_f32_16x16x32_bf16 v[156:159], v[44:47], a[252:255], v[156:159]
  s_waitcnt lgkmcnt(4)
  v_mfma_f32_16x16x32_bf16 v[160:163], v[32:35], a[224:227], v[160:163]
  ds_read_b64_tr_b16 v[44:45], v28 offset:12288
  v_mfma_f32_16x16x32_bf16 v[164:167], v[32:35], a[228:231], v[164:167]
  ds_read_b64_tr_b16 v[46:47], v28 offset:12800
  v_mul_f32 v128, v128, v144
  v_mfma_f32_16x16x32_bf16 v[168:171], v[32:35], a[232:235], v[168:171]
  v_mul_f32 v129, v129, v145
  v_mul_f32 v130, v130, v146
  v_mfma_f32_16x16x32_bf16 v[172:175], v[32:35], a[236:239], v[172:175]
  s_waitcnt lgkmcnt(4)
  v_mul_f32 v131, v131, v147
  v_mul_f32 v132, v132, v148
  v_mfma_f32_16x16x32_bf16 v[160:163], v[36:39], a[240:243], v[160:163]
  ds_read_b64_tr_b16 v[32:33], v14 offset:256
  v_mul_f32 v133, v133, v149
  v_mfma_f32_16x16x32_bf16 v[164:167], v[36:39], a[244:247], v[164:167]
  ds_read_b64_tr_b16 v[34:35], v14 offset:768
  v_mul_f32 v134, v134, v150
  v_mfma_f32_16x16x32_bf16 v[168:171], v[36:39], a[248:251], v[168:171]
  v_mul_f32 v135, v135, v151
  v_mul_f32 v136, v136, v152
  v_mfma_f32_16x16x32_bf16 v[172:175], v[36:39], a[252:255], v[172:175]
  s_waitcnt lgkmcnt(4)
  v_mul_f32 v137, v137, v153
  v_mul_f32 v138, v138, v154
  v_mfma_f32_16x16x32_bf16 v[176:179], v[40:43], a[224:227], v[176:179]
  ds_read_b64_tr_b16 v[36:37], v14 offset:4352
  v_mul_f32 v139, v139, v155
  v_mfma_f32_16x16x32_bf16 v[180:183], v[40:43], a[228:231], v[180:183]
  ds_read_b64_tr_b16 v[38:39], v14 offset:4864
  v_mul_f32 v140, v140, v156
  v_mfma_f32_16x16x32_bf16 v[184:187], v[40:43], a[232:235], v[184:187]
  v_mul_f32 v141, v141, v157
  v_mul_f32 v142, v142, v158
  v_mfma_f32_16x16x32_bf16 v[188:191], v[40:43], a[236:239], v[188:191]
  s_waitcnt lgkmcnt(4)
  buffer_load_dwordx4 v4, s[16:19], s72 offen offset:2048 lds
  v_mul_f32 v143, v143, v159
  v_mfma_f32_16x16x32_bf16 v[176:179], v[44:47], a[240:243], v[176:179]
  ds_read_b64_tr_b16 v[40:41], v14 offset:8448
  v_mfma_f32_16x16x32_bf16 v[180:183], v[44:47], a[244:247], v[180:183]
  ds_read_b64_tr_b16 v[42:43], v14 offset:8960
  v_mfma_f32_16x16x32_bf16 v[184:187], v[44:47], a[248:251], v[184:187]
  v_mfma_f32_16x16x32_bf16 v[188:191], v[44:47], a[252:255], v[188:191]
  s_waitcnt lgkmcnt(4)
  buffer_store_dwordx4 v[68:71], v15, s[36:39], s83 offen offset:1024
  v_mfma_f32_16x16x32_bf16 v[192:195], v[32:35], a[224:227], v[192:195]
  ds_read_b64_tr_b16 v[44:45], v14 offset:12544
  v_mfma_f32_16x16x32_bf16 v[196:199], v[32:35], a[228:231], v[196:199]
  ds_read_b64_tr_b16 v[46:47], v14 offset:13056
  v_mul_f32 v160, v160, v176
  v_mfma_f32_16x16x32_bf16 v[200:203], v[32:35], a[232:235], v[200:203]
  v_mul_f32 v161, v161, v177
  v_mul_f32 v162, v162, v178
  v_mfma_f32_16x16x32_bf16 v[204:207], v[32:35], a[236:239], v[204:207]
  s_waitcnt lgkmcnt(4)
  v_mul_f32 v163, v163, v179
  v_mul_f32 v164, v164, v180
  v_mfma_f32_16x16x32_bf16 v[192:195], v[36:39], a[240:243], v[192:195]
  ds_read_b64_tr_b16 v[32:33], v28 offset:256
  v_mul_f32 v165, v165, v181
  v_mfma_f32_16x16x32_bf16 v[196:199], v[36:39], a[244:247], v[196:199]
  ds_read_b64_tr_b16 v[34:35], v28 offset:768
  v_mul_f32 v166, v166, v182
  v_mfma_f32_16x16x32_bf16 v[200:203], v[36:39], a[248:251], v[200:203]
  v_mul_f32 v167, v167, v183
  v_mul_f32 v168, v168, v184
  v_mfma_f32_16x16x32_bf16 v[204:207], v[36:39], a[252:255], v[204:207]
  s_waitcnt lgkmcnt(4)
  v_mul_f32 v169, v169, v185
  v_mul_f32 v170, v170, v186
  v_mfma_f32_16x16x32_bf16 v[208:211], v[40:43], a[224:227], v[208:211]
  ds_read_b64_tr_b16 v[36:37], v28 offset:4352
  v_mul_f32 v171, v171, v187
  v_mfma_f32_16x16x32_bf16 v[212:215], v[40:43], a[228:231], v[212:215]
  ds_read_b64_tr_b16 v[38:39], v28 offset:4864
  v_mul_f32 v172, v172, v188
  v_mfma_f32_16x16x32_bf16 v[216:219], v[40:43], a[232:235], v[216:219]
  v_mul_f32 v173, v173, v189
  v_mul_f32 v174, v174, v190
  v_mfma_f32_16x16x32_bf16 v[220:223], v[40:43], a[236:239], v[220:223]
  s_waitcnt lgkmcnt(4)
  v_mul_f32 v175, v175, v191
  v_cvt_pk_bf16_f32 v96, v128, v129
  v_mfma_f32_16x16x32_bf16 v[208:211], v[44:47], a[240:243], v[208:211]
  ds_read_b64_tr_b16 v[40:41], v28 offset:8448
  v_cvt_pk_bf16_f32 v97, v130, v131
  v_mfma_f32_16x16x32_bf16 v[212:215], v[44:47], a[244:247], v[212:215]
  ds_read_b64_tr_b16 v[42:43], v28 offset:8960
  v_cvt_pk_bf16_f32 v98, v160, v161
  v_mfma_f32_16x16x32_bf16 v[216:219], v[44:47], a[248:251], v[216:219]
  v_cvt_pk_bf16_f32 v99, v162, v163
  v_cvt_pk_bf16_f32 v104, v132, v133
  v_mfma_f32_16x16x32_bf16 v[220:223], v[44:47], a[252:255], v[220:223]
  s_waitcnt lgkmcnt(4)
  v_cvt_pk_bf16_f32 v105, v134, v135
  v_cvt_pk_bf16_f32 v106, v164, v165
  v_mfma_f32_16x16x32_bf16 v[224:227], v[32:35], a[224:227], v[224:227]
  ds_read_b64_tr_b16 v[44:45], v28 offset:12544
  v_cvt_pk_bf16_f32 v107, v166, v167
  v_mfma_f32_16x16x32_bf16 v[228:231], v[32:35], a[228:231], v[228:231]
  ds_read_b64_tr_b16 v[46:47], v28 offset:13056
  v_cvt_pk_bf16_f32 v112, v136, v137
  v_mfma_f32_16x16x32_bf16 v[232:235], v[32:35], a[232:235], v[232:235]
  v_cvt_pk_bf16_f32 v113, v138, v139
  v_cvt_pk_bf16_f32 v114, v168, v169
  v_mfma_f32_16x16x32_bf16 v[236:239], v[32:35], a[236:239], v[236:239]
  s_waitcnt lgkmcnt(4)
  s_barrier
  v_add_u32 v12, v12, v59
  v_add_u32 v13, v13, v59
  v_mfma_f32_16x16x32_bf16 v[224:227], v[36:39], a[240:243], v[224:227]
  ds_read_b64_tr_b16 v[32:33], v12 offset:16384
  v_cvt_pk_bf16_f32 v115, v170, v171
  v_mfma_f32_16x16x32_bf16 v[228:231], v[36:39], a[244:247], v[228:231]
  s_add_u32 s71, s71, 1
  s_and_b32 s71, s71, 7
  ds_read_b64_tr_b16 v[34:35], v12 offset:17408
  buffer_load_dwordx4 v5, s[16:19], s72 offen offset:3072 lds
  v_cvt_pk_bf16_f32 v120, v140, v141
  v_mfma_f32_16x16x32_bf16 v[232:235], v[36:39], a[248:251], v[232:235]
  s_add_u32 m0, s77, 49152
  v_cvt_pk_bf16_f32 v121, v142, v143
  v_cvt_pk_bf16_f32 v122, v172, v173
  v_mfma_f32_16x16x32_bf16 v[236:239], v[36:39], a[252:255], v[236:239]
  s_waitcnt lgkmcnt(4)
  v_cvt_pk_bf16_f32 v123, v174, v175
  v_mul_f32 v192, v192, v208
  v_mfma_f32_16x16x32_bf16 v[240:243], v[40:43], a[224:227], v[240:243]
  s_lshl_b32 s72, s71, 19
  ds_read_b64_tr_b16 v[36:37], v12 offset:24576
  v_mul_f32 v193, v193, v209
  v_mfma_f32_16x16x32_bf16 v[244:247], v[40:43], a[228:231], v[244:247]
  ds_read_b64_tr_b16 v[38:39], v12 offset:25600
  v_mul_f32 v194, v194, v210
  v_mfma_f32_16x16x32_bf16 v[248:251], v[40:43], a[232:235], v[248:251]
  v_mul_f32 v195, v195, v211
  v_mul_f32 v196, v196, v212
  v_mfma_f32_16x16x32_bf16 v[252:255], v[40:43], a[236:239], v[252:255]
  s_waitcnt lgkmcnt(4)
  v_mul_f32 v197, v197, v213
  v_mul_f32 v198, v198, v214
  v_mfma_f32_16x16x32_bf16 v[240:243], v[44:47], a[240:243], v[240:243]
  ds_read_b64_tr_b16 v[40:41], v13 offset:16384
  v_mul_f32 v199, v199, v215
  v_mfma_f32_16x16x32_bf16 v[244:247], v[44:47], a[244:247], v[244:247]
  ds_read_b64_tr_b16 v[42:43], v13 offset:17408
  v_mul_f32 v200, v200, v216
  v_mfma_f32_16x16x32_bf16 v[248:251], v[44:47], a[248:251], v[248:251]
  v_mul_f32 v201, v201, v217
  v_mul_f32 v202, v202, v218
  v_mfma_f32_16x16x32_bf16 v[252:255], v[44:47], a[252:255], v[252:255]
  s_waitcnt lgkmcnt(4)
  v_mul_f32 v203, v203, v219
  v_mul_f32 v204, v204, v220
  v_mfma_f32_16x16x32_bf16 v[128:131], v[32:35], a[0:3], 0
  ds_read_b64_tr_b16 v[44:45], v13 offset:24576
  v_mul_f32 v205, v205, v221
  v_mfma_f32_16x16x32_bf16 v[132:135], v[32:35], a[4:7], 0
  ds_read_b64_tr_b16 v[46:47], v13 offset:25600
  v_mul_f32 v206, v206, v222
  v_mfma_f32_16x16x32_bf16 v[136:139], v[32:35], a[8:11], 0
  v_mul_f32 v207, v207, v223
  v_mul_f32 v224, v224, v240
  v_mfma_f32_16x16x32_bf16 v[140:143], v[32:35], a[12:15], 0
  s_waitcnt lgkmcnt(4)
  v_mul_f32 v225, v225, v241
  v_mul_f32 v226, v226, v242
  v_mfma_f32_16x16x32_bf16 v[128:131], v[36:39], a[16:19], v[128:131]
  ds_read_b64_tr_b16 v[32:33], v12 offset:16640
  v_mul_f32 v227, v227, v243
  v_mfma_f32_16x16x32_bf16 v[132:135], v[36:39], a[20:23], v[132:135]
  ds_read_b64_tr_b16 v[34:35], v12 offset:17664
  v_mul_f32 v228, v228, v244
  v_mfma_f32_16x16x32_bf16 v[136:139], v[36:39], a[24:27], v[136:139]
  v_mul_f32 v229, v229, v245
  v_mul_f32 v230, v230, v246
  v_mfma_f32_16x16x32_bf16 v[140:143], v[36:39], a[28:31], v[140:143]
  s_waitcnt lgkmcnt(4)
  v_mul_f32 v231, v231, v247
  v_mul_f32 v232, v232, v248
  v_mfma_f32_16x16x32_bf16 v[144:147], v[40:43], a[0:3], 0
  ds_read_b64_tr_b16 v[36:37], v12 offset:24832
  v_mul_f32 v233, v233, v249
  v_mfma_f32_16x16x32_bf16 v[148:151], v[40:43], a[4:7], 0
  ds_read_b64_tr_b16 v[38:39], v12 offset:25856
  v_mul_f32 v234, v234, v250
  v_mfma_f32_16x16x32_bf16 v[152:155], v[40:43], a[8:11], 0
  v_mul_f32 v235, v235, v251
  v_mul_f32 v236, v236, v252
  v_mfma_f32_16x16x32_bf16 v[156:159], v[40:43], a[12:15], 0
  s_waitcnt lgkmcnt(4)
  v_mul_f32 v237, v237, v253
  v_mul_f32 v238, v238, v254
  v_mfma_f32_16x16x32_bf16 v[144:147], v[44:47], a[16:19], v[144:147]
  ds_read_b64_tr_b16 v[40:41], v13 offset:16640
  v_mul_f32 v239, v239, v255
  v_mfma_f32_16x16x32_bf16 v[148:151], v[44:47], a[20:23], v[148:151]
  ds_read_b64_tr_b16 v[42:43], v13 offset:17664
  v_cvt_pk_bf16_f32 v100, v192, v193
  v_mfma_f32_16x16x32_bf16 v[152:155], v[44:47], a[24:27], v[152:155]
  v_cvt_pk_bf16_f32 v101, v194, v195
  v_cvt_pk_bf16_f32 v102, v224, v225
  v_mfma_f32_16x16x32_bf16 v[156:159], v[44:47], a[28:31], v[156:159]
  s_waitcnt lgkmcnt(4)
  v_cvt_pk_bf16_f32 v103, v226, v227
  v_cvt_pk_bf16_f32 v108, v196, v197
  v_mfma_f32_16x16x32_bf16 v[160:163], v[32:35], a[0:3], 0
  ds_read_b64_tr_b16 v[44:45], v13 offset:24832
  v_cvt_pk_bf16_f32 v109, v198, v199
  v_mfma_f32_16x16x32_bf16 v[164:167], v[32:35], a[4:7], 0
  ds_read_b64_tr_b16 v[46:47], v13 offset:25856
  v_cvt_pk_bf16_f32 v110, v228, v229
  v_add_u32 v10, v10, v59
  v_add_u32 v11, v11, v59
  v_add_u32 v14, v14, v59
  v_add_u32 v28, v28, v59
  v_mfma_f32_16x16x32_bf16 v[168:171], v[32:35], a[8:11], 0
  v_cvt_pk_bf16_f32 v111, v230, v231
  v_cvt_pk_bf16_f32 v116, v200, v201
  v_mfma_f32_16x16x32_bf16 v[172:175], v[32:35], a[12:15], 0
  s_waitcnt lgkmcnt(4)
  v_cvt_pk_bf16_f32 v117, v202, v203
  v_cvt_pk_bf16_f32 v118, v232, v233
  v_mfma_f32_16x16x32_bf16 v[160:163], v[36:39], a[16:19], v[160:163]
  ds_read_b64_tr_b16 v[32:33], v12 offset:16896
  v_cvt_pk_bf16_f32 v119, v234, v235
  v_mfma_f32_16x16x32_bf16 v[164:167], v[36:39], a[20:23], v[164:167]
  ds_read_b64_tr_b16 v[34:35], v12 offset:17920
  v_cvt_pk_bf16_f32 v124, v204, v205
  v_mfma_f32_16x16x32_bf16 v[168:171], v[36:39], a[24:27], v[168:171]
  v_cvt_pk_bf16_f32 v125, v206, v207
  v_cvt_pk_bf16_f32 v126, v236, v237
  v_mfma_f32_16x16x32_bf16 v[172:175], v[36:39], a[28:31], v[172:175]
  s_waitcnt lgkmcnt(4)
  buffer_load_dwordx4 v2, s[16:19], s72 offen offset:0 lds
  v_cvt_pk_bf16_f32 v127, v238, v239
  v_mfma_f32_16x16x32_bf16 v[176:179], v[40:43], a[0:3], 0
  ds_read_b64_tr_b16 v[36:37], v12 offset:25088
  v_mfma_f32_16x16x32_bf16 v[180:183], v[40:43], a[4:7], 0
  ds_read_b64_tr_b16 v[38:39], v12 offset:26112
  v_mfma_f32_16x16x32_bf16 v[184:187], v[40:43], a[8:11], 0
  v_mfma_f32_16x16x32_bf16 v[188:191], v[40:43], a[12:15], 0
  s_waitcnt lgkmcnt(4)
  buffer_load_dwordx4 v3, s[16:19], s72 offen offset:1024 lds
  v_mfma_f32_16x16x32_bf16 v[176:179], v[44:47], a[16:19], v[176:179]
  ds_read_b64_tr_b16 v[40:41], v13 offset:16896
  v_mfma_f32_16x16x32_bf16 v[180:183], v[44:47], a[20:23], v[180:183]
  ds_read_b64_tr_b16 v[42:43], v13 offset:17920
  v_mfma_f32_16x16x32_bf16 v[184:187], v[44:47], a[24:27], v[184:187]
  v_mfma_f32_16x16x32_bf16 v[188:191], v[44:47], a[28:31], v[188:191]
  s_waitcnt lgkmcnt(4)
  buffer_load_dwordx4 v4, s[16:19], s72 offen offset:2048 lds
  v_mfma_f32_16x16x32_bf16 v[192:195], v[32:35], a[0:3], 0
  ds_read_b64_tr_b16 v[44:45], v13 offset:25088
  v_mfma_f32_16x16x32_bf16 v[196:199], v[32:35], a[4:7], 0
  ds_read_b64_tr_b16 v[46:47], v13 offset:26112
  v_mfma_f32_16x16x32_bf16 v[200:203], v[32:35], a[8:11], 0
  v_mfma_f32_16x16x32_bf16 v[204:207], v[32:35], a[12:15], 0
  s_waitcnt lgkmcnt(4)
  buffer_store_dwordx4 v[72:75], v15, s[36:39], s83 offen offset:2048
  v_mfma_f32_16x16x32_bf16 v[192:195], v[36:39], a[16:19], v[192:195]
  ds_read_b64_tr_b16 v[32:33], v12 offset:17152
  v_mfma_f32_16x16x32_bf16 v[196:199], v[36:39], a[20:23], v[196:199]
  ds_read_b64_tr_b16 v[34:35], v12 offset:18176
  v_mfma_f32_16x16x32_bf16 v[200:203], v[36:39], a[24:27], v[200:203]
  v_mfma_f32_16x16x32_bf16 v[204:207], v[36:39], a[28:31], v[204:207]
  s_waitcnt lgkmcnt(4)
  buffer_load_dwordx4 v5, s[16:19], s72 offen offset:3072 lds
  v_mfma_f32_16x16x32_bf16 v[208:211], v[40:43], a[0:3], 0
  ds_read_b64_tr_b16 v[36:37], v12 offset:25344
  v_mfma_f32_16x16x32_bf16 v[212:215], v[40:43], a[4:7], 0
  ds_read_b64_tr_b16 v[38:39], v12 offset:26368
  v_mfma_f32_16x16x32_bf16 v[216:219], v[40:43], a[8:11], 0
  v_mfma_f32_16x16x32_bf16 v[220:223], v[40:43], a[12:15], 0
  s_waitcnt lgkmcnt(4)
  buffer_store_dwordx4 v[76:79], v15, s[36:39], s83 offen offset:3072
  s_add_u32 s83, s79, 20480
  v_mfma_f32_16x16x32_bf16 v[208:211], v[44:47], a[16:19], v[208:211]
  ds_read_b64_tr_b16 v[40:41], v13 offset:17152
  v_mfma_f32_16x16x32_bf16 v[212:215], v[44:47], a[20:23], v[212:215]
  ds_read_b64_tr_b16 v[42:43], v13 offset:18176
  v_mfma_f32_16x16x32_bf16 v[216:219], v[44:47], a[24:27], v[216:219]
  v_mfma_f32_16x16x32_bf16 v[220:223], v[44:47], a[28:31], v[220:223]
  s_waitcnt lgkmcnt(4)
  buffer_store_dwordx4 v[80:83], v15, s[36:39], s83 offen offset:0
  v_mfma_f32_16x16x32_bf16 v[224:227], v[32:35], a[0:3], 0
  ds_read_b64_tr_b16 v[44:45], v13 offset:25344
  v_mfma_f32_16x16x32_bf16 v[228:231], v[32:35], a[4:7], 0
  ds_read_b64_tr_b16 v[46:47], v13 offset:26368
  v_mfma_f32_16x16x32_bf16 v[232:235], v[32:35], a[8:11], 0
  v_mfma_f32_16x16x32_bf16 v[236:239], v[32:35], a[12:15], 0
  s_waitcnt lgkmcnt(4)
  s_waitcnt vmcnt(21)
  s_barrier
  v_mfma_f32_16x16x32_bf16 v[224:227], v[36:39], a[16:19], v[224:227]
  ds_read_b64_tr_b16 v[32:33], v14 offset:16384
  v_mfma_f32_16x16x32_bf16 v[228:231], v[36:39], a[20:23], v[228:231]
  s_add_u32 s71, s71, 1
  s_and_b32 s71, s71, 7
  ds_read_b64_tr_b16 v[34:35], v14 offset:17408
  v_mfma_f32_16x16x32_bf16 v[232:235], v[36:39], a[24:27], v[232:235]
  s_add_u32 m0, s77, 114688
  s_lshl_b32 s72, s71, 19
  v_mfma_f32_16x16x32_bf16 v[236:239], v[36:39], a[28:31], v[236:239]
  s_waitcnt lgkmcnt(4)
  buffer_load_dwordx4 v2, s[16:19], s72 offen offset:0 lds
  v_mfma_f32_16x16x32_bf16 v[240:243], v[40:43], a[0:3], 0
  ds_read_b64_tr_b16 v[36:37], v14 offset:24576
  v_mfma_f32_16x16x32_bf16 v[244:247], v[40:43], a[4:7], 0
  ds_read_b64_tr_b16 v[38:39], v14 offset:25600
  v_mfma_f32_16x16x32_bf16 v[248:251], v[40:43], a[8:11], 0
  v_mfma_f32_16x16x32_bf16 v[252:255], v[40:43], a[12:15], 0
  s_waitcnt lgkmcnt(4)
  buffer_store_dwordx4 v[84:87], v15, s[36:39], s83 offen offset:1024
  v_mfma_f32_16x16x32_bf16 v[240:243], v[44:47], a[16:19], v[240:243]
  ds_read_b64_tr_b16 v[40:41], v28 offset:16384
  v_mfma_f32_16x16x32_bf16 v[244:247], v[44:47], a[20:23], v[244:247]
  ds_read_b64_tr_b16 v[42:43], v28 offset:17408
  v_mfma_f32_16x16x32_bf16 v[248:251], v[44:47], a[24:27], v[248:251]
  v_mfma_f32_16x16x32_bf16 v[252:255], v[44:47], a[28:31], v[252:255]
  s_waitcnt lgkmcnt(4)
  buffer_store_dwordx4 v[88:91], v15, s[36:39], s83 offen offset:2048
  s_getpc_b64 s[98:99]
L_pc6:
  s_sub_u32 s98, s98, L_pc6-L_pc
  s_subb_u32 s99, s99, 0
  global_load_dword v0, v51, s[98:99]
  v_mfma_f32_16x16x32_bf16 v[128:131], v[32:35], a[32:35], v[128:131]
  ds_read_b64_tr_b16 v[44:45], v28 offset:24576
  v_accvgpr_write_b32 a0, 0
  v_mfma_f32_16x16x32_bf16 v[132:135], v[32:35], a[36:39], v[132:135]
  ds_read_b64_tr_b16 v[46:47], v28 offset:25600
  v_mfma_f32_16x16x32_bf16 v[136:139], v[32:35], a[40:43], v[136:139]
  v_accvgpr_write_b32 a1, 0
  v_mfma_f32_16x16x32_bf16 v[140:143], v[32:35], a[44:47], v[140:143]
  s_waitcnt lgkmcnt(4)
  v_mfma_f32_16x16x32_bf16 v[128:131], v[36:39], a[48:51], v[128:131]
  ds_read_b64_tr_b16 v[32:33], v14 offset:16640
  v_accvgpr_write_b32 a2, 0
  v_mfma_f32_16x16x32_bf16 v[132:135], v[36:39], a[52:55], v[132:135]
  ds_read_b64_tr_b16 v[34:35], v14 offset:17664
  v_mfma_f32_16x16x32_bf16 v[136:139], v[36:39], a[56:59], v[136:139]
  v_accvgpr_write_b32 a3, 0
  v_mfma_f32_16x16x32_bf16 v[140:143], v[36:39], a[60:63], v[140:143]
  s_waitcnt lgkmcnt(4)
  buffer_load_dwordx4 v3, s[16:19], s72 offen offset:1024 lds
  v_mfma_f32_16x16x32_bf16 v[144:147], v[40:43], a[32:35], v[144:147]
  ds_read_b64_tr_b16 v[36:37], v14 offset:24832
  v_accvgpr_write_b32 a4, 0
  v_mfma_f32_16x16x32_bf16 v[148:151], v[40:43], a[36:39], v[148:151]
  ds_read_b64_tr_b16 v[38:39], v14 offset:25856
  v_mfma_f32_16x16x32_bf16 v[152:155], v[40:43], a[40:43], v[152:155]
  v_accvgpr_write_b32 a5, 0
  v_mfma_f32_16x16x32_bf16 v[156:159], v[40:43], a[44:47], v[156:159]
  s_waitcnt lgkmcnt(4)
  v_mfma_f32_16x16x32_bf16 v[144:147], v[44:47], a[48:51], v[144:147]
  ds_read_b64_tr_b16 v[40:41], v28 offset:16640
  v_accvgpr_write_b32 a6, 0
  v_mfma_f32_16x16x32_bf16 v[148:151], v[44:47], a[52:55], v[148:151]
  ds_read_b64_tr_b16 v[42:43], v28 offset:17664
  v_mfma_f32_16x16x32_bf16 v[152:155], v[44:47], a[56:59], v[152:155]
  v_accvgpr_write_b32 a7, 0
  v_mfma_f32_16x16x32_bf16 v[156:159], v[44:47], a[60:63], v[156:159]
  s_waitcnt lgkmcnt(4)
  v_mfma_f32_16x16x32_bf16 v[160:163], v[32:35], a[32:35], v[160:163]
  ds_read_b64_tr_b16 v[44:45], v28 offset:24832
  v_accvgpr_write_b32 a8, 0
  v_mfma_f32_16x16x32_bf16 v[164:167], v[32:35], a[36:39], v[164:167]
  ds_read_b64_tr_b16 v[46:47], v28 offset:25856
  v_mfma_f32_16x16x32_bf16 v[168:171], v[32:35], a[40:43], v[168:171]
  v_accvgpr_write_b32 a9, 0
  v_mfma_f32_16x16x32_bf16 v[172:175], v[32:35], a[44:47], v[172:175]
  s_waitcnt lgkmcnt(4)
  v_mfma_f32_16x16x32_bf16 v[160:163], v[36:39], a[48:51], v[160:163]
  ds_read_b64_tr_b16 v[32:33], v14 offset:16896
  v_accvgpr_write_b32 a10, 0
  v_mfma_f32_16x16x32_bf16 v[164:167], v[36:39], a[52:55], v[164:167]
  ds_read_b64_tr_b16 v[34:35], v14 offset:17920
  v_mfma_f32_16x16x32_bf16 v[168:171], v[36:39], a[56:59], v[168:171]
  v_accvgpr_write_b32 a11, 0
  v_mfma_f32_16x16x32_bf16 v[172:175], v[36:39], a[60:63], v[172:175]
  s_waitcnt lgkmcnt(4)
  buffer_load_dwordx4 v4, s[16:19], s72 offen offset:2048 lds
  v_mfma_f32_16x16x32_bf16 v[176:179], v[40:43], a[32:35], v[176:179]
  ds_read_b64_tr_b16 v[36:37], v14 offset:25088
  v_accvgpr_write_b32 a12, 0
  v_mfma_f32_16x16x32_bf16 v[180:183], v[40:43], a[36:39], v[180:183]
  ds_read_b64_tr_b16 v[38:39], v14 offset:26112
  v_mfma_f32_16x16x32_bf16 v[184:187], v[40:43], a[40:43], v[184:187]
  v_accvgpr_write_b32 a13, 0
  v_mfma_f32_16x16x32_bf16 v[188:191], v[40:43], a[44:47], v[188:191]
  s_waitcnt lgkmcnt(4)
  buffer_store_dwordx4 v[92:95], v15, s[36:39], s83 offen offset:3072
  v_mfma_f32_16x16x32_bf16 v[176:179], v[44:47], a[48:51], v[176:179]
  ds_read_b64_tr_b16 v[40:41], v28 offset:16896
  v_accvgpr_write_b32 a14, 0
  v_mfma_f32_16x16x32_bf16 v[180:183], v[44:47], a[52:55], v[180:183]
  ds_read_b64_tr_b16 v[42:43], v28 offset:17920
  v_mfma_f32_16x16x32_bf16 v[184:187], v[44:47], a[56:59], v[184:187]
  v_accvgpr_write_b32 a15, 0
  v_mfma_f32_16x16x32_bf16 v[188:191], v[44:47], a[60:63], v[188:191]
  s_waitcnt lgkmcnt(4)
  v_mfma_f32_16x16x32_bf16 v[192:195], v[32:35], a[32:35], v[192:195]
  ds_read_b64_tr_b16 v[44:45], v28 offset:25088
  v_accvgpr_write_b32 a16, 0
  v_mfma_f32_16x16x32_bf16 v[196:199], v[32:35], a[36:39], v[196:199]
  ds_read_b64_tr_b16 v[46:47], v28 offset:26112
  v_mfma_f32_16x16x32_bf16 v[200:203], v[32:35], a[40:43], v[200:203]
  v_accvgpr_write_b32 a17, 0
  v_mfma_f32_16x16x32_bf16 v[204:207], v[32:35], a[44:47], v[204:207]
  s_waitcnt lgkmcnt(4)
  v_mfma_f32_16x16x32_bf16 v[192:195], v[36:39], a[48:51], v[192:195]
  ds_read_b64_tr_b16 v[32:33], v14 offset:17152
  v_accvgpr_write_b32 a18, 0
  v_mfma_f32_16x16x32_bf16 v[196:199], v[36:39], a[52:55], v[196:199]
  ds_read_b64_tr_b16 v[34:35], v14 offset:18176
  v_mfma_f32_16x16x32_bf16 v[200:203], v[36:39], a[56:59], v[200:203]
  v_accvgpr_write_b32 a19, 0
  v_mfma_f32_16x16x32_bf16 v[204:207], v[36:39], a[60:63], v[204:207]
  s_waitcnt lgkmcnt(4)
  buffer_load_dwordx4 v5, s[16:19], s72 offen offset:3072 lds
  v_mfma_f32_16x16x32_bf16 v[208:211], v[40:43], a[32:35], v[208:211]
  ds_read_b64_tr_b16 v[36:37], v14 offset:25344
  v_accvgpr_write_b32 a20, 0
  v_mfma_f32_16x16x32_bf16 v[212:215], v[40:43], a[36:39], v[212:215]
  ds_read_b64_tr_b16 v[38:39], v14 offset:26368
  v_mfma_f32_16x16x32_bf16 v[216:219], v[40:43], a[40:43], v[216:219]
  v_accvgpr_write_b32 a21, 0
  v_mfma_f32_16x16x32_bf16 v[220:223], v[40:43], a[44:47], v[220:223]
  s_waitcnt lgkmcnt(4)
  v_mfma_f32_16x16x32_bf16 v[208:211], v[44:47], a[48:51], v[208:211]
  ds_read_b64_tr_b16 v[40:41], v28 offset:17152
  v_accvgpr_write_b32 a22, 0
  v_mfma_f32_16x16x32_bf16 v[212:215], v[44:47], a[52:55], v[212:215]
  ds_read_b64_tr_b16 v[42:43], v28 offset:18176
  v_mfma_f32_16x16x32_bf16 v[216:219], v[44:47], a[56:59], v[216:219]
  v_accvgpr_write_b32 a23, 0
  v_mfma_f32_16x16x32_bf16 v[220:223], v[44:47], a[60:63], v[220:223]
  s_waitcnt lgkmcnt(4)
  v_mfma_f32_16x16x32_bf16 v[224:227], v[32:35], a[32:35], v[224:227]
  ds_read_b64_tr_b16 v[44:45], v28 offset:25344
  v_accvgpr_write_b32 a24, 0
  v_mfma_f32_16x16x32_bf16 v[228:231], v[32:35], a[36:39], v[228:231]
  ds_read_b64_tr_b16 v[46:47], v28 offset:26368
  v_mfma_f32_16x16x32_bf16 v[232:235], v[32:35], a[40:43], v[232:235]
  v_accvgpr_write_b32 a25, 0
  v_mfma_f32_16x16x32_bf16 v[236:239], v[32:35], a[44:47], v[236:239]
  s_waitcnt lgkmcnt(4)
  s_waitcnt vmcnt(22)
  s_barrier
  v_mfma_f32_16x16x32_bf16 v[224:227], v[36:39], a[48:51], v[224:227]
  ds_read_b64_tr_b16 v[32:33], v12 offset:32768
  v_accvgpr_write_b32 a26, 0
  v_mfma_f32_16x16x32_bf16 v[228:231], v[36:39], a[52:55], v[228:231]
  s_add_u32 s71, s71, 1
  s_and_b32 s71, s71, 7
  ds_read_b64_tr_b16 v[34:35], v12 offset:33792
  v_mfma_f32_16x16x32_bf16 v[232:235], v[36:39], a[56:59], v[232:235]
  s_add_u32 m0, s77, 131072
  s_lshl_b32 s72, s71, 19
  v_accvgpr_write_b32 a27, 0
  v_mfma_f32_16x16x32_bf16 v[236:239], v[36:39], a[60:63], v[236:239]
  s_waitcnt lgkmcnt(4)
  buffer_load_dwordx4 v2, s[16:19], s72 offen offset:0 lds
  v_mfma_f32_16x16x32_bf16 v[240:243], v[40:43], a[32:35], v[240:243]
  ds_read_b64_tr_b16 v[36:37], v12 offset:40960
  v_accvgpr_write_b32 a28, 0
  v_mfma_f32_16x16x32_bf16 v[244:247], v[40:43], a[36:39], v[244:247]
  ds_read_b64_tr_b16 v[38:39], v12 offset:41984
  v_mfma_f32_16x16x32_bf16 v[248:251], v[40:43], a[40:43], v[248:251]
  v_accvgpr_write_b32 a29, 0
  v_mfma_f32_16x16x32_bf16 v[252:255], v[40:43], a[44:47], v[252:255]
  s_waitcnt lgkmcnt(4)
  v_mfma_f32_16x16x32_bf16 v[240:243], v[44:47], a[48:51], v[240:243]
  ds_read_b64_tr_b16 v[40:41], v13 offset:32768
  v_accvgpr_write_b32 a30, 0
  v_mfma_f32_16x16x32_bf16 v[244:247], v[44:47], a[52:55], v[244:247]
  ds_read_b64_tr_b16 v[42:43], v13 offset:33792
  v_mfma_f32_16x16x32_bf16 v[248:251], v[44:47], a[56:59], v[248:251]
  v_accvgpr_write_b32 a31, 0
  v_mfma_f32_16x16x32_bf16 v[252:255], v[44:47], a[60:63], v[252:255]
  s_waitcnt lgkmcnt(4)
  buffer_load_dwordx4 v3, s[16:19], s72 offen offset:1024 lds
  v_mfma_f32_16x16x32_bf16 v[128:131], v[32:35], a[64:67], v[128:131]
  ds_read_b64_tr_b16 v[44:45], v13 offset:40960
  v_accvgpr_write_b32 a32, 0
  v_mfma_f32_16x16x32_bf16 v[132:135], v[32:35], a[68:71], v[132:135]
  ds_read_b64_tr_b16 v[46:47], v13 offset:41984
  v_mfma_f32_16x16x32_bf16 v[136:139], v[32:35], a[72:75], v[136:139]
  v_accvgpr_write_b32 a33, 0
  v_mfma_f32_16x16x32_bf16 v[140:143], v[32:35], a[76:79], v[140:143]
  s_waitcnt lgkmcnt(4)
  v_mfma_f32_16x16x32_bf16 v[128:131], v[36:39], a[80:83], v[128:131]
  ds_read_b64_tr_b16 v[32:33], v12 offset:33024
  v_accvgpr_write_b32 a34, 0
  v_mfma_f32_16x16x32_bf16 v[132:135], v[36:39], a[84:87], v[132:135]
  ds_read_b64_tr_b16 v[34:35], v12 offset:34048
  v_mfma_f32_16x16x32_bf16 v[136:139], v[36:39], a[88:91], v[136:139]
  v_accvgpr_write_b32 a35, 0
  v_mfma_f32_16x16x32_bf16 v[140:143], v[36:39], a[92:95], v[140:143]
  s_waitcnt lgkmcnt(4)
  buffer_load_dwordx4 v4, s[16:19], s72 offen offset:2048 lds
  v_mfma_f32_16x16x32_bf16 v[144:147], v[40:43], a[64:67], v[144:147]
  s_lshr_b32 s83, s81, 14
  s_add_u32 s83, s83, 0
  ds_read_b64_tr_b16 v[36:37], v12 offset:41216
  v_mfma_f32_16x16x32_bf16 v[148:151], v[40:43], a[68:71], v[148:151]
  s_mul_i32 s83, s83, 57344
  s_lshl_b32 s84, s69, 11
  ds_read_b64_tr_b16 v[38:39], v12 offset:42240
  v_mfma_f32_16x16x32_bf16 v[152:155], v[40:43], a[72:75], v[152:155]
  s_add_u32 s83, s83, s84
  v_accvgpr_write_b32 a36, 0
  v_accvgpr_write_b32 a37, 0
  v_mfma_f32_16x16x32_bf16 v[156:159], v[40:43], a[76:79], v[156:159]
  s_waitcnt lgkmcnt(4)
  buffer_store_dwordx4 v[96:99], v15, s[40:43], s83 offen offset:0 sc1
  v_mfma_f32_16x16x32_bf16 v[144:147], v[44:47], a[80:83], v[144:147]
  ds_read_b64_tr_b16 v[40:41], v13 offset:33024
  v_accvgpr_write_b32 a38, 0
  v_mfma_f32_16x16x32_bf16 v[148:151], v[44:47], a[84:87], v[148:151]
  ds_read_b64_tr_b16 v[42:43], v13 offset:34048
  v_mfma_f32_16x16x32_bf16 v[152:155], v[44:47], a[88:91], v[152:155]
  v_accvgpr_write_b32 a39, 0
  v_mfma_f32_16x16x32_bf16 v[156:159], v[44:47], a[92:95], v[156:159]
  s_waitcnt lgkmcnt(4)
  buffer_load_dwordx4 v5, s[16:19], s72 offen offset:3072 lds
  v_mfma_f32_16x16x32_bf16 v[160:163], v[32:35], a[64:67], v[160:163]
  ds_read_b64_tr_b16 v[44:45], v13 offset:41216
  v_accvgpr_write_b32 a40, 0
  v_mfma_f32_16x16x32_bf16 v[164:167], v[32:35], a[68:71], v[164:167]
  ds_read_b64_tr_b16 v[46:47], v13 offset:42240
  v_mfma_f32_16x16x32_bf16 v[168:171], v[32:35], a[72:75], v[168:171]
  v_accvgpr_write_b32 a41, 0
  v_mfma_f32_16x16x32_bf16 v[172:175], v[32:35], a[76:79], v[172:175]
  s_waitcnt lgkmcnt(4)
  v_mfma_f32_16x16x32_bf16 v[160:163], v[36:39], a[80:83], v[160:163]
  ds_read_b64_tr_b16 v[32:33], v12 offset:33280
  v_accvgpr_write_b32 a42, 0
  v_mfma_f32_16x16x32_bf16 v[164:167], v[36:39], a[84:87], v[164:167]
  s_add_u32 s71, s71, 1
  s_and_b32 s71, s71, 7
  ds_read_b64_tr_b16 v[34:35], v12 offset:34304
  v_mfma_f32_16x16x32_bf16 v[168:171], v[36:39], a[88:91], v[168:171]
  s_add_u32 m0, s77, 147456
  s_lshl_b32 s72, s71, 19
  v_accvgpr_write_b32 a43, 0
  v_mfma_f32_16x16x32_bf16 v[172:175], v[36:39], a[92:95], v[172:175]
  s_waitcnt lgkmcnt(4)
  buffer_load_dwordx4 v2, s[16:19], s72 offen offset:0 lds
  v_mfma_f32_16x16x32_bf16 v[176:179], v[40:43], a[64:67], v[176:179]
  ds_read_b64_tr_b16 v[36:37], v12 offset:41472
  v_accvgpr_write_b32 a44, 0
  v_mfma_f32_16x16x32_bf16 v[180:183], v[40:43], a[68:71], v[180:183]
  ds_read_b64_tr_b16 v[38:39], v12 offset:42496
  v_mfma_f32_16x16x32_bf16 v[184:187], v[40:43], a[72:75], v[184:187]
  v_accvgpr_write_b32 a45, 0
  v_mfma_f32_16x16x32_bf16 v[188:191], v[40:43], a[76:79], v[188:191]
  s_waitcnt lgkmcnt(4)
  buffer_store_dwordx4 v[100:103], v15, s[40:43], s83 offen offset:1024 sc1
  v_mfma_f32_16x16x32_bf16 v[176:179], v[44:47], a[80:83], v[176:179]
  ds_read_b64_tr_b16 v[40:41], v13 offset:33280
  v_accvgpr_write_b32 a46, 0
  v_mfma_f32_16x16x32_bf16 v[180:183], v[44:47], a[84:87], v[180:183]
  ds_read_b64_tr_b16 v[42:43], v13 offset:34304
  v_mfma_f32_16x16x32_bf16 v[184:187], v[44:47], a[88:91], v[184:187]
  v_accvgpr_write_b32 a47, 0
  v_mfma_f32_16x16x32_bf16 v[188:191], v[44:47], a[92:95], v[188:191]
  s_waitcnt lgkmcnt(4)
  buffer_load_dwordx4 v3, s[16:19], s72 offen offset:1024 lds
  v_mfma_f32_16x16x32_bf16 v[192:195], v[32:35], a[64:67], v[192:195]
  ds_read_b64_tr_b16 v[44:45], v13 offset:41472
  v_accvgpr_write_b32 a48, 0
  v_mfma_f32_16x16x32_bf16 v[196:199], v[32:35], a[68:71], v[196:199]
  ds_read_b64_tr_b16 v[46:47], v13 offset:42496
  v_mfma_f32_16x16x32_bf16 v[200:203], v[32:35], a[72:75], v[200:203]
  v_accvgpr_write_b32 a49, 0
  v_mfma_f32_16x16x32_bf16 v[204:207], v[32:35], a[76:79], v[204:207]
  s_waitcnt lgkmcnt(4)
  v_mfma_f32_16x16x32_bf16 v[192:195], v[36:39], a[80:83], v[192:195]
  ds_read_b64_tr_b16 v[32:33], v12 offset:33536
  v_accvgpr_write_b32 a50, 0
  v_mfma_f32_16x16x32_bf16 v[196:199], v[36:39], a[84:87], v[196:199]
  ds_read_b64_tr_b16 v[34:35], v12 offset:34560
  v_mfma_f32_16x16x32_bf16 v[200:203], v[36:39], a[88:91], v[200:203]
  v_accvgpr_write_b32 a51, 0
  v_mfma_f32_16x16x32_bf16 v[204:207], v[36:39], a[92:95], v[204:207]
  s_waitcnt lgkmcnt(4)
  buffer_load_dwordx4 v4, s[16:19], s72 offen offset:2048 lds
  v_mfma_f32_16x16x32_bf16 v[208:211], v[40:43], a[64:67], v[208:211]
  ds_read_b64_tr_b16 v[36:37], v12 offset:41728
  v_accvgpr_write_b32 a52, 0
  v_mfma_f32_16x16x32_bf16 v[212:215], v[40:43], a[68:71], v[212:215]
  ds_read_b64_tr_b16 v[38:39], v12 offset:42752
  v_mfma_f32_16x16x32_bf16 v[216:219], v[40:43], a[72:75], v[216:219]
  v_accvgpr_write_b32 a53, 0
  v_mfma_f32_16x16x32_bf16 v[220:223], v[40:43], a[76:79], v[220:223]
  s_waitcnt lgkmcnt(4)
  v_mfma_f32_16x16x32_bf16 v[208:211], v[44:47], a[80:83], v[208:211]
  s_lshr_b32 s83, s81, 14
  s_add_u32 s83, s83, s33
  ds_read_b64_tr_b16 v[40:41], v13 offset:33536
  v_mfma_f32_16x16x32_bf16 v[212:215], v[44:47], a[84:87], v[212:215]
  s_mul_i32 s83, s83, 57344
  s_lshl_b32 s84, s69, 11
  ds_read_b64_tr_b16 v[42:43], v13 offset:34560
  v_mfma_f32_16x16x32_bf16 v[216:219], v[44:47], a[88:91], v[216:219]
  s_add_u32 s83, s83, s84
  v_accvgpr_write_b32 a54, 0
  v_accvgpr_write_b32 a55, 0
  v_mfma_f32_16x16x32_bf16 v[220:223], v[44:47], a[92:95], v[220:223]
  s_waitcnt lgkmcnt(4)
  buffer_load_dwordx4 v5, s[16:19], s72 offen offset:3072 lds
  v_mfma_f32_16x16x32_bf16 v[224:227], v[32:35], a[64:67], v[224:227]
  ds_read_b64_tr_b16 v[44:45], v13 offset:41728
  v_accvgpr_write_b32 a56, 0
  v_mfma_f32_16x16x32_bf16 v[228:231], v[32:35], a[68:71], v[228:231]
  ds_read_b64_tr_b16 v[46:47], v13 offset:42752
  v_mfma_f32_16x16x32_bf16 v[232:235], v[32:35], a[72:75], v[232:235]
  v_accvgpr_write_b32 a57, 0
  v_mfma_f32_16x16x32_bf16 v[236:239], v[32:35], a[76:79], v[236:239]
  s_waitcnt lgkmcnt(4)
  s_waitcnt vmcnt(11)
  s_barrier
  v_mfma_f32_16x16x32_bf16 v[224:227], v[36:39], a[80:83], v[224:227]
  s_lshl_b32 s75, s69, 10
  ds_read_b64_tr_b16 v[32:33], v10 offset:0
  v_and_b32 v50, 7, v1
  v_mfma_f32_16x16x32_bf16 v[228:231], v[36:39], a[84:87], v[228:231]
  s_add_u32 s71, s71, 1
  s_and_b32 s71, s71, 7
  ds_read_b64_tr_b16 v[34:35], v10 offset:1024
  v_mfma_f32_16x16x32_bf16 v[232:235], v[36:39], a[88:91], v[232:235]
  v_lshlrev_b32 v50, 7, v50
  v_add_u32 v50, s75, v50
  s_cmp_lg_u32 s73, 0
  s_cbranch_scc1 Lwb
Lwbr:
  v_mfma_f32_16x16x32_bf16 v[236:239], v[36:39], a[92:95], v[236:239]
  s_waitcnt lgkmcnt(4)
  buffer_store_dwordx4 v[104:107], v15, s[40:43], s83 offen offset:0 sc1
  v_add_u32 v50, 0x1008000, v50
  v_mfma_f32_16x16x32_bf16 v[240:243], v[40:43], a[64:67], v[240:243]
  ds_read_b64_tr_b16 v[36:37], v10 offset:8192
  v_accvgpr_write_b32 a58, 0
  v_mfma_f32_16x16x32_bf16 v[244:247], v[40:43], a[68:71], v[244:247]
  ds_read_b64_tr_b16 v[38:39], v10 offset:9216
  v_accvgpr_write_b32 a59, 0
  v_mfma_f32_16x16x32_bf16 v[248:251], v[40:43], a[72:75], v[248:251]
  s_add_u32 s1, s0, 0
  v_accvgpr_write_b32 a60, 0
  v_accvgpr_write_b32 a61, 0
  v_mfma_f32_16x16x32_bf16 v[252:255], v[40:43], a[76:79], v[252:255]
  s_waitcnt lgkmcnt(4)
  buffer_load_dword v0, v55, s[56:59], s1 offen
  v_mfma_f32_16x16x32_bf16 v[240:243], v[44:47], a[80:83], v[240:243]
  ds_read_b64_tr_b16 v[40:41], v11 offset:0
  v_accvgpr_write_b32 a62, 0
  v_mfma_f32_16x16x32_bf16 v[244:247], v[44:47], a[84:87], v[244:247]
  ds_read_b64_tr_b16 v[42:43], v11 offset:1024
  buffer_store_dword v52, v31, s[44:47], s86 offen sc1
  v_mfma_f32_16x16x32_bf16 v[248:251], v[44:47], a[88:91], v[248:251]
  v_accvgpr_write_b32 a63, 0
  v_mfma_f32_16x16x32_bf16 v[252:255], v[44:47], a[92:95], v[252:255]
  s_waitcnt lgkmcnt(4)
  v_mfma_f32_16x16x32_bf16 v[128:131], v[32:35], a[96:99], v[128:131]
  ds_read_b64_tr_b16 v[44:45], v11 offset:8192
  v_accvgpr_write_b32 a64, 0
  v_mfma_f32_16x16x32_bf16 v[132:135], v[32:35], a[100:103], v[132:135]
  ds_read_b64_tr_b16 v[46:47], v11 offset:9216
  v_mfma_f32_16x16x32_bf16 v[136:139], v[32:35], a[104:107], v[136:139]
  v_accvgpr_write_b32 a65, 0
  v_mfma_f32_16x16x32_bf16 v[140:143], v[32:35], a[108:111], v[140:143]
  s_waitcnt lgkmcnt(4)
  buffer_store_dwordx4 v[108:111], v15, s[40:43], s83 offen offset:1024 sc1
  v_mfma_f32_16x16x32_bf16 v[128:131], v[36:39], a[112:115], v[128:131]
  ds_read_b64_tr_b16 v[32:33], v10 offset:256
  v_accvgpr_write_b32 a66, 0
  v_mfma_f32_16x16x32_bf16 v[132:135], v[36:39], a[116:119], v[132:135]
  ds_read_b64_tr_b16 v[34:35], v10 offset:1280
  v_mfma_f32_16x16x32_bf16 v[136:139], v[36:39], a[120:123], v[136:139]
  v_accvgpr_write_b32 a67, 0
  v_mfma_f32_16x16x32_bf16 v[140:143], v[36:39], a[124:127], v[140:143]
  s_waitcnt lgkmcnt(4)
  v_mfma_f32_16x16x32_bf16 v[144:147], v[40:43], a[96:99], v[144:147]
  s_and_b32 s85, s2, 3
  ds_read_b64_tr_b16 v[36:37], v10 offset:8448
  v_accvgpr_write_b32 a68, 0
  v_mfma_f32_16x16x32_bf16 v[148:151], v[40:43], a[100:103], v[148:151]
  s_bfe_u32 s32, s2, 0x10002
  s_lshl_b32 s32, s32, 3
  ds_read_b64_tr_b16 v[38:39], v10 offset:9472
  v_mfma_f32_16x16x32_bf16 v[152:155], v[40:43], a[104:107], v[152:155]
  s_bfe_u32 s35, s2, 0x30003
  s_add_u32 s32, s32, s35
  v_accvgpr_write_b32 a69, 0
  v_mfma_f32_16x16x32_bf16 v[156:159], v[40:43], a[108:111], v[156:159]
  s_waitcnt lgkmcnt(4)
  s_lshl_b32 s32, s32, 2
  s_lshr_b32 s35, s2, 6
  v_mfma_f32_16x16x32_bf16 v[144:147], v[44:47], a[112:115], v[144:147]
  s_add_u32 s78, s32, s35
  ds_read_b64_tr_b16 v[40:41], v11 offset:256
  v_accvgpr_write_b32 a70, 0
  v_mfma_f32_16x16x32_bf16 v[148:151], v[44:47], a[116:119], v[148:151]
  s_lshl_b32 s79, s78, 2
  s_add_u32 s79, s79, s85
  ds_read_b64_tr_b16 v[42:43], v11 offset:1280
  v_mfma_f32_16x16x32_bf16 v[152:155], v[44:47], a[120:123], v[152:155]
  s_lshl_b32 s79, s79, 2
  s_add_u32 s79, s79, s68
  v_accvgpr_write_b32 a71, 0
  v_mfma_f32_16x16x32_bf16 v[156:159], v[44:47], a[124:127], v[156:159]
  s_waitcnt lgkmcnt(4)
  s_lshl_b32 s79, s79, 13
  s_add_u32 s79, s79, 0x1800000
  v_mfma_f32_16x16x32_bf16 v[160:163], v[32:35], a[96:99], v[160:163]
  s_lshr_b32 s83, s82, 14
  s_add_u32 s83, s83, 0
  ds_read_b64_tr_b16 v[44:45], v11 offset:8448
  v_mfma_f32_16x16x32_bf16 v[164:167], v[32:35], a[100:103], v[164:167]
  s_mul_i32 s83, s83, 57344
  s_lshl_b32 s84, s69, 11
  ds_read_b64_tr_b16 v[46:47], v11 offset:9472
  v_mfma_f32_16x16x32_bf16 v[168:171], v[32:35], a[104:107], v[168:171]
  s_add_u32 s83, s83, s84
  v_accvgpr_write_b32 a72, 0
  v_accvgpr_write_b32 a73, 0
  v_mfma_f32_16x16x32_bf16 v[172:175], v[32:35], a[108:111], v[172:175]
  s_waitcnt lgkmcnt(4)
  buffer_store_dwordx4 v[112:115], v15, s[40:43], s83 offen offset:0 sc1
  v_mfma_f32_16x16x32_bf16 v[160:163], v[36:39], a[112:115], v[160:163]
  ds_read_b64_tr_b16 v[32:33], v10 offset:512
  v_accvgpr_write_b32 a74, 0
  v_mfma_f32_16x16x32_bf16 v[164:167], v[36:39], a[116:119], v[164:167]
  ds_read_b64_tr_b16 v[34:35], v10 offset:1536
  v_mfma_f32_16x16x32_bf16 v[168:171], v[36:39], a[120:123], v[168:171]
  v_accvgpr_write_b32 a75, 0
  v_mfma_f32_16x16x32_bf16 v[172:175], v[36:39], a[124:127], v[172:175]
  s_waitcnt lgkmcnt(4)
  v_mfma_f32_16x16x32_bf16 v[176:179], v[40:43], a[96:99], v[176:179]
  ds_read_b64_tr_b16 v[36:37], v10 offset:8704
  v_accvgpr_write_b32 a76, 0
  v_mfma_f32_16x16x32_bf16 v[180:183], v[40:43], a[100:103], v[180:183]
  ds_read_b64_tr_b16 v[38:39], v10 offset:9728
  v_mfma_f32_16x16x32_bf16 v[184:187], v[40:43], a[104:107], v[184:187]
  v_accvgpr_write_b32 a77, 0
  v_mfma_f32_16x16x32_bf16 v[188:191], v[40:43], a[108:111], v[188:191]
  s_waitcnt lgkmcnt(4)
  v_mfma_f32_16x16x32_bf16 v[176:179], v[44:47], a[112:115], v[176:179]
  ds_read_b64_tr_b16 v[40:41], v11 offset:512
  v_accvgpr_write_b32 a78, 0
  v_mfma_f32_16x16x32_bf16 v[180:183], v[44:47], a[116:119], v[180:183]
  ds_read_b64_tr_b16 v[42:43], v11 offset:1536
  v_mfma_f32_16x16x32_bf16 v[184:187], v[44:47], a[120:123], v[184:187]
  v_accvgpr_write_b32 a79, 0
  v_mfma_f32_16x16x32_bf16 v[188:191], v[44:47], a[124:127], v[188:191]
  s_waitcnt lgkmcnt(4)
  v_mfma_f32_16x16x32_bf16 v[192:195], v[32:35], a[96:99], v[192:195]
  ds_read_b64_tr_b16 v[44:45], v11 offset:8704
  v_accvgpr_write_b32 a80, 0
  v_mfma_f32_16x16x32_bf16 v[196:199], v[32:35], a[100:103], v[196:199]
  ds_read_b64_tr_b16 v[46:47], v11 offset:9728
  v_mfma_f32_16x16x32_bf16 v[200:203], v[32:35], a[104:107], v[200:203]
  v_accvgpr_write_b32 a81, 0
  v_mfma_f32_16x16x32_bf16 v[204:207], v[32:35], a[108:111], v[204:207]
  s_waitcnt lgkmcnt(4)
  buffer_store_dwordx4 v[116:119], v15, s[40:43], s83 offen offset:1024 sc1
  v_mfma_f32_16x16x32_bf16 v[192:195], v[36:39], a[112:115], v[192:195]
  ds_read_b64_tr_b16 v[32:33], v10 offset:768
  v_accvgpr_write_b32 a82, 0
  v_mfma_f32_16x16x32_bf16 v[196:199], v[36:39], a[116:119], v[196:199]
  ds_read_b64_tr_b16 v[34:35], v10 offset:1792
  v_mfma_f32_16x16x32_bf16 v[200:203], v[36:39], a[120:123], v[200:203]
  v_accvgpr_write_b32 a83, 0
  v_mfma_f32_16x16x32_bf16 v[204:207], v[36:39], a[124:127], v[204:207]
  s_waitcnt lgkmcnt(4)
  v_mfma_f32_16x16x32_bf16 v[208:211], v[40:43], a[96:99], v[208:211]
  ds_read_b64_tr_b16 v[36:37], v10 offset:8960
  v_accvgpr_write_b32 a84, 0
  v_mfma_f32_16x16x32_bf16 v[212:215], v[40:43], a[100:103], v[212:215]
  ds_read_b64_tr_b16 v[38:39], v10 offset:9984
  v_mfma_f32_16x16x32_bf16 v[216:219], v[40:43], a[104:107], v[216:219]
  v_accvgpr_write_b32 a85, 0
  v_mfma_f32_16x16x32_bf16 v[220:223], v[40:43], a[108:111], v[220:223]
  s_waitcnt lgkmcnt(4)
  v_mfma_f32_16x16x32_bf16 v[208:211], v[44:47], a[112:115], v[208:211]
  ds_read_b64_tr_b16 v[40:41], v11 offset:768
  v_accvgpr_write_b32 a86, 0
  v_mfma_f32_16x16x32_bf16 v[212:215], v[44:47], a[116:119], v[212:215]
  ds_read_b64_tr_b16 v[42:43], v11 offset:1792
  v_mfma_f32_16x16x32_bf16 v[216:219], v[44:47], a[120:123], v[216:219]
  v_accvgpr_write_b32 a87, 0
  v_mfma_f32_16x16x32_bf16 v[220:223], v[44:47], a[124:127], v[220:223]
  s_waitcnt lgkmcnt(4)
  v_mfma_f32_16x16x32_bf16 v[224:227], v[32:35], a[96:99], v[224:227]
  ds_read_b64_tr_b16 v[44:45], v11 offset:8960
  v_accvgpr_write_b32 a88, 0
  v_mfma_f32_16x16x32_bf16 v[228:231], v[32:35], a[100:103], v[228:231]
  ds_read_b64_tr_b16 v[46:47], v11 offset:9984
  v_mfma_f32_16x16x32_bf16 v[232:235], v[32:35], a[104:107], v[232:235]
  v_accvgpr_write_b32 a89, 0
  v_mfma_f32_16x16x32_bf16 v[236:239], v[32:35], a[108:111], v[236:239]
  s_waitcnt lgkmcnt(4)
  s_barrier
  v_mfma_f32_16x16x32_bf16 v[224:227], v[36:39], a[112:115], v[224:227]
  s_lshr_b32 s83, s82, 14
  s_add_u32 s83, s83, s33
  ds_read_b64_tr_b16 v[32:33], v12 offset:49152
  v_mfma_f32_16x16x32_bf16 v[228:231], v[36:39], a[116:119], v[228:231]
  s_mul_i32 s83, s83, 57344
  s_lshl_b32 s84, s69, 11
  ds_read_b64_tr_b16 v[34:35], v12 offset:50176
  v_mfma_f32_16x16x32_bf16 v[232:235], v[36:39], a[120:123], v[232:235]
  s_add_u32 s83, s83, s84
  v_accvgpr_write_b32 a90, 0
  v_accvgpr_write_b32 a91, 0
  v_mfma_f32_16x16x32_bf16 v[236:239], v[36:39], a[124:127], v[236:239]
  s_waitcnt lgkmcnt(4)
  buffer_store_dwordx4 v[120:123], v15, s[40:43], s83 offen offset:0 sc1
  v_mfma_f32_16x16x32_bf16 v[240:243], v[40:43], a[96:99], v[240:243]
  ds_read_b64_tr_b16 v[36:37], v12 offset:57344
  v_accvgpr_write_b32 a92, 0
  v_mfma_f32_16x16x32_bf16 v[244:247], v[40:43], a[100:103], v[244:247]
  ds_read_b64_tr_b16 v[38:39], v12 offset:58368
  v_mfma_f32_16x16x32_bf16 v[248:251], v[40:43], a[104:107], v[248:251]
  v_accvgpr_write_b32 a93, 0
  v_mfma_f32_16x16x32_bf16 v[252:255], v[40:43], a[108:111], v[252:255]
  s_waitcnt lgkmcnt(4)
  v_mfma_f32_16x16x32_bf16 v[240:243], v[44:47], a[112:115], v[240:243]
  ds_read_b64_tr_b16 v[40:41], v13 offset:49152
  v_accvgpr_write_b32 a94, 0
  v_mfma_f32_16x16x32_bf16 v[244:247], v[44:47], a[116:119], v[244:247]
  ds_read_b64_tr_b16 v[42:43], v13 offset:50176
  v_mfma_f32_16x16x32_bf16 v[248:251], v[44:47], a[120:123], v[248:251]
  v_accvgpr_write_b32 a95, 0
  v_mfma_f32_16x16x32_bf16 v[252:255], v[44:47], a[124:127], v[252:255]
  s_waitcnt lgkmcnt(4)
  buffer_load_dword v49, v50, s[44:47], 0 offen sc1
  v_mfma_f32_16x16x32_bf16 v[128:131], v[32:35], a[128:131], v[128:131]
  ds_read_b64_tr_b16 v[44:45], v13 offset:57344
  v_accvgpr_write_b32 a96, 0
  v_mfma_f32_16x16x32_bf16 v[132:135], v[32:35], a[132:135], v[132:135]
  ds_read_b64_tr_b16 v[46:47], v13 offset:58368
  v_mfma_f32_16x16x32_bf16 v[136:139], v[32:35], a[136:139], v[136:139]
  v_accvgpr_write_b32 a97, 0
  v_mfma_f32_16x16x32_bf16 v[140:143], v[32:35], a[140:143], v[140:143]
  s_waitcnt lgkmcnt(4)
  v_mfma_f32_16x16x32_bf16 v[128:131], v[36:39], a[144:147], v[128:131]
  ds_read_b64_tr_b16 v[32:33], v12 offset:49408
  v_accvgpr_write_b32 a98, 0
  v_mfma_f32_16x16x32_bf16 v[132:135], v[36:39], a[148:151], v[132:135]
  ds_read_b64_tr_b16 v[34:35], v12 offset:50432
  v_mfma_f32_16x16x32_bf16 v[136:139], v[36:39], a[152:155], v[136:139]
  v_accvgpr_write_b32 a99, 0
  v_mfma_f32_16x16x32_bf16 v[140:143], v[36:39], a[156:159], v[140:143]
  s_waitcnt lgkmcnt(4)
  buffer_store_dwordx4 v[124:127], v15, s[40:43], s83 offen offset:1024 sc1
  v_mfma_f32_16x16x32_bf16 v[144:147], v[40:43], a[128:131], v[144:147]
  ds_read_b64_tr_b16 v[36:37], v12 offset:57600
  v_accvgpr_write_b32 a100, 0
  v_mfma_f32_16x16x32_bf16 v[148:151], v[40:43], a[132:135], v[148:151]
  ds_read_b64_tr_b16 v[38:39], v12 offset:58624
  v_mfma_f32_16x16x32_bf16 v[152:155], v[40:43], a[136:139], v[152:155]
  v_accvgpr_write_b32 a101, 0
  v_mfma_f32_16x16x32_bf16 v[156:159], v[40:43], a[140:143], v[156:159]
  s_waitcnt lgkmcnt(4)
  v_mfma_f32_16x16x32_bf16 v[144:147], v[44:47], a[144:147], v[144:147]
  ds_read_b64_tr_b16 v[40:41], v13 offset:49408
  v_accvgpr_write_b32 a102, 0
  v_mfma_f32_16x16x32_bf16 v[148:151], v[44:47], a[148:151], v[148:151]
  ds_read_b64_tr_b16 v[42:43], v13 offset:50432
  v_mfma_f32_16x16x32_bf16 v[152:155], v[44:47], a[152:155], v[152:155]
  v_accvgpr_write_b32 a103, 0
  v_mfma_f32_16x16x32_bf16 v[156:159], v[44:47], a[156:159], v[156:159]
  s_waitcnt lgkmcnt(4)
  v_mfma_f32_16x16x32_bf16 v[160:163], v[32:35], a[128:131], v[160:163]
  ds_read_b64_tr_b16 v[44:45], v13 offset:57600
  v_accvgpr_write_b32 a104, 0
  v_mfma_f32_16x16x32_bf16 v[164:167], v[32:35], a[132:135], v[164:167]
  ds_read_b64_tr_b16 v[46:47], v13 offset:58624
  v_mfma_f32_16x16x32_bf16 v[168:171], v[32:35], a[136:139], v[168:171]
  v_accvgpr_write_b32 a105, 0
  v_mfma_f32_16x16x32_bf16 v[172:175], v[32:35], a[140:143], v[172:175]
  s_waitcnt lgkmcnt(4)
  v_mfma_f32_16x16x32_bf16 v[160:163], v[36:39], a[144:147], v[160:163]
  ds_read_b64_tr_b16 v[32:33], v12 offset:49664
  v_accvgpr_write_b32 a106, 0
  v_mfma_f32_16x16x32_bf16 v[164:167], v[36:39], a[148:151], v[164:167]
  ds_read_b64_tr_b16 v[34:35], v12 offset:50688
  v_mfma_f32_16x16x32_bf16 v[168:171], v[36:39], a[152:155], v[168:171]
  v_accvgpr_write_b32 a107, 0
  v_mfma_f32_16x16x32_bf16 v[172:175], v[36:39], a[156:159], v[172:175]
  s_waitcnt lgkmcnt(4)
  v_mfma_f32_16x16x32_bf16 v[176:179], v[40:43], a[128:131], v[176:179]
  ds_read_b64_tr_b16 v[36:37], v12 offset:57856
  v_accvgpr_write_b32 a108, 0
  v_mfma_f32_16x16x32_bf16 v[180:183], v[40:43], a[132:135], v[180:183]
  ds_read_b64_tr_b16 v[38:39], v12 offset:58880
  v_mfma_f32_16x16x32_bf16 v[184:187], v[40:43], a[136:139], v[184:187]
  v_accvgpr_write_b32 a109, 0
  v_mfma_f32_16x16x32_bf16 v[188:191], v[40:43], a[140:143], v[188:191]
  s_waitcnt lgkmcnt(4)
  v_mfma_f32_16x16x32_bf16 v[176:179], v[44:47], a[144:147], v[176:179]
  ds_read_b64_tr_b16 v[40:41], v13 offset:49664
  v_accvgpr_write_b32 a110, 0
  v_mfma_f32_16x16x32_bf16 v[180:183], v[44:47], a[148:151], v[180:183]
  ds_read_b64_tr_b16 v[42:43], v13 offset:50688
  v_mfma_f32_16x16x32_bf16 v[184:187], v[44:47], a[152:155], v[184:187]
  v_accvgpr_write_b32 a111, 0
  v_mfma_f32_16x16x32_bf16 v[188:191], v[44:47], a[156:159], v[188:191]
  s_waitcnt lgkmcnt(4)
  v_mfma_f32_16x16x32_bf16 v[192:195], v[32:35], a[128:131], v[192:195]
  ds_read_b64_tr_b16 v[44:45], v13 offset:57856
  v_accvgpr_write_b32 a112, 0
  v_mfma_f32_16x16x32_bf16 v[196:199], v[32:35], a[132:135], v[196:199]
  ds_read_b64_tr_b16 v[46:47], v13 offset:58880
  v_mfma_f32_16x16x32_bf16 v[200:203], v[32:35], a[136:139], v[200:203]
  v_accvgpr_write_b32 a113, 0
  v_mfma_f32_16x16x32_bf16 v[204:207], v[32:35], a[140:143], v[204:207]
  s_waitcnt lgkmcnt(4)
  v_mfma_f32_16x16x32_bf16 v[192:195], v[36:39], a[144:147], v[192:195]
  ds_read_b64_tr_b16 v[32:33], v12 offset:49920
  v_accvgpr_write_b32 a114, 0
  v_mfma_f32_16x16x32_bf16 v[196:199], v[36:39], a[148:151], v[196:199]
  ds_read_b64_tr_b16 v[34:35], v12 offset:50944
  v_mfma_f32_16x16x32_bf16 v[200:203], v[36:39], a[152:155], v[200:203]
  v_accvgpr_write_b32 a115, 0
  v_mfma_f32_16x16x32_bf16 v[204:207], v[36:39], a[156:159], v[204:207]
  s_waitcnt lgkmcnt(4)
  v_mfma_f32_16x16x32_bf16 v[208:211], v[40:43], a[128:131], v[208:211]
  ds_read_b64_tr_b16 v[36:37], v12 offset:58112
  v_accvgpr_write_b32 a116, 0
  v_mfma_f32_16x16x32_bf16 v[212:215], v[40:43], a[132:135], v[212:215]
  ds_read_b64_tr_b16 v[38:39], v12 offset:59136
  v_mfma_f32_16x16x32_bf16 v[216:219], v[40:43], a[136:139], v[216:219]
  v_accvgpr_write_b32 a117, 0
  v_mfma_f32_16x16x32_bf16 v[220:223], v[40:43], a[140:143], v[220:223]
  s_waitcnt lgkmcnt(4)
  v_mfma_f32_16x16x32_bf16 v[208:211], v[44:47], a[144:147], v[208:211]
  ds_read_b64_tr_b16 v[40:41], v13 offset:49920
  v_accvgpr_write_b32 a118, 0
  v_mfma_f32_16x16x32_bf16 v[212:215], v[44:47], a[148:151], v[212:215]
  ds_read_b64_tr_b16 v[42:43], v13 offset:50944
  v_mfma_f32_16x16x32_bf16 v[216:219], v[44:47], a[152:155], v[216:219]
  v_accvgpr_write_b32 a119, 0
  v_mfma_f32_16x16x32_bf16 v[220:223], v[44:47], a[156:159], v[220:223]
  s_waitcnt lgkmcnt(4)
  v_mfma_f32_16x16x32_bf16 v[224:227], v[32:35], a[128:131], v[224:227]
  ds_read_b64_tr_b16 v[44:45], v13 offset:58112
  v_accvgpr_write_b32 a120, 0
  v_mfma_f32_16x16x32_bf16 v[228:231], v[32:35], a[132:135], v[228:231]
  ds_read_b64_tr_b16 v[46:47], v13 offset:59136
  v_mfma_f32_16x16x32_bf16 v[232:235], v[32:35], a[136:139], v[232:235]
  v_accvgpr_write_b32 a121, 0
  v_mfma_f32_16x16x32_bf16 v[236:239], v[32:35], a[140:143], v[236:239]
  s_waitcnt lgkmcnt(4)
  s_waitcnt vmcnt(19)
  s_barrier
  v_mfma_f32_16x16x32_bf16 v[224:227], v[36:39], a[144:147], v[224:227]
  ds_read_b64_tr_b16 v[32:33], v10 offset:16384
  s_waitcnt vmcnt(1)
  v_cmp_ne_u32 vcc, v52, v49
  s_cbranch_vccnz Lspin9
Lback9:
  v_mfma_f32_16x16x32_bf16 v[228:231], v[36:39], a[148:151], v[228:231]
  s_lshl_b32 s90, s68, 12
  s_mov_b32 s92, s90
  ds_read_b64_tr_b16 v[34:35], v10 offset:17408
  v_mfma_f32_16x16x32_bf16 v[232:235], v[36:39], a[152:155], v[232:235]
  s_mov_b32 s91, s90
  s_add_u32 s93, s90, 0x4000
  s_sub_u32 s38, 16, s70
  v_mfma_f32_16x16x32_bf16 v[236:239], v[36:39], a[156:159], v[236:239]
  s_waitcnt lgkmcnt(4)
  s_lshl_b32 s38, s38, 16
  v_accvgpr_write_b32 a122, 0
  v_mfma_f32_16x16x32_bf16 v[240:243], v[40:43], a[128:131], v[240:243]
  ds_read_b64_tr_b16 v[36:37], v10 offset:24576
  v_accvgpr_write_b32 a123, 0
  v_mfma_f32_16x16x32_bf16 v[244:247], v[40:43], a[132:135], v[244:247]
  ds_read_b64_tr_b16 v[38:39], v10 offset:25600
  v_accvgpr_write_b32 a124, 0
  v_mfma_f32_16x16x32_bf16 v[248:251], v[40:43], a[136:139], v[248:251]
  v_accvgpr_write_b32 a125, 0
  v_mfma_f32_16x16x32_bf16 v[252:255], v[40:43], a[140:143], v[252:255]
  s_waitcnt lgkmcnt(4)
  v_mfma_f32_16x16x32_bf16 v[240:243], v[44:47], a[144:147], v[240:243]
  ds_read_b64_tr_b16 v[40:41], v11 offset:16384
  v_accvgpr_write_b32 a126, 0
  v_mfma_f32_16x16x32_bf16 v[244:247], v[44:47], a[148:151], v[244:247]
  ds_read_b64_tr_b16 v[42:43], v11 offset:17408
  v_mfma_f32_16x16x32_bf16 v[248:251], v[44:47], a[152:155], v[248:251]
  v_accvgpr_write_b32 a127, 0
  v_mfma_f32_16x16x32_bf16 v[252:255], v[44:47], a[156:159], v[252:255]
  s_waitcnt lgkmcnt(4)
  s_getpc_b64 s[98:99]
L_pc7:
  s_sub_u32 s98, s98, L_pc7-L_pc
  s_subb_u32 s99, s99, 0
  global_load_dword v0, v51, s[98:99]
  v_mfma_f32_16x16x32_bf16 v[128:131], v[32:35], a[160:163], v[128:131]
  ds_read_b64_tr_b16 v[44:45], v11 offset:24576
  s_mov_b32 m0, s90
  s_add_u32 s90, s90, 0x4000
  v_mfma_f32_16x16x32_bf16 v[132:135], v[32:35], a[164:167], v[132:135]
  ds_read_b64_tr_b16 v[46:47], v11 offset:25600
  v_mfma_f32_16x16x32_bf16 v[136:139], v[32:35], a[168:171], v[136:139]
  v_mfma_f32_16x16x32_bf16 v[140:143], v[32:35], a[172:175], v[140:143]
  s_waitcnt lgkmcnt(4)
  buffer_load_dwordx4 v15, s[36:39], s91 offen offset:0 sc1 lds
  v_mfma_f32_16x16x32_bf16 v[128:131], v[36:39], a[176:179], v[128:131]
  s_lshr_b32 s75, s78, 2
  s_and_b32 s76, s78, 3
  ds_read_b64_tr_b16 v[32:33], v10 offset:16640
  v_mfma_f32_16x16x32_bf16 v[132:135], v[36:39], a[180:183], v[132:135]
  ds_read_b64_tr_b16 v[34:35], v10 offset:17664
  v_bfe_u32 v18, v1, 2, 2
  v_mfma_f32_16x16x32_bf16 v[136:139], v[36:39], a[184:187], v[136:139]
  v_lshlrev_b32 v6, 10, v18
  v_bfe_u32 v19, v1, 4, 1
  v_mfma_f32_16x16x32_bf16 v[140:143], v[36:39], a[188:191], v[140:143]
  s_waitcnt lgkmcnt(4)
  buffer_load_dwordx4 v15, s[36:39], s91 offen offset:1024 sc1 lds
  v_lshl_add_u32 v6, v19, 6, v6
  v_mfma_f32_16x16x32_bf16 v[144:147], v[40:43], a[160:163], v[144:147]
  ds_read_b64_tr_b16 v[36:37], v10 offset:24832
  v_and_b32 v20, 3, v1
  v_mfma_f32_16x16x32_bf16 v[148:151], v[40:43], a[164:167], v[148:151]
  ds_read_b64_tr_b16 v[38:39], v10 offset:25856
  v_lshl_add_u32 v6, v20, 4, v6
  v_mfma_f32_16x16x32_bf16 v[152:155], v[40:43], a[168:171], v[152:155]
  s_and_b32 s71, s85, 1
  v_lshrrev_b32 v21, 5, v1
  v_lshl_add_u32 v6, v21, 9, v6
  v_mfma_f32_16x16x32_bf16 v[156:159], v[40:43], a[172:175], v[156:159]
  s_waitcnt lgkmcnt(4)
  s_lshl_b32 s71, s71, 6
  buffer_load_dwordx4 v15, s[36:39], s91 offen offset:2048 sc1 lds
  v_mfma_f32_16x16x32_bf16 v[144:147], v[44:47], a[176:179], v[144:147]
  ds_read_b64_tr_b16 v[40:41], v11 offset:16640
  v_xor_b32 v6, s71, v6
  v_mfma_f32_16x16x32_bf16 v[148:151], v[44:47], a[180:183], v[148:151]
  s_lshl_b32 s71, s68, 14
  s_lshl_b32 s72, s76, 7
  ds_read_b64_tr_b16 v[42:43], v11 offset:17664
  v_mfma_f32_16x16x32_bf16 v[152:155], v[44:47], a[184:187], v[152:155]
  s_add_u32 s71, s71, s72
  v_add_u32 v6, s71, v6
  v_xor_b32 v9, 32, v6
  v_mfma_f32_16x16x32_bf16 v[156:159], v[44:47], a[188:191], v[156:159]
  s_waitcnt lgkmcnt(4)
  buffer_load_dwordx4 v15, s[36:39], s91 offen offset:3072 sc1 lds
  v_add_u32 v7, 3072, v9
  v_mfma_f32_16x16x32_bf16 v[160:163], v[32:35], a[160:163], v[160:163]
  s_and_b32 s90, s90, 0xffff
  s_add_u32 s91, s91, 0x8000
  ds_read_b64_tr_b16 v[44:45], v11 offset:24832
  v_mfma_f32_16x16x32_bf16 v[164:167], v[32:35], a[164:167], v[164:167]
  ds_read_b64_tr_b16 v[46:47], v11 offset:25856
  v_add_u32 v8, 6144, v6
  v_mfma_f32_16x16x32_bf16 v[168:171], v[32:35], a[168:171], v[168:171]
  s_lshr_b32 s71, s68, 1
  s_lshl_b32 s71, s71, 13
  v_add_u32 v9, 9216, v9
  v_mfma_f32_16x16x32_bf16 v[172:175], v[32:35], a[172:175], v[172:175]
  s_waitcnt lgkmcnt(4)
  v_add_u32 v24, s71, v15
  v_lshlrev_b32 v2, 6, v18
  v_mfma_f32_16x16x32_bf16 v[160:163], v[36:39], a[176:179], v[160:163]
  s_add_u32 m0, s92, 65536
  s_add_u32 s92, s92, 0x4000
  ds_read_b64_tr_b16 v[32:33], v10 offset:16896
  v_mfma_f32_16x16x32_bf16 v[164:167], v[36:39], a[180:183], v[164:167]
  ds_read_b64_tr_b16 v[34:35], v10 offset:17920
  v_lshl_add_u32 v2, v19, 5, v2
  v_mfma_f32_16x16x32_bf16 v[168:171], v[36:39], a[184:187], v[168:171]
  s_and_b32 s71, s68, 1
  v_lshl_add_u32 v2, v20, 3, v2
  v_add_u32 v2, v2, v59
  v_mfma_f32_16x16x32_bf16 v[172:175], v[36:39], a[188:191], v[172:175]
  s_waitcnt lgkmcnt(4)
  s_lshl_b32 s71, s71, 9
  buffer_load_dwordx4 v15, s[36:39], s93 offen offset:0 sc1 lds
  v_mfma_f32_16x16x32_bf16 v[176:179], v[40:43], a[160:163], v[176:179]
  s_add_u32 s71, s71, 16384
  ds_read_b64_tr_b16 v[36:37], v10 offset:25088
  v_add_u32 v2, s71, v2
  v_mfma_f32_16x16x32_bf16 v[180:183], v[40:43], a[164:167], v[180:183]
  ds_read_b64_tr_b16 v[38:39], v10 offset:26112
  v_xor_b32 v3, 32, v2
  v_mfma_f32_16x16x32_bf16 v[184:187], v[40:43], a[168:171], v[184:187]
  v_add_u32 v25, 65536, v24
  v_add_u32 v4, 65536, v2
  v_mfma_f32_16x16x32_bf16 v[188:191], v[40:43], a[172:175], v[188:191]
  s_waitcnt lgkmcnt(4)
  buffer_load_dwordx4 v15, s[36:39], s93 offen offset:1024 sc1 lds
  v_add_u32 v5, 65536, v3
  v_mfma_f32_16x16x32_bf16 v[176:179], v[44:47], a[176:179], v[176:179]
  ds_read_b64_tr_b16 v[40:41], v11 offset:16896
  v_add_u32 v26, 131072, v24
  v_mfma_f32_16x16x32_bf16 v[180:183], v[44:47], a[180:183], v[180:183]
  ds_read_b64_tr_b16 v[42:43], v11 offset:17920
  v_add_u32 v27, 131072, v2
  v_mfma_f32_16x16x32_bf16 v[184:187], v[44:47], a[184:187], v[184:187]
  s_lshl_b32 s71, s75, 2
  s_and_b32 s72, s68, 2
  v_add_u32 v29, 131072, v3
  v_mfma_f32_16x16x32_bf16 v[188:191], v[44:47], a[188:191], v[188:191]
  s_waitcnt lgkmcnt(4)
  s_add_u32 s71, s71, s72
  buffer_load_dwordx4 v15, s[36:39], s93 offen offset:2048 sc1 lds
  v_mfma_f32_16x16x32_bf16 v[192:195], v[32:35], a[160:163], v[192:195]
  s_lshr_b32 s72, s85, 1
  s_add_u32 s71, s71, s72
  ds_read_b64_tr_b16 v[44:45], v11 offset:25088
  v_mfma_f32_16x16x32_bf16 v[196:199], v[32:35], a[164:167], v[196:199]
  s_lshl_b32 s71, s71, 15
  s_lshl_b32 s76, s76, 1
  ds_read_b64_tr_b16 v[46:47], v11 offset:26112
  v_mfma_f32_16x16x32_bf16 v[200:203], v[32:35], a[168:171], v[200:203]
  s_and_b32 s72, s68, 1
  s_lshl_b32 s72, s72, 3
  s_add_u32 s76, s76, s72
  v_mfma_f32_16x16x32_bf16 v[204:207], v[32:35], a[172:175], v[204:207]
  s_waitcnt lgkmcnt(4)
  s_and_b32 s72, s85, 1
  buffer_load_dwordx4 v15, s[36:39], s93 offen offset:3072 sc1 lds
  v_mfma_f32_16x16x32_bf16 v[192:195], v[36:39], a[176:179], v[192:195]
  s_and_b32 s92, s92, 0xffff
  s_add_u32 s93, s93, 0x8000
  ds_read_b64_tr_b16 v[32:33], v10 offset:17152
  v_mfma_f32_16x16x32_bf16 v[196:199], v[36:39], a[180:183], v[196:199]
  s_add_u32 s76, s76, s72
  s_lshl_b32 s76, s76, 6
  ds_read_b64_tr_b16 v[34:35], v10 offset:18176
  v_mfma_f32_16x16x32_bf16 v[200:203], v[36:39], a[184:187], v[200:203]
  s_add_u32 s71, s71, s76
  v_and_b32 v53, 15, v1
  v_lshlrev_b32 v53, 10, v53
  v_mfma_f32_16x16x32_bf16 v[204:207], v[36:39], a[188:191], v[204:207]
  s_waitcnt lgkmcnt(4)
  v_lshl_add_u32 v53, v19, 5, v53
  v_lshl_add_u32 v53, v21, 4, v53
  v_mfma_f32_16x16x32_bf16 v[208:211], v[40:43], a[160:163], v[208:211]
  ds_read_b64_tr_b16 v[36:37], v10 offset:25344
  s_mov_b32 m0, s90
  s_add_u32 s90, s90, 0x4000
  v_mfma_f32_16x16x32_bf16 v[212:215], v[40:43], a[164:167], v[212:215]
  ds_read_b64_tr_b16 v[38:39], v10 offset:26368
  v_add_u32 v53, s71, v53
  v_mfma_f32_16x16x32_bf16 v[216:219], v[40:43], a[168:171], v[216:219]
  s_lshr_b32 s71, s85, 1
  s_xor_b32 s71, s71, s68
  s_lshl_b32 s76, s75, 2
  v_mfma_f32_16x16x32_bf16 v[220:223], v[40:43], a[172:175], v[220:223]
  s_waitcnt lgkmcnt(4)
  s_add_u32 s76, s76, s71
  buffer_load_dwordx4 v15, s[36:39], s91 offen offset:0 sc1 lds
  v_mfma_f32_16x16x32_bf16 v[208:211], v[44:47], a[176:179], v[208:211]
  s_mul_i32 s71, s76, 114688
  s_mul_i32 s77, s85, 14336
  ds_read_b64_tr_b16 v[40:41], v11 offset:17152
  v_mfma_f32_16x16x32_bf16 v[212:215], v[44:47], a[180:183], v[212:215]
  s_add_u32 s71, s71, s77
  s_lshl_b32 s77, s77, 5
  ds_read_b64_tr_b16 v[42:43], v11 offset:18176
  v_mfma_f32_16x16x32_bf16 v[216:219], v[44:47], a[184:187], v[216:219]
  s_lshl_b32 s72, s76, 18
  s_lshl_b32 s83, s85, 15
  s_add_u32 s72, s72, s83
  v_mfma_f32_16x16x32_bf16 v[220:223], v[44:47], a[188:191], v[220:223]
  s_waitcnt lgkmcnt(4)
  s_lshl_b32 s83, s83, 5
  buffer_load_dwordx4 v15, s[36:39], s91 offen offset:1024 sc1 lds
  v_mfma_f32_16x16x32_bf16 v[224:227], v[32:35], a[160:163], v[224:227]
  s_lshl_b32 s84, s85, 15
  s_lshl_b32 s86, s68, 12
  ds_read_b64_tr_b16 v[44:45], v11 offset:25344
  v_mfma_f32_16x16x32_bf16 v[228:231], v[32:35], a[164:167], v[228:231]
  s_sub_u32 s76, 15, s75
  s_min_u32 s75, s75, s76
  ds_read_b64_tr_b16 v[46:47], v11 offset:26368
  v_mfma_f32_16x16x32_bf16 v[232:235], v[32:35], a[168:171], v[232:235]
  s_lshl_b32 s75, s75, 12
  v_and_b32 v50, 31, v1
  v_lshlrev_b32 v50, 7, v50
  v_mfma_f32_16x16x32_bf16 v[236:239], v[32:35], a[172:175], v[236:239]
  s_waitcnt lgkmcnt(4)
  s_waitcnt vmcnt(11)
  s_barrier
  v_mfma_f32_16x16x32_bf16 v[224:227], v[36:39], a[176:179], v[224:227]
  ds_read_b64_tr_b16 v[32:33], v10 offset:32768
  v_add_u32 v50, s75, v50
  v_mfma_f32_16x16x32_bf16 v[228:231], v[36:39], a[180:183], v[228:231]
  s_mov_b32 s42, 0x700000
  ds_read_b64_tr_b16 v[34:35], v10 offset:33792
  v_add_u32 v50, 0x1010000, v50
  v_mfma_f32_16x16x32_bf16 v[232:235], v[36:39], a[184:187], v[232:235]
  v_mfma_f32_16x16x32_bf16 v[236:239], v[36:39], a[188:191], v[236:239]
  s_waitcnt lgkmcnt(4)
  buffer_load_dwordx4 v15, s[36:39], s91 offen offset:2048 sc1 lds
  v_mfma_f32_16x16x32_bf16 v[240:243], v[40:43], a[160:163], v[240:243]
  ds_read_b64_tr_b16 v[36:37], v10 offset:40960
  v_mfma_f32_16x16x32_bf16 v[244:247], v[40:43], a[164:167], v[244:247]
  ds_read_b64_tr_b16 v[38:39], v10 offset:41984
  v_mfma_f32_16x16x32_bf16 v[248:251], v[40:43], a[168:171], v[248:251]
  v_mfma_f32_16x16x32_bf16 v[252:255], v[40:43], a[172:175], v[252:255]
  s_waitcnt lgkmcnt(4)
  s_and_b32 s90, s90, 0xffff
  buffer_load_dwordx4 v15, s[36:39], s91 offen offset:3072 sc1 lds
  v_mfma_f32_16x16x32_bf16 v[240:243], v[44:47], a[176:179], v[240:243]
  s_add_u32 s91, s91, 0x8000
  s_add_u32 m0, s92, 65536
  ds_read_b64_tr_b16 v[40:41], v11 offset:32768
  v_mfma_f32_16x16x32_bf16 v[244:247], v[44:47], a[180:183], v[244:247]
  s_add_u32 s92, s92, 0x4000
  ds_read_b64_tr_b16 v[42:43], v11 offset:33792
  buffer_store_dword v52, v31, s[44:47], s87 offen sc1
  v_mfma_f32_16x16x32_bf16 v[248:251], v[44:47], a[184:187], v[248:251]
  v_mfma_f32_16x16x32_bf16 v[252:255], v[44:47], a[188:191], v[252:255]
  s_waitcnt lgkmcnt(4)
  v_mfma_f32_16x16x32_bf16 v[128:131], v[32:35], a[192:195], v[128:131]
  s_mov_b32 s35, 0x3e0293ee
  ds_read_b64_tr_b16 v[44:45], v11 offset:40960
  v_mfma_f32_16x16x32_bf16 v[132:135], v[32:35], a[196:199], v[132:135]
  ds_read_b64_tr_b16 v[46:47], v11 offset:41984
  v_mfma_f32_16x16x32_bf16 v[136:139], v[32:35], a[200:203], v[136:139]
  v_mfma_f32_16x16x32_bf16 v[140:143], v[32:35], a[204:207], v[140:143]
  s_waitcnt lgkmcnt(4)
  buffer_load_dwordx4 v15, s[36:39], s93 offen offset:0 sc1 lds
  v_mfma_f32_16x16x32_bf16 v[128:131], v[36:39], a[208:211], v[128:131]
  ds_read_b64_tr_b16 v[32:33], v10 offset:49152
  v_mfma_f32_16x16x32_bf16 v[132:135], v[36:39], a[212:215], v[132:135]
  ds_read_b64_tr_b16 v[34:35], v10 offset:50176
  v_mfma_f32_16x16x32_bf16 v[136:139], v[36:39], a[216:219], v[136:139]
  v_mfma_f32_16x16x32_bf16 v[140:143], v[36:39], a[220:223], v[140:143]
  s_waitcnt lgkmcnt(4)
  buffer_load_dwordx4 v15, s[36:39], s93 offen offset:1024 sc1 lds
  v_mfma_f32_16x16x32_bf16 v[144:147], v[40:43], a[192:195], v[144:147]
  ds_read_b64_tr_b16 v[36:37], v10 offset:57344
  v_lshrrev_b32 v16, 4, v1
  v_mfma_f32_16x16x32_bf16 v[148:151], v[40:43], a[196:199], v[148:151]
  ds_read_b64_tr_b16 v[38:39], v10 offset:58368
  v_lshlrev_b32 v16, 2, v16
  v_mfma_f32_16x16x32_bf16 v[152:155], v[40:43], a[200:203], v[152:155]
  s_lshl_b32 s94, s68, 4
  v_and_b32 v17, 15, v1
  v_sub_u32 v16, v17, v16
  v_mfma_f32_16x16x32_bf16 v[156:159], v[40:43], a[204:207], v[156:159]
  s_waitcnt lgkmcnt(4)
  buffer_load_dwordx4 v15, s[36:39], s93 offen offset:2048 sc1 lds
  v_add_u32 v48, s94, v16
  v_mfma_f32_16x16x32_bf16 v[144:147], v[44:47], a[208:211], v[144:147]
  s_lshl_b32 s94, s33, 4
  ds_read_b64_tr_b16 v[40:41], v11 offset:49152
  v_add_u32 v63, s94, v48
  v_mfma_f32_16x16x32_bf16 v[148:151], v[44:47], a[212:215], v[148:151]
  s_mov_b32 s73, 0
  ds_read_b64_tr_b16 v[42:43], v11 offset:50176
  v_mov_b32 v30, v55
  v_mfma_f32_16x16x32_bf16 v[152:155], v[44:47], a[216:219], v[152:155]
  s_mov_b32 s32, 0
  s_mov_b32 s74, 0xf149f2ca
  v_add_u32 v55, 65536, v15
  v_mfma_f32_16x16x32_bf16 v[156:159], v[44:47], a[220:223], v[156:159]
  s_waitcnt lgkmcnt(4)
  s_and_b32 s92, s92, 0xffff
  buffer_load_dwordx4 v15, s[36:39], s93 offen offset:3072 sc1 lds
  v_mfma_f32_16x16x32_bf16 v[128:131], v[32:35], a[224:227], v[128:131]
  s_add_u32 s93, s93, 0x8000
  ds_read_b64_tr_b16 v[44:45], v11 offset:57344
  s_mov_b32 m0, s90
  v_mfma_f32_16x16x32_bf16 v[132:135], v[32:35], a[228:231], v[132:135]
  s_add_u32 s90, s90, 0x4000
  s_mov_b32 s3, 0x4b800000
  ds_read_b64_tr_b16 v[46:47], v11 offset:58368
  v_mfma_f32_16x16x32_bf16 v[136:139], v[32:35], a[232:235], v[136:139]
  s_lshl_b32 s95, s70, 2
  v_mov_b32 v60, v15
  v_add_u32 v61, 65536, v15
  v_mfma_f32_16x16x32_bf16 v[140:143], v[32:35], a[236:239], v[140:143]
  s_waitcnt lgkmcnt(4)
  s_mov_b32 s94, 0
  buffer_load_dwordx4 v15, s[36:39], s91 offen offset:0 sc1 lds
  v_mfma_f32_16x16x32_bf16 v[128:131], v[36:39], a[240:243], v[128:131]
  ds_read_b64_tr_b16 v[32:33], v10 offset:33024
  v_mfma_f32_16x16x32_bf16 v[132:135], v[36:39], a[244:247], v[132:135]
  ds_read_b64_tr_b16 v[34:35], v10 offset:34048
  v_mfma_f32_16x16x32_bf16 v[136:139], v[36:39], a[248:251], v[136:139]
  v_mfma_f32_16x16x32_bf16 v[140:143], v[36:39], a[252:255], v[140:143]
  s_waitcnt lgkmcnt(4)
  buffer_load_dwordx4 v15, s[36:39], s91 offen offset:1024 sc1 lds
  v_mfma_f32_16x16x32_bf16 v[144:147], v[40:43], a[224:227], v[144:147]
  ds_read_b64_tr_b16 v[36:37], v10 offset:41216
  v_mfma_f32_16x16x32_bf16 v[148:151], v[40:43], a[228:231], v[148:151]
  ds_read_b64_tr_b16 v[38:39], v10 offset:42240
  v_mfma_f32_16x16x32_bf16 v[152:155], v[40:43], a[232:235], v[152:155]
  v_mfma_f32_16x16x32_bf16 v[156:159], v[40:43], a[236:239], v[156:159]
  s_waitcnt lgkmcnt(4)
  buffer_load_dwordx4 v15, s[36:39], s91 offen offset:2048 sc1 lds
  v_mfma_f32_16x16x32_bf16 v[144:147], v[44:47], a[240:243], v[144:147]
  ds_read_b64_tr_b16 v[40:41], v11 offset:33024
  v_mfma_f32_16x16x32_bf16 v[148:151], v[44:47], a[244:247], v[148:151]
  ds_read_b64_tr_b16 v[42:43], v11 offset:34048
  v_mfma_f32_16x16x32_bf16 v[152:155], v[44:47], a[248:251], v[152:155]
  v_mfma_f32_16x16x32_bf16 v[156:159], v[44:47], a[252:255], v[156:159]
  s_waitcnt lgkmcnt(4)
  buffer_load_dwordx4 v15, s[36:39], s91 offen offset:3072 sc1 lds
  v_mfma_f32_16x16x32_bf16 v[160:163], v[32:35], a[192:195], v[160:163]
  s_and_b32 s90, s90, 0xffff
  s_add_u32 s91, s91, 0x8000
  ds_read_b64_tr_b16 v[44:45], v11 offset:41216
  v_mfma_f32_16x16x32_bf16 v[164:167], v[32:35], a[196:199], v[164:167]
  ds_read_b64_tr_b16 v[46:47], v11 offset:42240
  v_mul_f32 v128, s35, v128
  v_mfma_f32_16x16x32_bf16 v[168:171], v[32:35], a[200:203], v[168:171]
  v_mul_f32 v129, s35, v129
  v_mul_f32 v130, s35, v130
  v_mfma_f32_16x16x32_bf16 v[172:175], v[32:35], a[204:207], v[172:175]
  s_waitcnt lgkmcnt(4)
  v_mul_f32 v131, s35, v131
  v_mul_f32 v144, s35, v144
  v_mfma_f32_16x16x32_bf16 v[160:163], v[36:39], a[208:211], v[160:163]
  s_add_u32 m0, s92, 65536
  ds_read_b64_tr_b16 v[32:33], v10 offset:49408
  v_mul_f32 v145, s35, v145
  v_mfma_f32_16x16x32_bf16 v[164:167], v[36:39], a[212:215], v[164:167]
  s_add_u32 s92, s92, 0x4000
  ds_read_b64_tr_b16 v[34:35], v10 offset:50432
  v_mul_f32 v146, s35, v146
  v_mfma_f32_16x16x32_bf16 v[168:171], v[36:39], a[216:219], v[168:171]
  v_mul_f32 v147, s35, v147
  v_cvt_pk_bf16_f32 v64, v128, v129
  v_mfma_f32_16x16x32_bf16 v[172:175], v[36:39], a[220:223], v[172:175]
  s_waitcnt lgkmcnt(4)
  v_cvt_pk_bf16_f32 v65, v130, v131
  v_cvt_pk_bf16_f32 v66, v144, v145
  v_mfma_f32_16x16x32_bf16 v[176:179], v[40:43], a[192:195], v[176:179]
  ds_read_b64_tr_b16 v[36:37], v10 offset:57600
  v_cvt_pk_bf16_f32 v67, v146, v147
  v_mfma_f32_16x16x32_bf16 v[180:183], v[40:43], a[196:199], v[180:183]
  ds_read_b64_tr_b16 v[38:39], v10 offset:58624
  v_mul_f32 v132, s35, v132
  v_mfma_f32_16x16x32_bf16 v[184:187], v[40:43], a[200:203], v[184:187]
  v_mul_f32 v133, s35, v133
  v_mul_f32 v134, s35, v134
  v_mfma_f32_16x16x32_bf16 v[188:191], v[40:43], a[204:207], v[188:191]
  s_waitcnt lgkmcnt(4)
  v_mul_f32 v135, s35, v135
  v_mul_f32 v148, s35, v148
  v_mfma_f32_16x16x32_bf16 v[176:179], v[44:47], a[208:211], v[176:179]
  ds_read_b64_tr_b16 v[40:41], v11 offset:49408
  v_mul_f32 v149, s35, v149
  v_mfma_f32_16x16x32_bf16 v[180:183], v[44:47], a[212:215], v[180:183]
  ds_read_b64_tr_b16 v[42:43], v11 offset:50432
  v_mul_f32 v150, s35, v150
  v_mfma_f32_16x16x32_bf16 v[184:187], v[44:47], a[216:219], v[184:187]
  v_mul_f32 v151, s35, v151
  v_cvt_pk_bf16_f32 v80, v132, v133
  v_mfma_f32_16x16x32_bf16 v[188:191], v[44:47], a[220:223], v[188:191]
  s_waitcnt lgkmcnt(4)
  v_cvt_pk_bf16_f32 v81, v134, v135
  v_cvt_pk_bf16_f32 v82, v148, v149
  v_mfma_f32_16x16x32_bf16 v[160:163], v[32:35], a[224:227], v[160:163]
  ds_read_b64_tr_b16 v[44:45], v11 offset:57600
  v_cvt_pk_bf16_f32 v83, v150, v151
  v_mfma_f32_16x16x32_bf16 v[164:167], v[32:35], a[228:231], v[164:167]
  ds_read_b64_tr_b16 v[46:47], v11 offset:58624
  v_mul_f32 v136, s35, v136
  v_mfma_f32_16x16x32_bf16 v[168:171], v[32:35], a[232:235], v[168:171]
  v_mul_f32 v137, s35, v137
  v_mul_f32 v138, s35, v138
  v_mfma_f32_16x16x32_bf16 v[172:175], v[32:35], a[236:239], v[172:175]
  s_waitcnt lgkmcnt(4)
  s_barrier
  v_mfma_f32_16x16x32_bf16 v[160:163], v[36:39], a[240:243], v[160:163]
  ds_read_b64_tr_b16 v[32:33], v10 offset:33280
  v_mul_f32 v139, s35, v139
  v_mfma_f32_16x16x32_bf16 v[164:167], v[36:39], a[244:247], v[164:167]
  ds_read_b64_tr_b16 v[34:35], v10 offset:34304
  v_mul_f32 v152, s35, v152
  v_mfma_f32_16x16x32_bf16 v[168:171], v[36:39], a[248:251], v[168:171]
  v_mul_f32 v153, s35, v153
  v_mul_f32 v154, s35, v154
  v_mfma_f32_16x16x32_bf16 v[172:175], v[36:39], a[252:255], v[172:175]
  s_waitcnt lgkmcnt(4)
  v_mul_f32 v155, s35, v155
  v_cvt_pk_bf16_f32 v96, v136, v137
  v_mfma_f32_16x16x32_bf16 v[176:179], v[40:43], a[224:227], v[176:179]
  ds_read_b64_tr_b16 v[36:37], v10 offset:41472
  v_cvt_pk_bf16_f32 v97, v138, v139
  v_mfma_f32_16x16x32_bf16 v[180:183], v[40:43], a[228:231], v[180:183]
  ds_read_b64_tr_b16 v[38:39], v10 offset:42496
  v_cvt_pk_bf16_f32 v98, v152, v153
  v_mfma_f32_16x16x32_bf16 v[184:187], v[40:43], a[232:235], v[184:187]
  v_cvt_pk_bf16_f32 v99, v154, v155
  v_mul_f32 v140, s35, v140
  v_mfma_f32_16x16x32_bf16 v[188:191], v[40:43], a[236:239], v[188:191]
  s_waitcnt lgkmcnt(4)
  v_mul_f32 v141, s35, v141
  v_mul_f32 v142, s35, v142
  v_mfma_f32_16x16x32_bf16 v[176:179], v[44:47], a[240:243], v[176:179]
  ds_read_b64_tr_b16 v[40:41], v11 offset:33280
  v_mul_f32 v143, s35, v143
  v_mfma_f32_16x16x32_bf16 v[180:183], v[44:47], a[244:247], v[180:183]
  ds_read_b64_tr_b16 v[42:43], v11 offset:34304
  v_mul_f32 v156, s35, v156
  v_mfma_f32_16x16x32_bf16 v[184:187], v[44:47], a[248:251], v[184:187]
  v_mul_f32 v157, s35, v157
  v_mul_f32 v158, s35, v158
  v_mfma_f32_16x16x32_bf16 v[188:191], v[44:47], a[252:255], v[188:191]
  s_waitcnt lgkmcnt(4)
  v_mul_f32 v159, s35, v159
  v_cvt_pk_bf16_f32 v112, v140, v141
  v_mfma_f32_16x16x32_bf16 v[192:195], v[32:35], a[192:195], v[192:195]
  ds_read_b64_tr_b16 v[44:45], v11 offset:41472
  v_cvt_pk_bf16_f32 v113, v142, v143
  v_mfma_f32_16x16x32_bf16 v[196:199], v[32:35], a[196:199], v[196:199]
  ds_read_b64_tr_b16 v[46:47], v11 offset:42496
  v_cvt_pk_bf16_f32 v114, v156, v157
  v_mfma_f32_16x16x32_bf16 v[200:203], v[32:35], a[200:203], v[200:203]
  v_cvt_pk_bf16_f32 v115, v158, v159
  v_mul_f32 v160, s35, v160
  v_mfma_f32_16x16x32_bf16 v[204:207], v[32:35], a[204:207], v[204:207]
  s_waitcnt lgkmcnt(4)
  v_mul_f32 v161, s35, v161
  v_mul_f32 v162, s35, v162
  v_mfma_f32_16x16x32_bf16 v[192:195], v[36:39], a[208:211], v[192:195]
  ds_read_b64_tr_b16 v[32:33], v10 offset:49664
  v_mul_f32 v163, s35, v163
  v_mfma_f32_16x16x32_bf16 v[196:199], v[36:39], a[212:215], v[196:199]
  ds_read_b64_tr_b16 v[34:35], v10 offset:50688
  v_mul_f32 v176, s35, v176
  v_mfma_f32_16x16x32_bf16 v[200:203], v[36:39], a[216:219], v[200:203]
  v_mul_f32 v177, s35, v177
  v_mul_f32 v178, s35, v178
  v_mfma_f32_16x16x32_bf16 v[204:207], v[36:39], a[220:223], v[204:207]
  s_waitcnt lgkmcnt(4)
  v_mul_f32 v179, s35, v179
  v_cvt_pk_bf16_f32 v68, v160, v161
  v_mfma_f32_16x16x32_bf16 v[208:211], v[40:43], a[192:195], v[208:211]
  ds_read_b64_tr_b16 v[36:37], v10 offset:57856
  v_cvt_pk_bf16_f32 v69, v162, v163
  v_mfma_f32_16x16x32_bf16 v[212:215], v[40:43], a[196:199], v[212:215]
  ds_read_b64_tr_b16 v[38:39], v10 offset:58880
  v_cvt_pk_bf16_f32 v70, v176, v177
  v_mfma_f32_16x16x32_bf16 v[216:219], v[40:43], a[200:203], v[216:219]
  v_cvt_pk_bf16_f32 v71, v178, v179
  v_mul_f32 v164, s35, v164
  v_mfma_f32_16x16x32_bf16 v[220:223], v[40:43], a[204:207], v[220:223]
  s_waitcnt lgkmcnt(4)
  v_mul_f32 v165, s35, v165
  v_mul_f32 v166, s35, v166
  v_mfma_f32_16x16x32_bf16 v[208:211], v[44:47], a[208:211], v[208:211]
  ds_read_b64_tr_b16 v[40:41], v11 offset:49664
  v_mul_f32 v167, s35, v167
  v_mfma_f32_16x16x32_bf16 v[212:215], v[44:47], a[212:215], v[212:215]
  ds_read_b64_tr_b16 v[42:43], v11 offset:50688
  v_mul_f32 v180, s35, v180
  v_mfma_f32_16x16x32_bf16 v[216:219], v[44:47], a[216:219], v[216:219]
  v_mul_f32 v181, s35, v181
  v_mul_f32 v182, s35, v182
  v_mfma_f32_16x16x32_bf16 v[220:223], v[44:47], a[220:223], v[220:223]
  s_waitcnt lgkmcnt(4)
  v_mul_f32 v183, s35, v183
  v_cvt_pk_bf16_f32 v84, v164, v165
  v_mfma_f32_16x16x32_bf16 v[192:195], v[32:35], a[224:227], v[192:195]
  ds_read_b64_tr_b16 v[44:45], v11 offset:57856
  v_cvt_pk_bf16_f32 v85, v166, v167
  v_mfma_f32_16x16x32_bf16 v[196:199], v[32:35], a[228:231], v[196:199]
  ds_read_b64_tr_b16 v[46:47], v11 offset:58880
  v_cvt_pk_bf16_f32 v86, v180, v181
  v_mfma_f32_16x16x32_bf16 v[200:203], v[32:35], a[232:235], v[200:203]
  v_cvt_pk_bf16_f32 v87, v182, v183
  v_mul_f32 v168, s35, v168
  v_mfma_f32_16x16x32_bf16 v[204:207], v[32:35], a[236:239], v[204:207]
  s_waitcnt lgkmcnt(4)
  v_mul_f32 v169, s35, v169
  v_mul_f32 v170, s35, v170
  v_mfma_f32_16x16x32_bf16 v[192:195], v[36:39], a[240:243], v[192:195]
  ds_read_b64_tr_b16 v[32:33], v10 offset:33536
  v_mul_f32 v171, s35, v171
  v_mfma_f32_16x16x32_bf16 v[196:199], v[36:39], a[244:247], v[196:199]
  ds_read_b64_tr_b16 v[34:35], v10 offset:34560
  v_mul_f32 v184, s35, v184
  v_mfma_f32_16x16x32_bf16 v[200:203], v[36:39], a[248:251], v[200:203]
  v_mul_f32 v185, s35, v185
  v_mul_f32 v186, s35, v186
  v_mfma_f32_16x16x32_bf16 v[204:207], v[36:39], a[252:255], v[204:207]
  s_waitcnt lgkmcnt(4)
  v_mul_f32 v187, s35, v187
  v_cvt_pk_bf16_f32 v100, v168, v169
  v_mfma_f32_16x16x32_bf16 v[208:211], v[40:43], a[224:227], v[208:211]
  ds_read_b64_tr_b16 v[36:37], v10 offset:41728
  v_cvt_pk_bf16_f32 v101, v170, v171
  v_mfma_f32_16x16x32_bf16 v[212:215], v[40:43], a[228:231], v[212:215]
  ds_read_b64_tr_b16 v[38:39], v10 offset:42752
  v_cvt_pk_bf16_f32 v102, v184, v185
  v_mfma_f32_16x16x32_bf16 v[216:219], v[40:43], a[232:235], v[216:219]
  v_cvt_pk_bf16_f32 v103, v186, v187
  v_mul_f32 v172, s35, v172
  v_mfma_f32_16x16x32_bf16 v[220:223], v[40:43], a[236:239], v[220:223]
  s_waitcnt lgkmcnt(4)
  v_mul_f32 v173, s35, v173
  v_mul_f32 v174, s35, v174
  v_mfma_f32_16x16x32_bf16 v[208:211], v[44:47], a[240:243], v[208:211]
  ds_read_b64_tr_b16 v[40:41], v11 offset:33536
  v_mul_f32 v175, s35, v175
  v_mfma_f32_16x16x32_bf16 v[212:215], v[44:47], a[244:247], v[212:215]
  ds_read_b64_tr_b16 v[42:43], v11 offset:34560
  v_mul_f32 v188, s35, v188
  v_mfma_f32_16x16x32_bf16 v[216:219], v[44:47], a[248:251], v[216:219]
  v_mul_f32 v189, s35, v189
  v_mul_f32 v190, s35, v190
  v_mfma_f32_16x16x32_bf16 v[220:223], v[44:47], a[252:255], v[220:223]
  s_waitcnt lgkmcnt(4)
  v_mul_f32 v191, s35, v191
  v_cvt_pk_bf16_f32 v116, v172, v173
  v_mfma_f32_16x16x32_bf16 v[224:227], v[32:35], a[192:195], v[224:227]
  ds_read_b64_tr_b16 v[44:45], v11 offset:41728
  v_cvt_pk_bf16_f32 v117, v174, v175
  v_mfma_f32_16x16x32_bf16 v[228:231], v[32:35], a[196:199], v[228:231]
  ds_read_b64_tr_b16 v[46:47], v11 offset:42752
  v_cvt_pk_bf16_f32 v118, v188, v189
  v_mfma_f32_16x16x32_bf16 v[232:235], v[32:35], a[200:203], v[232:235]
  v_cvt_pk_bf16_f32 v119, v190, v191
  v_mul_f32 v192, s35, v192
  v_mfma_f32_16x16x32_bf16 v[236:239], v[32:35], a[204:207], v[236:239]
  s_waitcnt lgkmcnt(4)
  v_mul_f32 v193, s35, v193
  v_mul_f32 v194, s35, v194
  v_mfma_f32_16x16x32_bf16 v[224:227], v[36:39], a[208:211], v[224:227]
  ds_read_b64_tr_b16 v[32:33], v10 offset:49920
  v_mul_f32 v195, s35, v195
  v_mfma_f32_16x16x32_bf16 v[228:231], v[36:39], a[212:215], v[228:231]
  ds_read_b64_tr_b16 v[34:35], v10 offset:50944
  v_mul_f32 v208, s35, v208
  v_mfma_f32_16x16x32_bf16 v[232:235], v[36:39], a[216:219], v[232:235]
  v_mul_f32 v209, s35, v209
  v_mul_f32 v210, s35, v210
  v_mfma_f32_16x16x32_bf16 v[236:239], v[36:39], a[220:223], v[236:239]
  s_waitcnt lgkmcnt(4)
  v_mul_f32 v211, s35, v211
  v_cvt_pk_bf16_f32 v72, v192, v193
  v_mfma_f32_16x16x32_bf16 v[240:243], v[40:43], a[192:195], v[240:243]
  ds_read_b64_tr_b16 v[36:37], v10 offset:58112
  v_cvt_pk_bf16_f32 v73, v194, v195
  v_mfma_f32_16x16x32_bf16 v[244:247], v[40:43], a[196:199], v[244:247]
  ds_read_b64_tr_b16 v[38:39], v10 offset:59136
  v_cvt_pk_bf16_f32 v74, v208, v209
  v_mfma_f32_16x16x32_bf16 v[248:251], v[40:43], a[200:203], v[248:251]
  v_cvt_pk_bf16_f32 v75, v210, v211
  v_mul_f32 v196, s35, v196
  v_mfma_f32_16x16x32_bf16 v[252:255], v[40:43], a[204:207], v[252:255]
  s_waitcnt lgkmcnt(4)
  v_mul_f32 v197, s35, v197
  v_mul_f32 v198, s35, v198
  v_mfma_f32_16x16x32_bf16 v[240:243], v[44:47], a[208:211], v[240:243]
  ds_read_b64_tr_b16 v[40:41], v11 offset:49920
  v_mul_f32 v199, s35, v199
  v_mfma_f32_16x16x32_bf16 v[244:247], v[44:47], a[212:215], v[244:247]
  ds_read_b64_tr_b16 v[42:43], v11 offset:50944
  v_mul_f32 v212, s35, v212
  v_mfma_f32_16x16x32_bf16 v[248:251], v[44:47], a[216:219], v[248:251]
  v_mul_f32 v213, s35, v213
  v_mul_f32 v214, s35, v214
  v_mfma_f32_16x16x32_bf16 v[252:255], v[44:47], a[220:223], v[252:255]
  s_waitcnt lgkmcnt(4)
  v_mul_f32 v215, s35, v215
  v_cvt_pk_bf16_f32 v88, v196, v197
  v_mfma_f32_16x16x32_bf16 v[224:227], v[32:35], a[224:227], v[224:227]
  ds_read_b64_tr_b16 v[44:45], v11 offset:58112
  v_cvt_pk_bf16_f32 v89, v198, v199
  v_mfma_f32_16x16x32_bf16 v[228:231], v[32:35], a[228:231], v[228:231]
  ds_read_b64_tr_b16 v[46:47], v11 offset:59136
  v_cvt_pk_bf16_f32 v90, v212, v213
  v_mfma_f32_16x16x32_bf16 v[232:235], v[32:35], a[232:235], v[232:235]
  v_cvt_pk_bf16_f32 v91, v214, v215
  v_mul_f32 v200, s35, v200
  v_mfma_f32_16x16x32_bf16 v[236:239], v[32:35], a[236:239], v[236:239]
  s_waitcnt lgkmcnt(4)
  s_waitcnt vmcnt(13)
  s_barrier
  v_mfma_f32_16x16x32_bf16 v[224:227], v[36:39], a[240:243], v[224:227]
  s_and_b32 s92, s92, 0xffff
  ds_read_b128 a[128:131], v15 offset:0
  buffer_load_dwordx4 v15, s[36:39], s93 offen offset:0 sc1 lds
  buffer_load_dwordx4 v15, s[36:39], s93 offen offset:1024 sc1 lds
  buffer_load_dwordx4 v15, s[36:39], s93 offen offset:2048 sc1 lds
  buffer_load_dwordx4 v15, s[36:39], s93 offen offset:3072 sc1 lds
  s_add_u32 s93, s93, 0x8000
  v_mul_f32 v201, s35, v201
  v_mfma_f32_16x16x32_bf16 v[228:231], v[36:39], a[244:247], v[228:231]
  ds_read_b128 a[132:135], v15 offset:4096
  v_mul_f32 v202, s35, v202
  v_mfma_f32_16x16x32_bf16 v[232:235], v[36:39], a[248:251], v[232:235]
  ds_read_b128 a[136:139], v15 offset:1024
  v_mul_f32 v203, s35, v203
  v_mfma_f32_16x16x32_bf16 v[236:239], v[36:39], a[252:255], v[236:239]
  s_waitcnt lgkmcnt(5)
  ds_read_b128 a[140:143], v15 offset:5120
  v_mul_f32 v216, s35, v216
  v_mfma_f32_16x16x32_bf16 v[240:243], v[40:43], a[224:227], v[240:243]
  ds_read_b128 a[144:147], v15 offset:2048
  v_mul_f32 v217, s35, v217
  v_mfma_f32_16x16x32_bf16 v[244:247], v[40:43], a[228:231], v[244:247]
  ds_read_b128 a[148:151], v15 offset:6144
  v_mul_f32 v218, s35, v218
  v_mfma_f32_16x16x32_bf16 v[248:251], v[40:43], a[232:235], v[248:251]
  ds_read_b128 a[152:155], v15 offset:3072
  v_mul_f32 v219, s35, v219
  v_mfma_f32_16x16x32_bf16 v[252:255], v[40:43], a[236:239], v[252:255]
  s_waitcnt lgkmcnt(7)
  ds_read_b128 a[156:159], v15 offset:7168
  v_cvt_pk_bf16_f32 v104, v200, v201
  v_mfma_f32_16x16x32_bf16 v[240:243], v[44:47], a[240:243], v[240:243]
  v_cvt_pk_bf16_f32 v105, v202, v203
  v_cvt_pk_bf16_f32 v106, v216, v217
  v_mfma_f32_16x16x32_bf16 v[244:247], v[44:47], a[244:247], v[244:247]
  v_cvt_pk_bf16_f32 v107, v218, v219
  v_mul_f32 v204, s35, v204
  v_mfma_f32_16x16x32_bf16 v[248:251], v[44:47], a[248:251], v[248:251]
  v_mul_f32 v205, s35, v205
  v_mul_f32 v206, s35, v206
  v_mfma_f32_16x16x32_bf16 v[252:255], v[44:47], a[252:255], v[252:255]
  s_waitcnt lgkmcnt(7)
  v_mul_f32 v207, s35, v207
  v_mul_f32 v220, s35, v220
  v_mfma_f32_16x16x32_bf16 v[128:131], a[128:131], v[64:67], 0
  v_mul_f32 v221, s35, v221
  v_mul_f32 v222, s35, v222
  v_mfma_f32_16x16x32_bf16 v[136:139], a[128:131], v[80:83], 0
  v_mul_f32 v223, s35, v223
  v_cvt_pk_bf16_f32 v120, v204, v205
  v_mfma_f32_16x16x32_bf16 v[144:147], a[128:131], v[96:99], 0
  v_cvt_pk_bf16_f32 v121, v206, v207
  v_cvt_pk_bf16_f32 v122, v220, v221
  v_mfma_f32_16x16x32_bf16 v[152:155], a[128:131], v[112:115], 0
  s_waitcnt lgkmcnt(6)
  v_cvt_pk_bf16_f32 v123, v222, v223
  v_mul_f32 v224, s35, v224
  v_mfma_f32_16x16x32_bf16 v[132:135], a[132:135], v[64:67], 0
  v_mul_f32 v225, s35, v225
  v_mul_f32 v226, s35, v226
  v_mfma_f32_16x16x32_bf16 v[140:143], a[132:135], v[80:83], 0
  v_mul_f32 v227, s35, v227
  v_mul_f32 v240, s35, v240
  v_mfma_f32_16x16x32_bf16 v[148:151], a[132:135], v[96:99], 0
  v_mul_f32 v241, s35, v241
  v_mul_f32 v242, s35, v242
  v_mfma_f32_16x16x32_bf16 v[156:159], a[132:135], v[112:115], 0
  s_waitcnt lgkmcnt(5)
  v_mul_f32 v243, s35, v243
  v_cvt_pk_bf16_f32 v76, v224, v225
  v_mfma_f32_16x16x32_bf16 v[128:131], a[136:139], v[68:71], v[128:131]
  v_cvt_pk_bf16_f32 v77, v226, v227
  v_cvt_pk_bf16_f32 v78, v240, v241
  v_mfma_f32_16x16x32_bf16 v[136:139], a[136:139], v[84:87], v[136:139]
  v_cvt_pk_bf16_f32 v79, v242, v243
  v_mul_f32 v228, s35, v228
  v_mfma_f32_16x16x32_bf16 v[144:147], a[136:139], v[100:103], v[144:147]
  v_mul_f32 v229, s35, v229
  v_mul_f32 v230, s35, v230
  v_mfma_f32_16x16x32_bf16 v[152:155], a[136:139], v[116:119], v[152:155]
  s_waitcnt lgkmcnt(4)
  v_mul_f32 v231, s35, v231
  v_mul_f32 v244, s35, v244
  v_mfma_f32_16x16x32_bf16 v[132:135], a[140:143], v[68:71], v[132:135]
  v_mul_f32 v245, s35, v245
  v_mul_f32 v246, s35, v246
  v_mfma_f32_16x16x32_bf16 v[140:143], a[140:143], v[84:87], v[140:143]
  v_mul_f32 v247, s35, v247
  v_cvt_pk_bf16_f32 v92, v228, v229
  v_mfma_f32_16x16x32_bf16 v[148:151], a[140:143], v[100:103], v[148:151]
  v_cvt_pk_bf16_f32 v93, v230, v231
  v_cvt_pk_bf16_f32 v94, v244, v245
  v_mfma_f32_16x16x32_bf16 v[156:159], a[140:143], v[116:119], v[156:159]
  s_waitcnt lgkmcnt(3)
  v_cvt_pk_bf16_f32 v95, v246, v247
  v_mul_f32 v232, s35, v232
  v_mfma_f32_16x16x32_bf16 v[128:131], a[144:147], v[72:75], v[128:131]
  v_mul_f32 v233, s35, v233
  v_mul_f32 v234, s35, v234
  v_mfma_f32_16x16x32_bf16 v[136:139], a[144:147], v[88:91], v[136:139]
  v_mul_f32 v235, s35, v235
  v_mul_f32 v248, s35, v248
  v_mfma_f32_16x16x32_bf16 v[144:147], a[144:147], v[104:107], v[144:147]
  v_mul_f32 v249, s35, v249
  v_mul_f32 v250, s35, v250
  v_mfma_f32_16x16x32_bf16 v[152:155], a[144:147], v[120:123], v[152:155]
  s_waitcnt lgkmcnt(2)
  v_mul_f32 v251, s35, v251
  v_cvt_pk_bf16_f32 v108, v232, v233
  v_mfma_f32_16x16x32_bf16 v[132:135], a[148:151], v[72:75], v[132:135]
  v_cvt_pk_bf16_f32 v109, v234, v235
  v_cvt_pk_bf16_f32 v110, v248, v249
  v_mfma_f32_16x16x32_bf16 v[140:143], a[148:151], v[88:91], v[140:143]
  v_cvt_pk_bf16_f32 v111, v250, v251
  v_mul_f32 v236, s35, v236
  v_mul_f32 v237, s35, v237
  v_mul_f32 v238, s35, v238
  v_mul_f32 v239, s35, v239
  v_mul_f32 v252, s35, v252
  v_mul_f32 v253, s35, v253
  v_mul_f32 v254, s35, v254
  v_mul_f32 v255, s35, v255
  v_cvt_pk_bf16_f32 v124, v236, v237
  v_cvt_pk_bf16_f32 v125, v238, v239
  v_cvt_pk_bf16_f32 v126, v252, v253
  v_cvt_pk_bf16_f32 v127, v254, v255
  v_mfma_f32_16x16x32_bf16 v[148:151], a[148:151], v[104:107], v[148:151]
  v_mfma_f32_16x16x32_bf16 v[156:159], a[148:151], v[120:123], v[156:159]
  s_waitcnt lgkmcnt(1)
  v_mfma_f32_16x16x32_bf16 v[128:131], a[152:155], v[76:79], v[128:131]
  v_mfma_f32_16x16x32_bf16 v[136:139], a[152:155], v[92:95], v[136:139]
  v_mfma_f32_16x16x32_bf16 v[144:147], a[152:155], v[108:111], v[144:147]
  v_mfma_f32_16x16x32_bf16 v[152:155], a[152:155], v[124:127], v[152:155]
  s_waitcnt lgkmcnt(0)
  v_mfma_f32_16x16x32_bf16 v[132:135], a[156:159], v[76:79], v[132:135]
  v_mfma_f32_16x16x32_bf16 v[140:143], a[156:159], v[92:95], v[140:143]
  v_mfma_f32_16x16x32_bf16 v[148:151], a[156:159], v[108:111], v[148:151]
  v_mfma_f32_16x16x32_bf16 v[156:159], a[156:159], v[124:127], v[156:159]
  ds_read_b128 a[128:131], v60 offset:8192
  ds_read_b128 a[132:135], v60 offset:12288
  ds_read_b128 a[136:139], v60 offset:9216
  ds_read_b128 a[140:143], v60 offset:13312
  ds_read_b128 a[144:147], v60 offset:10240
  v_mov_b32 v56, 0
  v_mov_b32 v57, 0
  v_mov_b32 v58, 0
  v_mov_b32 v59, 0
  v_mov_b32 v62, 0x3f803f80
  v_accvgpr_write_b32 a192, v62
  v_accvgpr_write_b32 a193, v62
  v_accvgpr_write_b32 a194, v62
  v_accvgpr_write_b32 a195, v62
  s_cmp_eq_u32 s70, 0
  s_cbranch_scc1 L_diag0
L_diag0r:
  v_max3_f32 v32, v128, v129, v130
  v_max3_f32 v33, v136, v137, v138
  v_max3_f32 v34, v144, v145, v146
  v_max3_f32 v35, v152, v153, v154
  v_max3_f32 v32, v32, v131, v132
  v_max3_f32 v33, v33, v139, v140
  v_max3_f32 v34, v34, v147, v148
  v_max3_f32 v35, v35, v155, v156
  v_max3_f32 v32, v32, v133, v134
  v_max3_f32 v33, v33, v141, v142
  v_max3_f32 v34, v34, v149, v150
  v_max3_f32 v35, v35, v157, v158
  v_max_f32 v32, v32, v135
  v_max_f32 v33, v33, v143
  v_max_f32 v34, v34, v151
  v_max_f32 v35, v35, v159
  v_mov_b32 v36, v32
  v_mov_b32 v37, v33
  v_mov_b32 v38, v34
  v_mov_b32 v39, v35
  v_permlane16_swap_b32 v32, v36
  v_permlane16_swap_b32 v33, v37
  v_permlane16_swap_b32 v34, v38
  v_permlane16_swap_b32 v35, v39
  v_max_f32 v32, v32, v36
  v_max_f32 v33, v33, v37
  v_max_f32 v34, v34, v38
  v_max_f32 v35, v35, v39
  v_mov_b32 v36, v32
  v_mov_b32 v37, v33
  v_mov_b32 v38, v34
  v_mov_b32 v39, v35
  v_permlane32_swap_b32 v32, v36
  v_permlane32_swap_b32 v33, v37
  v_permlane32_swap_b32 v34, v38
  v_permlane32_swap_b32 v35, v39
  v_max_f32 v32, v32, v36
  v_max_f32 v33, v33, v37
  v_max_f32 v34, v34, v38
  v_max_f32 v35, v35, v39
  v_sub_f32 v128, v128, v32
  v_sub_f32 v129, v129, v32
  v_sub_f32 v130, v130, v32
  v_sub_f32 v131, v131, v32
  v_sub_f32 v132, v132, v32
  v_sub_f32 v133, v133, v32
  v_sub_f32 v134, v134, v32
  v_sub_f32 v135, v135, v32
  v_sub_f32 v224, 0, v32
  v_sub_f32 v225, 0, v32
  v_sub_f32 v226, 0, v32
  v_sub_f32 v227, 0, v32
  v_sub_f32 v228, 0, v32
  v_sub_f32 v229, 0, v32
  v_sub_f32 v230, 0, v32
  v_sub_f32 v231, 0, v32
  v_sub_f32 v136, v136, v33
  v_sub_f32 v137, v137, v33
  v_sub_f32 v138, v138, v33
  v_sub_f32 v139, v139, v33
  v_sub_f32 v140, v140, v33
  v_sub_f32 v141, v141, v33
  v_sub_f32 v142, v142, v33
  v_sub_f32 v143, v143, v33
  v_sub_f32 v232, 0, v33
  v_sub_f32 v233, 0, v33
  v_sub_f32 v234, 0, v33
  v_sub_f32 v235, 0, v33
  v_sub_f32 v236, 0, v33
  v_sub_f32 v237, 0, v33
  v_sub_f32 v238, 0, v33
  v_sub_f32 v239, 0, v33
  v_sub_f32 v144, v144, v34
  v_sub_f32 v145, v145, v34
  v_sub_f32 v146, v146, v34
  v_sub_f32 v147, v147, v34
  v_sub_f32 v148, v148, v34
  v_sub_f32 v149, v149, v34
  v_sub_f32 v150, v150, v34
  v_sub_f32 v151, v151, v34
  v_sub_f32 v240, 0, v34
  v_sub_f32 v241, 0, v34
  v_sub_f32 v242, 0, v34
  v_sub_f32 v243, 0, v34
  v_sub_f32 v244, 0, v34
  v_sub_f32 v245, 0, v34
  v_sub_f32 v246, 0, v34
  v_sub_f32 v247, 0, v34
  v_sub_f32 v152, v152, v35
  v_sub_f32 v153, v153, v35
  v_sub_f32 v154, v154, v35
  v_sub_f32 v155, v155, v35
  v_sub_f32 v156, v156, v35
  v_sub_f32 v157, v157, v35
  v_sub_f32 v158, v158, v35
  v_sub_f32 v159, v159, v35
  v_sub_f32 v248, 0, v35
  v_sub_f32 v249, 0, v35
  v_sub_f32 v250, 0, v35
  v_sub_f32 v251, 0, v35
  v_sub_f32 v252, 0, v35
  v_sub_f32 v253, 0, v35
  v_sub_f32 v254, 0, v35
  v_sub_f32 v255, 0, v35
  s_add_u32 s94, s94, 1
  s_sub_u32 s75, s94, s95
  s_call_b64 s[98:99], Lmask
  v_exp_f32 v32, v128
  v_exp_f32 v33, v129
  v_exp_f32 v34, v130
  v_exp_f32 v35, v131
  v_cvt_pk_bf16_f32 v192, v32, v33
  v_exp_f32 v36, v132
  v_exp_f32 v37, v133
  v_cvt_pk_bf16_f32 v193, v34, v35
  v_exp_f32 v38, v134
  v_exp_f32 v39, v135
  v_cvt_pk_bf16_f32 v194, v36, v37
  v_exp_f32 v32, v136
  v_exp_f32 v33, v137
  v_cvt_pk_bf16_f32 v195, v38, v39
  v_exp_f32 v34, v138
  v_exp_f32 v35, v139
  v_cvt_pk_bf16_f32 v196, v32, v33
  v_exp_f32 v36, v140
  v_exp_f32 v37, v141
  v_cvt_pk_bf16_f32 v197, v34, v35
  v_exp_f32 v38, v142
  v_exp_f32 v39, v143
  v_cvt_pk_bf16_f32 v198, v36, v37
  s_nop 0
  v_cvt_pk_bf16_f32 v199, v38, v39
  s_lshl_b32 s96, s70, 1
  s_add_u32 s96, s96, 1
  s_add_u32 s1, s0, 0
  buffer_load_dword v0, v30, s[52:55], s1 offen
  s_add_u32 s1, s0, 2097152
  buffer_load_dword v0, v30, s[52:55], s1 offen
  s_getpc_b64 s[98:99]
L_pc10:
  s_sub_u32 s98, s98, L_pc10-L_pc
  s_subb_u32 s99, s99, 0
  global_load_dword v0, v51, s[98:99]
  s_branch L_E
  .p2align 6
Lmask:
  v_mov_b32 v37, s74
  s_cmp_lt_i32 s75, 0
  s_cbranch_scc1 Lmkend
  s_lshl_b32 s76, s75, 5
  s_cmp_ge_u32 s75, 2
  s_cbranch_scc1 Lmk1_1
Lmk1_0:
  v_subrev_u32 v36, s76, v48
  v_cmp_gt_i32 vcc, 0, v36
  v_cmp_gt_i32 s[34:35], 1, v36
  v_cmp_gt_i32 s[28:29], 2, v36
  v_cmp_gt_i32 s[30:31], 3, v36
  v_cndmask_b32 v240, v240, v37, vcc
  v_cndmask_b32 v241, v241, v37, s[34:35]
  v_cndmask_b32 v242, v242, v37, s[28:29]
  v_cndmask_b32 v243, v243, v37, s[30:31]
  v_cmp_gt_i32 vcc, 16, v36
  v_cmp_gt_i32 s[34:35], 17, v36
  v_cmp_gt_i32 s[28:29], 18, v36
  v_cmp_gt_i32 s[30:31], 19, v36
  v_cndmask_b32 v244, v244, v37, vcc
  v_cndmask_b32 v245, v245, v37, s[34:35]
  v_cndmask_b32 v246, v246, v37, s[28:29]
  v_cndmask_b32 v247, v247, v37, s[30:31]
  s_branch Lmk1_d
Lmk1_1:
  v_subrev_u32 v36, s76, v63
  v_cmp_gt_i32 vcc, 0, v36
  v_cmp_gt_i32 s[34:35], 1, v36
  v_cmp_gt_i32 s[28:29], 2, v36
  v_cmp_gt_i32 s[30:31], 3, v36
  v_cndmask_b32 v248, v248, v37, vcc
  v_cndmask_b32 v249, v249, v37, s[34:35]
  v_cndmask_b32 v250, v250, v37, s[28:29]
  v_cndmask_b32 v251, v251, v37, s[30:31]
  v_cmp_gt_i32 vcc, 16, v36
  v_cmp_gt_i32 s[34:35], 17, v36
  v_cmp_gt_i32 s[28:29], 18, v36
  v_cmp_gt_i32 s[30:31], 19, v36
  v_cndmask_b32 v252, v252, v37, vcc
  v_cndmask_b32 v253, v253, v37, s[34:35]
  v_cndmask_b32 v254, v254, v37, s[28:29]
  v_cndmask_b32 v255, v255, v37, s[30:31]
Lmk1_d:
  s_cmp_lt_u32 s95, 32
  s_cbranch_scc1 Lmkend
  s_sub_u32 s75, s75, 1
  s_cmp_lt_i32 s75, 0
  s_cbranch_scc1 Lmkend
  s_lshl_b32 s76, s75, 5
  s_cmp_ge_u32 s75, 2
  s_cbranch_scc1 Lmk0_1
Lmk0_0:
  v_subrev_u32 v36, s76, v48
  v_cmp_gt_i32 vcc, 0, v36
  v_cmp_gt_i32 s[34:35], 1, v36
  v_cmp_gt_i32 s[28:29], 2, v36
  v_cmp_gt_i32 s[30:31], 3, v36
  v_cndmask_b32 v224, v224, v37, vcc
  v_cndmask_b32 v225, v225, v37, s[34:35]
  v_cndmask_b32 v226, v226, v37, s[28:29]
  v_cndmask_b32 v227, v227, v37, s[30:31]
  v_cmp_gt_i32 vcc, 16, v36
  v_cmp_gt_i32 s[34:35], 17, v36
  v_cmp_gt_i32 s[28:29], 18, v36
  v_cmp_gt_i32 s[30:31], 19, v36
  v_cndmask_b32 v228, v228, v37, vcc
  v_cndmask_b32 v229, v229, v37, s[34:35]
  v_cndmask_b32 v230, v230, v37, s[28:29]
  v_cndmask_b32 v231, v231, v37, s[30:31]
  s_branch Lmk0_d
Lmk0_1:
  v_subrev_u32 v36, s76, v63
  v_cmp_gt_i32 vcc, 0, v36
  v_cmp_gt_i32 s[34:35], 1, v36
  v_cmp_gt_i32 s[28:29], 2, v36
  v_cmp_gt_i32 s[30:31], 3, v36
  v_cndmask_b32 v232, v232, v37, vcc
  v_cndmask_b32 v233, v233, v37, s[34:35]
  v_cndmask_b32 v234, v234, v37, s[28:29]
  v_cndmask_b32 v235, v235, v37, s[30:31]
  v_cmp_gt_i32 vcc, 16, v36
  v_cmp_gt_i32 s[34:35], 17, v36
  v_cmp_gt_i32 s[28:29], 18, v36
  v_cmp_gt_i32 s[30:31], 19, v36
  v_cndmask_b32 v236, v236, v37, vcc
  v_cndmask_b32 v237, v237, v37, s[34:35]
  v_cndmask_b32 v238, v238, v37, s[28:29]
  v_cndmask_b32 v239, v239, v37, s[30:31]
Lmk0_d:
Lmkend:
  s_setpc_b64 s[98:99]
LrareE:
  s_call_b64 s[98:99], Lmask
  v_cmp_lt_f32 vcc, s3, v62
  s_cbranch_vccz LretE
  s_branch LrealE
LrareO:
  s_call_b64 s[98:99], Lmask
  v_cmp_lt_f32 vcc, s3, v62
  s_cbranch_vccz LretO
  s_branch LrealO
LrareOL:
  s_call_b64 s[98:99], Lmask
  v_cmp_lt_f32 vcc, s3, v62
  s_cbranch_vccz LretOL
  s_branch LrealOL
LrareT:
  s_call_b64 s[98:99], Lmask
  v_cmp_lt_f32 vcc, s3, v62
  s_cbranch_vccz LretT
  s_branch LrealT
LrareE2:
  s_call_b64 s[98:99], Lmask
  v_cmp_lt_f32 vcc, s3, v62
  s_cbranch_vccz LretE2
  s_branch LrealE2
LrareO2:
  s_call_b64 s[98:99], Lmask
  v_cmp_lt_f32 vcc, s3, v62
  s_cbranch_vccz LretO2
  s_branch LrealO2
L_O:
  v_mfma_f32_16x16x32_bf16 v[128:131], a[128:131], v[64:67], v[224:227]
  v_exp_f32 v32, v176
  v_mfma_f32_16x16x32_bf16 v[136:139], a[128:131], v[80:83], v[232:235]
  v_exp_f32 v33, v177
  v_mfma_f32_16x16x32_bf16 v[40:43], a[192:195], v[208:211], 0
  ds_read_b128 a[148:151], v60 offset:6144
  v_cvt_pk_bf16_f32 v216, v32, v33
  v_mfma_f32_16x16x32_bf16 v[44:47], a[192:195], v[212:215], 0
  v_exp_f32 v34, v178
  v_mfma_f32_16x16x32_bf16 v[144:147], a[128:131], v[96:99], v[240:243]
  s_add_u32 s94, s94, 1
  v_exp_f32 v35, v179
  v_mfma_f32_16x16x32_bf16 v[152:155], a[128:131], v[112:115], v[248:251]
  s_sub_u32 s75, s94, s95
  v_exp_f32 v36, v180
  v_mfma_f32_16x16x32_bf16 v[132:135], a[132:135], v[64:67], v[228:231]
  s_add_u32 m0, s92, 65536
  s_add_u32 s92, s92, 0x4000
  ds_read_b128 a[152:155], v60 offset:3072
  v_mfma_f32_16x16x32_bf16 v[140:143], a[132:135], v[80:83], v[236:239]
  s_waitcnt lgkmcnt(3)
  v_exp_f32 v37, v181
  v_mfma_f32_16x16x32_bf16 v[148:151], a[132:135], v[96:99], v[244:247]
  v_exp_f32 v38, v182
  v_mfma_f32_16x16x32_bf16 v[156:159], a[132:135], v[112:115], v[252:255]
  v_exp_f32 v39, v183
  v_mfma_f32_16x16x32_bf16 v[128:131], a[136:139], v[68:71], v[128:131]
  buffer_load_dwordx4 v15, s[36:39], s93 offen offset:0 sc1 lds
  v_mfma_f32_16x16x32_bf16 v[136:139], a[136:139], v[84:87], v[136:139]
  v_exp_f32 v32, v184
  v_mfma_f32_16x16x32_bf16 v[144:147], a[136:139], v[100:103], v[144:147]
  ds_read_b128 a[156:159], v60 offset:7168
  v_cvt_pk_bf16_f32 v217, v34, v35
  v_mfma_f32_16x16x32_bf16 v[152:155], a[136:139], v[116:119], v[152:155]
  v_exp_f32 v33, v185
  v_mfma_f32_16x16x32_bf16 v[132:135], a[140:143], v[68:71], v[132:135]
  v_exp_f32 v34, v186
  v_mfma_f32_16x16x32_bf16 v[140:143], a[140:143], v[84:87], v[140:143]
  s_waitcnt lgkmcnt(2)
  v_exp_f32 v35, v187
  v_mfma_f32_16x16x32_bf16 v[148:151], a[140:143], v[100:103], v[148:151]
  ds_read_b128 a[160:163], v61 offset:8192
  v_cvt_pk_bf16_f32 v218, v36, v37
  v_mfma_f32_16x16x32_bf16 v[156:159], a[140:143], v[116:119], v[156:159]
  v_exp_f32 v36, v188
  v_mfma_f32_16x16x32_bf16 v[128:131], a[144:147], v[72:75], v[128:131]
  s_cmp_lt_u32 s75, 4
  s_cselect_b32 s97, -1.0, s3
  v_exp_f32 v37, v189
  v_mfma_f32_16x16x32_bf16 v[136:139], a[144:147], v[88:91], v[136:139]
  v_cvt_pk_bf16_f32 v219, v38, v39
  v_cvt_pk_bf16_f32 v220, v32, v33
  v_mfma_f32_16x16x32_bf16 v[144:147], a[144:147], v[104:107], v[144:147]
  ds_read_b128 a[164:167], v61 offset:9216
  v_cvt_pk_bf16_f32 v221, v34, v35
  v_mfma_f32_16x16x32_bf16 v[152:155], a[144:147], v[120:123], v[152:155]
  v_exp_f32 v38, v190
  v_mfma_f32_16x16x32_bf16 v[132:135], a[148:151], v[72:75], v[132:135]
  v_exp_f32 v39, v191
  v_mfma_f32_16x16x32_bf16 v[140:143], a[148:151], v[88:91], v[140:143]
  s_waitcnt lgkmcnt(3)
  v_cvt_pk_bf16_f32 v222, v36, v37
  v_cvt_pk_bf16_f32 v223, v38, v39
  v_mfma_f32_16x16x32_bf16 v[148:151], a[148:151], v[104:107], v[148:151]
  ds_read_b128 a[168:171], v61 offset:10240
  v_mfma_f32_16x16x32_bf16 v[156:159], a[148:151], v[120:123], v[156:159]
  v_mfma_f32_16x16x32_bf16 v[128:131], a[152:155], v[76:79], v[128:131]
  v_mfma_f32_16x16x32_bf16 v[136:139], a[152:155], v[92:95], v[136:139]
  buffer_load_dwordx4 v15, s[36:39], s93 offen offset:1024 sc1 lds
  v_mfma_f32_16x16x32_bf16 v[16:19], a[192:195], v[216:219], 0
  ds_read_b128 a[172:175], v61 offset:11264
  v_mfma_f32_16x16x32_bf16 v[20:23], a[192:195], v[220:223], 0
  v_mfma_f32_16x16x32_bf16 v[144:147], a[152:155], v[108:111], v[144:147]
  v_mfma_f32_16x16x32_bf16 v[152:155], a[152:155], v[124:127], v[152:155]
  s_waitcnt lgkmcnt(3)
  v_mfma_f32_16x16x32_bf16 v[132:135], a[156:159], v[76:79], v[132:135]
  ds_read_b128 a[176:179], v61 offset:12288
  s_nop 0
  v_max3_f32 v62, v40, v44, v16
  v_mfma_f32_16x16x32_bf16 v[140:143], a[156:159], v[92:95], v[140:143]
  buffer_load_dwordx4 v15, s[36:39], s93 offen offset:2048 sc1 lds
  v_max_f32 v62, v62, v20
  v_cmp_lt_f32 vcc, s97, v62
  v_mfma_f32_16x16x32_bf16 v[148:151], a[156:159], v[108:111], v[148:151]
  v_mfma_f32_16x16x32_bf16 v[156:159], a[156:159], v[124:127], v[156:159]
  s_cbranch_vccnz LrareO
LretO:
  v_mfma_f32_16x16x32_bf16 a[0:3], a[160:163], v[208:211], a[0:3]
  s_add_u32 s32, s32, 0x4000
  ds_read_b128 a[180:183], v61 offset:13312
  v_add_f32 v56, v56, v40
  v_mfma_f32_16x16x32_bf16 a[32:35], a[160:163], v[212:215], a[32:35]
  s_and_b32 s32, s32, 0xffff
  v_exp_f32 v32, v128
  v_mfma_f32_16x16x32_bf16 a[64:67], a[160:163], v[216:219], a[64:67]
  v_exp_f32 v33, v129
  v_mfma_f32_16x16x32_bf16 a[96:99], a[160:163], v[220:223], a[96:99]
  s_waitcnt lgkmcnt(3)
  v_exp_f32 v34, v130
  v_mfma_f32_16x16x32_bf16 a[4:7], a[164:167], v[208:211], a[4:7]
  ds_read_b128 a[184:187], v61 offset:14336
  v_add_f32 v57, v57, v44
  v_add_f32 v58, v58, v16
  v_add_f32 v59, v59, v20
  v_mfma_f32_16x16x32_bf16 a[36:39], a[164:167], v[212:215], a[36:39]
  v_exp_f32 v35, v131
  v_mfma_f32_16x16x32_bf16 a[68:71], a[164:167], v[216:219], a[68:71]
  v_exp_f32 v36, v132
  v_mfma_f32_16x16x32_bf16 a[100:103], a[164:167], v[220:223], a[100:103]
  buffer_load_dwordx4 v15, s[36:39], s93 offen offset:3072 sc1 lds
  v_mfma_f32_16x16x32_bf16 a[8:11], a[168:171], v[208:211], a[8:11]
  s_and_b32 s92, s92, 0xffff
  s_add_u32 s93, s93, 0x8000
  ds_read_b128 a[188:191], v61 offset:15360
  v_mfma_f32_16x16x32_bf16 a[40:43], a[168:171], v[212:215], a[40:43]
  v_exp_f32 v37, v133
  v_mfma_f32_16x16x32_bf16 a[72:75], a[168:171], v[216:219], a[72:75]
  v_exp_f32 v38, v134
  v_mfma_f32_16x16x32_bf16 a[104:107], a[168:171], v[220:223], a[104:107]
  s_waitcnt lgkmcnt(3)
  v_exp_f32 v39, v135
  v_mfma_f32_16x16x32_bf16 a[12:15], a[172:175], v[208:211], a[12:15]
  ds_read_b128 a[128:131], v60 offset:8192
  v_cvt_pk_bf16_f32 v192, v32, v33
  v_mfma_f32_16x16x32_bf16 a[44:47], a[172:175], v[212:215], a[44:47]
  v_exp_f32 v32, v136
  v_mfma_f32_16x16x32_bf16 a[76:79], a[172:175], v[216:219], a[76:79]
  v_exp_f32 v33, v137
  v_mfma_f32_16x16x32_bf16 a[108:111], a[172:175], v[220:223], a[108:111]
  v_cvt_pk_bf16_f32 v193, v34, v35
  v_cvt_pk_bf16_f32 v194, v36, v37
  v_mfma_f32_16x16x32_bf16 a[16:19], a[176:179], v[208:211], a[16:19]
  ds_read_b128 a[132:135], v60 offset:12288
  v_cvt_pk_bf16_f32 v195, v38, v39
  v_mfma_f32_16x16x32_bf16 a[48:51], a[176:179], v[212:215], a[48:51]
  v_exp_f32 v34, v138
  v_mfma_f32_16x16x32_bf16 a[80:83], a[176:179], v[216:219], a[80:83]
  v_exp_f32 v35, v139
  v_mfma_f32_16x16x32_bf16 a[112:115], a[176:179], v[220:223], a[112:115]
  s_waitcnt lgkmcnt(3)
  v_exp_f32 v36, v140
  v_mfma_f32_16x16x32_bf16 a[20:23], a[180:183], v[208:211], a[20:23]
  ds_read_b128 a[136:139], v60 offset:9216
  v_cvt_pk_bf16_f32 v196, v32, v33
  v_mfma_f32_16x16x32_bf16 a[52:55], a[180:183], v[212:215], a[52:55]
  v_exp_f32 v37, v141
  v_mfma_f32_16x16x32_bf16 a[84:87], a[180:183], v[216:219], a[84:87]
  v_exp_f32 v38, v142
  v_mfma_f32_16x16x32_bf16 a[116:119], a[180:183], v[220:223], a[116:119]
  v_exp_f32 v39, v143
  v_mfma_f32_16x16x32_bf16 a[24:27], a[184:187], v[208:211], a[24:27]
  ds_read_b128 a[140:143], v60 offset:13312
  v_cvt_pk_bf16_f32 v197, v34, v35
  v_mfma_f32_16x16x32_bf16 a[56:59], a[184:187], v[212:215], a[56:59]
  v_cvt_pk_bf16_f32 v198, v36, v37
  v_cvt_pk_bf16_f32 v199, v38, v39
  v_mfma_f32_16x16x32_bf16 a[88:91], a[184:187], v[216:219], a[88:91]
  v_add_u32 v61, s32, v55
  v_mfma_f32_16x16x32_bf16 a[120:123], a[184:187], v[220:223], a[120:123]
  s_waitcnt lgkmcnt(4)
  v_mfma_f32_16x16x32_bf16 a[28:31], a[188:191], v[208:211], a[28:31]
  ds_read_b128 a[144:147], v60 offset:10240
  v_mfma_f32_16x16x32_bf16 a[60:63], a[188:191], v[212:215], a[60:63]
  v_mfma_f32_16x16x32_bf16 a[92:95], a[188:191], v[216:219], a[92:95]
  v_mfma_f32_16x16x32_bf16 a[124:127], a[188:191], v[220:223], a[124:127]
  s_waitcnt lgkmcnt(3)
L_E:
  s_waitcnt lgkmcnt(4)
  v_mfma_f32_16x16x32_bf16 v[160:163], a[128:131], v[64:67], v[224:227]
  v_exp_f32 v32, v144
  v_mfma_f32_16x16x32_bf16 v[168:171], a[128:131], v[80:83], v[232:235]
  v_exp_f32 v33, v145
  v_mfma_f32_16x16x32_bf16 v[40:43], a[192:195], v[192:195], 0
  s_add_u32 s73, s73, 0x4000
  ds_read_b128 a[148:151], v60 offset:14336
  v_cvt_pk_bf16_f32 v200, v32, v33
  v_mfma_f32_16x16x32_bf16 v[44:47], a[192:195], v[196:199], 0
  s_and_b32 s73, s73, 0xffff
  v_exp_f32 v34, v146
  v_mfma_f32_16x16x32_bf16 v[176:179], a[128:131], v[96:99], v[240:243]
  s_add_u32 s94, s94, 1
  v_exp_f32 v35, v147
  v_mfma_f32_16x16x32_bf16 v[184:187], a[128:131], v[112:115], v[248:251]
  s_sub_u32 s75, s94, s95
  v_exp_f32 v36, v148
  s_waitcnt lgkmcnt(4)
  v_mfma_f32_16x16x32_bf16 v[164:167], a[132:135], v[64:67], v[228:231]
  ds_read_b128 a[152:155], v60 offset:11264
  v_cvt_pk_bf16_f32 v201, v34, v35
  v_mfma_f32_16x16x32_bf16 v[172:175], a[132:135], v[80:83], v[236:239]
  s_waitcnt lgkmcnt(3)
  v_exp_f32 v37, v149
  v_mfma_f32_16x16x32_bf16 v[180:183], a[132:135], v[96:99], v[244:247]
  v_exp_f32 v38, v150
  v_mfma_f32_16x16x32_bf16 v[188:191], a[132:135], v[112:115], v[252:255]
  v_exp_f32 v39, v151
  v_mfma_f32_16x16x32_bf16 v[160:163], a[136:139], v[68:71], v[160:163]
  v_exp_f32 v32, v152
  v_mfma_f32_16x16x32_bf16 v[168:171], a[136:139], v[84:87], v[168:171]
  v_exp_f32 v33, v153
  v_mfma_f32_16x16x32_bf16 v[176:179], a[136:139], v[100:103], v[176:179]
  ds_read_b128 a[156:159], v60 offset:15360
  v_cvt_pk_bf16_f32 v202, v36, v37
  v_mfma_f32_16x16x32_bf16 v[184:187], a[136:139], v[116:119], v[184:187]
  v_exp_f32 v34, v154
  v_mfma_f32_16x16x32_bf16 v[164:167], a[140:143], v[68:71], v[164:167]
  v_exp_f32 v35, v155
  v_mfma_f32_16x16x32_bf16 v[172:175], a[140:143], v[84:87], v[172:175]
  s_waitcnt lgkmcnt(2)
  v_exp_f32 v36, v156
  v_mfma_f32_16x16x32_bf16 v[180:183], a[140:143], v[100:103], v[180:183]
  ds_read_b128 a[160:163], v61 offset:0
  v_cvt_pk_bf16_f32 v203, v38, v39
  v_mfma_f32_16x16x32_bf16 v[188:191], a[140:143], v[116:119], v[188:191]
  v_exp_f32 v37, v157
  v_mfma_f32_16x16x32_bf16 v[160:163], a[144:147], v[72:75], v[160:163]
  s_cmp_lt_u32 s75, 4
  s_cselect_b32 s97, -1.0, s3
  v_exp_f32 v38, v158
  v_mfma_f32_16x16x32_bf16 v[168:171], a[144:147], v[88:91], v[168:171]
  v_exp_f32 v39, v159
  v_mfma_f32_16x16x32_bf16 v[176:179], a[144:147], v[104:107], v[176:179]
  ds_read_b128 a[164:167], v61 offset:1024
  v_cvt_pk_bf16_f32 v204, v32, v33
  v_mfma_f32_16x16x32_bf16 v[184:187], a[144:147], v[120:123], v[184:187]
  v_cvt_pk_bf16_f32 v205, v34, v35
  v_cvt_pk_bf16_f32 v206, v36, v37
  v_mfma_f32_16x16x32_bf16 v[164:167], a[148:151], v[72:75], v[164:167]
  v_cvt_pk_bf16_f32 v207, v38, v39
  v_mfma_f32_16x16x32_bf16 v[172:175], a[148:151], v[88:91], v[172:175]
  s_waitcnt lgkmcnt(3)
  v_mfma_f32_16x16x32_bf16 v[180:183], a[148:151], v[104:107], v[180:183]
  ds_read_b128 a[168:171], v61 offset:2048
  v_mfma_f32_16x16x32_bf16 v[188:191], a[148:151], v[120:123], v[188:191]
  v_mfma_f32_16x16x32_bf16 v[160:163], a[152:155], v[76:79], v[160:163]
  v_mfma_f32_16x16x32_bf16 v[168:171], a[152:155], v[92:95], v[168:171]
  v_mfma_f32_16x16x32_bf16 v[16:19], a[192:195], v[200:203], 0
  ds_read_b128 a[172:175], v61 offset:3072
  v_mfma_f32_16x16x32_bf16 v[20:23], a[192:195], v[204:207], 0
  v_mfma_f32_16x16x32_bf16 v[176:179], a[152:155], v[108:111], v[176:179]
  v_mfma_f32_16x16x32_bf16 v[184:187], a[152:155], v[124:127], v[184:187]
  s_waitcnt lgkmcnt(3)
  v_mfma_f32_16x16x32_bf16 v[164:167], a[156:159], v[76:79], v[164:167]
  ds_read_b128 a[176:179], v61 offset:4096
  s_nop 0
  v_max3_f32 v62, v40, v44, v16
  v_mfma_f32_16x16x32_bf16 v[172:175], a[156:159], v[92:95], v[172:175]
  v_max_f32 v62, v62, v20
  v_cmp_lt_f32 vcc, s97, v62
  v_mfma_f32_16x16x32_bf16 v[180:183], a[156:159], v[108:111], v[180:183]
  v_mfma_f32_16x16x32_bf16 v[188:191], a[156:159], v[124:127], v[188:191]
  s_cbranch_vccnz LrareE
LretE:
  v_mfma_f32_16x16x32_bf16 a[0:3], a[160:163], v[192:195], a[0:3]
  s_sub_u32 s96, s96, 1
  ds_read_b128 a[180:183], v61 offset:5120
  v_add_f32 v56, v56, v40
  v_mfma_f32_16x16x32_bf16 a[32:35], a[160:163], v[196:199], a[32:35]
  v_exp_f32 v32, v160
  v_mfma_f32_16x16x32_bf16 a[64:67], a[160:163], v[200:203], a[64:67]
  v_exp_f32 v33, v161
  v_mfma_f32_16x16x32_bf16 a[96:99], a[160:163], v[204:207], a[96:99]
  s_waitcnt lgkmcnt(3)
  v_exp_f32 v34, v162
  v_mfma_f32_16x16x32_bf16 a[4:7], a[164:167], v[192:195], a[4:7]
  ds_read_b128 a[184:187], v61 offset:6144
  v_add_f32 v57, v57, v44
  v_add_f32 v58, v58, v16
  v_add_f32 v59, v59, v20
  v_mfma_f32_16x16x32_bf16 a[36:39], a[164:167], v[196:199], a[36:39]
  v_exp_f32 v35, v163
  v_mfma_f32_16x16x32_bf16 a[68:71], a[164:167], v[200:203], a[68:71]
  v_exp_f32 v36, v164
  v_mfma_f32_16x16x32_bf16 a[100:103], a[164:167], v[204:207], a[100:103]
  v_exp_f32 v37, v165
  v_mfma_f32_16x16x32_bf16 a[8:11], a[168:171], v[192:195], a[8:11]
  ds_read_b128 a[188:191], v61 offset:7168
  v_cvt_pk_bf16_f32 v208, v32, v33
  v_mfma_f32_16x16x32_bf16 a[40:43], a[168:171], v[196:199], a[40:43]
  v_exp_f32 v38, v166
  v_mfma_f32_16x16x32_bf16 a[72:75], a[168:171], v[200:203], a[72:75]
  s_mov_b32 m0, s90
  s_add_u32 s90, s90, 0x4000
  v_cvt_pk_bf16_f32 v209, v34, v35
  v_add_u32 v60, s73, v15
  v_mfma_f32_16x16x32_bf16 a[104:107], a[168:171], v[204:207], a[104:107]
  s_waitcnt lgkmcnt(3)
  s_waitcnt vmcnt(8)
  s_barrier
  v_mfma_f32_16x16x32_bf16 a[12:15], a[172:175], v[192:195], a[12:15]
  ds_read_b128 a[128:131], v60 offset:0
  v_cvt_pk_bf16_f32 v210, v36, v37
  v_mfma_f32_16x16x32_bf16 a[44:47], a[172:175], v[196:199], a[44:47]
  v_exp_f32 v39, v167
  v_mfma_f32_16x16x32_bf16 a[76:79], a[172:175], v[200:203], a[76:79]
  buffer_load_dwordx4 v15, s[36:39], s91 offen offset:0 sc1 lds
  v_mfma_f32_16x16x32_bf16 a[108:111], a[172:175], v[204:207], a[108:111]
  v_exp_f32 v32, v168
  v_mfma_f32_16x16x32_bf16 a[16:19], a[176:179], v[192:195], a[16:19]
  ds_read_b128 a[132:135], v60 offset:4096
  v_cvt_pk_bf16_f32 v211, v38, v39
  v_mfma_f32_16x16x32_bf16 a[48:51], a[176:179], v[196:199], a[48:51]
  v_exp_f32 v33, v169
  v_mfma_f32_16x16x32_bf16 a[80:83], a[176:179], v[200:203], a[80:83]
  v_exp_f32 v34, v170
  v_mfma_f32_16x16x32_bf16 a[112:115], a[176:179], v[204:207], a[112:115]
  s_waitcnt lgkmcnt(3)
  buffer_load_dwordx4 v15, s[36:39], s91 offen offset:1024 sc1 lds
  v_mfma_f32_16x16x32_bf16 a[20:23], a[180:183], v[192:195], a[20:23]
  ds_read_b128 a[136:139], v60 offset:1024
  v_cvt_pk_bf16_f32 v212, v32, v33
  v_mfma_f32_16x16x32_bf16 a[52:55], a[180:183], v[196:199], a[52:55]
  v_exp_f32 v35, v171
  v_mfma_f32_16x16x32_bf16 a[84:87], a[180:183], v[200:203], a[84:87]
  v_exp_f32 v36, v172
  v_mfma_f32_16x16x32_bf16 a[116:119], a[180:183], v[204:207], a[116:119]
  v_exp_f32 v37, v173
  v_mfma_f32_16x16x32_bf16 a[24:27], a[184:187], v[192:195], a[24:27]
  buffer_load_dwordx4 v15, s[36:39], s91 offen offset:2048 sc1 lds
  v_mfma_f32_16x16x32_bf16 a[56:59], a[184:187], v[196:199], a[56:59]
  ds_read_b128 a[140:143], v60 offset:5120
  v_cvt_pk_bf16_f32 v213, v34, v35
  v_mfma_f32_16x16x32_bf16 a[88:91], a[184:187], v[200:203], a[88:91]
  v_exp_f32 v38, v174
  v_mfma_f32_16x16x32_bf16 a[120:123], a[184:187], v[204:207], a[120:123]
  s_waitcnt lgkmcnt(4)
  v_exp_f32 v39, v175
  v_mfma_f32_16x16x32_bf16 a[28:31], a[188:191], v[192:195], a[28:31]
  ds_read_b128 a[144:147], v60 offset:2048
  v_cvt_pk_bf16_f32 v214, v36, v37
  v_mfma_f32_16x16x32_bf16 a[60:63], a[188:191], v[196:199], a[60:63]
  buffer_load_dwordx4 v15, s[36:39], s91 offen offset:3072 sc1 lds
  v_mfma_f32_16x16x32_bf16 a[92:95], a[188:191], v[200:203], a[92:95]
  s_and_b32 s90, s90, 0xffff
  s_add_u32 s91, s91, 0x8000
  v_cvt_pk_bf16_f32 v215, v38, v39
  v_mfma_f32_16x16x32_bf16 a[124:127], a[188:191], v[204:207], a[124:127]
  s_waitcnt lgkmcnt(3)
  s_cmp_lg_u32 s96, 0
  s_cbranch_scc1 L_O
  v_mfma_f32_16x16x32_bf16 v[128:131], a[128:131], v[64:67], v[224:227]
  v_exp_f32 v32, v176
  v_mfma_f32_16x16x32_bf16 v[136:139], a[128:131], v[80:83], v[232:235]
  v_exp_f32 v33, v177
  v_mfma_f32_16x16x32_bf16 v[40:43], a[192:195], v[208:211], 0
  v_exp_f32 v34, v178
  v_mfma_f32_16x16x32_bf16 v[44:47], a[192:195], v[212:215], 0
  ds_read_b128 a[148:151], v60 offset:6144
  v_cvt_pk_bf16_f32 v216, v32, v33
  v_mfma_f32_16x16x32_bf16 v[152:155], a[128:131], v[112:115], v[248:251]
  s_add_u32 s94, s94, 1
  v_exp_f32 v35, v179
  v_mfma_f32_16x16x32_bf16 v[132:135], a[132:135], v[64:67], v[228:231]
  s_sub_u32 s75, s94, s95
  v_exp_f32 v36, v180
  v_mfma_f32_16x16x32_bf16 v[140:143], a[132:135], v[80:83], v[236:239]
  s_add_u32 m0, s92, 65536
  s_add_u32 s92, s92, 0x4000
  v_cvt_pk_bf16_f32 v217, v34, v35
  v_mfma_f32_16x16x32_bf16 v[156:159], a[132:135], v[112:115], v[252:255]
  s_waitcnt lgkmcnt(1)
  v_exp_f32 v37, v181
  v_mfma_f32_16x16x32_bf16 v[128:131], a[136:139], v[68:71], v[128:131]
  ds_read_b128 a[152:155], v60 offset:3072
  v_cvt_pk_bf16_f32 v218, v36, v37
  v_mfma_f32_16x16x32_bf16 v[136:139], a[136:139], v[84:87], v[136:139]
  v_exp_f32 v38, v182
  v_mfma_f32_16x16x32_bf16 v[152:155], a[136:139], v[116:119], v[152:155]
  buffer_load_dwordx4 v15, s[36:39], s93 offen offset:0 sc1 lds
  v_mfma_f32_16x16x32_bf16 v[132:135], a[140:143], v[68:71], v[132:135]
  s_cmp_lt_u32 s75, 4
  s_cselect_b32 s97, -1.0, s3
  ds_read_b128 a[156:159], v60 offset:7168
  v_mfma_f32_16x16x32_bf16 v[140:143], a[140:143], v[84:87], v[140:143]
  v_exp_f32 v39, v183
  v_mfma_f32_16x16x32_bf16 v[156:159], a[140:143], v[116:119], v[156:159]
  v_exp_f32 v32, v184
  v_mfma_f32_16x16x32_bf16 v[128:131], a[144:147], v[72:75], v[128:131]
  ds_read_b128 a[160:163], v61 offset:8192
  v_cvt_pk_bf16_f32 v219, v38, v39
  v_mfma_f32_16x16x32_bf16 v[136:139], a[144:147], v[88:91], v[136:139]
  s_waitcnt lgkmcnt(2)
  v_exp_f32 v33, v185
  v_mfma_f32_16x16x32_bf16 v[152:155], a[144:147], v[120:123], v[152:155]
  v_exp_f32 v34, v186
  v_mfma_f32_16x16x32_bf16 v[132:135], a[148:151], v[72:75], v[132:135]
  v_exp_f32 v35, v187
  v_exp_f32 v36, v188
  v_exp_f32 v37, v189
  v_exp_f32 v38, v190
  v_exp_f32 v39, v191
  v_mfma_f32_16x16x32_bf16 v[140:143], a[148:151], v[88:91], v[140:143]
  ds_read_b128 a[164:167], v61 offset:9216
  v_cvt_pk_bf16_f32 v220, v32, v33
  v_cvt_pk_bf16_f32 v221, v34, v35
  v_cvt_pk_bf16_f32 v222, v36, v37
  v_cvt_pk_bf16_f32 v223, v38, v39
  v_mfma_f32_16x16x32_bf16 v[156:159], a[148:151], v[120:123], v[156:159]
  buffer_load_dwordx4 v15, s[36:39], s93 offen offset:1024 sc1 lds
  v_mfma_f32_16x16x32_bf16 v[16:19], a[192:195], v[216:219], 0
  v_mfma_f32_16x16x32_bf16 v[20:23], a[192:195], v[220:223], 0
  v_mfma_f32_16x16x32_bf16 v[128:131], a[152:155], v[76:79], v[128:131]
  ds_read_b128 a[168:171], v61 offset:10240
  v_mfma_f32_16x16x32_bf16 v[136:139], a[152:155], v[92:95], v[136:139]
  s_waitcnt lgkmcnt(2)
  v_mfma_f32_16x16x32_bf16 v[152:155], a[152:155], v[124:127], v[152:155]
  s_nop 1
  v_max3_f32 v62, v40, v44, v16
  v_max_f32 v62, v62, v20
  v_mfma_f32_16x16x32_bf16 v[132:135], a[156:159], v[76:79], v[132:135]
  buffer_load_dwordx4 v15, s[36:39], s93 offen offset:2048 sc1 lds
  v_cmp_lt_f32 vcc, s97, v62
  v_mfma_f32_16x16x32_bf16 v[140:143], a[156:159], v[92:95], v[140:143]
  ds_read_b128 a[172:175], v61 offset:11264
  v_mfma_f32_16x16x32_bf16 v[156:159], a[156:159], v[124:127], v[156:159]
  s_cbranch_vccnz LrareOL
LretOL:
  v_mfma_f32_16x16x32_bf16 a[0:3], a[160:163], v[208:211], a[0:3]
  s_add_u32 s32, s32, 0x4000
  v_add_f32 v56, v56, v40
  v_add_f32 v57, v57, v44
  v_mfma_f32_16x16x32_bf16 a[32:35], a[160:163], v[212:215], a[32:35]
  s_and_b32 s32, s32, 0xffff
  v_exp_f32 v32, v128
  v_mfma_f32_16x16x32_bf16 a[64:67], a[160:163], v[216:219], a[64:67]
  ds_read_b128 a[176:179], v61 offset:12288
  v_add_f32 v58, v58, v16
  v_mfma_f32_16x16x32_bf16 a[96:99], a[160:163], v[220:223], a[96:99]
  s_waitcnt lgkmcnt(2)
  v_exp_f32 v33, v129
  v_mfma_f32_16x16x32_bf16 a[4:7], a[164:167], v[208:211], a[4:7]
  v_exp_f32 v34, v130
  v_add_f32 v59, v59, v20
  v_mfma_f32_16x16x32_bf16 a[36:39], a[164:167], v[212:215], a[36:39]
  v_exp_f32 v35, v131
  v_mfma_f32_16x16x32_bf16 a[68:71], a[164:167], v[216:219], a[68:71]
  ds_read_b128 a[180:183], v61 offset:13312
  v_cvt_pk_bf16_f32 v192, v32, v33
  v_mfma_f32_16x16x32_bf16 a[100:103], a[164:167], v[220:223], a[100:103]
  buffer_load_dwordx4 v15, s[36:39], s93 offen offset:3072 sc1 lds
  v_mfma_f32_16x16x32_bf16 a[8:11], a[168:171], v[208:211], a[8:11]
  s_and_b32 s92, s92, 0xffff
  s_add_u32 s93, s93, 0x8000
  v_cvt_pk_bf16_f32 v193, v34, v35
  v_mfma_f32_16x16x32_bf16 a[40:43], a[168:171], v[212:215], a[40:43]
  v_exp_f32 v36, v132
  v_mfma_f32_16x16x32_bf16 a[72:75], a[168:171], v[216:219], a[72:75]
  ds_read_b128 a[184:187], v61 offset:14336
  v_exp_f32 v37, v133
  v_mfma_f32_16x16x32_bf16 a[104:107], a[168:171], v[220:223], a[104:107]
  s_waitcnt lgkmcnt(2)
  v_exp_f32 v38, v134
  v_mfma_f32_16x16x32_bf16 a[12:15], a[172:175], v[208:211], a[12:15]
  v_exp_f32 v39, v135
  v_mfma_f32_16x16x32_bf16 a[44:47], a[172:175], v[212:215], a[44:47]
  v_exp_f32 v32, v136
  v_mfma_f32_16x16x32_bf16 a[76:79], a[172:175], v[216:219], a[76:79]
  ds_read_b128 a[188:191], v61 offset:15360
  ds_read_b128 a[128:131], v60 offset:8192
  v_mfma_f32_16x16x32_bf16 a[108:111], a[172:175], v[220:223], a[108:111]
  v_exp_f32 v33, v137
  v_mfma_f32_16x16x32_bf16 a[16:19], a[176:179], v[208:211], a[16:19]
  ds_read_b128 a[132:135], v60 offset:12288
  v_cvt_pk_bf16_f32 v194, v36, v37
  v_mfma_f32_16x16x32_bf16 a[48:51], a[176:179], v[212:215], a[48:51]
  v_exp_f32 v34, v138
  v_mfma_f32_16x16x32_bf16 a[80:83], a[176:179], v[216:219], a[80:83]
  v_exp_f32 v35, v139
  v_mfma_f32_16x16x32_bf16 a[112:115], a[176:179], v[220:223], a[112:115]
  s_waitcnt lgkmcnt(3)
  v_exp_f32 v36, v140
  v_mfma_f32_16x16x32_bf16 a[20:23], a[180:183], v[208:211], a[20:23]
  ds_read_b128 a[136:139], v60 offset:9216
  v_cvt_pk_bf16_f32 v195, v38, v39
  v_mfma_f32_16x16x32_bf16 a[52:55], a[180:183], v[212:215], a[52:55]
  v_exp_f32 v37, v141
  v_mfma_f32_16x16x32_bf16 a[84:87], a[180:183], v[216:219], a[84:87]
  v_exp_f32 v38, v142
  v_mfma_f32_16x16x32_bf16 a[116:119], a[180:183], v[220:223], a[116:119]
  v_exp_f32 v39, v143
  v_mfma_f32_16x16x32_bf16 a[24:27], a[184:187], v[208:211], a[24:27]
  ds_read_b128 a[140:143], v60 offset:13312
  v_cvt_pk_bf16_f32 v196, v32, v33
  v_mfma_f32_16x16x32_bf16 a[56:59], a[184:187], v[212:215], a[56:59]
  v_cvt_pk_bf16_f32 v197, v34, v35
  v_cvt_pk_bf16_f32 v198, v36, v37
  v_mfma_f32_16x16x32_bf16 a[88:91], a[184:187], v[216:219], a[88:91]
  v_cvt_pk_bf16_f32 v199, v38, v39
  v_add_u32 v61, s32, v55
  v_mfma_f32_16x16x32_bf16 a[120:123], a[184:187], v[220:223], a[120:123]
  s_waitcnt lgkmcnt(4)
  v_mfma_f32_16x16x32_bf16 a[28:31], a[188:191], v[208:211], a[28:31]
  ds_read_b128 a[144:147], v60 offset:10240
  v_mfma_f32_16x16x32_bf16 a[60:63], a[188:191], v[212:215], a[60:63]
  v_mfma_f32_16x16x32_bf16 a[92:95], a[188:191], v[216:219], a[92:95]
  v_mfma_f32_16x16x32_bf16 a[124:127], a[188:191], v[220:223], a[124:127]
  s_waitcnt lgkmcnt(3)
  v_mfma_f32_16x16x32_bf16 v[160:163], a[128:131], v[64:67], v[224:227]
  ds_read_b128 a[148:151], v60 offset:14336
  v_exp_f32 v32, v152
  v_mfma_f32_16x16x32_bf16 v[168:171], a[128:131], v[80:83], v[232:235]
  ds_read_b128 a[152:155], v60 offset:11264
  v_mfma_f32_16x16x32_bf16 v[40:43], a[192:195], v[192:195], 0
  s_add_u32 s73, s73, 0x4000
  v_exp_f32 v33, v153
  v_mfma_f32_16x16x32_bf16 v[44:47], a[192:195], v[196:199], 0
  s_and_b32 s73, s73, 0xffff
  v_exp_f32 v34, v154
  v_mfma_f32_16x16x32_bf16 v[184:187], a[128:131], v[112:115], v[248:251]
  s_add_u32 s94, s94, 1
  ds_read_b128 a[156:159], v60 offset:15360
  v_cvt_pk_bf16_f32 v204, v32, v33
  v_mfma_f32_16x16x32_bf16 v[164:167], a[132:135], v[64:67], v[228:231]
  v_exp_f32 v35, v155
  v_mfma_f32_16x16x32_bf16 v[172:175], a[132:135], v[80:83], v[236:239]
  v_exp_f32 v36, v156
  v_mfma_f32_16x16x32_bf16 v[188:191], a[132:135], v[112:115], v[252:255]
  s_waitcnt lgkmcnt(3)
  ds_read_b128 a[160:163], v61 offset:0
  v_cvt_pk_bf16_f32 v205, v34, v35
  v_mfma_f32_16x16x32_bf16 v[160:163], a[136:139], v[68:71], v[160:163]
  v_exp_f32 v37, v157
  v_mfma_f32_16x16x32_bf16 v[168:171], a[136:139], v[84:87], v[168:171]
  v_exp_f32 v38, v158
  v_mfma_f32_16x16x32_bf16 v[184:187], a[136:139], v[116:119], v[184:187]
  ds_read_b128 a[164:167], v61 offset:1024
  v_cvt_pk_bf16_f32 v206, v36, v37
  v_mfma_f32_16x16x32_bf16 v[164:167], a[140:143], v[68:71], v[164:167]
  v_exp_f32 v39, v159
  v_mfma_f32_16x16x32_bf16 v[172:175], a[140:143], v[84:87], v[172:175]
  v_cvt_pk_bf16_f32 v207, v38, v39
  v_mfma_f32_16x16x32_bf16 v[188:191], a[140:143], v[116:119], v[188:191]
  ds_read_b128 a[168:171], v61 offset:2048
  v_mfma_f32_16x16x32_bf16 v[160:163], a[144:147], v[72:75], v[160:163]
  v_mfma_f32_16x16x32_bf16 v[168:171], a[144:147], v[88:91], v[168:171]
  s_waitcnt lgkmcnt(4)
  v_mfma_f32_16x16x32_bf16 v[184:187], a[144:147], v[120:123], v[184:187]
  ds_read_b128 a[172:175], v61 offset:3072
  v_mfma_f32_16x16x32_bf16 v[164:167], a[148:151], v[72:75], v[164:167]
  v_mfma_f32_16x16x32_bf16 v[172:175], a[148:151], v[88:91], v[172:175]
  v_mfma_f32_16x16x32_bf16 v[188:191], a[148:151], v[120:123], v[188:191]
  ds_read_b128 a[176:179], v61 offset:4096
  v_mfma_f32_16x16x32_bf16 v[20:23], a[192:195], v[204:207], 0
  v_mfma_f32_16x16x32_bf16 v[160:163], a[152:155], v[76:79], v[160:163]
  v_mfma_f32_16x16x32_bf16 v[168:171], a[152:155], v[92:95], v[168:171]
  ds_read_b128 a[180:183], v61 offset:5120
  v_mfma_f32_16x16x32_bf16 v[184:187], a[152:155], v[124:127], v[184:187]
  s_waitcnt lgkmcnt(4)
  s_nop 2
  v_max3_f32 v62, v40, v44, v20
  v_cmp_lt_f32 vcc, s3, v62
  v_mfma_f32_16x16x32_bf16 v[164:167], a[156:159], v[76:79], v[164:167]
  v_mfma_f32_16x16x32_bf16 v[172:175], a[156:159], v[92:95], v[172:175]
  ds_read_b128 a[184:187], v61 offset:6144
  v_mfma_f32_16x16x32_bf16 v[188:191], a[156:159], v[124:127], v[188:191]
  s_cbranch_vccnz LrealEM
LretEM:
  v_mfma_f32_16x16x32_bf16 a[0:3], a[160:163], v[192:195], a[0:3]
  v_add_f32 v56, v56, v40
  v_add_f32 v57, v57, v44
  v_mfma_f32_16x16x32_bf16 a[32:35], a[160:163], v[196:199], a[32:35]
  ds_read_b128 a[188:191], v61 offset:7168
  v_add_f32 v59, v59, v20
  v_mfma_f32_16x16x32_bf16 a[96:99], a[160:163], v[204:207], a[96:99]
  s_mov_b32 m0, s90
  s_add_u32 s90, s90, 0x4000
  v_add_u32 v60, s73, v15
  v_mfma_f32_16x16x32_bf16 a[4:7], a[164:167], v[192:195], a[4:7]
  s_waitcnt vmcnt(8)
  s_barrier
  v_mfma_f32_16x16x32_bf16 a[36:39], a[164:167], v[196:199], a[36:39]
  s_waitcnt lgkmcnt(3)
  ds_read_b128 a[128:131], v60 offset:0
  v_exp_f32 v32, v160
  v_mfma_f32_16x16x32_bf16 a[100:103], a[164:167], v[204:207], a[100:103]
  v_exp_f32 v33, v161
  v_mfma_f32_16x16x32_bf16 a[8:11], a[168:171], v[192:195], a[8:11]
  buffer_load_dwordx4 v15, s[36:39], s91 offen offset:0 sc1 lds
  v_mfma_f32_16x16x32_bf16 a[40:43], a[168:171], v[196:199], a[40:43]
  v_exp_f32 v34, v162
  v_mfma_f32_16x16x32_bf16 a[104:107], a[168:171], v[204:207], a[104:107]
  ds_read_b128 a[132:135], v60 offset:4096
  v_cvt_pk_bf16_f32 v208, v32, v33
  v_mfma_f32_16x16x32_bf16 a[12:15], a[172:175], v[192:195], a[12:15]
  v_exp_f32 v35, v163
  v_mfma_f32_16x16x32_bf16 a[44:47], a[172:175], v[196:199], a[44:47]
  v_exp_f32 v36, v164
  v_mfma_f32_16x16x32_bf16 a[108:111], a[172:175], v[204:207], a[108:111]
  buffer_load_dwordx4 v15, s[36:39], s91 offen offset:1024 sc1 lds
  v_mfma_f32_16x16x32_bf16 a[16:19], a[176:179], v[192:195], a[16:19]
  s_waitcnt lgkmcnt(3)
  ds_read_b128 a[136:139], v60 offset:1024
  v_cvt_pk_bf16_f32 v209, v34, v35
  v_mfma_f32_16x16x32_bf16 a[48:51], a[176:179], v[196:199], a[48:51]
  v_exp_f32 v37, v165
  v_mfma_f32_16x16x32_bf16 a[112:115], a[176:179], v[204:207], a[112:115]
  v_exp_f32 v38, v166
  v_mfma_f32_16x16x32_bf16 a[20:23], a[180:183], v[192:195], a[20:23]
  v_exp_f32 v39, v167
  v_mfma_f32_16x16x32_bf16 a[52:55], a[180:183], v[196:199], a[52:55]
  buffer_load_dwordx4 v15, s[36:39], s91 offen offset:2048 sc1 lds
  v_cvt_pk_bf16_f32 v210, v36, v37
  v_mfma_f32_16x16x32_bf16 a[116:119], a[180:183], v[204:207], a[116:119]
  ds_read_b128 a[140:143], v60 offset:5120
  v_cvt_pk_bf16_f32 v211, v38, v39
  v_mfma_f32_16x16x32_bf16 a[24:27], a[184:187], v[192:195], a[24:27]
  v_exp_f32 v32, v168
  v_mfma_f32_16x16x32_bf16 a[56:59], a[184:187], v[196:199], a[56:59]
  v_exp_f32 v33, v169
  v_mfma_f32_16x16x32_bf16 a[120:123], a[184:187], v[204:207], a[120:123]
  s_waitcnt lgkmcnt(4)
  ds_read_b128 a[144:147], v60 offset:2048
  v_cvt_pk_bf16_f32 v212, v32, v33
  v_mfma_f32_16x16x32_bf16 a[28:31], a[188:191], v[192:195], a[28:31]
  buffer_load_dwordx4 v15, s[36:39], s91 offen offset:3072 sc1 lds
  v_exp_f32 v34, v170
  v_exp_f32 v35, v171
  v_exp_f32 v36, v172
  v_exp_f32 v37, v173
  v_exp_f32 v38, v174
  v_exp_f32 v39, v175
  v_mfma_f32_16x16x32_bf16 a[60:63], a[188:191], v[196:199], a[60:63]
  s_and_b32 s90, s90, 0xffff
  s_add_u32 s91, s91, 0x8000
  v_cvt_pk_bf16_f32 v213, v34, v35
  v_mfma_f32_16x16x32_bf16 a[124:127], a[188:191], v[204:207], a[124:127]
  s_waitcnt lgkmcnt(3)
  v_cvt_pk_bf16_f32 v214, v36, v37
  v_cvt_pk_bf16_f32 v215, v38, v39
  v_mov_b32 v240, v224
  v_mov_b32 v241, v225
  v_mov_b32 v242, v226
  v_mov_b32 v243, v227
  v_mov_b32 v244, v228
  v_mov_b32 v245, v229
  v_mov_b32 v246, v230
  v_mov_b32 v247, v231
  v_mov_b32 v248, v232
  v_mov_b32 v249, v233
  v_mov_b32 v250, v234
  v_mov_b32 v251, v235
  v_mov_b32 v252, v236
  v_mov_b32 v253, v237
  v_mov_b32 v254, v238
  v_mov_b32 v255, v239
  s_sub_u32 s95, 60, s95
  s_add_u32 s94, s94, 1
  s_sub_u32 s75, s94, s95
  s_call_b64 s[98:99], Lmask
  s_lshl_b32 s96, s70, 1
  s_sub_u32 s96, 14, s96
  v_mfma_f32_16x16x32_bf16 v[128:131], a[128:131], v[64:67], v[224:227]
  ds_read_b128 a[148:151], v60 offset:6144
  ds_read_b128 a[152:155], v60 offset:3072
  v_mfma_f32_16x16x32_bf16 v[136:139], a[128:131], v[80:83], v[232:235]
  ds_read_b128 a[156:159], v60 offset:7168
  ds_read_b128 a[160:163], v60 offset:8192
  v_mfma_f32_16x16x32_bf16 v[40:43], a[192:195], v[208:211], 0
  s_add_u32 s73, s73, 0x4000
  ds_read_b128 a[164:167], v60 offset:12288
  ds_read_b128 a[168:171], v60 offset:9216
  v_mfma_f32_16x16x32_bf16 v[44:47], a[192:195], v[212:215], 0
  s_and_b32 s73, s73, 0xffff
  v_exp_f32 v32, v184
  v_mfma_f32_16x16x32_bf16 v[132:135], a[132:135], v[64:67], v[228:231]
  s_add_u32 s94, s94, 2
  ds_read_b128 a[172:175], v60 offset:13312
  v_mov_b32 v124, -1
  v_mfma_f32_16x16x32_bf16 v[140:143], a[132:135], v[80:83], v[236:239]
  s_sub_u32 s75, s94, s95
  v_exp_f32 v33, v185
  s_waitcnt lgkmcnt(9)
  v_mfma_f32_16x16x32_bf16 v[128:131], a[136:139], v[68:71], v[128:131]
  s_add_u32 m0, s92, 65536
  s_add_u32 s92, s92, 0x4000
  ds_read_b128 a[176:179], v60 offset:10240
  v_mfma_f32_16x16x32_bf16 v[136:139], a[136:139], v[84:87], v[136:139]
  s_waitcnt lgkmcnt(6)
  v_exp_f32 v34, v186
  v_mfma_f32_16x16x32_bf16 v[132:135], a[140:143], v[68:71], v[132:135]
  v_exp_f32 v35, v187
  v_mfma_f32_16x16x32_bf16 v[140:143], a[140:143], v[84:87], v[140:143]
  ds_read_b128 a[180:183], v60 offset:14336
  v_cvt_pk_bf16_f32 v220, v32, v33
  v_mfma_f32_16x16x32_bf16 v[128:131], a[144:147], v[72:75], v[128:131]
  buffer_load_dwordx4 v15, s[36:39], s93 offen offset:0 sc1 lds
  v_mfma_f32_16x16x32_bf16 v[136:139], a[144:147], v[88:91], v[136:139]
  ds_read_b128 a[184:187], v60 offset:11264
  v_cvt_pk_bf16_f32 v221, v34, v35
  v_mfma_f32_16x16x32_bf16 v[132:135], a[148:151], v[72:75], v[132:135]
  v_exp_f32 v36, v188
  v_mfma_f32_16x16x32_bf16 v[140:143], a[148:151], v[88:91], v[140:143]
  s_cmp_lt_u32 s75, 4
  s_cselect_b32 s97, -1.0, s3
  ds_read_b128 a[188:191], v60 offset:15360
  v_mfma_f32_16x16x32_bf16 v[128:131], a[152:155], v[76:79], v[128:131]
  v_exp_f32 v37, v189
  v_mfma_f32_16x16x32_bf16 v[136:139], a[152:155], v[92:95], v[136:139]
  s_waitcnt lgkmcnt(5)
  ds_read_b128 a[128:131], v61 offset:8192
  v_cvt_pk_bf16_f32 v222, v36, v37
  v_mfma_f32_16x16x32_bf16 v[132:135], a[156:159], v[76:79], v[132:135]
  v_exp_f32 v38, v190
  v_mfma_f32_16x16x32_bf16 v[140:143], a[156:159], v[92:95], v[140:143]
  v_exp_f32 v39, v191
  v_mfma_f32_16x16x32_bf16 v[144:147], a[160:163], v[64:67], v[240:243]
  ds_read_b128 a[132:135], v61 offset:9216
  v_cvt_pk_bf16_f32 v223, v38, v39
  v_mfma_f32_16x16x32_bf16 v[152:155], a[160:163], v[80:83], v[248:251]
  v_mov_b32 v125, -1
  v_mov_b32 v126, -1
  v_mfma_f32_16x16x32_bf16 v[148:151], a[164:167], v[64:67], v[244:247]
  s_add_u32 s89, s79, 0x800000
  v_mov_b32 v127, -1
  buffer_store_dwordx4 v[124:127], v15, s[44:47], s89 offen offset:2048 sc1
  v_mfma_f32_16x16x32_bf16 v[156:159], a[164:167], v[80:83], v[252:255]
  ds_read_b128 a[136:139], v61 offset:10240
  v_mfma_f32_16x16x32_bf16 v[144:147], a[168:171], v[68:71], v[144:147]
  buffer_store_dwordx4 v[124:127], v15, s[44:47], s89 offen offset:3072 sc1
  s_add_u32 s89, s79, 0x801000
  v_mfma_f32_16x16x32_bf16 v[152:155], a[168:171], v[84:87], v[152:155]
  s_waitcnt lgkmcnt(4)
  v_mfma_f32_16x16x32_bf16 v[148:151], a[172:175], v[68:71], v[148:151]
  ds_read_b128 a[140:143], v61 offset:11264
  buffer_store_dwordx4 v[124:127], v15, s[44:47], s89 offen offset:0 sc1
  v_mfma_f32_16x16x32_bf16 v[156:159], a[172:175], v[84:87], v[156:159]
  v_mfma_f32_16x16x32_bf16 v[144:147], a[176:179], v[72:75], v[144:147]
  buffer_load_dwordx4 v15, s[36:39], s93 offen offset:1024 sc1 lds
  v_mfma_f32_16x16x32_bf16 v[152:155], a[176:179], v[88:91], v[152:155]
  ds_read_b128 a[144:147], v61 offset:12288
  v_exp_f32 v32, v128
  v_mfma_f32_16x16x32_bf16 v[20:23], a[192:195], v[220:223], 0
  v_exp_f32 v33, v129
  v_mfma_f32_16x16x32_bf16 v[148:151], a[180:183], v[72:75], v[148:151]
  v_exp_f32 v34, v130
  v_mfma_f32_16x16x32_bf16 v[156:159], a[180:183], v[88:91], v[156:159]
  ds_read_b128 a[148:151], v61 offset:13312
  buffer_store_dwordx4 v[124:127], v15, s[44:47], s89 offen offset:1024 sc1
  v_mfma_f32_16x16x32_bf16 v[144:147], a[184:187], v[76:79], v[144:147]
  s_waitcnt lgkmcnt(4)
  v_exp_f32 v35, v131
  v_mfma_f32_16x16x32_bf16 v[152:155], a[184:187], v[92:95], v[152:155]
  buffer_load_dwordx4 v15, s[36:39], s93 offen offset:2048 sc1 lds
  v_max3_f32 v62, v40, v44, v20
  v_cmp_lt_f32 vcc, s97, v62
  v_mfma_f32_16x16x32_bf16 v[148:151], a[188:191], v[76:79], v[148:151]
  ds_read_b128 a[152:155], v61 offset:14336
  v_mfma_f32_16x16x32_bf16 v[156:159], a[188:191], v[92:95], v[156:159]
  s_cbranch_vccnz LrareT
LretT:
  v_mfma_f32_16x16x32_bf16 a[0:3], a[128:131], v[208:211], a[0:3]
  buffer_load_dwordx4 v15, s[36:39], s93 offen offset:3072 sc1 lds
  v_mfma_f32_16x16x32_bf16 a[32:35], a[128:131], v[212:215], a[32:35]
  s_and_b32 s92, s92, 0xffff
  s_add_u32 s93, s93, 0x8000
  ds_read_b128 a[156:159], v61 offset:15360
  v_mfma_f32_16x16x32_bf16 a[96:99], a[128:131], v[220:223], a[96:99]
  s_mov_b32 m0, s90
  s_add_u32 s90, s90, 0x4000
  v_add_f32 v56, v56, v40
  v_add_u32 v60, s73, v15
  v_mfma_f32_16x16x32_bf16 a[4:7], a[132:135], v[208:211], a[4:7]
  s_waitcnt vmcnt(12)
  s_barrier
  v_mfma_f32_16x16x32_bf16 a[36:39], a[132:135], v[212:215], a[36:39]
  s_waitcnt lgkmcnt(3)
  ds_read_b128 a[160:163], v60 offset:0
  v_add_f32 v57, v57, v44
  v_add_f32 v59, v59, v20
  v_mfma_f32_16x16x32_bf16 a[100:103], a[132:135], v[220:223], a[100:103]
  s_add_u32 s32, s32, 0x4000
  v_exp_f32 v36, v132
  v_mfma_f32_16x16x32_bf16 a[8:11], a[136:139], v[208:211], a[8:11]
  s_and_b32 s32, s32, 0xffff
  buffer_load_dwordx4 v15, s[36:39], s91 offen offset:0 sc1 lds
  v_mfma_f32_16x16x32_bf16 a[40:43], a[136:139], v[212:215], a[40:43]
  ds_read_b128 a[164:167], v60 offset:4096
  v_cvt_pk_bf16_f32 v192, v32, v33
  v_mfma_f32_16x16x32_bf16 a[104:107], a[136:139], v[220:223], a[104:107]
  ds_read_b128 a[168:171], v60 offset:1024
  v_cvt_pk_bf16_f32 v193, v34, v35
  v_mfma_f32_16x16x32_bf16 a[12:15], a[140:143], v[208:211], a[12:15]
  v_exp_f32 v37, v133
  v_mfma_f32_16x16x32_bf16 a[44:47], a[140:143], v[212:215], a[44:47]
  ds_read_b128 a[172:175], v60 offset:5120
  v_cvt_pk_bf16_f32 v194, v36, v37
  v_mfma_f32_16x16x32_bf16 a[108:111], a[140:143], v[220:223], a[108:111]
  buffer_load_dwordx4 v15, s[36:39], s91 offen offset:1024 sc1 lds
  v_mfma_f32_16x16x32_bf16 a[16:19], a[144:147], v[208:211], a[16:19]
  s_waitcnt lgkmcnt(5)
  ds_read_b128 a[176:179], v60 offset:2048
  v_exp_f32 v38, v134
  v_mfma_f32_16x16x32_bf16 a[48:51], a[144:147], v[212:215], a[48:51]
  v_exp_f32 v39, v135
  v_mfma_f32_16x16x32_bf16 a[112:115], a[144:147], v[220:223], a[112:115]
  ds_read_b128 a[180:183], v60 offset:6144
  v_cvt_pk_bf16_f32 v195, v38, v39
  v_mfma_f32_16x16x32_bf16 a[20:23], a[148:151], v[208:211], a[20:23]
  v_exp_f32 v32, v136
  v_mfma_f32_16x16x32_bf16 a[52:55], a[148:151], v[212:215], a[52:55]
  buffer_load_dwordx4 v15, s[36:39], s91 offen offset:2048 sc1 lds
  v_mfma_f32_16x16x32_bf16 a[116:119], a[148:151], v[220:223], a[116:119]
  ds_read_b128 a[184:187], v60 offset:3072
  v_exp_f32 v33, v137
  v_mfma_f32_16x16x32_bf16 a[24:27], a[152:155], v[208:211], a[24:27]
  ds_read_b128 a[188:191], v60 offset:7168
  v_cvt_pk_bf16_f32 v196, v32, v33
  v_mfma_f32_16x16x32_bf16 a[56:59], a[152:155], v[212:215], a[56:59]
  v_exp_f32 v34, v138
  v_mfma_f32_16x16x32_bf16 a[120:123], a[152:155], v[220:223], a[120:123]
  s_waitcnt lgkmcnt(8)
  ds_read_b128 a[128:131], v60 offset:8192
  v_exp_f32 v35, v139
  v_mfma_f32_16x16x32_bf16 a[28:31], a[156:159], v[208:211], a[28:31]
  buffer_load_dwordx4 v15, s[36:39], s91 offen offset:3072 sc1 lds
  v_exp_f32 v36, v140
  v_exp_f32 v37, v141
  v_exp_f32 v38, v142
  v_exp_f32 v39, v143
  v_mfma_f32_16x16x32_bf16 a[60:63], a[156:159], v[212:215], a[60:63]
  s_and_b32 s90, s90, 0xffff
  s_add_u32 s91, s91, 0x8000
  ds_read_b128 a[132:135], v60 offset:12288
  v_mfma_f32_16x16x32_bf16 a[124:127], a[156:159], v[220:223], a[124:127]
  s_waitcnt lgkmcnt(6)
  buffer_store_dwordx4 v[124:127], v15, s[44:47], s89 offen offset:2048 sc1
  buffer_store_dwordx4 v[124:127], v15, s[44:47], s89 offen offset:3072 sc1
  v_cvt_pk_bf16_f32 v197, v34, v35
  v_cvt_pk_bf16_f32 v198, v36, v37
  v_cvt_pk_bf16_f32 v199, v38, v39
  v_add_u32 v61, s32, v55
  s_sub_u32 s92, s92, 0x4000
  s_and_b32 s92, s92, 0xffff
  s_sub_u32 s93, s93, 0x8000
  s_lshl_b32 s75, s82, 3
  s_lshl_b32 s76, s69, 12
  s_add_u32 s75, s75, s76
  s_lshl_b32 s76, s33, 17
  s_add_u32 s76, s76, s75
  v_rcp_f32 v40, v58
  v_rcp_f32 v41, v58
  v_rcp_f32 v42, v59
  v_rcp_f32 v43, v59
  v_accvgpr_read_b32 v160, a64
  v_accvgpr_read_b32 v161, a65
  v_accvgpr_read_b32 v162, a66
  v_accvgpr_read_b32 v163, a67
  v_accvgpr_read_b32 v164, a68
  v_accvgpr_read_b32 v165, a69
  v_accvgpr_read_b32 v166, a70
  v_accvgpr_read_b32 v167, a71
  v_accvgpr_read_b32 v168, a72
  v_accvgpr_read_b32 v169, a73
  v_accvgpr_read_b32 v170, a74
  v_accvgpr_read_b32 v171, a75
  v_accvgpr_read_b32 v172, a76
  v_accvgpr_read_b32 v173, a77
  v_accvgpr_read_b32 v174, a78
  v_accvgpr_read_b32 v175, a79
  v_pk_mul_f32 v[160:161], v[160:161], v[40:41]
  v_pk_mul_f32 v[162:163], v[162:163], v[40:41]
  v_pk_mul_f32 v[164:165], v[164:165], v[40:41]
  v_pk_mul_f32 v[166:167], v[166:167], v[40:41]
  v_pk_mul_f32 v[168:169], v[168:169], v[40:41]
  v_pk_mul_f32 v[170:171], v[170:171], v[40:41]
  v_pk_mul_f32 v[172:173], v[172:173], v[40:41]
  v_pk_mul_f32 v[174:175], v[174:175], v[40:41]
  v_cvt_pk_bf16_f32 v96, v160, v161
  v_cvt_pk_bf16_f32 v97, v162, v163
  v_cvt_pk_bf16_f32 v98, v164, v165
  v_cvt_pk_bf16_f32 v99, v166, v167
  v_cvt_pk_bf16_f32 v100, v168, v169
  v_cvt_pk_bf16_f32 v101, v170, v171
  v_cvt_pk_bf16_f32 v102, v172, v173
  v_cvt_pk_bf16_f32 v103, v174, v175
  buffer_store_dwordx4 v[96:99], v15, s[44:47], s75 offen offset:0 sc1
  buffer_store_dwordx4 v[100:103], v15, s[44:47], s75 offen offset:1024 sc1
  v_accvgpr_read_b32 v176, a80
  v_accvgpr_read_b32 v177, a81
  v_accvgpr_read_b32 v178, a82
  v_accvgpr_read_b32 v179, a83
  v_accvgpr_read_b32 v180, a84
  v_accvgpr_read_b32 v181, a85
  v_accvgpr_read_b32 v182, a86
  v_accvgpr_read_b32 v183, a87
  v_accvgpr_read_b32 v184, a88
  v_accvgpr_read_b32 v185, a89
  v_accvgpr_read_b32 v186, a90
  v_accvgpr_read_b32 v187, a91
  v_accvgpr_read_b32 v188, a92
  v_accvgpr_read_b32 v189, a93
  v_accvgpr_read_b32 v190, a94
  v_accvgpr_read_b32 v191, a95
  v_pk_mul_f32 v[176:177], v[176:177], v[40:41]
  v_pk_mul_f32 v[178:179], v[178:179], v[40:41]
  v_pk_mul_f32 v[180:181], v[180:181], v[40:41]
  v_pk_mul_f32 v[182:183], v[182:183], v[40:41]
  v_pk_mul_f32 v[184:185], v[184:185], v[40:41]
  v_pk_mul_f32 v[186:187], v[186:187], v[40:41]
  v_pk_mul_f32 v[188:189], v[188:189], v[40:41]
  v_pk_mul_f32 v[190:191], v[190:191], v[40:41]
  v_cvt_pk_bf16_f32 v104, v176, v177
  v_cvt_pk_bf16_f32 v105, v178, v179
  v_cvt_pk_bf16_f32 v106, v180, v181
  v_cvt_pk_bf16_f32 v107, v182, v183
  v_cvt_pk_bf16_f32 v108, v184, v185
  v_cvt_pk_bf16_f32 v109, v186, v187
  v_cvt_pk_bf16_f32 v110, v188, v189
  v_cvt_pk_bf16_f32 v111, v190, v191
  buffer_store_dwordx4 v[104:107], v15, s[44:47], s75 offen offset:2048 sc1
  buffer_store_dwordx4 v[108:111], v15, s[44:47], s75 offen offset:3072 sc1
  v_accvgpr_read_b32 v160, a96
  v_accvgpr_read_b32 v161, a97
  v_accvgpr_read_b32 v162, a98
  v_accvgpr_read_b32 v163, a99
  v_accvgpr_read_b32 v164, a100
  v_accvgpr_read_b32 v165, a101
  v_accvgpr_read_b32 v166, a102
  v_accvgpr_read_b32 v167, a103
  v_accvgpr_read_b32 v168, a104
  v_accvgpr_read_b32 v169, a105
  v_accvgpr_read_b32 v170, a106
  v_accvgpr_read_b32 v171, a107
  v_accvgpr_read_b32 v172, a108
  v_accvgpr_read_b32 v173, a109
  v_accvgpr_read_b32 v174, a110
  v_accvgpr_read_b32 v175, a111
  v_pk_mul_f32 v[160:161], v[160:161], v[42:43]
  v_pk_mul_f32 v[162:163], v[162:163], v[42:43]
  v_pk_mul_f32 v[164:165], v[164:165], v[42:43]
  v_pk_mul_f32 v[166:167], v[166:167], v[42:43]
  v_pk_mul_f32 v[168:169], v[168:169], v[42:43]
  v_pk_mul_f32 v[170:171], v[170:171], v[42:43]
  v_pk_mul_f32 v[172:173], v[172:173], v[42:43]
  v_pk_mul_f32 v[174:175], v[174:175], v[42:43]
  v_cvt_pk_bf16_f32 v112, v160, v161
  v_cvt_pk_bf16_f32 v113, v162, v163
  v_cvt_pk_bf16_f32 v114, v164, v165
  v_cvt_pk_bf16_f32 v115, v166, v167
  v_cvt_pk_bf16_f32 v116, v168, v169
  v_cvt_pk_bf16_f32 v117, v170, v171
  v_cvt_pk_bf16_f32 v118, v172, v173
  v_cvt_pk_bf16_f32 v119, v174, v175
  buffer_store_dwordx4 v[112:115], v15, s[44:47], s76 offen offset:0 sc1
  buffer_store_dwordx4 v[116:119], v15, s[44:47], s76 offen offset:1024 sc1
  v_accvgpr_read_b32 v176, a112
  v_accvgpr_read_b32 v177, a113
  v_accvgpr_read_b32 v178, a114
  v_accvgpr_read_b32 v179, a115
  v_accvgpr_read_b32 v180, a116
  v_accvgpr_read_b32 v181, a117
  v_accvgpr_read_b32 v182, a118
  v_accvgpr_read_b32 v183, a119
  v_accvgpr_read_b32 v184, a120
  v_accvgpr_read_b32 v185, a121
  v_accvgpr_read_b32 v186, a122
  v_accvgpr_read_b32 v187, a123
  v_accvgpr_read_b32 v188, a124
  v_accvgpr_read_b32 v189, a125
  v_accvgpr_read_b32 v190, a126
  v_accvgpr_read_b32 v191, a127
  v_pk_mul_f32 v[176:177], v[176:177], v[42:43]
  v_pk_mul_f32 v[178:179], v[178:179], v[42:43]
  v_pk_mul_f32 v[180:181], v[180:181], v[42:43]
  v_pk_mul_f32 v[182:183], v[182:183], v[42:43]
  v_pk_mul_f32 v[184:185], v[184:185], v[42:43]
  v_pk_mul_f32 v[186:187], v[186:187], v[42:43]
  v_pk_mul_f32 v[188:189], v[188:189], v[42:43]
  v_pk_mul_f32 v[190:191], v[190:191], v[42:43]
  v_cvt_pk_bf16_f32 v120, v176, v177
  v_cvt_pk_bf16_f32 v121, v178, v179
  v_cvt_pk_bf16_f32 v122, v180, v181
  v_cvt_pk_bf16_f32 v123, v182, v183
  v_cvt_pk_bf16_f32 v124, v184, v185
  v_cvt_pk_bf16_f32 v125, v186, v187
  v_cvt_pk_bf16_f32 v126, v188, v189
  v_cvt_pk_bf16_f32 v127, v190, v191
  buffer_store_dwordx4 v[120:123], v15, s[44:47], s76 offen offset:2048 sc1
  buffer_store_dwordx4 v[124:127], v15, s[44:47], s76 offen offset:3072 sc1
  buffer_load_dword v49, v50, s[44:47], 0 offen sc1
  s_getpc_b64 s[98:99]
L_pc12:
  s_sub_u32 s98, s98, L_pc12-L_pc
  s_subb_u32 s99, s99, 0
  global_load_dword v0, v51, s[98:99]
  s_cmp_eq_u32 s96, 0
  s_cbranch_scc1 L_EL
L_E2:
  v_mfma_f32_16x16x32_bf16 v[160:163], a[160:163], v[64:67], v[224:227]
  v_exp_f32 v32, v144
  v_mfma_f32_16x16x32_bf16 v[168:171], a[160:163], v[80:83], v[232:235]
  v_exp_f32 v33, v145
  v_mfma_f32_16x16x32_bf16 v[40:43], a[192:195], v[192:195], 0
  s_add_u32 s73, s73, 0x4000
  ds_read_b128 a[136:139], v60 offset:9216
  v_cvt_pk_bf16_f32 v200, v32, v33
  v_mfma_f32_16x16x32_bf16 v[44:47], a[192:195], v[196:199], 0
  s_and_b32 s73, s73, 0xffff
  v_exp_f32 v34, v146
  v_mfma_f32_16x16x32_bf16 v[164:167], a[164:167], v[64:67], v[228:231]
  s_add_u32 s94, s94, 2
  ds_read_b128 a[140:143], v60 offset:13312
  v_exp_f32 v35, v147
  v_mfma_f32_16x16x32_bf16 v[172:175], a[164:167], v[80:83], v[236:239]
  s_sub_u32 s75, s94, s95
  v_exp_f32 v36, v148
  v_mfma_f32_16x16x32_bf16 v[160:163], a[168:171], v[68:71], v[160:163]
  s_add_u32 m0, s92, 65536
  s_add_u32 s92, s92, 0x4000
  ds_read_b128 a[144:147], v60 offset:10240
  v_mfma_f32_16x16x32_bf16 v[168:171], a[168:171], v[84:87], v[168:171]
  s_waitcnt lgkmcnt(6)
  v_exp_f32 v37, v149
  v_mfma_f32_16x16x32_bf16 v[164:167], a[172:175], v[68:71], v[164:167]
  v_exp_f32 v38, v150
  v_mfma_f32_16x16x32_bf16 v[172:175], a[172:175], v[84:87], v[172:175]
  v_exp_f32 v39, v151
  v_mfma_f32_16x16x32_bf16 v[160:163], a[176:179], v[72:75], v[160:163]
  buffer_load_dwordx4 v15, s[36:39], s93 offen offset:0 sc1 lds
  v_mfma_f32_16x16x32_bf16 v[168:171], a[176:179], v[88:91], v[168:171]
  ds_read_b128 a[148:151], v60 offset:14336
  v_cvt_pk_bf16_f32 v201, v34, v35
  v_mfma_f32_16x16x32_bf16 v[164:167], a[180:183], v[72:75], v[164:167]
  ds_read_b128 a[152:155], v60 offset:11264
  v_cvt_pk_bf16_f32 v202, v36, v37
  v_mfma_f32_16x16x32_bf16 v[172:175], a[180:183], v[88:91], v[172:175]
  v_exp_f32 v32, v152
  v_mfma_f32_16x16x32_bf16 v[160:163], a[184:187], v[76:79], v[160:163]
  ds_read_b128 a[156:159], v60 offset:15360
  v_cvt_pk_bf16_f32 v203, v38, v39
  v_mfma_f32_16x16x32_bf16 v[168:171], a[184:187], v[92:95], v[168:171]
  s_waitcnt lgkmcnt(5)
  v_exp_f32 v33, v153
  v_mfma_f32_16x16x32_bf16 v[164:167], a[188:191], v[76:79], v[164:167]
  ds_read_b128 a[160:163], v61 offset:0
  v_cvt_pk_bf16_f32 v204, v32, v33
  v_mfma_f32_16x16x32_bf16 v[172:175], a[188:191], v[92:95], v[172:175]
  v_exp_f32 v34, v154
  v_mfma_f32_16x16x32_bf16 v[176:179], a[128:131], v[64:67], v[240:243]
  s_cmp_lt_u32 s75, 4
  s_cselect_b32 s97, -1.0, s3
  ds_read_b128 a[164:167], v61 offset:1024
  v_mfma_f32_16x16x32_bf16 v[184:187], a[128:131], v[80:83], v[248:251]
  v_exp_f32 v35, v155
  v_mfma_f32_16x16x32_bf16 v[180:183], a[132:135], v[64:67], v[244:247]
  ds_read_b128 a[168:171], v61 offset:2048
  v_cvt_pk_bf16_f32 v205, v34, v35
  v_mfma_f32_16x16x32_bf16 v[188:191], a[132:135], v[80:83], v[252:255]
  v_exp_f32 v36, v156
  v_mfma_f32_16x16x32_bf16 v[176:179], a[136:139], v[68:71], v[176:179]
  ds_read_b128 a[172:175], v61 offset:3072
  v_exp_f32 v37, v157
  v_mfma_f32_16x16x32_bf16 v[184:187], a[136:139], v[84:87], v[184:187]
  s_waitcnt lgkmcnt(6)
  v_exp_f32 v38, v158
  v_mfma_f32_16x16x32_bf16 v[180:183], a[140:143], v[68:71], v[180:183]
  ds_read_b128 a[176:179], v61 offset:4096
  v_cvt_pk_bf16_f32 v206, v36, v37
  v_mfma_f32_16x16x32_bf16 v[188:191], a[140:143], v[84:87], v[188:191]
  v_exp_f32 v39, v159
  v_mfma_f32_16x16x32_bf16 v[176:179], a[144:147], v[72:75], v[176:179]
  ds_read_b128 a[180:183], v61 offset:5120
  v_cvt_pk_bf16_f32 v207, v38, v39
  v_mfma_f32_16x16x32_bf16 v[184:187], a[144:147], v[88:91], v[184:187]
  buffer_load_dwordx4 v15, s[36:39], s93 offen offset:1024 sc1 lds
  v_mfma_f32_16x16x32_bf16 v[40:43], a[192:195], v[200:203], v[40:43]
  ds_read_b128 a[184:187], v61 offset:6144
  v_exp_f32 v32, v160
  v_mfma_f32_16x16x32_bf16 v[44:47], a[192:195], v[204:207], v[44:47]
  v_exp_f32 v33, v161
  v_mfma_f32_16x16x32_bf16 v[180:183], a[148:151], v[72:75], v[180:183]
  ds_read_b128 a[188:191], v61 offset:7168
  v_exp_f32 v34, v162
  v_mfma_f32_16x16x32_bf16 v[188:191], a[148:151], v[88:91], v[188:191]
  s_waitcnt lgkmcnt(6)
  v_exp_f32 v35, v163
  v_mfma_f32_16x16x32_bf16 v[176:179], a[152:155], v[76:79], v[176:179]
  ds_read_b128 a[128:131], v61 offset:8192
  v_max_f32 v62, v40, v44
  v_mfma_f32_16x16x32_bf16 v[184:187], a[152:155], v[92:95], v[184:187]
  buffer_load_dwordx4 v15, s[36:39], s93 offen offset:2048 sc1 lds
  v_cmp_lt_f32 vcc, s97, v62
  v_mfma_f32_16x16x32_bf16 v[180:183], a[156:159], v[76:79], v[180:183]
  ds_read_b128 a[132:135], v61 offset:9216
  v_mfma_f32_16x16x32_bf16 v[188:191], a[156:159], v[92:95], v[188:191]
  s_cbranch_vccnz LrareE2
LretE2:
  v_mfma_f32_16x16x32_bf16 a[0:3], a[160:163], v[192:195], a[0:3]
  ds_read_b128 a[136:139], v61 offset:10240
  v_add_f32 v56, v56, v40
  v_mfma_f32_16x16x32_bf16 a[32:35], a[160:163], v[196:199], a[32:35]
  v_exp_f32 v36, v164
  v_mfma_f32_16x16x32_bf16 a[4:7], a[164:167], v[192:195], a[4:7]
  ds_read_b128 a[140:143], v61 offset:11264
  v_add_f32 v57, v57, v44
  v_mfma_f32_16x16x32_bf16 a[36:39], a[164:167], v[196:199], a[36:39]
  s_waitcnt lgkmcnt(6)
  v_exp_f32 v37, v165
  v_mfma_f32_16x16x32_bf16 a[8:11], a[168:171], v[192:195], a[8:11]
  ds_read_b128 a[144:147], v61 offset:12288
  v_cvt_pk_bf16_f32 v208, v32, v33
  v_mfma_f32_16x16x32_bf16 a[40:43], a[168:171], v[196:199], a[40:43]
  v_exp_f32 v38, v166
  v_mfma_f32_16x16x32_bf16 a[12:15], a[172:175], v[192:195], a[12:15]
  ds_read_b128 a[148:151], v61 offset:13312
  v_cvt_pk_bf16_f32 v209, v34, v35
  v_mfma_f32_16x16x32_bf16 a[44:47], a[172:175], v[196:199], a[44:47]
  buffer_load_dwordx4 v15, s[36:39], s93 offen offset:3072 sc1 lds
  v_mfma_f32_16x16x32_bf16 a[16:19], a[176:179], v[192:195], a[16:19]
  s_and_b32 s92, s92, 0xffff
  s_add_u32 s93, s93, 0x8000
  ds_read_b128 a[152:155], v61 offset:14336
  v_mfma_f32_16x16x32_bf16 a[48:51], a[176:179], v[196:199], a[48:51]
  v_exp_f32 v39, v167
  v_mfma_f32_16x16x32_bf16 a[20:23], a[180:183], v[192:195], a[20:23]
  s_mov_b32 m0, s90
  s_add_u32 s90, s90, 0x4000
  ds_read_b128 a[156:159], v61 offset:15360
  v_add_u32 v60, s73, v15
  v_mfma_f32_16x16x32_bf16 a[52:55], a[180:183], v[196:199], a[52:55]
  s_waitcnt lgkmcnt(6)
  s_waitcnt vmcnt(8)
  s_barrier
  v_mfma_f32_16x16x32_bf16 a[24:27], a[184:187], v[192:195], a[24:27]
  s_add_u32 s32, s32, 0x4000
  ds_read_b128 a[160:163], v60 offset:0
  v_cvt_pk_bf16_f32 v210, v36, v37
  v_mfma_f32_16x16x32_bf16 a[56:59], a[184:187], v[196:199], a[56:59]
  s_and_b32 s32, s32, 0xffff
  v_exp_f32 v32, v168
  v_mfma_f32_16x16x32_bf16 a[28:31], a[188:191], v[192:195], a[28:31]
  buffer_load_dwordx4 v15, s[36:39], s91 offen offset:0 sc1 lds
  v_mfma_f32_16x16x32_bf16 a[60:63], a[188:191], v[196:199], a[60:63]
  ds_read_b128 a[164:167], v60 offset:4096
  v_cvt_pk_bf16_f32 v211, v38, v39
  v_mfma_f32_16x16x32_bf16 a[0:3], a[128:131], v[200:203], a[0:3]
  ds_read_b128 a[168:171], v60 offset:1024
  v_exp_f32 v33, v169
  v_mfma_f32_16x16x32_bf16 a[32:35], a[128:131], v[204:207], a[32:35]
  v_exp_f32 v34, v170
  v_mfma_f32_16x16x32_bf16 a[4:7], a[132:135], v[200:203], a[4:7]
  ds_read_b128 a[172:175], v60 offset:5120
  v_cvt_pk_bf16_f32 v212, v32, v33
  v_mfma_f32_16x16x32_bf16 a[36:39], a[132:135], v[204:207], a[36:39]
  s_waitcnt lgkmcnt(6)
  buffer_load_dwordx4 v15, s[36:39], s91 offen offset:1024 sc1 lds
  v_mfma_f32_16x16x32_bf16 a[8:11], a[136:139], v[200:203], a[8:11]
  ds_read_b128 a[176:179], v60 offset:2048
  v_exp_f32 v35, v171
  v_mfma_f32_16x16x32_bf16 a[40:43], a[136:139], v[204:207], a[40:43]
  v_exp_f32 v36, v172
  v_mfma_f32_16x16x32_bf16 a[12:15], a[140:143], v[200:203], a[12:15]
  ds_read_b128 a[180:183], v60 offset:6144
  v_cvt_pk_bf16_f32 v213, v34, v35
  v_mfma_f32_16x16x32_bf16 a[44:47], a[140:143], v[204:207], a[44:47]
  v_exp_f32 v37, v173
  v_mfma_f32_16x16x32_bf16 a[16:19], a[144:147], v[200:203], a[16:19]
  buffer_load_dwordx4 v15, s[36:39], s91 offen offset:2048 sc1 lds
  v_mfma_f32_16x16x32_bf16 a[48:51], a[144:147], v[204:207], a[48:51]
  ds_read_b128 a[184:187], v60 offset:3072
  v_cvt_pk_bf16_f32 v214, v36, v37
  v_mfma_f32_16x16x32_bf16 a[20:23], a[148:151], v[200:203], a[20:23]
  ds_read_b128 a[188:191], v60 offset:7168
  v_add_u32 v61, s32, v55
  v_mfma_f32_16x16x32_bf16 a[52:55], a[148:151], v[204:207], a[52:55]
  s_waitcnt lgkmcnt(8)
  v_exp_f32 v38, v174
  v_mfma_f32_16x16x32_bf16 a[24:27], a[152:155], v[200:203], a[24:27]
  ds_read_b128 a[128:131], v60 offset:8192
  v_exp_f32 v39, v175
  v_mfma_f32_16x16x32_bf16 a[56:59], a[152:155], v[204:207], a[56:59]
  buffer_load_dwordx4 v15, s[36:39], s91 offen offset:3072 sc1 lds
  v_mfma_f32_16x16x32_bf16 a[28:31], a[156:159], v[200:203], a[28:31]
  s_and_b32 s90, s90, 0xffff
  s_add_u32 s91, s91, 0x8000
  ds_read_b128 a[132:135], v60 offset:12288
  v_mfma_f32_16x16x32_bf16 a[60:63], a[156:159], v[204:207], a[60:63]
  s_waitcnt lgkmcnt(6)
  v_cvt_pk_bf16_f32 v215, v38, v39
  v_mfma_f32_16x16x32_bf16 v[128:131], a[160:163], v[64:67], v[224:227]
  v_exp_f32 v32, v176
  v_mfma_f32_16x16x32_bf16 v[136:139], a[160:163], v[80:83], v[232:235]
  v_exp_f32 v33, v177
  v_mfma_f32_16x16x32_bf16 v[40:43], a[192:195], v[208:211], 0
  s_add_u32 s73, s73, 0x4000
  ds_read_b128 a[136:139], v60 offset:9216
  v_cvt_pk_bf16_f32 v216, v32, v33
  v_mfma_f32_16x16x32_bf16 v[44:47], a[192:195], v[212:215], 0
  s_and_b32 s73, s73, 0xffff
  v_exp_f32 v34, v178
  v_mfma_f32_16x16x32_bf16 v[132:135], a[164:167], v[64:67], v[228:231]
  s_add_u32 s94, s94, 2
  ds_read_b128 a[140:143], v60 offset:13312
  v_exp_f32 v35, v179
  v_mfma_f32_16x16x32_bf16 v[140:143], a[164:167], v[80:83], v[236:239]
  s_sub_u32 s75, s94, s95
  v_exp_f32 v36, v180
  v_mfma_f32_16x16x32_bf16 v[128:131], a[168:171], v[68:71], v[128:131]
  s_add_u32 m0, s92, 65536
  s_add_u32 s92, s92, 0x4000
  ds_read_b128 a[144:147], v60 offset:10240
  v_mfma_f32_16x16x32_bf16 v[136:139], a[168:171], v[84:87], v[136:139]
  s_waitcnt lgkmcnt(6)
  v_exp_f32 v37, v181
  v_mfma_f32_16x16x32_bf16 v[132:135], a[172:175], v[68:71], v[132:135]
  v_exp_f32 v38, v182
  v_mfma_f32_16x16x32_bf16 v[140:143], a[172:175], v[84:87], v[140:143]
  v_exp_f32 v39, v183
  v_mfma_f32_16x16x32_bf16 v[128:131], a[176:179], v[72:75], v[128:131]
  buffer_load_dwordx4 v15, s[36:39], s93 offen offset:0 sc1 lds
  v_mfma_f32_16x16x32_bf16 v[136:139], a[176:179], v[88:91], v[136:139]
  ds_read_b128 a[148:151], v60 offset:14336
  v_cvt_pk_bf16_f32 v217, v34, v35
  v_mfma_f32_16x16x32_bf16 v[132:135], a[180:183], v[72:75], v[132:135]
  ds_read_b128 a[152:155], v60 offset:11264
  v_cvt_pk_bf16_f32 v218, v36, v37
  v_mfma_f32_16x16x32_bf16 v[140:143], a[180:183], v[88:91], v[140:143]
  v_exp_f32 v32, v184
  v_mfma_f32_16x16x32_bf16 v[128:131], a[184:187], v[76:79], v[128:131]
  ds_read_b128 a[156:159], v60 offset:15360
  v_cvt_pk_bf16_f32 v219, v38, v39
  v_mfma_f32_16x16x32_bf16 v[136:139], a[184:187], v[92:95], v[136:139]
  s_waitcnt lgkmcnt(5)
  v_exp_f32 v33, v185
  v_mfma_f32_16x16x32_bf16 v[132:135], a[188:191], v[76:79], v[132:135]
  ds_read_b128 a[160:163], v61 offset:0
  v_cvt_pk_bf16_f32 v220, v32, v33
  v_mfma_f32_16x16x32_bf16 v[140:143], a[188:191], v[92:95], v[140:143]
  v_exp_f32 v34, v186
  v_mfma_f32_16x16x32_bf16 v[144:147], a[128:131], v[64:67], v[240:243]
  s_cmp_lt_u32 s75, 4
  s_cselect_b32 s97, -1.0, s3
  ds_read_b128 a[164:167], v61 offset:1024
  v_mfma_f32_16x16x32_bf16 v[152:155], a[128:131], v[80:83], v[248:251]
  v_exp_f32 v35, v187
  v_mfma_f32_16x16x32_bf16 v[148:151], a[132:135], v[64:67], v[244:247]
  ds_read_b128 a[168:171], v61 offset:2048
  v_cvt_pk_bf16_f32 v221, v34, v35
  v_mfma_f32_16x16x32_bf16 v[156:159], a[132:135], v[80:83], v[252:255]
  v_exp_f32 v36, v188
  v_mfma_f32_16x16x32_bf16 v[144:147], a[136:139], v[68:71], v[144:147]
  ds_read_b128 a[172:175], v61 offset:3072
  v_exp_f32 v37, v189
  v_mfma_f32_16x16x32_bf16 v[152:155], a[136:139], v[84:87], v[152:155]
  s_waitcnt lgkmcnt(6)
  v_exp_f32 v38, v190
  v_mfma_f32_16x16x32_bf16 v[148:151], a[140:143], v[68:71], v[148:151]
  ds_read_b128 a[176:179], v61 offset:4096
  v_cvt_pk_bf16_f32 v222, v36, v37
  v_mfma_f32_16x16x32_bf16 v[156:159], a[140:143], v[84:87], v[156:159]
  v_exp_f32 v39, v191
  v_mfma_f32_16x16x32_bf16 v[144:147], a[144:147], v[72:75], v[144:147]
  ds_read_b128 a[180:183], v61 offset:5120
  v_cvt_pk_bf16_f32 v223, v38, v39
  v_mfma_f32_16x16x32_bf16 v[152:155], a[144:147], v[88:91], v[152:155]
  buffer_load_dwordx4 v15, s[36:39], s93 offen offset:1024 sc1 lds
  v_mfma_f32_16x16x32_bf16 v[40:43], a[192:195], v[216:219], v[40:43]
  ds_read_b128 a[184:187], v61 offset:6144
  v_exp_f32 v32, v128
  v_mfma_f32_16x16x32_bf16 v[44:47], a[192:195], v[220:223], v[44:47]
  v_exp_f32 v33, v129
  v_mfma_f32_16x16x32_bf16 v[148:151], a[148:151], v[72:75], v[148:151]
  ds_read_b128 a[188:191], v61 offset:7168
  v_exp_f32 v34, v130
  v_mfma_f32_16x16x32_bf16 v[156:159], a[148:151], v[88:91], v[156:159]
  s_waitcnt lgkmcnt(6)
  v_exp_f32 v35, v131
  v_mfma_f32_16x16x32_bf16 v[144:147], a[152:155], v[76:79], v[144:147]
  ds_read_b128 a[128:131], v61 offset:8192
  v_max_f32 v62, v40, v44
  v_mfma_f32_16x16x32_bf16 v[152:155], a[152:155], v[92:95], v[152:155]
  buffer_load_dwordx4 v15, s[36:39], s93 offen offset:2048 sc1 lds
  v_cmp_lt_f32 vcc, s97, v62
  v_mfma_f32_16x16x32_bf16 v[148:151], a[156:159], v[76:79], v[148:151]
  ds_read_b128 a[132:135], v61 offset:9216
  v_mfma_f32_16x16x32_bf16 v[156:159], a[156:159], v[92:95], v[156:159]
  s_cbranch_vccnz LrareO2
LretO2:
  v_mfma_f32_16x16x32_bf16 a[0:3], a[160:163], v[208:211], a[0:3]
  s_sub_u32 s96, s96, 1
  ds_read_b128 a[136:139], v61 offset:10240
  v_add_f32 v56, v56, v40
  v_mfma_f32_16x16x32_bf16 a[32:35], a[160:163], v[212:215], a[32:35]
  v_exp_f32 v36, v132
  v_mfma_f32_16x16x32_bf16 a[4:7], a[164:167], v[208:211], a[4:7]
  ds_read_b128 a[140:143], v61 offset:11264
  v_add_f32 v57, v57, v44
  v_mfma_f32_16x16x32_bf16 a[36:39], a[164:167], v[212:215], a[36:39]
  s_waitcnt lgkmcnt(6)
  v_exp_f32 v37, v133
  v_mfma_f32_16x16x32_bf16 a[8:11], a[168:171], v[208:211], a[8:11]
  ds_read_b128 a[144:147], v61 offset:12288
  v_cvt_pk_bf16_f32 v192, v32, v33
  v_mfma_f32_16x16x32_bf16 a[40:43], a[168:171], v[212:215], a[40:43]
  v_exp_f32 v38, v134
  v_mfma_f32_16x16x32_bf16 a[12:15], a[172:175], v[208:211], a[12:15]
  ds_read_b128 a[148:151], v61 offset:13312
  v_cvt_pk_bf16_f32 v193, v34, v35
  v_mfma_f32_16x16x32_bf16 a[44:47], a[172:175], v[212:215], a[44:47]
  buffer_load_dwordx4 v15, s[36:39], s93 offen offset:3072 sc1 lds
  v_mfma_f32_16x16x32_bf16 a[16:19], a[176:179], v[208:211], a[16:19]
  s_and_b32 s92, s92, 0xffff
  s_add_u32 s93, s93, 0x8000
  ds_read_b128 a[152:155], v61 offset:14336
  v_mfma_f32_16x16x32_bf16 a[48:51], a[176:179], v[212:215], a[48:51]
  v_exp_f32 v39, v135
  v_mfma_f32_16x16x32_bf16 a[20:23], a[180:183], v[208:211], a[20:23]
  s_mov_b32 m0, s90
  s_add_u32 s90, s90, 0x4000
  ds_read_b128 a[156:159], v61 offset:15360
  v_add_u32 v60, s73, v15
  v_mfma_f32_16x16x32_bf16 a[52:55], a[180:183], v[212:215], a[52:55]
  s_waitcnt lgkmcnt(6)
  s_waitcnt vmcnt(8)
  s_barrier
  v_mfma_f32_16x16x32_bf16 a[24:27], a[184:187], v[208:211], a[24:27]
  s_add_u32 s32, s32, 0x4000
  ds_read_b128 a[160:163], v60 offset:0
  v_cvt_pk_bf16_f32 v194, v36, v37
  v_mfma_f32_16x16x32_bf16 a[56:59], a[184:187], v[212:215], a[56:59]
  s_and_b32 s32, s32, 0xffff
  v_exp_f32 v32, v136
  v_mfma_f32_16x16x32_bf16 a[28:31], a[188:191], v[208:211], a[28:31]
  buffer_load_dwordx4 v15, s[36:39], s91 offen offset:0 sc1 lds
  v_mfma_f32_16x16x32_bf16 a[60:63], a[188:191], v[212:215], a[60:63]
  ds_read_b128 a[164:167], v60 offset:4096
  v_cvt_pk_bf16_f32 v195, v38, v39
  v_mfma_f32_16x16x32_bf16 a[0:3], a[128:131], v[216:219], a[0:3]
  ds_read_b128 a[168:171], v60 offset:1024
  v_exp_f32 v33, v137
  v_mfma_f32_16x16x32_bf16 a[32:35], a[128:131], v[220:223], a[32:35]
  v_exp_f32 v34, v138
  v_mfma_f32_16x16x32_bf16 a[4:7], a[132:135], v[216:219], a[4:7]
  ds_read_b128 a[172:175], v60 offset:5120
  v_cvt_pk_bf16_f32 v196, v32, v33
  v_mfma_f32_16x16x32_bf16 a[36:39], a[132:135], v[220:223], a[36:39]
  s_waitcnt lgkmcnt(6)
  buffer_load_dwordx4 v15, s[36:39], s91 offen offset:1024 sc1 lds
  v_mfma_f32_16x16x32_bf16 a[8:11], a[136:139], v[216:219], a[8:11]
  ds_read_b128 a[176:179], v60 offset:2048
  v_exp_f32 v35, v139
  v_mfma_f32_16x16x32_bf16 a[40:43], a[136:139], v[220:223], a[40:43]
  v_exp_f32 v36, v140
  v_mfma_f32_16x16x32_bf16 a[12:15], a[140:143], v[216:219], a[12:15]
  ds_read_b128 a[180:183], v60 offset:6144
  v_cvt_pk_bf16_f32 v197, v34, v35
  v_mfma_f32_16x16x32_bf16 a[44:47], a[140:143], v[220:223], a[44:47]
  v_exp_f32 v37, v141
  v_mfma_f32_16x16x32_bf16 a[16:19], a[144:147], v[216:219], a[16:19]
  buffer_load_dwordx4 v15, s[36:39], s91 offen offset:2048 sc1 lds
  v_mfma_f32_16x16x32_bf16 a[48:51], a[144:147], v[220:223], a[48:51]
  ds_read_b128 a[184:187], v60 offset:3072
  v_cvt_pk_bf16_f32 v198, v36, v37
  v_mfma_f32_16x16x32_bf16 a[20:23], a[148:151], v[216:219], a[20:23]
  ds_read_b128 a[188:191], v60 offset:7168
  v_add_u32 v61, s32, v55
  v_mfma_f32_16x16x32_bf16 a[52:55], a[148:151], v[220:223], a[52:55]
  s_waitcnt lgkmcnt(8)
  v_exp_f32 v38, v142
  v_mfma_f32_16x16x32_bf16 a[24:27], a[152:155], v[216:219], a[24:27]
  ds_read_b128 a[128:131], v60 offset:8192
  v_exp_f32 v39, v143
  v_mfma_f32_16x16x32_bf16 a[56:59], a[152:155], v[220:223], a[56:59]
  buffer_load_dwordx4 v15, s[36:39], s91 offen offset:3072 sc1 lds
  v_mfma_f32_16x16x32_bf16 a[28:31], a[156:159], v[216:219], a[28:31]
  s_and_b32 s90, s90, 0xffff
  s_add_u32 s91, s91, 0x8000
  ds_read_b128 a[132:135], v60 offset:12288
  v_mfma_f32_16x16x32_bf16 a[60:63], a[156:159], v[220:223], a[60:63]
  s_waitcnt lgkmcnt(6)
  v_cvt_pk_bf16_f32 v199, v38, v39
  s_cmp_lg_u32 s96, 0
  s_cbranch_scc1 L_E2
L_EL:
  v_mfma_f32_16x16x32_bf16 v[168:171], a[160:163], v[80:83], v[232:235]
  v_exp_f32 v32, v144
  v_mfma_f32_16x16x32_bf16 v[172:175], a[164:167], v[80:83], v[236:239]
  v_exp_f32 v33, v145
  v_mfma_f32_16x16x32_bf16 v[40:43], a[192:195], v[192:195], 0
  s_add_u32 s73, s73, 0x4000
  v_exp_f32 v34, v146
  v_mfma_f32_16x16x32_bf16 v[44:47], a[192:195], v[196:199], 0
  s_waitcnt lgkmcnt(4)
  v_exp_f32 v35, v147
  v_mfma_f32_16x16x32_bf16 v[168:171], a[168:171], v[84:87], v[168:171]
  s_add_u32 s94, s94, 2
  v_exp_f32 v36, v148
  v_mfma_f32_16x16x32_bf16 v[172:175], a[172:175], v[84:87], v[172:175]
  s_and_b32 s73, s73, 0xffff
  ds_read_b128 a[136:139], v60 offset:9216
  v_cvt_pk_bf16_f32 v200, v32, v33
  v_mfma_f32_16x16x32_bf16 v[168:171], a[176:179], v[88:91], v[168:171]
  ds_read_b128 a[140:143], v60 offset:13312
  v_cvt_pk_bf16_f32 v201, v34, v35
  v_mfma_f32_16x16x32_bf16 v[172:175], a[180:183], v[88:91], v[172:175]
  s_waitcnt lgkmcnt(2)
  ds_read_b128 a[144:147], v60 offset:10240
  v_exp_f32 v37, v149
  v_mfma_f32_16x16x32_bf16 v[168:171], a[184:187], v[92:95], v[168:171]
  ds_read_b128 a[148:151], v60 offset:14336
  v_cvt_pk_bf16_f32 v202, v36, v37
  v_mfma_f32_16x16x32_bf16 v[172:175], a[188:191], v[92:95], v[172:175]
  ds_read_b128 a[152:155], v60 offset:11264
  v_exp_f32 v38, v150
  v_exp_f32 v39, v151
  v_exp_f32 v32, v152
  v_exp_f32 v33, v153
  v_exp_f32 v34, v154
  v_exp_f32 v35, v155
  v_exp_f32 v36, v156
  v_exp_f32 v37, v157
  v_mfma_f32_16x16x32_bf16 v[184:187], a[128:131], v[80:83], v[248:251]
  ds_read_b128 a[156:159], v60 offset:15360
  v_cvt_pk_bf16_f32 v203, v38, v39
  v_exp_f32 v38, v158
  v_exp_f32 v39, v159
  v_cvt_pk_bf16_f32 v204, v32, v33
  v_cvt_pk_bf16_f32 v205, v34, v35
  v_cvt_pk_bf16_f32 v206, v36, v37
  v_cvt_pk_bf16_f32 v207, v38, v39
  v_mfma_f32_16x16x32_bf16 v[188:191], a[132:135], v[80:83], v[252:255]
  s_waitcnt lgkmcnt(4)
  ds_read_b128 a[160:163], v61 offset:0
  v_mfma_f32_16x16x32_bf16 v[40:43], a[192:195], v[200:203], v[40:43]
  v_mfma_f32_16x16x32_bf16 v[44:47], a[192:195], v[204:207], v[44:47]
  ds_read_b128 a[164:167], v61 offset:1024
  v_mfma_f32_16x16x32_bf16 v[184:187], a[136:139], v[84:87], v[184:187]
  v_mfma_f32_16x16x32_bf16 v[188:191], a[140:143], v[84:87], v[188:191]
  s_waitcnt lgkmcnt(2)
  ds_read_b128 a[168:171], v61 offset:2048
  s_waitcnt vmcnt(1)
  v_cmp_ne_u32 vcc, v52, v49
  s_cbranch_vccnz Lspin11
Lback11:
  v_add_u32 v50, 32768, v50
  v_and_b32 v50, 0xfffff3ff, v50
  s_lshl_b32 s76, s85, 10
  v_or_b32 v50, s76, v50
  v_mfma_f32_16x16x32_bf16 v[184:187], a[144:147], v[88:91], v[184:187]
  s_add_u32 m0, s86, 147456
  v_max_f32 v62, v40, v44
  v_cmp_lt_f32 vcc, s3, v62
  v_mfma_f32_16x16x32_bf16 v[188:191], a[148:151], v[88:91], v[188:191]
  s_add_u32 s0, s77, 0
  ds_read_b128 a[172:175], v61 offset:3072
  buffer_load_dwordx4 v6, s[56:59], s0 offen offset:0 lds
  v_mfma_f32_16x16x32_bf16 v[184:187], a[152:155], v[92:95], v[184:187]
  v_mfma_f32_16x16x32_bf16 v[188:191], a[156:159], v[92:95], v[188:191]
  s_waitcnt lgkmcnt(2)
  s_cbranch_vccnz LrealEL
LretEL:
  v_mfma_f32_16x16x32_bf16 a[0:3], a[160:163], v[192:195], a[0:3]
  ds_read_b128 a[176:179], v61 offset:4096
  v_add_f32 v56, v56, v40
  v_mfma_f32_16x16x32_bf16 a[32:35], a[160:163], v[196:199], a[32:35]
  ds_read_b128 a[180:183], v61 offset:5120
  v_add_f32 v57, v57, v44
  v_mfma_f32_16x16x32_bf16 a[4:7], a[164:167], v[192:195], a[4:7]
  v_exp_f32 v32, v168
  v_mfma_f32_16x16x32_bf16 a[36:39], a[164:167], v[196:199], a[36:39]
  s_waitcnt lgkmcnt(2)
  ds_read_b128 a[184:187], v61 offset:6144
  v_add_u32 v60, s73, v15
  v_mfma_f32_16x16x32_bf16 a[8:11], a[168:171], v[192:195], a[8:11]
  s_add_u32 s32, s32, 0x4000
  v_exp_f32 v33, v169
  v_mfma_f32_16x16x32_bf16 a[40:43], a[168:171], v[196:199], a[40:43]
  s_and_b32 s32, s32, 0xffff
  ds_read_b128 a[188:191], v61 offset:7168
  v_cvt_pk_bf16_f32 v212, v32, v33
  v_mfma_f32_16x16x32_bf16 a[12:15], a[172:175], v[192:195], a[12:15]
  v_exp_f32 v34, v170
  v_mfma_f32_16x16x32_bf16 a[44:47], a[172:175], v[196:199], a[44:47]
  s_waitcnt lgkmcnt(2)
  ds_read_b128 a[128:131], v61 offset:8192
  buffer_load_dwordx4 v7, s[56:59], s0 offen offset:1024 lds
  v_mfma_f32_16x16x32_bf16 a[16:19], a[176:179], v[192:195], a[16:19]
  v_exp_f32 v35, v171
  v_mfma_f32_16x16x32_bf16 a[48:51], a[176:179], v[196:199], a[48:51]
  ds_read_b128 a[132:135], v61 offset:9216
  v_cvt_pk_bf16_f32 v213, v34, v35
  v_mfma_f32_16x16x32_bf16 a[20:23], a[180:183], v[192:195], a[20:23]
  v_exp_f32 v36, v172
  v_mfma_f32_16x16x32_bf16 a[52:55], a[180:183], v[196:199], a[52:55]
  s_waitcnt lgkmcnt(2)
  s_waitcnt vmcnt(6)
  s_barrier
  v_mfma_f32_16x16x32_bf16 a[24:27], a[184:187], v[192:195], a[24:27]
  ds_read_b128 a[136:139], v61 offset:10240
  buffer_load_dwordx4 v8, s[56:59], s0 offen offset:2048 lds
  v_mfma_f32_16x16x32_bf16 a[56:59], a[184:187], v[196:199], a[56:59]
  ds_read_b128 a[140:143], v61 offset:11264
  v_mfma_f32_16x16x32_bf16 a[28:31], a[188:191], v[192:195], a[28:31]
  v_exp_f32 v37, v173
  v_mfma_f32_16x16x32_bf16 a[60:63], a[188:191], v[196:199], a[60:63]
  s_waitcnt lgkmcnt(2)
  ds_read_b128 a[144:147], v61 offset:12288
  buffer_load_dwordx4 v9, s[56:59], s0 offen offset:3072 lds
  s_add_u32 m0, s86, 131072
  s_add_u32 s0, s71, 0
  buffer_load_dwordx4 v15, s[40:43], s0 offen offset:0 sc1 lds
  buffer_load_dwordx4 v15, s[40:43], s0 offen offset:1024 sc1 lds
  s_add_u32 s0, s71, 55296
  buffer_load_dwordx4 v15, s[40:43], s0 offen offset:2048 sc1 lds
  buffer_load_dwordx4 v15, s[40:43], s0 offen offset:3072 sc1 lds
  v_cvt_pk_bf16_f32 v214, v36, v37
  v_mfma_f32_16x16x32_bf16 a[0:3], a[128:131], v[200:203], a[0:3]
  s_add_u32 m0, s86, 16384
  v_exp_f32 v38, v174
  v_mfma_f32_16x16x32_bf16 a[32:35], a[128:131], v[204:207], a[32:35]
  s_add_u32 s0, s77, 65536
  ds_read_b128 a[148:151], v61 offset:13312
  buffer_load_dwordx4 v6, s[56:59], s0 offen offset:0 lds
  v_mfma_f32_16x16x32_bf16 a[4:7], a[132:135], v[200:203], a[4:7]
  v_exp_f32 v39, v175
  v_mfma_f32_16x16x32_bf16 a[36:39], a[132:135], v[204:207], a[36:39]
  s_waitcnt lgkmcnt(2)
  ds_read_b128 a[152:155], v61 offset:14336
  v_cvt_pk_bf16_f32 v215, v38, v39
  v_mfma_f32_16x16x32_bf16 a[8:11], a[136:139], v[200:203], a[8:11]
  buffer_load_dwordx4 v7, s[56:59], s0 offen offset:1024 lds
  v_mfma_f32_16x16x32_bf16 a[40:43], a[136:139], v[204:207], a[40:43]
  ds_read_b128 a[156:159], v61 offset:15360
  v_mfma_f32_16x16x32_bf16 a[12:15], a[140:143], v[200:203], a[12:15]
  buffer_load_dwordx4 v8, s[56:59], s0 offen offset:2048 lds
  v_mfma_f32_16x16x32_bf16 a[44:47], a[140:143], v[204:207], a[44:47]
  s_waitcnt lgkmcnt(2)
  v_mfma_f32_16x16x32_bf16 a[16:19], a[144:147], v[200:203], a[16:19]
  buffer_load_dwordx4 v9, s[56:59], s0 offen offset:3072 lds
  s_add_u32 m0, s86, 0
  v_mfma_f32_16x16x32_bf16 a[48:51], a[144:147], v[204:207], a[48:51]
  s_add_u32 s0, s71, 2048
  v_add_u32 v61, s32, v55
  v_mfma_f32_16x16x32_bf16 a[20:23], a[148:151], v[200:203], a[20:23]
  buffer_load_dwordx4 v15, s[40:43], s0 offen offset:0 sc1 lds
  v_mfma_f32_16x16x32_bf16 a[52:55], a[148:151], v[204:207], a[52:55]
  s_waitcnt lgkmcnt(0)
  v_mfma_f32_16x16x32_bf16 a[24:27], a[152:155], v[200:203], a[24:27]
  buffer_load_dwordx4 v15, s[40:43], s0 offen offset:1024 sc1 lds
  s_add_u32 s0, s71, 57344
  v_mfma_f32_16x16x32_bf16 a[56:59], a[152:155], v[204:207], a[56:59]
  v_mfma_f32_16x16x32_bf16 a[28:31], a[156:159], v[200:203], a[28:31]
  buffer_load_dwordx4 v15, s[40:43], s0 offen offset:2048 sc1 lds
  v_mfma_f32_16x16x32_bf16 a[60:63], a[156:159], v[204:207], a[60:63]
  buffer_load_dwordx4 v15, s[40:43], s0 offen offset:3072 sc1 lds
  ds_read_b128 a[160:163], v61 offset:0
  ds_read_b128 a[164:167], v61 offset:1024
  ds_read_b128 a[168:171], v61 offset:2048
  ds_read_b128 a[172:175], v61 offset:3072
  ds_read_b128 a[176:179], v61 offset:4096
  ds_read_b128 a[180:183], v61 offset:5120
  ds_read_b128 a[184:187], v61 offset:6144
  ds_read_b128 a[188:191], v61 offset:7168
  ds_read_b128 a[128:131], v61 offset:8192
  ds_read_b128 a[132:135], v61 offset:9216
  ds_read_b128 a[136:139], v61 offset:10240
  ds_read_b128 a[140:143], v61 offset:11264
  v_mfma_f32_16x16x32_bf16 v[44:47], a[192:195], v[212:215], 0
  v_exp_f32 v32, v184
  v_exp_f32 v33, v185
  v_exp_f32 v34, v186
  v_exp_f32 v35, v187
  v_cvt_pk_bf16_f32 v220, v32, v33
  v_exp_f32 v36, v188
  v_exp_f32 v37, v189
  v_cvt_pk_bf16_f32 v221, v34, v35
  v_exp_f32 v38, v190
  v_exp_f32 v39, v191
  v_cvt_pk_bf16_f32 v222, v36, v37
  s_nop 0
  v_cvt_pk_bf16_f32 v223, v38, v39
  s_nop 1
  v_mfma_f32_16x16x32_bf16 v[44:47], a[192:195], v[220:223], v[44:47]
  s_nop 7
  v_mov_b32 v62, v44
  v_cmp_lt_f32 vcc, s3, v62
  s_cbranch_vccnz LrealF
LretF:
  s_waitcnt lgkmcnt(11)
  v_mfma_f32_16x16x32_bf16 a[32:35], a[160:163], v[212:215], a[32:35]
  s_add_u32 m0, s86, 49152
  ds_read_b128 a[144:147], v61 offset:12288
  ds_read_b128 a[148:151], v61 offset:13312
  s_waitcnt lgkmcnt(12)
  v_mfma_f32_16x16x32_bf16 a[36:39], a[164:167], v[212:215], a[36:39]
  s_add_u32 s0, s77, 131072
  ds_read_b128 a[152:155], v61 offset:14336
  ds_read_b128 a[156:159], v61 offset:15360
  s_waitcnt lgkmcnt(13)
  v_mfma_f32_16x16x32_bf16 a[40:43], a[168:171], v[212:215], a[40:43]
  buffer_load_dwordx4 v6, s[56:59], s0 offen offset:0 lds
  v_add_f32 v57, v57, v44
  s_waitcnt lgkmcnt(12)
  v_mfma_f32_16x16x32_bf16 a[44:47], a[172:175], v[212:215], a[44:47]
  s_waitcnt lgkmcnt(8)
  buffer_load_dwordx4 v7, s[56:59], s0 offen offset:1024 lds
  v_mfma_f32_16x16x32_bf16 a[48:51], a[176:179], v[212:215], a[48:51]
  buffer_load_dwordx4 v8, s[56:59], s0 offen offset:2048 lds
  v_mfma_f32_16x16x32_bf16 a[52:55], a[180:183], v[212:215], a[52:55]
  v_mfma_f32_16x16x32_bf16 a[56:59], a[184:187], v[212:215], a[56:59]
  buffer_load_dwordx4 v9, s[56:59], s0 offen offset:3072 lds
  v_mfma_f32_16x16x32_bf16 a[60:63], a[188:191], v[212:215], a[60:63]
  s_waitcnt lgkmcnt(4)
  v_mfma_f32_16x16x32_bf16 a[32:35], a[128:131], v[220:223], a[32:35]
  s_add_u32 m0, s86, 32768
  s_add_u32 s0, s71, 4096
  buffer_load_dwordx4 v15, s[40:43], s0 offen offset:0 sc1 lds
  v_mfma_f32_16x16x32_bf16 a[36:39], a[132:135], v[220:223], a[36:39]
  v_mfma_f32_16x16x32_bf16 a[40:43], a[136:139], v[220:223], a[40:43]
  buffer_load_dwordx4 v15, s[40:43], s0 offen offset:1024 sc1 lds
  v_mfma_f32_16x16x32_bf16 a[44:47], a[140:143], v[220:223], a[44:47]
  s_waitcnt lgkmcnt(0)
  v_mfma_f32_16x16x32_bf16 a[48:51], a[144:147], v[220:223], a[48:51]
  s_add_u32 s0, s71, 59392
  buffer_load_dwordx4 v15, s[40:43], s0 offen offset:2048 sc1 lds
  v_mfma_f32_16x16x32_bf16 a[52:55], a[148:151], v[220:223], a[52:55]
  v_mfma_f32_16x16x32_bf16 a[56:59], a[152:155], v[220:223], a[56:59]
  buffer_load_dwordx4 v15, s[40:43], s0 offen offset:3072 sc1 lds
  v_mfma_f32_16x16x32_bf16 a[60:63], a[156:159], v[220:223], a[60:63]
  s_lshl_b32 s75, s81, 3
  s_lshl_b32 s76, s69, 12
  s_add_u32 s75, s75, s76
  s_lshl_b32 s76, s33, 17
  s_add_u32 s76, s76, s75
  v_rcp_f32 v40, v56
  v_rcp_f32 v41, v56
  v_rcp_f32 v42, v57
  v_rcp_f32 v43, v57
  v_accvgpr_read_b32 v128, a0
  v_accvgpr_read_b32 v129, a1
  v_accvgpr_read_b32 v130, a2
  v_accvgpr_read_b32 v131, a3
  v_accvgpr_read_b32 v132, a4
  v_accvgpr_read_b32 v133, a5
  v_accvgpr_read_b32 v134, a6
  v_accvgpr_read_b32 v135, a7
  v_accvgpr_read_b32 v136, a8
  v_accvgpr_read_b32 v137, a9
  v_accvgpr_read_b32 v138, a10
  v_accvgpr_read_b32 v139, a11
  v_accvgpr_read_b32 v140, a12
  v_accvgpr_read_b32 v141, a13
  v_accvgpr_read_b32 v142, a14
  v_accvgpr_read_b32 v143, a15
  v_pk_mul_f32 v[128:129], v[128:129], v[40:41]
  v_pk_mul_f32 v[130:131], v[130:131], v[40:41]
  v_pk_mul_f32 v[132:133], v[132:133], v[40:41]
  v_pk_mul_f32 v[134:135], v[134:135], v[40:41]
  v_pk_mul_f32 v[136:137], v[136:137], v[40:41]
  v_pk_mul_f32 v[138:139], v[138:139], v[40:41]
  v_pk_mul_f32 v[140:141], v[140:141], v[40:41]
  v_pk_mul_f32 v[142:143], v[142:143], v[40:41]
  v_cvt_pk_bf16_f32 v128, v128, v129
  v_cvt_pk_bf16_f32 v129, v130, v131
  v_cvt_pk_bf16_f32 v130, v132, v133
  v_cvt_pk_bf16_f32 v131, v134, v135
  v_cvt_pk_bf16_f32 v132, v136, v137
  v_cvt_pk_bf16_f32 v133, v138, v139
  v_cvt_pk_bf16_f32 v134, v140, v141
  v_cvt_pk_bf16_f32 v135, v142, v143
  buffer_store_dwordx4 v[128:131], v15, s[44:47], s75 offen offset:0 sc1
  buffer_store_dwordx4 v[132:135], v15, s[44:47], s75 offen offset:1024 sc1
  v_accvgpr_read_b32 v144, a16
  v_accvgpr_read_b32 v145, a17
  v_accvgpr_read_b32 v146, a18
  v_accvgpr_read_b32 v147, a19
  v_accvgpr_read_b32 v148, a20
  v_accvgpr_read_b32 v149, a21
  v_accvgpr_read_b32 v150, a22
  v_accvgpr_read_b32 v151, a23
  v_accvgpr_read_b32 v152, a24
  v_accvgpr_read_b32 v153, a25
  v_accvgpr_read_b32 v154, a26
  v_accvgpr_read_b32 v155, a27
  v_accvgpr_read_b32 v156, a28
  v_accvgpr_read_b32 v157, a29
  v_accvgpr_read_b32 v158, a30
  v_accvgpr_read_b32 v159, a31
  v_pk_mul_f32 v[144:145], v[144:145], v[40:41]
  v_pk_mul_f32 v[146:147], v[146:147], v[40:41]
  v_pk_mul_f32 v[148:149], v[148:149], v[40:41]
  v_pk_mul_f32 v[150:151], v[150:151], v[40:41]
  v_pk_mul_f32 v[152:153], v[152:153], v[40:41]
  v_pk_mul_f32 v[154:155], v[154:155], v[40:41]
  v_pk_mul_f32 v[156:157], v[156:157], v[40:41]
  v_pk_mul_f32 v[158:159], v[158:159], v[40:41]
  v_cvt_pk_bf16_f32 v144, v144, v145
  v_cvt_pk_bf16_f32 v145, v146, v147
  v_cvt_pk_bf16_f32 v146, v148, v149
  v_cvt_pk_bf16_f32 v147, v150, v151
  v_cvt_pk_bf16_f32 v148, v152, v153
  v_cvt_pk_bf16_f32 v149, v154, v155
  v_cvt_pk_bf16_f32 v150, v156, v157
  v_cvt_pk_bf16_f32 v151, v158, v159
  buffer_store_dwordx4 v[144:147], v15, s[44:47], s75 offen offset:2048 sc1
  buffer_store_dwordx4 v[148:151], v15, s[44:47], s75 offen offset:3072 sc1
  v_accvgpr_read_b32 v160, a32
  v_accvgpr_read_b32 v161, a33
  v_accvgpr_read_b32 v162, a34
  v_accvgpr_read_b32 v163, a35
  v_accvgpr_read_b32 v164, a36
  v_accvgpr_read_b32 v165, a37
  v_accvgpr_read_b32 v166, a38
  v_accvgpr_read_b32 v167, a39
  v_accvgpr_read_b32 v168, a40
  v_accvgpr_read_b32 v169, a41
  v_accvgpr_read_b32 v170, a42
  v_accvgpr_read_b32 v171, a43
  v_accvgpr_read_b32 v172, a44
  v_accvgpr_read_b32 v173, a45
  v_accvgpr_read_b32 v174, a46
  v_accvgpr_read_b32 v175, a47
  v_pk_mul_f32 v[160:161], v[160:161], v[42:43]
  v_pk_mul_f32 v[162:163], v[162:163], v[42:43]
  v_pk_mul_f32 v[164:165], v[164:165], v[42:43]
  v_pk_mul_f32 v[166:167], v[166:167], v[42:43]
  v_pk_mul_f32 v[168:169], v[168:169], v[42:43]
  v_pk_mul_f32 v[170:171], v[170:171], v[42:43]
  v_pk_mul_f32 v[172:173], v[172:173], v[42:43]
  v_pk_mul_f32 v[174:175], v[174:175], v[42:43]
  v_cvt_pk_bf16_f32 v160, v160, v161
  v_cvt_pk_bf16_f32 v161, v162, v163
  v_cvt_pk_bf16_f32 v162, v164, v165
  v_cvt_pk_bf16_f32 v163, v166, v167
  v_cvt_pk_bf16_f32 v164, v168, v169
  v_cvt_pk_bf16_f32 v165, v170, v171
  v_cvt_pk_bf16_f32 v166, v172, v173
  v_cvt_pk_bf16_f32 v167, v174, v175
  buffer_store_dwordx4 v[160:163], v15, s[44:47], s76 offen offset:0 sc1
  buffer_store_dwordx4 v[164:167], v15, s[44:47], s76 offen offset:1024 sc1
  v_accvgpr_read_b32 v176, a48
  v_accvgpr_read_b32 v177, a49
  v_accvgpr_read_b32 v178, a50
  v_accvgpr_read_b32 v179, a51
  v_accvgpr_read_b32 v180, a52
  v_accvgpr_read_b32 v181, a53
  v_accvgpr_read_b32 v182, a54
  v_accvgpr_read_b32 v183, a55
  v_accvgpr_read_b32 v184, a56
  v_accvgpr_read_b32 v185, a57
  v_accvgpr_read_b32 v186, a58
  v_accvgpr_read_b32 v187, a59
  v_accvgpr_read_b32 v188, a60
  v_accvgpr_read_b32 v189, a61
  v_accvgpr_read_b32 v190, a62
  v_accvgpr_read_b32 v191, a63
  v_pk_mul_f32 v[176:177], v[176:177], v[42:43]
  v_pk_mul_f32 v[178:179], v[178:179], v[42:43]
  v_pk_mul_f32 v[180:181], v[180:181], v[42:43]
  v_pk_mul_f32 v[182:183], v[182:183], v[42:43]
  v_pk_mul_f32 v[184:185], v[184:185], v[42:43]
  v_pk_mul_f32 v[186:187], v[186:187], v[42:43]
  v_pk_mul_f32 v[188:189], v[188:189], v[42:43]
  v_pk_mul_f32 v[190:191], v[190:191], v[42:43]
  v_cvt_pk_bf16_f32 v176, v176, v177
  v_cvt_pk_bf16_f32 v177, v178, v179
  v_cvt_pk_bf16_f32 v178, v180, v181
  v_cvt_pk_bf16_f32 v179, v182, v183
  v_cvt_pk_bf16_f32 v180, v184, v185
  v_cvt_pk_bf16_f32 v181, v186, v187
  v_cvt_pk_bf16_f32 v182, v188, v189
  v_cvt_pk_bf16_f32 v183, v190, v191
  buffer_store_dwordx4 v[176:179], v15, s[44:47], s76 offen offset:2048 sc1
  buffer_store_dwordx4 v[180:183], v15, s[44:47], s76 offen offset:3072 sc1
L_D:
  s_waitcnt vmcnt(24)
  s_barrier
  ds_read_b64_tr_b16 v[96:97], v27 offset:0
  ds_read_b64_tr_b16 v[98:99], v27 offset:4096
  ds_read_b128 v[64:67], v26 offset:0
  ds_read_b128 v[68:71], v26 offset:2048
  ds_read_b128 v[72:75], v26 offset:4096
  ds_read_b128 v[76:79], v26 offset:6144
  ds_read_b64_tr_b16 v[100:101], v29 offset:0
  ds_read_b64_tr_b16 v[102:103], v29 offset:4096
  ds_read_b64_tr_b16 v[104:105], v27 offset:256
  ds_read_b64_tr_b16 v[106:107], v27 offset:4352
  ds_read_b64_tr_b16 v[108:109], v29 offset:256
  ds_read_b64_tr_b16 v[110:111], v29 offset:4352
  s_waitcnt lgkmcnt(9)
  v_mfma_f32_16x16x32_bf16 v[128:131], v[96:99], v[64:67], 0
  s_add_u32 m0, s86, 81920
  s_add_u32 s0, s77, 196608
  ds_read_b64_tr_b16 v[112:113], v27 offset:8192
  s_waitcnt lgkmcnt(9)
  v_mfma_f32_16x16x32_bf16 v[136:139], v[96:99], v[68:71], 0
  ds_read_b64_tr_b16 v[114:115], v27 offset:12288
  buffer_load_dwordx4 v6, s[56:59], s0 offen offset:0 lds
  s_waitcnt lgkmcnt(9)
  v_mfma_f32_16x16x32_bf16 v[160:163], v[96:99], v[72:75], 0
  ds_read_b128 v[80:83], v26 offset:1024
  s_waitcnt lgkmcnt(9)
  v_mfma_f32_16x16x32_bf16 v[168:171], v[96:99], v[76:79], 0
  ds_read_b128 v[84:87], v26 offset:3072
  buffer_load_dwordx4 v7, s[56:59], s0 offen offset:1024 lds
  s_waitcnt lgkmcnt(8)
  v_mfma_f32_16x16x32_bf16 v[132:135], v[100:103], v[64:67], 0
  ds_read_b128 v[88:91], v26 offset:5120
  v_mfma_f32_16x16x32_bf16 v[140:143], v[100:103], v[68:71], 0
  ds_read_b128 v[92:95], v26 offset:7168
  v_mfma_f32_16x16x32_bf16 v[164:167], v[100:103], v[72:75], 0
  ds_read_b64_tr_b16 v[116:117], v29 offset:8192
  buffer_load_dwordx4 v8, s[56:59], s0 offen offset:2048 lds
  v_mfma_f32_16x16x32_bf16 v[172:175], v[100:103], v[76:79], 0
  s_waitcnt lgkmcnt(7)
  ds_read_b64_tr_b16 v[118:119], v29 offset:12288
  v_mfma_f32_16x16x32_bf16 v[144:147], v[104:107], v[64:67], 0
  ds_read_b64_tr_b16 v[120:121], v27 offset:8448
  v_mfma_f32_16x16x32_bf16 v[152:155], v[104:107], v[68:71], 0
  ds_read_b64_tr_b16 v[122:123], v27 offset:12544
  buffer_load_dwordx4 v9, s[56:59], s0 offen offset:3072 lds
  v_mfma_f32_16x16x32_bf16 v[176:179], v[104:107], v[72:75], 0
  ds_read_b64_tr_b16 v[124:125], v29 offset:8448
  v_mfma_f32_16x16x32_bf16 v[184:187], v[104:107], v[76:79], 0
  ds_read_b64_tr_b16 v[126:127], v29 offset:12544
  v_mfma_f32_16x16x32_bf16 v[148:151], v[108:111], v[64:67], 0
  s_add_u32 m0, s86, 65536
  s_add_u32 s0, s71, 6144
  buffer_load_dwordx4 v15, s[40:43], s0 offen offset:0 sc1 lds
  v_mfma_f32_16x16x32_bf16 v[156:159], v[108:111], v[68:71], 0
  v_mfma_f32_16x16x32_bf16 v[180:183], v[108:111], v[72:75], 0
  v_mfma_f32_16x16x32_bf16 v[188:191], v[108:111], v[76:79], 0
  s_waitcnt lgkmcnt(4)
  s_waitcnt vmcnt(5)
  s_barrier
  v_mfma_f32_16x16x32_bf16 v[128:131], v[112:115], v[80:83], v[128:131]
  ds_read_b64_tr_b16 v[96:97], v2 offset:0
  buffer_load_dwordx4 v15, s[40:43], s0 offen offset:1024 sc1 lds
  v_mfma_f32_16x16x32_bf16 v[136:139], v[112:115], v[84:87], v[136:139]
  ds_read_b64_tr_b16 v[98:99], v2 offset:4096
  v_mfma_f32_16x16x32_bf16 v[160:163], v[112:115], v[88:91], v[160:163]
  s_add_u32 s0, s71, 61440
  ds_read_b128 v[64:67], v24 offset:0
  buffer_load_dwordx4 v15, s[40:43], s0 offen offset:2048 sc1 lds
  buffer_store_dword v52, v31, s[44:47], s88 offen sc1
  v_mfma_f32_16x16x32_bf16 v[168:171], v[112:115], v[92:95], v[168:171]
  ds_read_b128 v[68:71], v24 offset:2048
  v_mfma_f32_16x16x32_bf16 v[132:135], v[116:119], v[80:83], v[132:135]
  ds_read_b128 v[72:75], v24 offset:4096
  v_mfma_f32_16x16x32_bf16 v[140:143], v[116:119], v[84:87], v[140:143]
  ds_read_b128 v[76:79], v24 offset:6144
  buffer_load_dwordx4 v15, s[40:43], s0 offen offset:3072 sc1 lds
  v_mfma_f32_16x16x32_bf16 v[164:167], v[116:119], v[88:91], v[164:167]
  s_add_u32 m0, s86, 114688
  s_add_u32 s0, s77, 262144
  ds_read_b64_tr_b16 v[100:101], v3 offset:0
  v_mfma_f32_16x16x32_bf16 v[172:175], v[116:119], v[92:95], v[172:175]
  s_waitcnt lgkmcnt(7)
  ds_read_b64_tr_b16 v[102:103], v3 offset:4096
  buffer_load_dwordx4 v6, s[56:59], s0 offen offset:0 lds
  v_mfma_f32_16x16x32_bf16 v[144:147], v[120:123], v[80:83], v[144:147]
  ds_read_b64_tr_b16 v[104:105], v2 offset:256
  v_mfma_f32_16x16x32_bf16 v[152:155], v[120:123], v[84:87], v[152:155]
  ds_read_b64_tr_b16 v[106:107], v2 offset:4352
  buffer_load_dwordx4 v7, s[56:59], s0 offen offset:1024 lds
  v_mfma_f32_16x16x32_bf16 v[176:179], v[120:123], v[88:91], v[176:179]
  ds_read_b64_tr_b16 v[108:109], v3 offset:256
  v_mfma_f32_16x16x32_bf16 v[184:187], v[120:123], v[92:95], v[184:187]
  ds_read_b64_tr_b16 v[110:111], v3 offset:4352
  v_mfma_f32_16x16x32_bf16 v[148:151], v[124:127], v[80:83], v[148:151]
  buffer_load_dwordx4 v8, s[56:59], s0 offen offset:2048 lds
  v_mfma_f32_16x16x32_bf16 v[156:159], v[124:127], v[84:87], v[156:159]
  v_mfma_f32_16x16x32_bf16 v[180:183], v[124:127], v[88:91], v[180:183]
  v_mfma_f32_16x16x32_bf16 v[188:191], v[124:127], v[92:95], v[188:191]
  s_waitcnt lgkmcnt(4)
  buffer_load_dwordx4 v9, s[56:59], s0 offen offset:3072 lds
  v_mfma_f32_16x16x32_bf16 v[128:131], v[96:99], v[64:67], v[128:131]
  s_add_u32 m0, s86, 98304
  s_add_u32 s0, s71, 8192
  ds_read_b64_tr_b16 v[112:113], v2 offset:8192
  v_mfma_f32_16x16x32_bf16 v[136:139], v[96:99], v[68:71], v[136:139]
  ds_read_b64_tr_b16 v[114:115], v2 offset:12288
  buffer_load_dwordx4 v15, s[40:43], s0 offen offset:0 sc1 lds
  v_mfma_f32_16x16x32_bf16 v[160:163], v[96:99], v[72:75], v[160:163]
  ds_read_b128 v[80:83], v24 offset:1024
  v_mfma_f32_16x16x32_bf16 v[168:171], v[96:99], v[76:79], v[168:171]
  ds_read_b128 v[84:87], v24 offset:3072
  v_mfma_f32_16x16x32_bf16 v[132:135], v[100:103], v[64:67], v[132:135]
  ds_read_b128 v[88:91], v24 offset:5120
  buffer_load_dwordx4 v15, s[40:43], s0 offen offset:1024 sc1 lds
  v_mfma_f32_16x16x32_bf16 v[140:143], v[100:103], v[68:71], v[140:143]
  ds_read_b128 v[92:95], v24 offset:7168
  v_mfma_f32_16x16x32_bf16 v[164:167], v[100:103], v[72:75], v[164:167]
  ds_read_b64_tr_b16 v[116:117], v3 offset:8192
  v_mfma_f32_16x16x32_bf16 v[172:175], v[100:103], v[76:79], v[172:175]
  s_waitcnt lgkmcnt(7)
  ds_read_b64_tr_b16 v[118:119], v3 offset:12288
  v_mfma_f32_16x16x32_bf16 v[144:147], v[104:107], v[64:67], v[144:147]
  s_add_u32 s0, s71, 63488
  ds_read_b64_tr_b16 v[120:121], v2 offset:8448
  buffer_load_dwordx4 v15, s[40:43], s0 offen offset:2048 sc1 lds
  v_mfma_f32_16x16x32_bf16 v[152:155], v[104:107], v[68:71], v[152:155]
  ds_read_b64_tr_b16 v[122:123], v2 offset:12544
  v_mfma_f32_16x16x32_bf16 v[176:179], v[104:107], v[72:75], v[176:179]
  ds_read_b64_tr_b16 v[124:125], v3 offset:8448
  v_mfma_f32_16x16x32_bf16 v[184:187], v[104:107], v[76:79], v[184:187]
  ds_read_b64_tr_b16 v[126:127], v3 offset:12544
  v_mfma_f32_16x16x32_bf16 v[148:151], v[108:111], v[64:67], v[148:151]
  buffer_load_dwordx4 v15, s[40:43], s0 offen offset:3072 sc1 lds
  v_mfma_f32_16x16x32_bf16 v[156:159], v[108:111], v[68:71], v[156:159]
  v_mfma_f32_16x16x32_bf16 v[180:183], v[108:111], v[72:75], v[180:183]
  v_mfma_f32_16x16x32_bf16 v[188:191], v[108:111], v[76:79], v[188:191]
  s_waitcnt lgkmcnt(4)
  s_barrier
  v_mfma_f32_16x16x32_bf16 v[128:131], v[112:115], v[80:83], v[128:131]
  ds_read_b64_tr_b16 v[96:97], v2 offset:32768
  v_mfma_f32_16x16x32_bf16 v[136:139], v[112:115], v[84:87], v[136:139]
  s_add_u32 m0, s86, 147456
  s_add_u32 s0, s77, 327680
  ds_read_b64_tr_b16 v[98:99], v2 offset:36864
  v_mfma_f32_16x16x32_bf16 v[160:163], v[112:115], v[88:91], v[160:163]
  ds_read_b128 v[64:67], v24 offset:32768
  buffer_load_dwordx4 v6, s[56:59], s0 offen offset:0 lds
  v_mfma_f32_16x16x32_bf16 v[168:171], v[112:115], v[92:95], v[168:171]
  ds_read_b128 v[68:71], v24 offset:34816
  v_mfma_f32_16x16x32_bf16 v[132:135], v[116:119], v[80:83], v[132:135]
  ds_read_b128 v[72:75], v24 offset:36864
  v_mfma_f32_16x16x32_bf16 v[140:143], v[116:119], v[84:87], v[140:143]
  ds_read_b128 v[76:79], v24 offset:38912
  buffer_load_dwordx4 v7, s[56:59], s0 offen offset:1024 lds
  v_mfma_f32_16x16x32_bf16 v[164:167], v[116:119], v[88:91], v[164:167]
  ds_read_b64_tr_b16 v[100:101], v3 offset:32768
  v_mfma_f32_16x16x32_bf16 v[172:175], v[116:119], v[92:95], v[172:175]
  s_waitcnt lgkmcnt(7)
  ds_read_b64_tr_b16 v[102:103], v3 offset:36864
  v_mfma_f32_16x16x32_bf16 v[144:147], v[120:123], v[80:83], v[144:147]
  ds_read_b64_tr_b16 v[104:105], v2 offset:33024
  v_mfma_f32_16x16x32_bf16 v[152:155], v[120:123], v[84:87], v[152:155]
  ds_read_b64_tr_b16 v[106:107], v2 offset:37120
  buffer_load_dwordx4 v8, s[56:59], s0 offen offset:2048 lds
  v_mfma_f32_16x16x32_bf16 v[176:179], v[120:123], v[88:91], v[176:179]
  ds_read_b64_tr_b16 v[108:109], v3 offset:33024
  v_mfma_f32_16x16x32_bf16 v[184:187], v[120:123], v[92:95], v[184:187]
  ds_read_b64_tr_b16 v[110:111], v3 offset:37120
  v_mfma_f32_16x16x32_bf16 v[148:151], v[124:127], v[80:83], v[148:151]
  v_mfma_f32_16x16x32_bf16 v[156:159], v[124:127], v[84:87], v[156:159]
  buffer_load_dwordx4 v9, s[56:59], s0 offen offset:3072 lds
  v_mfma_f32_16x16x32_bf16 v[180:183], v[124:127], v[88:91], v[180:183]
  v_mfma_f32_16x16x32_bf16 v[188:191], v[124:127], v[92:95], v[188:191]
  s_waitcnt lgkmcnt(4)
  v_mfma_f32_16x16x32_bf16 v[128:131], v[96:99], v[64:67], v[128:131]
  s_add_u32 m0, s86, 131072
  s_add_u32 s0, s71, 10240
  ds_read_b64_tr_b16 v[112:113], v2 offset:40960
  v_mfma_f32_16x16x32_bf16 v[136:139], v[96:99], v[68:71], v[136:139]
  ds_read_b64_tr_b16 v[114:115], v2 offset:45056
  buffer_load_dwordx4 v15, s[40:43], s0 offen offset:0 sc1 lds
  v_mfma_f32_16x16x32_bf16 v[160:163], v[96:99], v[72:75], v[160:163]
  ds_read_b128 v[80:83], v24 offset:33792
  v_mfma_f32_16x16x32_bf16 v[168:171], v[96:99], v[76:79], v[168:171]
  ds_read_b128 v[84:87], v24 offset:35840
  v_mfma_f32_16x16x32_bf16 v[132:135], v[100:103], v[64:67], v[132:135]
  ds_read_b128 v[88:91], v24 offset:37888
  buffer_load_dwordx4 v15, s[40:43], s0 offen offset:1024 sc1 lds
  v_mfma_f32_16x16x32_bf16 v[140:143], v[100:103], v[68:71], v[140:143]
  ds_read_b128 v[92:95], v24 offset:39936
  v_mfma_f32_16x16x32_bf16 v[164:167], v[100:103], v[72:75], v[164:167]
  ds_read_b64_tr_b16 v[116:117], v3 offset:40960
  v_mfma_f32_16x16x32_bf16 v[172:175], v[100:103], v[76:79], v[172:175]
  s_waitcnt lgkmcnt(7)
  ds_read_b64_tr_b16 v[118:119], v3 offset:45056
  v_mfma_f32_16x16x32_bf16 v[144:147], v[104:107], v[64:67], v[144:147]
  s_add_u32 s0, s71, 65536
  ds_read_b64_tr_b16 v[120:121], v2 offset:41216
  buffer_load_dwordx4 v15, s[40:43], s0 offen offset:2048 sc1 lds
  v_mfma_f32_16x16x32_bf16 v[152:155], v[104:107], v[68:71], v[152:155]
  ds_read_b64_tr_b16 v[122:123], v2 offset:45312
  v_mfma_f32_16x16x32_bf16 v[176:179], v[104:107], v[72:75], v[176:179]
  ds_read_b64_tr_b16 v[124:125], v3 offset:41216
  v_mfma_f32_16x16x32_bf16 v[184:187], v[104:107], v[76:79], v[184:187]
  ds_read_b64_tr_b16 v[126:127], v3 offset:45312
  v_mfma_f32_16x16x32_bf16 v[148:151], v[108:111], v[64:67], v[148:151]
  buffer_load_dwordx4 v15, s[40:43], s0 offen offset:3072 sc1 lds
  v_mfma_f32_16x16x32_bf16 v[156:159], v[108:111], v[68:71], v[156:159]
  v_mfma_f32_16x16x32_bf16 v[180:183], v[108:111], v[72:75], v[180:183]
  v_mfma_f32_16x16x32_bf16 v[188:191], v[108:111], v[76:79], v[188:191]
  s_waitcnt lgkmcnt(4)
  s_waitcnt vmcnt(16)
  s_barrier
  v_mfma_f32_16x16x32_bf16 v[128:131], v[112:115], v[80:83], v[128:131]
  ds_read_b64_tr_b16 v[96:97], v4 offset:0
  v_mfma_f32_16x16x32_bf16 v[136:139], v[112:115], v[84:87], v[136:139]
  s_add_u32 m0, s86, 16384
  s_add_u32 s0, s77, 393216
  ds_read_b64_tr_b16 v[98:99], v4 offset:4096
  v_mfma_f32_16x16x32_bf16 v[160:163], v[112:115], v[88:91], v[160:163]
  ds_read_b128 v[64:67], v25 offset:0
  buffer_load_dwordx4 v6, s[56:59], s0 offen offset:0 lds
  v_mfma_f32_16x16x32_bf16 v[168:171], v[112:115], v[92:95], v[168:171]
  ds_read_b128 v[68:71], v25 offset:2048
  v_mfma_f32_16x16x32_bf16 v[132:135], v[116:119], v[80:83], v[132:135]
  ds_read_b128 v[72:75], v25 offset:4096
  v_mfma_f32_16x16x32_bf16 v[140:143], v[116:119], v[84:87], v[140:143]
  ds_read_b128 v[76:79], v25 offset:6144
  buffer_load_dwordx4 v7, s[56:59], s0 offen offset:1024 lds
  v_mfma_f32_16x16x32_bf16 v[164:167], v[116:119], v[88:91], v[164:167]
  ds_read_b64_tr_b16 v[100:101], v5 offset:0
  v_mfma_f32_16x16x32_bf16 v[172:175], v[116:119], v[92:95], v[172:175]
  s_waitcnt lgkmcnt(7)
  ds_read_b64_tr_b16 v[102:103], v5 offset:4096
  v_mfma_f32_16x16x32_bf16 v[144:147], v[120:123], v[80:83], v[144:147]
  ds_read_b64_tr_b16 v[104:105], v4 offset:256
  v_mfma_f32_16x16x32_bf16 v[152:155], v[120:123], v[84:87], v[152:155]
  ds_read_b64_tr_b16 v[106:107], v4 offset:4352
  buffer_load_dwordx4 v8, s[56:59], s0 offen offset:2048 lds
  v_mfma_f32_16x16x32_bf16 v[176:179], v[120:123], v[88:91], v[176:179]
  ds_read_b64_tr_b16 v[108:109], v5 offset:256
  v_mfma_f32_16x16x32_bf16 v[184:187], v[120:123], v[92:95], v[184:187]
  ds_read_b64_tr_b16 v[110:111], v5 offset:4352
  v_mfma_f32_16x16x32_bf16 v[148:151], v[124:127], v[80:83], v[148:151]
  v_mfma_f32_16x16x32_bf16 v[156:159], v[124:127], v[84:87], v[156:159]
  buffer_load_dwordx4 v9, s[56:59], s0 offen offset:3072 lds
  v_mfma_f32_16x16x32_bf16 v[180:183], v[124:127], v[88:91], v[180:183]
  v_mfma_f32_16x16x32_bf16 v[188:191], v[124:127], v[92:95], v[188:191]
  s_waitcnt lgkmcnt(4)
  v_mfma_f32_16x16x32_bf16 v[128:131], v[96:99], v[64:67], v[128:131]
  s_add_u32 m0, s86, 0
  s_add_u32 s0, s71, 12288
  ds_read_b64_tr_b16 v[112:113], v4 offset:8192
  v_mfma_f32_16x16x32_bf16 v[136:139], v[96:99], v[68:71], v[136:139]
  ds_read_b64_tr_b16 v[114:115], v4 offset:12288
  buffer_load_dwordx4 v15, s[40:43], s0 offen offset:0 sc1 lds
  v_mfma_f32_16x16x32_bf16 v[160:163], v[96:99], v[72:75], v[160:163]
  ds_read_b128 v[80:83], v25 offset:1024
  v_mfma_f32_16x16x32_bf16 v[168:171], v[96:99], v[76:79], v[168:171]
  ds_read_b128 v[84:87], v25 offset:3072
  v_mfma_f32_16x16x32_bf16 v[132:135], v[100:103], v[64:67], v[132:135]
  ds_read_b128 v[88:91], v25 offset:5120
  buffer_load_dwordx4 v15, s[40:43], s0 offen offset:1024 sc1 lds
  v_mfma_f32_16x16x32_bf16 v[140:143], v[100:103], v[68:71], v[140:143]
  ds_read_b128 v[92:95], v25 offset:7168
  v_mfma_f32_16x16x32_bf16 v[164:167], v[100:103], v[72:75], v[164:167]
  ds_read_b64_tr_b16 v[116:117], v5 offset:8192
  v_mfma_f32_16x16x32_bf16 v[172:175], v[100:103], v[76:79], v[172:175]
  s_waitcnt lgkmcnt(7)
  ds_read_b64_tr_b16 v[118:119], v5 offset:12288
  v_mfma_f32_16x16x32_bf16 v[144:147], v[104:107], v[64:67], v[144:147]
  s_add_u32 s0, s71, 67584
  ds_read_b64_tr_b16 v[120:121], v4 offset:8448
  buffer_load_dwordx4 v15, s[40:43], s0 offen offset:2048 sc1 lds
  v_mfma_f32_16x16x32_bf16 v[152:155], v[104:107], v[68:71], v[152:155]
  ds_read_b64_tr_b16 v[122:123], v4 offset:12544
  v_mfma_f32_16x16x32_bf16 v[176:179], v[104:107], v[72:75], v[176:179]
  ds_read_b64_tr_b16 v[124:125], v5 offset:8448
  v_mfma_f32_16x16x32_bf16 v[184:187], v[104:107], v[76:79], v[184:187]
  ds_read_b64_tr_b16 v[126:127], v5 offset:12544
  v_mfma_f32_16x16x32_bf16 v[148:151], v[108:111], v[64:67], v[148:151]
  buffer_load_dwordx4 v15, s[40:43], s0 offen offset:3072 sc1 lds
  v_mfma_f32_16x16x32_bf16 v[156:159], v[108:111], v[68:71], v[156:159]
  v_mfma_f32_16x16x32_bf16 v[180:183], v[108:111], v[72:75], v[180:183]
  v_mfma_f32_16x16x32_bf16 v[188:191], v[108:111], v[76:79], v[188:191]
  s_waitcnt lgkmcnt(4)
  s_waitcnt vmcnt(16)
  s_barrier
  v_mfma_f32_16x16x32_bf16 v[128:131], v[112:115], v[80:83], v[128:131]
  ds_read_b64_tr_b16 v[96:97], v4 offset:32768
  v_mfma_f32_16x16x32_bf16 v[136:139], v[112:115], v[84:87], v[136:139]
  s_add_u32 m0, s86, 49152
  s_add_u32 s0, s83, 0
  ds_read_b64_tr_b16 v[98:99], v4 offset:36864
  v_mfma_f32_16x16x32_bf16 v[160:163], v[112:115], v[88:91], v[160:163]
  ds_read_b128 v[64:67], v25 offset:32768
  buffer_load_dwordx4 v6, s[52:55], s0 offen offset:0 lds
  v_mfma_f32_16x16x32_bf16 v[168:171], v[112:115], v[92:95], v[168:171]
  ds_read_b128 v[68:71], v25 offset:34816
  v_mfma_f32_16x16x32_bf16 v[132:135], v[116:119], v[80:83], v[132:135]
  ds_read_b128 v[72:75], v25 offset:36864
  buffer_load_dword v49, v50, s[44:47], 0 offen sc1
  v_mfma_f32_16x16x32_bf16 v[140:143], v[116:119], v[84:87], v[140:143]
  ds_read_b128 v[76:79], v25 offset:38912
  v_mfma_f32_16x16x32_bf16 v[164:167], v[116:119], v[88:91], v[164:167]
  ds_read_b64_tr_b16 v[100:101], v5 offset:32768
  buffer_load_dwordx4 v7, s[52:55], s0 offen offset:1024 lds
  v_mfma_f32_16x16x32_bf16 v[172:175], v[116:119], v[92:95], v[172:175]
  s_waitcnt lgkmcnt(7)
  ds_read_b64_tr_b16 v[102:103], v5 offset:36864
  v_mfma_f32_16x16x32_bf16 v[144:147], v[120:123], v[80:83], v[144:147]
  ds_read_b64_tr_b16 v[104:105], v4 offset:33024
  v_mfma_f32_16x16x32_bf16 v[152:155], v[120:123], v[84:87], v[152:155]
  ds_read_b64_tr_b16 v[106:107], v4 offset:37120
  buffer_load_dwordx4 v8, s[52:55], s0 offen offset:2048 lds
  v_mfma_f32_16x16x32_bf16 v[176:179], v[120:123], v[88:91], v[176:179]
  ds_read_b64_tr_b16 v[108:109], v5 offset:33024
  v_mfma_f32_16x16x32_bf16 v[184:187], v[120:123], v[92:95], v[184:187]
  ds_read_b64_tr_b16 v[110:111], v5 offset:37120
  v_mfma_f32_16x16x32_bf16 v[148:151], v[124:127], v[80:83], v[148:151]
  v_mfma_f32_16x16x32_bf16 v[156:159], v[124:127], v[84:87], v[156:159]
  buffer_load_dwordx4 v9, s[52:55], s0 offen offset:3072 lds
  v_mfma_f32_16x16x32_bf16 v[180:183], v[124:127], v[88:91], v[180:183]
  v_mfma_f32_16x16x32_bf16 v[188:191], v[124:127], v[92:95], v[188:191]
  s_waitcnt lgkmcnt(4)
  v_mfma_f32_16x16x32_bf16 v[128:131], v[96:99], v[64:67], v[128:131]
  ds_read_b64_tr_b16 v[112:113], v4 offset:40960
  s_waitcnt vmcnt(3)
  v_cmp_ne_u32 vcc, v52, v49
  s_cbranch_vccnz Lspin13
Lback13:
  v_mfma_f32_16x16x32_bf16 v[136:139], v[96:99], v[68:71], v[136:139]
  s_add_u32 m0, s86, 32768
  s_add_u32 s0, s72, 0
  ds_read_b64_tr_b16 v[114:115], v4 offset:45056
  v_mfma_f32_16x16x32_bf16 v[160:163], v[96:99], v[72:75], v[160:163]
  ds_read_b128 v[80:83], v25 offset:33792
  buffer_load_dwordx4 v15, s[44:47], s0 offen offset:0 sc1 lds
  v_mfma_f32_16x16x32_bf16 v[168:171], v[96:99], v[76:79], v[168:171]
  ds_read_b128 v[84:87], v25 offset:35840
  v_mfma_f32_16x16x32_bf16 v[132:135], v[100:103], v[64:67], v[132:135]
  ds_read_b128 v[88:91], v25 offset:37888
  buffer_load_dwordx4 v15, s[44:47], s0 offen offset:1024 sc1 lds
  v_mfma_f32_16x16x32_bf16 v[140:143], v[100:103], v[68:71], v[140:143]
  ds_read_b128 v[92:95], v25 offset:39936
  v_mfma_f32_16x16x32_bf16 v[164:167], v[100:103], v[72:75], v[164:167]
  ds_read_b64_tr_b16 v[116:117], v5 offset:40960
  v_mfma_f32_16x16x32_bf16 v[172:175], v[100:103], v[76:79], v[172:175]
  s_waitcnt lgkmcnt(7)
  ds_read_b64_tr_b16 v[118:119], v5 offset:45056
  v_mfma_f32_16x16x32_bf16 v[144:147], v[104:107], v[64:67], v[144:147]
  s_add_u32 s0, s72, 129024
  ds_read_b64_tr_b16 v[120:121], v4 offset:41216
  buffer_load_dwordx4 v15, s[44:47], s0 offen offset:2048 sc1 lds
  v_mfma_f32_16x16x32_bf16 v[152:155], v[104:107], v[68:71], v[152:155]
  ds_read_b64_tr_b16 v[122:123], v4 offset:45312
  v_mfma_f32_16x16x32_bf16 v[176:179], v[104:107], v[72:75], v[176:179]
  ds_read_b64_tr_b16 v[124:125], v5 offset:41216
  v_mfma_f32_16x16x32_bf16 v[184:187], v[104:107], v[76:79], v[184:187]
  ds_read_b64_tr_b16 v[126:127], v5 offset:45312
  v_mfma_f32_16x16x32_bf16 v[148:151], v[108:111], v[64:67], v[148:151]
  buffer_load_dwordx4 v15, s[44:47], s0 offen offset:3072 sc1 lds
  v_mfma_f32_16x16x32_bf16 v[156:159], v[108:111], v[68:71], v[156:159]
  v_mfma_f32_16x16x32_bf16 v[180:183], v[108:111], v[72:75], v[180:183]
  v_mfma_f32_16x16x32_bf16 v[188:191], v[108:111], v[76:79], v[188:191]
  s_waitcnt lgkmcnt(4)
  s_barrier
  v_mfma_f32_16x16x32_bf16 v[128:131], v[112:115], v[80:83], v[128:131]
  ds_read_b64_tr_b16 v[96:97], v27 offset:0
  v_mfma_f32_16x16x32_bf16 v[136:139], v[112:115], v[84:87], v[136:139]
  s_add_u32 m0, s86, 81920
  s_add_u32 s0, s83, 65536
  ds_read_b64_tr_b16 v[98:99], v27 offset:4096
  v_mfma_f32_16x16x32_bf16 v[160:163], v[112:115], v[88:91], v[160:163]
  ds_read_b128 v[64:67], v26 offset:0
  buffer_load_dwordx4 v6, s[52:55], s0 offen offset:0 lds
  v_mfma_f32_16x16x32_bf16 v[168:171], v[112:115], v[92:95], v[168:171]
  ds_read_b128 v[68:71], v26 offset:2048
  v_mfma_f32_16x16x32_bf16 v[132:135], v[116:119], v[80:83], v[132:135]
  ds_read_b128 v[72:75], v26 offset:4096
  v_mfma_f32_16x16x32_bf16 v[140:143], v[116:119], v[84:87], v[140:143]
  ds_read_b128 v[76:79], v26 offset:6144
  buffer_load_dwordx4 v7, s[52:55], s0 offen offset:1024 lds
  v_mfma_f32_16x16x32_bf16 v[164:167], v[116:119], v[88:91], v[164:167]
  ds_read_b64_tr_b16 v[100:101], v29 offset:0
  v_mfma_f32_16x16x32_bf16 v[172:175], v[116:119], v[92:95], v[172:175]
  s_waitcnt lgkmcnt(7)
  ds_read_b64_tr_b16 v[102:103], v29 offset:4096
  v_mfma_f32_16x16x32_bf16 v[144:147], v[120:123], v[80:83], v[144:147]
  ds_read_b64_tr_b16 v[104:105], v27 offset:256
  v_mfma_f32_16x16x32_bf16 v[152:155], v[120:123], v[84:87], v[152:155]
  ds_read_b64_tr_b16 v[106:107], v27 offset:4352
  buffer_load_dwordx4 v8, s[52:55], s0 offen offset:2048 lds
  v_mfma_f32_16x16x32_bf16 v[176:179], v[120:123], v[88:91], v[176:179]
  ds_read_b64_tr_b16 v[108:109], v29 offset:256
  v_mfma_f32_16x16x32_bf16 v[184:187], v[120:123], v[92:95], v[184:187]
  ds_read_b64_tr_b16 v[110:111], v29 offset:4352
  v_mfma_f32_16x16x32_bf16 v[148:151], v[124:127], v[80:83], v[148:151]
  v_mfma_f32_16x16x32_bf16 v[156:159], v[124:127], v[84:87], v[156:159]
  buffer_load_dwordx4 v9, s[52:55], s0 offen offset:3072 lds
  v_mfma_f32_16x16x32_bf16 v[180:183], v[124:127], v[88:91], v[180:183]
  v_mfma_f32_16x16x32_bf16 v[188:191], v[124:127], v[92:95], v[188:191]
  s_waitcnt lgkmcnt(4)
  v_mfma_f32_16x16x32_bf16 v[128:131], v[96:99], v[64:67], v[128:131]
  s_add_u32 m0, s86, 65536
  s_add_u32 s0, s72, 2048
  ds_read_b64_tr_b16 v[112:113], v27 offset:8192
  v_mfma_f32_16x16x32_bf16 v[136:139], v[96:99], v[68:71], v[136:139]
  ds_read_b64_tr_b16 v[114:115], v27 offset:12288
  buffer_load_dwordx4 v15, s[44:47], s0 offen offset:0 sc1 lds
  v_mfma_f32_16x16x32_bf16 v[160:163], v[96:99], v[72:75], v[160:163]
  ds_read_b128 v[80:83], v26 offset:1024
  v_mfma_f32_16x16x32_bf16 v[168:171], v[96:99], v[76:79], v[168:171]
  ds_read_b128 v[84:87], v26 offset:3072
  v_mfma_f32_16x16x32_bf16 v[132:135], v[100:103], v[64:67], v[132:135]
  ds_read_b128 v[88:91], v26 offset:5120
  buffer_load_dwordx4 v15, s[44:47], s0 offen offset:1024 sc1 lds
  v_mfma_f32_16x16x32_bf16 v[140:143], v[100:103], v[68:71], v[140:143]
  ds_read_b128 v[92:95], v26 offset:7168
  v_mfma_f32_16x16x32_bf16 v[164:167], v[100:103], v[72:75], v[164:167]
  ds_read_b64_tr_b16 v[116:117], v29 offset:8192
  v_mfma_f32_16x16x32_bf16 v[172:175], v[100:103], v[76:79], v[172:175]
  s_waitcnt lgkmcnt(7)
  ds_read_b64_tr_b16 v[118:119], v29 offset:12288
  v_mfma_f32_16x16x32_bf16 v[144:147], v[104:107], v[64:67], v[144:147]
  s_add_u32 s0, s72, 131072
  ds_read_b64_tr_b16 v[120:121], v27 offset:8448
  buffer_load_dwordx4 v15, s[44:47], s0 offen offset:2048 sc1 lds
  v_mfma_f32_16x16x32_bf16 v[152:155], v[104:107], v[68:71], v[152:155]
  ds_read_b64_tr_b16 v[122:123], v27 offset:12544
  v_mfma_f32_16x16x32_bf16 v[176:179], v[104:107], v[72:75], v[176:179]
  ds_read_b64_tr_b16 v[124:125], v29 offset:8448
  v_mfma_f32_16x16x32_bf16 v[184:187], v[104:107], v[76:79], v[184:187]
  ds_read_b64_tr_b16 v[126:127], v29 offset:12544
  v_mfma_f32_16x16x32_bf16 v[148:151], v[108:111], v[64:67], v[148:151]
  buffer_load_dwordx4 v15, s[44:47], s0 offen offset:3072 sc1 lds
  v_mfma_f32_16x16x32_bf16 v[156:159], v[108:111], v[68:71], v[156:159]
  v_mfma_f32_16x16x32_bf16 v[180:183], v[108:111], v[72:75], v[180:183]
  v_mfma_f32_16x16x32_bf16 v[188:191], v[108:111], v[76:79], v[188:191]
  s_waitcnt lgkmcnt(4)
  s_barrier
  v_mfma_f32_16x16x32_bf16 v[128:131], v[112:115], v[80:83], v[128:131]
  ds_read_b64_tr_b16 v[96:97], v2 offset:0
  v_mfma_f32_16x16x32_bf16 v[136:139], v[112:115], v[84:87], v[136:139]
  s_add_u32 m0, s86, 114688
  s_add_u32 s0, s83, 131072
  ds_read_b64_tr_b16 v[98:99], v2 offset:4096
  v_mfma_f32_16x16x32_bf16 v[160:163], v[112:115], v[88:91], v[160:163]
  ds_read_b128 v[64:67], v24 offset:0
  buffer_load_dwordx4 v6, s[52:55], s0 offen offset:0 lds
  v_mfma_f32_16x16x32_bf16 v[168:171], v[112:115], v[92:95], v[168:171]
  ds_read_b128 v[68:71], v24 offset:2048
  v_mfma_f32_16x16x32_bf16 v[132:135], v[116:119], v[80:83], v[132:135]
  ds_read_b128 v[72:75], v24 offset:4096
  v_mfma_f32_16x16x32_bf16 v[140:143], v[116:119], v[84:87], v[140:143]
  ds_read_b128 v[76:79], v24 offset:6144
  buffer_load_dwordx4 v7, s[52:55], s0 offen offset:1024 lds
  v_mfma_f32_16x16x32_bf16 v[164:167], v[116:119], v[88:91], v[164:167]
  ds_read_b64_tr_b16 v[100:101], v3 offset:0
  v_mfma_f32_16x16x32_bf16 v[172:175], v[116:119], v[92:95], v[172:175]
  s_waitcnt lgkmcnt(7)
  ds_read_b64_tr_b16 v[102:103], v3 offset:4096
  v_mfma_f32_16x16x32_bf16 v[144:147], v[120:123], v[80:83], v[144:147]
  ds_read_b64_tr_b16 v[104:105], v2 offset:256
  v_mfma_f32_16x16x32_bf16 v[152:155], v[120:123], v[84:87], v[152:155]
  ds_read_b64_tr_b16 v[106:107], v2 offset:4352
  buffer_load_dwordx4 v8, s[52:55], s0 offen offset:2048 lds
  v_mfma_f32_16x16x32_bf16 v[176:179], v[120:123], v[88:91], v[176:179]
  ds_read_b64_tr_b16 v[108:109], v3 offset:256
  v_mfma_f32_16x16x32_bf16 v[184:187], v[120:123], v[92:95], v[184:187]
  ds_read_b64_tr_b16 v[110:111], v3 offset:4352
  v_mfma_f32_16x16x32_bf16 v[148:151], v[124:127], v[80:83], v[148:151]
  v_mfma_f32_16x16x32_bf16 v[156:159], v[124:127], v[84:87], v[156:159]
  buffer_load_dwordx4 v9, s[52:55], s0 offen offset:3072 lds
  v_mfma_f32_16x16x32_bf16 v[180:183], v[124:127], v[88:91], v[180:183]
  v_mfma_f32_16x16x32_bf16 v[188:191], v[124:127], v[92:95], v[188:191]
  s_waitcnt lgkmcnt(4)
  v_mfma_f32_16x16x32_bf16 v[128:131], v[96:99], v[64:67], v[128:131]
  s_add_u32 m0, s86, 98304
  s_add_u32 s0, s72, 4096
  ds_read_b64_tr_b16 v[112:113], v2 offset:8192
  v_mfma_f32_16x16x32_bf16 v[136:139], v[96:99], v[68:71], v[136:139]
  ds_read_b64_tr_b16 v[114:115], v2 offset:12288
  buffer_load_dwordx4 v15, s[44:47], s0 offen offset:0 sc1 lds
  v_mfma_f32_16x16x32_bf16 v[160:163], v[96:99], v[72:75], v[160:163]
  ds_read_b128 v[80:83], v24 offset:1024
  v_mfma_f32_16x16x32_bf16 v[168:171], v[96:99], v[76:79], v[168:171]
  ds_read_b128 v[84:87], v24 offset:3072
  v_mfma_f32_16x16x32_bf16 v[132:135], v[100:103], v[64:67], v[132:135]
  ds_read_b128 v[88:91], v24 offset:5120
  buffer_load_dwordx4 v15, s[44:47], s0 offen offset:1024 sc1 lds
  v_mfma_f32_16x16x32_bf16 v[140:143], v[100:103], v[68:71], v[140:143]
  ds_read_b128 v[92:95], v24 offset:7168
  v_mfma_f32_16x16x32_bf16 v[164:167], v[100:103], v[72:75], v[164:167]
  ds_read_b64_tr_b16 v[116:117], v3 offset:8192
  v_mfma_f32_16x16x32_bf16 v[172:175], v[100:103], v[76:79], v[172:175]
  s_waitcnt lgkmcnt(7)
  ds_read_b64_tr_b16 v[118:119], v3 offset:12288
  v_mfma_f32_16x16x32_bf16 v[144:147], v[104:107], v[64:67], v[144:147]
  s_add_u32 s0, s72, 133120
  ds_read_b64_tr_b16 v[120:121], v2 offset:8448
  buffer_load_dwordx4 v15, s[44:47], s0 offen offset:2048 sc1 lds
  v_mfma_f32_16x16x32_bf16 v[152:155], v[104:107], v[68:71], v[152:155]
  ds_read_b64_tr_b16 v[122:123], v2 offset:12544
  v_mfma_f32_16x16x32_bf16 v[176:179], v[104:107], v[72:75], v[176:179]
  ds_read_b64_tr_b16 v[124:125], v3 offset:8448
  v_mfma_f32_16x16x32_bf16 v[184:187], v[104:107], v[76:79], v[184:187]
  ds_read_b64_tr_b16 v[126:127], v3 offset:12544
  v_mfma_f32_16x16x32_bf16 v[148:151], v[108:111], v[64:67], v[148:151]
  buffer_load_dwordx4 v15, s[44:47], s0 offen offset:3072 sc1 lds
  v_mfma_f32_16x16x32_bf16 v[156:159], v[108:111], v[68:71], v[156:159]
  v_mfma_f32_16x16x32_bf16 v[180:183], v[108:111], v[72:75], v[180:183]
  v_mfma_f32_16x16x32_bf16 v[188:191], v[108:111], v[76:79], v[188:191]
  s_waitcnt lgkmcnt(4)
  s_waitcnt vmcnt(16)
  s_barrier
  v_mfma_f32_16x16x32_bf16 v[128:131], v[112:115], v[80:83], v[128:131]
  ds_read_b64_tr_b16 v[96:97], v2 offset:32768
  v_mfma_f32_16x16x32_bf16 v[136:139], v[112:115], v[84:87], v[136:139]
  s_add_u32 m0, s86, 147456
  s_add_u32 s0, s83, 196608
  ds_read_b64_tr_b16 v[98:99], v2 offset:36864
  v_mfma_f32_16x16x32_bf16 v[160:163], v[112:115], v[88:91], v[160:163]
  ds_read_b128 v[64:67], v24 offset:32768
  buffer_load_dwordx4 v6, s[52:55], s0 offen offset:0 lds
  v_mfma_f32_16x16x32_bf16 v[168:171], v[112:115], v[92:95], v[168:171]
  ds_read_b128 v[68:71], v24 offset:34816
  v_mfma_f32_16x16x32_bf16 v[132:135], v[116:119], v[80:83], v[132:135]
  ds_read_b128 v[72:75], v24 offset:36864
  v_mfma_f32_16x16x32_bf16 v[140:143], v[116:119], v[84:87], v[140:143]
  ds_read_b128 v[76:79], v24 offset:38912
  buffer_load_dwordx4 v7, s[52:55], s0 offen offset:1024 lds
  v_mfma_f32_16x16x32_bf16 v[164:167], v[116:119], v[88:91], v[164:167]
  ds_read_b64_tr_b16 v[100:101], v3 offset:32768
  v_mfma_f32_16x16x32_bf16 v[172:175], v[116:119], v[92:95], v[172:175]
  s_waitcnt lgkmcnt(7)
  ds_read_b64_tr_b16 v[102:103], v3 offset:36864
  v_mfma_f32_16x16x32_bf16 v[144:147], v[120:123], v[80:83], v[144:147]
  ds_read_b64_tr_b16 v[104:105], v2 offset:33024
  v_mfma_f32_16x16x32_bf16 v[152:155], v[120:123], v[84:87], v[152:155]
  ds_read_b64_tr_b16 v[106:107], v2 offset:37120
  buffer_load_dwordx4 v8, s[52:55], s0 offen offset:2048 lds
  v_mfma_f32_16x16x32_bf16 v[176:179], v[120:123], v[88:91], v[176:179]
  ds_read_b64_tr_b16 v[108:109], v3 offset:33024
  v_mfma_f32_16x16x32_bf16 v[184:187], v[120:123], v[92:95], v[184:187]
  ds_read_b64_tr_b16 v[110:111], v3 offset:37120
  v_mfma_f32_16x16x32_bf16 v[148:151], v[124:127], v[80:83], v[148:151]
  v_mfma_f32_16x16x32_bf16 v[156:159], v[124:127], v[84:87], v[156:159]
  buffer_load_dwordx4 v9, s[52:55], s0 offen offset:3072 lds
  v_mfma_f32_16x16x32_bf16 v[180:183], v[124:127], v[88:91], v[180:183]
  v_mfma_f32_16x16x32_bf16 v[188:191], v[124:127], v[92:95], v[188:191]
  s_waitcnt lgkmcnt(4)
  v_mfma_f32_16x16x32_bf16 v[192:195], v[96:99], v[64:67], 0
  s_add_u32 m0, s86, 131072
  s_add_u32 s0, s72, 6144
  ds_read_b64_tr_b16 v[112:113], v2 offset:40960
  v_mfma_f32_16x16x32_bf16 v[200:203], v[96:99], v[68:71], 0
  ds_read_b64_tr_b16 v[114:115], v2 offset:45056
  buffer_load_dwordx4 v15, s[44:47], s0 offen offset:0 sc1 lds
  v_mfma_f32_16x16x32_bf16 v[224:227], v[96:99], v[72:75], 0
  ds_read_b128 v[80:83], v24 offset:33792
  v_mfma_f32_16x16x32_bf16 v[232:235], v[96:99], v[76:79], 0
  ds_read_b128 v[84:87], v24 offset:35840
  v_mfma_f32_16x16x32_bf16 v[196:199], v[100:103], v[64:67], 0
  ds_read_b128 v[88:91], v24 offset:37888
  buffer_load_dwordx4 v15, s[44:47], s0 offen offset:1024 sc1 lds
  v_mfma_f32_16x16x32_bf16 v[204:207], v[100:103], v[68:71], 0
  ds_read_b128 v[92:95], v24 offset:39936
  v_mfma_f32_16x16x32_bf16 v[228:231], v[100:103], v[72:75], 0
  ds_read_b64_tr_b16 v[116:117], v3 offset:40960
  v_cvt_pk_bf16_f32 v144, v144, v145
  v_mfma_f32_16x16x32_bf16 v[236:239], v[100:103], v[76:79], 0
  s_waitcnt lgkmcnt(7)
  ds_read_b64_tr_b16 v[118:119], v3 offset:45056
  v_cvt_pk_bf16_f32 v145, v146, v147
  v_mfma_f32_16x16x32_bf16 v[208:211], v[104:107], v[64:67], 0
  s_add_u32 s0, s72, 135168
  ds_read_b64_tr_b16 v[120:121], v2 offset:41216
  buffer_load_dwordx4 v15, s[44:47], s0 offen offset:2048 sc1 lds
  v_mfma_f32_16x16x32_bf16 v[216:219], v[104:107], v[68:71], 0
  ds_read_b64_tr_b16 v[122:123], v2 offset:45312
  v_cvt_pk_bf16_f32 v146, v148, v149
  v_mfma_f32_16x16x32_bf16 v[240:243], v[104:107], v[72:75], 0
  ds_read_b64_tr_b16 v[124:125], v3 offset:41216
  v_cvt_pk_bf16_f32 v147, v150, v151
  v_mfma_f32_16x16x32_bf16 v[248:251], v[104:107], v[76:79], 0
  ds_read_b64_tr_b16 v[126:127], v3 offset:45312
  v_cvt_pk_bf16_f32 v148, v152, v153
  v_mfma_f32_16x16x32_bf16 v[212:215], v[108:111], v[64:67], 0
  buffer_load_dwordx4 v15, s[44:47], s0 offen offset:3072 sc1 lds
  v_cvt_pk_bf16_f32 v149, v154, v155
  v_mfma_f32_16x16x32_bf16 v[220:223], v[108:111], v[68:71], 0
  s_add_u32 s75, s79, 0x0
  v_cvt_pk_bf16_f32 v150, v156, v157
  v_cvt_pk_bf16_f32 v151, v158, v159
  v_mfma_f32_16x16x32_bf16 v[244:247], v[108:111], v[72:75], 0
  buffer_store_dwordx4 v[144:147], v15, s[44:47], s75 offen offset:2048 sc1
  v_mfma_f32_16x16x32_bf16 v[252:255], v[108:111], v[76:79], 0
  s_waitcnt lgkmcnt(4)
  s_waitcnt vmcnt(17)
  s_barrier
  v_mfma_f32_16x16x32_bf16 v[192:195], v[112:115], v[80:83], v[192:195]
  ds_read_b64_tr_b16 v[96:97], v4 offset:0
  v_mfma_f32_16x16x32_bf16 v[200:203], v[112:115], v[84:87], v[200:203]
  s_add_u32 m0, s86, 16384
  s_add_u32 s0, s83, 262144
  ds_read_b64_tr_b16 v[98:99], v4 offset:4096
  v_mfma_f32_16x16x32_bf16 v[224:227], v[112:115], v[88:91], v[224:227]
  ds_read_b128 v[64:67], v25 offset:0
  buffer_load_dwordx4 v6, s[52:55], s0 offen offset:0 lds
  v_mfma_f32_16x16x32_bf16 v[232:235], v[112:115], v[92:95], v[232:235]
  ds_read_b128 v[68:71], v25 offset:2048
  v_mfma_f32_16x16x32_bf16 v[196:199], v[116:119], v[80:83], v[196:199]
  ds_read_b128 v[72:75], v25 offset:4096
  v_mfma_f32_16x16x32_bf16 v[204:207], v[116:119], v[84:87], v[204:207]
  ds_read_b128 v[76:79], v25 offset:6144
  buffer_load_dwordx4 v7, s[52:55], s0 offen offset:1024 lds
  v_mfma_f32_16x16x32_bf16 v[228:231], v[116:119], v[88:91], v[228:231]
  ds_read_b64_tr_b16 v[100:101], v5 offset:0
  v_mfma_f32_16x16x32_bf16 v[236:239], v[116:119], v[92:95], v[236:239]
  s_waitcnt lgkmcnt(7)
  ds_read_b64_tr_b16 v[102:103], v5 offset:4096
  v_mfma_f32_16x16x32_bf16 v[208:211], v[120:123], v[80:83], v[208:211]
  ds_read_b64_tr_b16 v[104:105], v4 offset:256
  v_mfma_f32_16x16x32_bf16 v[216:219], v[120:123], v[84:87], v[216:219]
  ds_read_b64_tr_b16 v[106:107], v4 offset:4352
  buffer_load_dwordx4 v8, s[52:55], s0 offen offset:2048 lds
  v_mfma_f32_16x16x32_bf16 v[240:243], v[120:123], v[88:91], v[240:243]
  ds_read_b64_tr_b16 v[108:109], v5 offset:256
  v_mfma_f32_16x16x32_bf16 v[248:251], v[120:123], v[92:95], v[248:251]
  ds_read_b64_tr_b16 v[110:111], v5 offset:4352
  v_mfma_f32_16x16x32_bf16 v[212:215], v[124:127], v[80:83], v[212:215]
  v_mfma_f32_16x16x32_bf16 v[220:223], v[124:127], v[84:87], v[220:223]
  buffer_load_dwordx4 v9, s[52:55], s0 offen offset:3072 lds
  v_mfma_f32_16x16x32_bf16 v[244:247], v[124:127], v[88:91], v[244:247]
  v_mfma_f32_16x16x32_bf16 v[252:255], v[124:127], v[92:95], v[252:255]
  s_waitcnt lgkmcnt(4)
  buffer_store_dwordx4 v[148:151], v15, s[44:47], s75 offen offset:3072 sc1
  v_mfma_f32_16x16x32_bf16 v[192:195], v[96:99], v[64:67], v[192:195]
  s_add_u32 m0, s86, 0
  s_add_u32 s0, s72, 8192
  ds_read_b64_tr_b16 v[112:113], v4 offset:8192
  v_mfma_f32_16x16x32_bf16 v[200:203], v[96:99], v[68:71], v[200:203]
  s_lshl_b32 s71, s78, 9
  ds_read_b64_tr_b16 v[114:115], v4 offset:12288
  buffer_load_dwordx4 v15, s[44:47], s0 offen offset:0 sc1 lds
  v_mfma_f32_16x16x32_bf16 v[224:227], v[96:99], v[72:75], v[224:227]
  ds_read_b128 v[80:83], v25 offset:1024
  v_and_b32 v50, 3, v1
  v_mfma_f32_16x16x32_bf16 v[232:235], v[96:99], v[76:79], v[232:235]
  ds_read_b128 v[84:87], v25 offset:3072
  v_lshlrev_b32 v50, 7, v50
  v_mfma_f32_16x16x32_bf16 v[196:199], v[100:103], v[64:67], v[196:199]
  ds_read_b128 v[88:91], v25 offset:5120
  buffer_load_dwordx4 v15, s[44:47], s0 offen offset:1024 sc1 lds
  v_mfma_f32_16x16x32_bf16 v[204:207], v[100:103], v[68:71], v[204:207]
  ds_read_b128 v[92:95], v25 offset:7168
  v_add_u32 v50, s71, v50
  v_mfma_f32_16x16x32_bf16 v[228:231], v[100:103], v[72:75], v[228:231]
  s_lshl_b32 s88, s85, 7
  ds_read_b64_tr_b16 v[116:117], v5 offset:8192
  v_add_u32 v50, 0x1020000, v50
  v_mfma_f32_16x16x32_bf16 v[236:239], v[100:103], v[76:79], v[236:239]
  s_waitcnt lgkmcnt(7)
  s_add_u32 s88, s88, s71
  ds_read_b64_tr_b16 v[118:119], v5 offset:12288
  v_mfma_f32_16x16x32_bf16 v[208:211], v[104:107], v[64:67], v[208:211]
  s_add_u32 s0, s72, 137216
  ds_read_b64_tr_b16 v[120:121], v4 offset:8448
  buffer_load_dwordx4 v15, s[44:47], s0 offen offset:2048 sc1 lds
  v_mfma_f32_16x16x32_bf16 v[216:219], v[104:107], v[68:71], v[216:219]
  s_add_u32 s88, s88, 131072
  ds_read_b64_tr_b16 v[122:123], v4 offset:12544
  v_mfma_f32_16x16x32_bf16 v[240:243], v[104:107], v[72:75], v[240:243]
  ds_read_b64_tr_b16 v[124:125], v5 offset:8448
  v_mfma_f32_16x16x32_bf16 v[248:251], v[104:107], v[76:79], v[248:251]
  ds_read_b64_tr_b16 v[126:127], v5 offset:12544
  v_mfma_f32_16x16x32_bf16 v[212:215], v[108:111], v[64:67], v[212:215]
  buffer_load_dwordx4 v15, s[44:47], s0 offen offset:3072 sc1 lds
  v_mfma_f32_16x16x32_bf16 v[220:223], v[108:111], v[68:71], v[220:223]
  v_mfma_f32_16x16x32_bf16 v[244:247], v[108:111], v[72:75], v[244:247]
  v_mfma_f32_16x16x32_bf16 v[252:255], v[108:111], v[76:79], v[252:255]
  s_waitcnt lgkmcnt(4)
  s_waitcnt vmcnt(18)
  s_barrier
  v_mfma_f32_16x16x32_bf16 v[192:195], v[112:115], v[80:83], v[192:195]
  ds_read_b64_tr_b16 v[96:97], v4 offset:32768
  v_mfma_f32_16x16x32_bf16 v[200:203], v[112:115], v[84:87], v[200:203]
  s_add_u32 m0, s86, 49152
  s_add_u32 s0, s83, 327680
  ds_read_b64_tr_b16 v[98:99], v4 offset:36864
  v_mfma_f32_16x16x32_bf16 v[224:227], v[112:115], v[88:91], v[224:227]
  ds_read_b128 v[64:67], v25 offset:32768
  buffer_load_dwordx4 v6, s[52:55], s0 offen offset:0 lds
  v_mfma_f32_16x16x32_bf16 v[232:235], v[112:115], v[92:95], v[232:235]
  ds_read_b128 v[68:71], v25 offset:34816
  v_mfma_f32_16x16x32_bf16 v[196:199], v[116:119], v[80:83], v[196:199]
  ds_read_b128 v[72:75], v25 offset:36864
  v_mfma_f32_16x16x32_bf16 v[204:207], v[116:119], v[84:87], v[204:207]
  ds_read_b128 v[76:79], v25 offset:38912
  buffer_load_dwordx4 v7, s[52:55], s0 offen offset:1024 lds
  v_mfma_f32_16x16x32_bf16 v[228:231], v[116:119], v[88:91], v[228:231]
  ds_read_b64_tr_b16 v[100:101], v5 offset:32768
  v_cvt_pk_bf16_f32 v160, v160, v161
  v_mfma_f32_16x16x32_bf16 v[236:239], v[116:119], v[92:95], v[236:239]
  s_waitcnt lgkmcnt(7)
  ds_read_b64_tr_b16 v[102:103], v5 offset:36864
  v_cvt_pk_bf16_f32 v161, v162, v163
  v_mfma_f32_16x16x32_bf16 v[208:211], v[120:123], v[80:83], v[208:211]
  ds_read_b64_tr_b16 v[104:105], v4 offset:33024
  v_cvt_pk_bf16_f32 v162, v164, v165
  v_mfma_f32_16x16x32_bf16 v[216:219], v[120:123], v[84:87], v[216:219]
  ds_read_b64_tr_b16 v[106:107], v4 offset:37120
  buffer_load_dwordx4 v8, s[52:55], s0 offen offset:2048 lds
  v_mfma_f32_16x16x32_bf16 v[240:243], v[120:123], v[88:91], v[240:243]
  ds_read_b64_tr_b16 v[108:109], v5 offset:33024
  v_cvt_pk_bf16_f32 v163, v166, v167
  v_mfma_f32_16x16x32_bf16 v[248:251], v[120:123], v[92:95], v[248:251]
  ds_read_b64_tr_b16 v[110:111], v5 offset:37120
  v_cvt_pk_bf16_f32 v164, v168, v169
  v_mfma_f32_16x16x32_bf16 v[212:215], v[124:127], v[80:83], v[212:215]
  v_cvt_pk_bf16_f32 v165, v170, v171
  v_cvt_pk_bf16_f32 v166, v172, v173
  v_mfma_f32_16x16x32_bf16 v[220:223], v[124:127], v[84:87], v[220:223]
  s_add_u32 s75, s79, 0x1000
  buffer_load_dwordx4 v9, s[52:55], s0 offen offset:3072 lds
  v_cvt_pk_bf16_f32 v167, v174, v175
  v_mfma_f32_16x16x32_bf16 v[244:247], v[124:127], v[88:91], v[244:247]
  v_mfma_f32_16x16x32_bf16 v[252:255], v[124:127], v[92:95], v[252:255]
  s_waitcnt lgkmcnt(4)
  buffer_store_dwordx4 v[160:163], v15, s[44:47], s75 offen offset:0 sc1
  v_mfma_f32_16x16x32_bf16 v[192:195], v[96:99], v[64:67], v[192:195]
  s_add_u32 m0, s86, 32768
  s_add_u32 s0, s72, 10240
  ds_read_b64_tr_b16 v[112:113], v4 offset:40960
  v_mfma_f32_16x16x32_bf16 v[200:203], v[96:99], v[68:71], v[200:203]
  ds_read_b64_tr_b16 v[114:115], v4 offset:45056
  buffer_load_dwordx4 v15, s[44:47], s0 offen offset:0 sc1 lds
  v_mfma_f32_16x16x32_bf16 v[224:227], v[96:99], v[72:75], v[224:227]
  ds_read_b128 v[80:83], v25 offset:33792
  v_mfma_f32_16x16x32_bf16 v[232:235], v[96:99], v[76:79], v[232:235]
  ds_read_b128 v[84:87], v25 offset:35840
  v_mfma_f32_16x16x32_bf16 v[196:199], v[100:103], v[64:67], v[196:199]
  ds_read_b128 v[88:91], v25 offset:37888
  buffer_load_dwordx4 v15, s[44:47], s0 offen offset:1024 sc1 lds
  v_mfma_f32_16x16x32_bf16 v[204:207], v[100:103], v[68:71], v[204:207]
  ds_read_b128 v[92:95], v25 offset:39936
  v_mfma_f32_16x16x32_bf16 v[228:231], v[100:103], v[72:75], v[228:231]
  ds_read_b64_tr_b16 v[116:117], v5 offset:40960
  v_mfma_f32_16x16x32_bf16 v[236:239], v[100:103], v[76:79], v[236:239]
  s_waitcnt lgkmcnt(7)
  ds_read_b64_tr_b16 v[118:119], v5 offset:45056
  v_mfma_f32_16x16x32_bf16 v[208:211], v[104:107], v[64:67], v[208:211]
  s_add_u32 s0, s72, 139264
  ds_read_b64_tr_b16 v[120:121], v4 offset:41216
  buffer_load_dwordx4 v15, s[44:47], s0 offen offset:2048 sc1 lds
  v_mfma_f32_16x16x32_bf16 v[216:219], v[104:107], v[68:71], v[216:219]
  ds_read_b64_tr_b16 v[122:123], v4 offset:45312
  v_mfma_f32_16x16x32_bf16 v[240:243], v[104:107], v[72:75], v[240:243]
  ds_read_b64_tr_b16 v[124:125], v5 offset:41216
  v_mfma_f32_16x16x32_bf16 v[248:251], v[104:107], v[76:79], v[248:251]
  ds_read_b64_tr_b16 v[126:127], v5 offset:45312
  v_mfma_f32_16x16x32_bf16 v[212:215], v[108:111], v[64:67], v[212:215]
  buffer_load_dwordx4 v15, s[44:47], s0 offen offset:3072 sc1 lds
  v_mfma_f32_16x16x32_bf16 v[220:223], v[108:111], v[68:71], v[220:223]
  v_mfma_f32_16x16x32_bf16 v[244:247], v[108:111], v[72:75], v[244:247]
  buffer_store_dwordx4 v[164:167], v15, s[44:47], s75 offen offset:1024 sc1
  v_mfma_f32_16x16x32_bf16 v[252:255], v[108:111], v[76:79], v[252:255]
  s_waitcnt lgkmcnt(4)
  s_waitcnt vmcnt(20)
  s_barrier
  v_mfma_f32_16x16x32_bf16 v[192:195], v[112:115], v[80:83], v[192:195]
  ds_read_b64_tr_b16 v[96:97], v27 offset:0
  v_mfma_f32_16x16x32_bf16 v[200:203], v[112:115], v[84:87], v[200:203]
  s_add_u32 m0, s86, 81920
  s_add_u32 s0, s83, 393216
  ds_read_b64_tr_b16 v[98:99], v27 offset:4096
  v_mfma_f32_16x16x32_bf16 v[224:227], v[112:115], v[88:91], v[224:227]
  ds_read_b128 v[64:67], v26 offset:0
  buffer_load_dwordx4 v6, s[52:55], s0 offen offset:0 lds
  v_mfma_f32_16x16x32_bf16 v[232:235], v[112:115], v[92:95], v[232:235]
  ds_read_b128 v[68:71], v26 offset:2048
  v_mfma_f32_16x16x32_bf16 v[196:199], v[116:119], v[80:83], v[196:199]
  ds_read_b128 v[72:75], v26 offset:4096
  v_mfma_f32_16x16x32_bf16 v[204:207], v[116:119], v[84:87], v[204:207]
  ds_read_b128 v[76:79], v26 offset:6144
  buffer_load_dwordx4 v7, s[52:55], s0 offen offset:1024 lds
  v_mfma_f32_16x16x32_bf16 v[228:231], v[116:119], v[88:91], v[228:231]
  ds_read_b64_tr_b16 v[100:101], v29 offset:0
  v_mfma_f32_16x16x32_bf16 v[236:239], v[116:119], v[92:95], v[236:239]
  s_waitcnt lgkmcnt(7)
  ds_read_b64_tr_b16 v[102:103], v29 offset:4096
  v_mfma_f32_16x16x32_bf16 v[208:211], v[120:123], v[80:83], v[208:211]
  ds_read_b64_tr_b16 v[104:105], v27 offset:256
  v_mfma_f32_16x16x32_bf16 v[216:219], v[120:123], v[84:87], v[216:219]
  ds_read_b64_tr_b16 v[106:107], v27 offset:4352
  buffer_load_dwordx4 v8, s[52:55], s0 offen offset:2048 lds
  v_mfma_f32_16x16x32_bf16 v[240:243], v[120:123], v[88:91], v[240:243]
  ds_read_b64_tr_b16 v[108:109], v29 offset:256
  v_mfma_f32_16x16x32_bf16 v[248:251], v[120:123], v[92:95], v[248:251]
  ds_read_b64_tr_b16 v[110:111], v29 offset:4352
  v_mfma_f32_16x16x32_bf16 v[212:215], v[124:127], v[80:83], v[212:215]
  v_mfma_f32_16x16x32_bf16 v[220:223], v[124:127], v[84:87], v[220:223]
  buffer_load_dwordx4 v9, s[52:55], s0 offen offset:3072 lds
  v_mfma_f32_16x16x32_bf16 v[244:247], v[124:127], v[88:91], v[244:247]
  v_mfma_f32_16x16x32_bf16 v[252:255], v[124:127], v[92:95], v[252:255]
  s_waitcnt lgkmcnt(4)
  v_mfma_f32_16x16x32_bf16 v[192:195], v[96:99], v[64:67], v[192:195]
  s_add_u32 m0, s86, 65536
  s_add_u32 s0, s72, 12288
  ds_read_b64_tr_b16 v[112:113], v27 offset:8192
  v_mfma_f32_16x16x32_bf16 v[200:203], v[96:99], v[68:71], v[200:203]
  ds_read_b64_tr_b16 v[114:115], v27 offset:12288
  buffer_load_dwordx4 v15, s[44:47], s0 offen offset:0 sc1 lds
  v_mfma_f32_16x16x32_bf16 v[224:227], v[96:99], v[72:75], v[224:227]
  ds_read_b128 v[80:83], v26 offset:1024
  v_mfma_f32_16x16x32_bf16 v[232:235], v[96:99], v[76:79], v[232:235]
  ds_read_b128 v[84:87], v26 offset:3072
  v_mfma_f32_16x16x32_bf16 v[196:199], v[100:103], v[64:67], v[196:199]
  ds_read_b128 v[88:91], v26 offset:5120
  buffer_load_dwordx4 v15, s[44:47], s0 offen offset:1024 sc1 lds
  v_mfma_f32_16x16x32_bf16 v[204:207], v[100:103], v[68:71], v[204:207]
  ds_read_b128 v[92:95], v26 offset:7168
  v_mfma_f32_16x16x32_bf16 v[228:231], v[100:103], v[72:75], v[228:231]
  ds_read_b64_tr_b16 v[116:117], v29 offset:8192
  v_cvt_pk_bf16_f32 v176, v176, v177
  v_mfma_f32_16x16x32_bf16 v[236:239], v[100:103], v[76:79], v[236:239]
  s_waitcnt lgkmcnt(7)
  ds_read_b64_tr_b16 v[118:119], v29 offset:12288
  v_cvt_pk_bf16_f32 v177, v178, v179
  v_mfma_f32_16x16x32_bf16 v[208:211], v[104:107], v[64:67], v[208:211]
  s_add_u32 s0, s72, 141312
  ds_read_b64_tr_b16 v[120:121], v27 offset:8448
  buffer_load_dwordx4 v15, s[44:47], s0 offen offset:2048 sc1 lds
  v_mfma_f32_16x16x32_bf16 v[216:219], v[104:107], v[68:71], v[216:219]
  ds_read_b64_tr_b16 v[122:123], v27 offset:12544
  v_cvt_pk_bf16_f32 v178, v180, v181
  v_mfma_f32_16x16x32_bf16 v[240:243], v[104:107], v[72:75], v[240:243]
  ds_read_b64_tr_b16 v[124:125], v29 offset:8448
  v_cvt_pk_bf16_f32 v179, v182, v183
  v_mfma_f32_16x16x32_bf16 v[248:251], v[104:107], v[76:79], v[248:251]
  ds_read_b64_tr_b16 v[126:127], v29 offset:12544
  v_cvt_pk_bf16_f32 v180, v184, v185
  v_mfma_f32_16x16x32_bf16 v[212:215], v[108:111], v[64:67], v[212:215]
  buffer_load_dwordx4 v15, s[44:47], s0 offen offset:3072 sc1 lds
  v_cvt_pk_bf16_f32 v181, v186, v187
  v_mfma_f32_16x16x32_bf16 v[220:223], v[108:111], v[68:71], v[220:223]
  v_cvt_pk_bf16_f32 v182, v188, v189
  v_cvt_pk_bf16_f32 v183, v190, v191
  v_mfma_f32_16x16x32_bf16 v[244:247], v[108:111], v[72:75], v[244:247]
  buffer_store_dwordx4 v[176:179], v15, s[44:47], s75 offen offset:2048 sc1
  v_mfma_f32_16x16x32_bf16 v[252:255], v[108:111], v[76:79], v[252:255]
  s_waitcnt lgkmcnt(4)
  s_waitcnt vmcnt(19)
  s_barrier
  v_mfma_f32_16x16x32_bf16 v[192:195], v[112:115], v[80:83], v[192:195]
  ds_read_b64_tr_b16 v[96:97], v2 offset:0
  v_mfma_f32_16x16x32_bf16 v[200:203], v[112:115], v[84:87], v[200:203]
  s_add_u32 m0, s86, 114688
  s_add_u32 s0, s83, 458752
  ds_read_b64_tr_b16 v[98:99], v2 offset:4096
  v_mfma_f32_16x16x32_bf16 v[224:227], v[112:115], v[88:91], v[224:227]
  ds_read_b128 v[64:67], v24 offset:0
  buffer_load_dwordx4 v6, s[52:55], s0 offen offset:0 lds
  v_mfma_f32_16x16x32_bf16 v[232:235], v[112:115], v[92:95], v[232:235]
  ds_read_b128 v[68:71], v24 offset:2048
  v_mfma_f32_16x16x32_bf16 v[196:199], v[116:119], v[80:83], v[196:199]
  ds_read_b128 v[72:75], v24 offset:4096
  v_mfma_f32_16x16x32_bf16 v[204:207], v[116:119], v[84:87], v[204:207]
  ds_read_b128 v[76:79], v24 offset:6144
  buffer_load_dwordx4 v7, s[52:55], s0 offen offset:1024 lds
  v_mfma_f32_16x16x32_bf16 v[228:231], v[116:119], v[88:91], v[228:231]
  ds_read_b64_tr_b16 v[100:101], v3 offset:0
  v_mfma_f32_16x16x32_bf16 v[236:239], v[116:119], v[92:95], v[236:239]
  s_waitcnt lgkmcnt(7)
  ds_read_b64_tr_b16 v[102:103], v3 offset:4096
  v_mfma_f32_16x16x32_bf16 v[208:211], v[120:123], v[80:83], v[208:211]
  ds_read_b64_tr_b16 v[104:105], v2 offset:256
  v_mfma_f32_16x16x32_bf16 v[216:219], v[120:123], v[84:87], v[216:219]
  ds_read_b64_tr_b16 v[106:107], v2 offset:4352
  buffer_load_dwordx4 v8, s[52:55], s0 offen offset:2048 lds
  v_mfma_f32_16x16x32_bf16 v[240:243], v[120:123], v[88:91], v[240:243]
  ds_read_b64_tr_b16 v[108:109], v3 offset:256
  v_mfma_f32_16x16x32_bf16 v[248:251], v[120:123], v[92:95], v[248:251]
  ds_read_b64_tr_b16 v[110:111], v3 offset:4352
  v_mfma_f32_16x16x32_bf16 v[212:215], v[124:127], v[80:83], v[212:215]
  v_mfma_f32_16x16x32_bf16 v[220:223], v[124:127], v[84:87], v[220:223]
  buffer_load_dwordx4 v9, s[52:55], s0 offen offset:3072 lds
  v_mfma_f32_16x16x32_bf16 v[244:247], v[124:127], v[88:91], v[244:247]
  v_mfma_f32_16x16x32_bf16 v[252:255], v[124:127], v[92:95], v[252:255]
  s_waitcnt lgkmcnt(4)
  buffer_store_dwordx4 v[180:183], v15, s[44:47], s75 offen offset:3072 sc1
  v_mfma_f32_16x16x32_bf16 v[192:195], v[96:99], v[64:67], v[192:195]
  s_add_u32 m0, s86, 98304
  s_add_u32 s0, s72, 14336
  ds_read_b64_tr_b16 v[112:113], v2 offset:8192
  v_mfma_f32_16x16x32_bf16 v[200:203], v[96:99], v[68:71], v[200:203]
  ds_read_b64_tr_b16 v[114:115], v2 offset:12288
  buffer_load_dwordx4 v15, s[44:47], s0 offen offset:0 sc1 lds
  v_mfma_f32_16x16x32_bf16 v[224:227], v[96:99], v[72:75], v[224:227]
  ds_read_b128 v[80:83], v24 offset:1024
  v_mfma_f32_16x16x32_bf16 v[232:235], v[96:99], v[76:79], v[232:235]
  ds_read_b128 v[84:87], v24 offset:3072
  v_mfma_f32_16x16x32_bf16 v[196:199], v[100:103], v[64:67], v[196:199]
  ds_read_b128 v[88:91], v24 offset:5120
  buffer_load_dwordx4 v15, s[44:47], s0 offen offset:1024 sc1 lds
  v_mfma_f32_16x16x32_bf16 v[204:207], v[100:103], v[68:71], v[204:207]
  ds_read_b128 v[92:95], v24 offset:7168
  v_mfma_f32_16x16x32_bf16 v[228:231], v[100:103], v[72:75], v[228:231]
  ds_read_b64_tr_b16 v[116:117], v3 offset:8192
  v_mfma_f32_16x16x32_bf16 v[236:239], v[100:103], v[76:79], v[236:239]
  s_waitcnt lgkmcnt(7)
  ds_read_b64_tr_b16 v[118:119], v3 offset:12288
  v_mfma_f32_16x16x32_bf16 v[208:211], v[104:107], v[64:67], v[208:211]
  s_add_u32 s0, s72, 143360
  ds_read_b64_tr_b16 v[120:121], v2 offset:8448
  buffer_load_dwordx4 v15, s[44:47], s0 offen offset:2048 sc1 lds
  v_mfma_f32_16x16x32_bf16 v[216:219], v[104:107], v[68:71], v[216:219]
  ds_read_b64_tr_b16 v[122:123], v2 offset:12544
  v_mfma_f32_16x16x32_bf16 v[240:243], v[104:107], v[72:75], v[240:243]
  ds_read_b64_tr_b16 v[124:125], v3 offset:8448
  v_mfma_f32_16x16x32_bf16 v[248:251], v[104:107], v[76:79], v[248:251]
  ds_read_b64_tr_b16 v[126:127], v3 offset:12544
  v_mfma_f32_16x16x32_bf16 v[212:215], v[108:111], v[64:67], v[212:215]
  buffer_load_dwordx4 v15, s[44:47], s0 offen offset:3072 sc1 lds
  v_mfma_f32_16x16x32_bf16 v[220:223], v[108:111], v[68:71], v[220:223]
  v_mfma_f32_16x16x32_bf16 v[244:247], v[108:111], v[72:75], v[244:247]
  v_mfma_f32_16x16x32_bf16 v[252:255], v[108:111], v[76:79], v[252:255]
  s_waitcnt lgkmcnt(4)
  s_waitcnt vmcnt(19)
  s_barrier
  v_mfma_f32_16x16x32_bf16 v[192:195], v[112:115], v[80:83], v[192:195]
  ds_read_b64_tr_b16 v[96:97], v2 offset:32768
  v_mfma_f32_16x16x32_bf16 v[200:203], v[112:115], v[84:87], v[200:203]
  s_add_u32 m0, s86, 147456
  s_add_u32 s0, s83, 524288
  ds_read_b64_tr_b16 v[98:99], v2 offset:36864
  v_mfma_f32_16x16x32_bf16 v[224:227], v[112:115], v[88:91], v[224:227]
  ds_read_b128 v[64:67], v24 offset:32768
  buffer_load_dwordx4 v6, s[52:55], s0 offen offset:0 lds
  v_mfma_f32_16x16x32_bf16 v[232:235], v[112:115], v[92:95], v[232:235]
  ds_read_b128 v[68:71], v24 offset:34816
  v_mfma_f32_16x16x32_bf16 v[196:199], v[116:119], v[80:83], v[196:199]
  ds_read_b128 v[72:75], v24 offset:36864
  v_mfma_f32_16x16x32_bf16 v[204:207], v[116:119], v[84:87], v[204:207]
  ds_read_b128 v[76:79], v24 offset:38912
  buffer_load_dwordx4 v7, s[52:55], s0 offen offset:1024 lds
  v_mfma_f32_16x16x32_bf16 v[228:231], v[116:119], v[88:91], v[228:231]
  ds_read_b64_tr_b16 v[100:101], v3 offset:32768
  v_mfma_f32_16x16x32_bf16 v[236:239], v[116:119], v[92:95], v[236:239]
  s_waitcnt lgkmcnt(7)
  ds_read_b64_tr_b16 v[102:103], v3 offset:36864
  v_mfma_f32_16x16x32_bf16 v[208:211], v[120:123], v[80:83], v[208:211]
  ds_read_b64_tr_b16 v[104:105], v2 offset:33024
  v_mfma_f32_16x16x32_bf16 v[216:219], v[120:123], v[84:87], v[216:219]
  ds_read_b64_tr_b16 v[106:107], v2 offset:37120
  buffer_load_dwordx4 v8, s[52:55], s0 offen offset:2048 lds
  v_mfma_f32_16x16x32_bf16 v[240:243], v[120:123], v[88:91], v[240:243]
  ds_read_b64_tr_b16 v[108:109], v3 offset:33024
  v_mfma_f32_16x16x32_bf16 v[248:251], v[120:123], v[92:95], v[248:251]
  ds_read_b64_tr_b16 v[110:111], v3 offset:37120
  v_mfma_f32_16x16x32_bf16 v[212:215], v[124:127], v[80:83], v[212:215]
  v_mfma_f32_16x16x32_bf16 v[220:223], v[124:127], v[84:87], v[220:223]
  buffer_load_dwordx4 v9, s[52:55], s0 offen offset:3072 lds
  v_mfma_f32_16x16x32_bf16 v[244:247], v[124:127], v[88:91], v[244:247]
  v_mfma_f32_16x16x32_bf16 v[252:255], v[124:127], v[92:95], v[252:255]
  s_waitcnt lgkmcnt(4)
  v_mfma_f32_16x16x32_bf16 v[192:195], v[96:99], v[64:67], v[192:195]
  s_add_u32 m0, s86, 131072
  s_add_u32 s0, s72, 16384
  ds_read_b64_tr_b16 v[112:113], v2 offset:40960
  v_mfma_f32_16x16x32_bf16 v[200:203], v[96:99], v[68:71], v[200:203]
  ds_read_b64_tr_b16 v[114:115], v2 offset:45056
  buffer_load_dwordx4 v15, s[44:47], s0 offen offset:0 sc1 lds
  v_mfma_f32_16x16x32_bf16 v[224:227], v[96:99], v[72:75], v[224:227]
  ds_read_b128 v[80:83], v24 offset:33792
  v_mfma_f32_16x16x32_bf16 v[232:235], v[96:99], v[76:79], v[232:235]
  ds_read_b128 v[84:87], v24 offset:35840
  v_mfma_f32_16x16x32_bf16 v[196:199], v[100:103], v[64:67], v[196:199]
  ds_read_b128 v[88:91], v24 offset:37888
  buffer_load_dwordx4 v15, s[44:47], s0 offen offset:1024 sc1 lds
  v_mfma_f32_16x16x32_bf16 v[204:207], v[100:103], v[68:71], v[204:207]
  ds_read_b128 v[92:95], v24 offset:39936
  v_mfma_f32_16x16x32_bf16 v[228:231], v[100:103], v[72:75], v[228:231]
  ds_read_b64_tr_b16 v[116:117], v3 offset:40960
  v_mfma_f32_16x16x32_bf16 v[236:239], v[100:103], v[76:79], v[236:239]
  s_waitcnt lgkmcnt(7)
  ds_read_b64_tr_b16 v[118:119], v3 offset:45056
  v_mfma_f32_16x16x32_bf16 v[208:211], v[104:107], v[64:67], v[208:211]
  s_add_u32 s0, s72, 145408
  ds_read_b64_tr_b16 v[120:121], v2 offset:41216
  buffer_load_dwordx4 v15, s[44:47], s0 offen offset:2048 sc1 lds
  v_mfma_f32_16x16x32_bf16 v[216:219], v[104:107], v[68:71], v[216:219]
  ds_read_b64_tr_b16 v[122:123], v2 offset:45312
  v_mfma_f32_16x16x32_bf16 v[240:243], v[104:107], v[72:75], v[240:243]
  ds_read_b64_tr_b16 v[124:125], v3 offset:41216
  v_mfma_f32_16x16x32_bf16 v[248:251], v[104:107], v[76:79], v[248:251]
  ds_read_b64_tr_b16 v[126:127], v3 offset:45312
  v_mfma_f32_16x16x32_bf16 v[212:215], v[108:111], v[64:67], v[212:215]
  buffer_load_dwordx4 v15, s[44:47], s0 offen offset:3072 sc1 lds
  v_mfma_f32_16x16x32_bf16 v[220:223], v[108:111], v[68:71], v[220:223]
  v_mfma_f32_16x16x32_bf16 v[244:247], v[108:111], v[72:75], v[244:247]
  v_mfma_f32_16x16x32_bf16 v[252:255], v[108:111], v[76:79], v[252:255]
  s_waitcnt lgkmcnt(4)
  s_waitcnt vmcnt(18)
  s_barrier
  v_mfma_f32_16x16x32_bf16 v[192:195], v[112:115], v[80:83], v[192:195]
  ds_read_b64_tr_b16 v[96:97], v4 offset:0
  v_mfma_f32_16x16x32_bf16 v[200:203], v[112:115], v[84:87], v[200:203]
  s_add_u32 m0, s86, 16384
  s_add_u32 s0, s83, 589824
  ds_read_b64_tr_b16 v[98:99], v4 offset:4096
  v_mfma_f32_16x16x32_bf16 v[224:227], v[112:115], v[88:91], v[224:227]
  ds_read_b128 v[64:67], v25 offset:0
  buffer_load_dwordx4 v6, s[52:55], s0 offen offset:0 lds
  v_mfma_f32_16x16x32_bf16 v[232:235], v[112:115], v[92:95], v[232:235]
  ds_read_b128 v[68:71], v25 offset:2048
  v_mfma_f32_16x16x32_bf16 v[196:199], v[116:119], v[80:83], v[196:199]
  ds_read_b128 v[72:75], v25 offset:4096
  v_mfma_f32_16x16x32_bf16 v[204:207], v[116:119], v[84:87], v[204:207]
  ds_read_b128 v[76:79], v25 offset:6144
  buffer_load_dwordx4 v7, s[52:55], s0 offen offset:1024 lds
  v_mfma_f32_16x16x32_bf16 v[228:231], v[116:119], v[88:91], v[228:231]
  ds_read_b64_tr_b16 v[100:101], v5 offset:0
  v_mfma_f32_16x16x32_bf16 v[236:239], v[116:119], v[92:95], v[236:239]
  s_waitcnt lgkmcnt(7)
  ds_read_b64_tr_b16 v[102:103], v5 offset:4096
  v_mfma_f32_16x16x32_bf16 v[208:211], v[120:123], v[80:83], v[208:211]
  ds_read_b64_tr_b16 v[104:105], v4 offset:256
  v_mfma_f32_16x16x32_bf16 v[216:219], v[120:123], v[84:87], v[216:219]
  ds_read_b64_tr_b16 v[106:107], v4 offset:4352
  buffer_load_dwordx4 v8, s[52:55], s0 offen offset:2048 lds
  v_mfma_f32_16x16x32_bf16 v[240:243], v[120:123], v[88:91], v[240:243]
  ds_read_b64_tr_b16 v[108:109], v5 offset:256
  v_mfma_f32_16x16x32_bf16 v[248:251], v[120:123], v[92:95], v[248:251]
  ds_read_b64_tr_b16 v[110:111], v5 offset:4352
  v_mfma_f32_16x16x32_bf16 v[212:215], v[124:127], v[80:83], v[212:215]
  v_mfma_f32_16x16x32_bf16 v[220:223], v[124:127], v[84:87], v[220:223]
  buffer_load_dwordx4 v9, s[52:55], s0 offen offset:3072 lds
  v_mfma_f32_16x16x32_bf16 v[244:247], v[124:127], v[88:91], v[244:247]
  v_mfma_f32_16x16x32_bf16 v[252:255], v[124:127], v[92:95], v[252:255]
  s_waitcnt lgkmcnt(4)
  v_mfma_f32_16x16x32_bf16 v[192:195], v[96:99], v[64:67], v[192:195]
  s_add_u32 m0, s86, 0
  s_add_u32 s0, s72, 18432
  ds_read_b64_tr_b16 v[112:113], v4 offset:8192
  v_mfma_f32_16x16x32_bf16 v[200:203], v[96:99], v[68:71], v[200:203]
  ds_read_b64_tr_b16 v[114:115], v4 offset:12288
  buffer_load_dwordx4 v15, s[44:47], s0 offen offset:0 sc1 lds
  v_mfma_f32_16x16x32_bf16 v[224:227], v[96:99], v[72:75], v[224:227]
  ds_read_b128 v[80:83], v25 offset:1024
  v_mfma_f32_16x16x32_bf16 v[232:235], v[96:99], v[76:79], v[232:235]
  ds_read_b128 v[84:87], v25 offset:3072
  v_mfma_f32_16x16x32_bf16 v[196:199], v[100:103], v[64:67], v[196:199]
  ds_read_b128 v[88:91], v25 offset:5120
  buffer_load_dwordx4 v15, s[44:47], s0 offen offset:1024 sc1 lds
  v_mfma_f32_16x16x32_bf16 v[204:207], v[100:103], v[68:71], v[204:207]
  ds_read_b128 v[92:95], v25 offset:7168
  v_mfma_f32_16x16x32_bf16 v[228:231], v[100:103], v[72:75], v[228:231]
  ds_read_b64_tr_b16 v[116:117], v5 offset:8192
  v_mfma_f32_16x16x32_bf16 v[236:239], v[100:103], v[76:79], v[236:239]
  s_waitcnt lgkmcnt(7)
  ds_read_b64_tr_b16 v[118:119], v5 offset:12288
  v_mfma_f32_16x16x32_bf16 v[208:211], v[104:107], v[64:67], v[208:211]
  s_add_u32 s0, s72, 147456
  ds_read_b64_tr_b16 v[120:121], v4 offset:8448
  buffer_load_dwordx4 v15, s[44:47], s0 offen offset:2048 sc1 lds
  v_mfma_f32_16x16x32_bf16 v[216:219], v[104:107], v[68:71], v[216:219]
  ds_read_b64_tr_b16 v[122:123], v4 offset:12544
  v_mfma_f32_16x16x32_bf16 v[240:243], v[104:107], v[72:75], v[240:243]
  ds_read_b64_tr_b16 v[124:125], v5 offset:8448
  v_mfma_f32_16x16x32_bf16 v[248:251], v[104:107], v[76:79], v[248:251]
  ds_read_b64_tr_b16 v[126:127], v5 offset:12544
  v_mfma_f32_16x16x32_bf16 v[212:215], v[108:111], v[64:67], v[212:215]
  buffer_load_dwordx4 v15, s[44:47], s0 offen offset:3072 sc1 lds
  v_mfma_f32_16x16x32_bf16 v[220:223], v[108:111], v[68:71], v[220:223]
  v_mfma_f32_16x16x32_bf16 v[244:247], v[108:111], v[72:75], v[244:247]
  v_mfma_f32_16x16x32_bf16 v[252:255], v[108:111], v[76:79], v[252:255]
  s_waitcnt lgkmcnt(4)
  s_waitcnt vmcnt(16)
  s_barrier
  v_mfma_f32_16x16x32_bf16 v[192:195], v[112:115], v[80:83], v[192:195]
  ds_read_b64_tr_b16 v[96:97], v4 offset:32768
  v_mfma_f32_16x16x32_bf16 v[200:203], v[112:115], v[84:87], v[200:203]
  s_add_u32 m0, s86, 49152
  s_add_u32 s0, s83, 655360
  ds_read_b64_tr_b16 v[98:99], v4 offset:36864
  v_mfma_f32_16x16x32_bf16 v[224:227], v[112:115], v[88:91], v[224:227]
  ds_read_b128 v[64:67], v25 offset:32768
  buffer_load_dwordx4 v6, s[52:55], s0 offen offset:0 lds
  v_mfma_f32_16x16x32_bf16 v[232:235], v[112:115], v[92:95], v[232:235]
  ds_read_b128 v[68:71], v25 offset:34816
  v_mfma_f32_16x16x32_bf16 v[196:199], v[116:119], v[80:83], v[196:199]
  ds_read_b128 v[72:75], v25 offset:36864
  v_mfma_f32_16x16x32_bf16 v[204:207], v[116:119], v[84:87], v[204:207]
  ds_read_b128 v[76:79], v25 offset:38912
  buffer_load_dwordx4 v7, s[52:55], s0 offen offset:1024 lds
  v_mfma_f32_16x16x32_bf16 v[228:231], v[116:119], v[88:91], v[228:231]
  ds_read_b64_tr_b16 v[100:101], v5 offset:32768
  v_mfma_f32_16x16x32_bf16 v[236:239], v[116:119], v[92:95], v[236:239]
  s_waitcnt lgkmcnt(7)
  ds_read_b64_tr_b16 v[102:103], v5 offset:36864
  v_mfma_f32_16x16x32_bf16 v[208:211], v[120:123], v[80:83], v[208:211]
  ds_read_b64_tr_b16 v[104:105], v4 offset:33024
  v_mfma_f32_16x16x32_bf16 v[216:219], v[120:123], v[84:87], v[216:219]
  ds_read_b64_tr_b16 v[106:107], v4 offset:37120
  buffer_load_dwordx4 v8, s[52:55], s0 offen offset:2048 lds
  v_mfma_f32_16x16x32_bf16 v[240:243], v[120:123], v[88:91], v[240:243]
  ds_read_b64_tr_b16 v[108:109], v5 offset:33024
  v_mfma_f32_16x16x32_bf16 v[248:251], v[120:123], v[92:95], v[248:251]
  ds_read_b64_tr_b16 v[110:111], v5 offset:37120
  v_mfma_f32_16x16x32_bf16 v[212:215], v[124:127], v[80:83], v[212:215]
  v_mfma_f32_16x16x32_bf16 v[220:223], v[124:127], v[84:87], v[220:223]
  buffer_load_dwordx4 v9, s[52:55], s0 offen offset:3072 lds
  v_mfma_f32_16x16x32_bf16 v[244:247], v[124:127], v[88:91], v[244:247]
  v_mfma_f32_16x16x32_bf16 v[252:255], v[124:127], v[92:95], v[252:255]
  s_waitcnt lgkmcnt(4)
  v_mfma_f32_16x16x32_bf16 v[192:195], v[96:99], v[64:67], v[192:195]
  s_add_u32 m0, s86, 32768
  s_add_u32 s0, s72, 20480
  ds_read_b64_tr_b16 v[112:113], v4 offset:40960
  v_mfma_f32_16x16x32_bf16 v[200:203], v[96:99], v[68:71], v[200:203]
  ds_read_b64_tr_b16 v[114:115], v4 offset:45056
  buffer_load_dwordx4 v15, s[44:47], s0 offen offset:0 sc1 lds
  v_mfma_f32_16x16x32_bf16 v[224:227], v[96:99], v[72:75], v[224:227]
  ds_read_b128 v[80:83], v25 offset:33792
  v_mfma_f32_16x16x32_bf16 v[232:235], v[96:99], v[76:79], v[232:235]
  ds_read_b128 v[84:87], v25 offset:35840
  v_mfma_f32_16x16x32_bf16 v[196:199], v[100:103], v[64:67], v[196:199]
  ds_read_b128 v[88:91], v25 offset:37888
  buffer_load_dwordx4 v15, s[44:47], s0 offen offset:1024 sc1 lds
  v_mfma_f32_16x16x32_bf16 v[204:207], v[100:103], v[68:71], v[204:207]
  ds_read_b128 v[92:95], v25 offset:39936
  v_mfma_f32_16x16x32_bf16 v[228:231], v[100:103], v[72:75], v[228:231]
  ds_read_b64_tr_b16 v[116:117], v5 offset:40960
  v_mfma_f32_16x16x32_bf16 v[236:239], v[100:103], v[76:79], v[236:239]
  s_waitcnt lgkmcnt(7)
  ds_read_b64_tr_b16 v[118:119], v5 offset:45056
  v_mfma_f32_16x16x32_bf16 v[208:211], v[104:107], v[64:67], v[208:211]
  s_add_u32 s0, s72, 149504
  ds_read_b64_tr_b16 v[120:121], v4 offset:41216
  buffer_load_dwordx4 v15, s[44:47], s0 offen offset:2048 sc1 lds
  v_mfma_f32_16x16x32_bf16 v[216:219], v[104:107], v[68:71], v[216:219]
  ds_read_b64_tr_b16 v[122:123], v4 offset:45312
  v_mfma_f32_16x16x32_bf16 v[240:243], v[104:107], v[72:75], v[240:243]
  ds_read_b64_tr_b16 v[124:125], v5 offset:41216
  v_mfma_f32_16x16x32_bf16 v[248:251], v[104:107], v[76:79], v[248:251]
  ds_read_b64_tr_b16 v[126:127], v5 offset:45312
  v_mfma_f32_16x16x32_bf16 v[212:215], v[108:111], v[64:67], v[212:215]
  buffer_load_dwordx4 v15, s[44:47], s0 offen offset:3072 sc1 lds
  v_mfma_f32_16x16x32_bf16 v[220:223], v[108:111], v[68:71], v[220:223]
  v_mfma_f32_16x16x32_bf16 v[244:247], v[108:111], v[72:75], v[244:247]
  v_mfma_f32_16x16x32_bf16 v[252:255], v[108:111], v[76:79], v[252:255]
  s_waitcnt lgkmcnt(4)
  s_waitcnt vmcnt(16)
  s_barrier
  v_mfma_f32_16x16x32_bf16 v[192:195], v[112:115], v[80:83], v[192:195]
  ds_read_b64_tr_b16 v[96:97], v27 offset:0
  v_mfma_f32_16x16x32_bf16 v[200:203], v[112:115], v[84:87], v[200:203]
  s_add_u32 m0, s86, 81920
  s_add_u32 s0, s83, 720896
  ds_read_b64_tr_b16 v[98:99], v27 offset:4096
  v_mfma_f32_16x16x32_bf16 v[224:227], v[112:115], v[88:91], v[224:227]
  ds_read_b128 v[64:67], v26 offset:0
  buffer_load_dwordx4 v6, s[52:55], s0 offen offset:0 lds
  v_mfma_f32_16x16x32_bf16 v[232:235], v[112:115], v[92:95], v[232:235]
  ds_read_b128 v[68:71], v26 offset:2048
  v_mfma_f32_16x16x32_bf16 v[196:199], v[116:119], v[80:83], v[196:199]
  ds_read_b128 v[72:75], v26 offset:4096
  v_mfma_f32_16x16x32_bf16 v[204:207], v[116:119], v[84:87], v[204:207]
  ds_read_b128 v[76:79], v26 offset:6144
  buffer_load_dwordx4 v7, s[52:55], s0 offen offset:1024 lds
  v_mfma_f32_16x16x32_bf16 v[228:231], v[116:119], v[88:91], v[228:231]
  ds_read_b64_tr_b16 v[100:101], v29 offset:0
  v_mfma_f32_16x16x32_bf16 v[236:239], v[116:119], v[92:95], v[236:239]
  s_waitcnt lgkmcnt(7)
  ds_read_b64_tr_b16 v[102:103], v29 offset:4096
  v_mfma_f32_16x16x32_bf16 v[208:211], v[120:123], v[80:83], v[208:211]
  ds_read_b64_tr_b16 v[104:105], v27 offset:256
  v_mfma_f32_16x16x32_bf16 v[216:219], v[120:123], v[84:87], v[216:219]
  ds_read_b64_tr_b16 v[106:107], v27 offset:4352
  buffer_load_dwordx4 v8, s[52:55], s0 offen offset:2048 lds
  v_mfma_f32_16x16x32_bf16 v[240:243], v[120:123], v[88:91], v[240:243]
  ds_read_b64_tr_b16 v[108:109], v29 offset:256
  v_mfma_f32_16x16x32_bf16 v[248:251], v[120:123], v[92:95], v[248:251]
  ds_read_b64_tr_b16 v[110:111], v29 offset:4352
  v_mfma_f32_16x16x32_bf16 v[212:215], v[124:127], v[80:83], v[212:215]
  v_mfma_f32_16x16x32_bf16 v[220:223], v[124:127], v[84:87], v[220:223]
  buffer_load_dwordx4 v9, s[52:55], s0 offen offset:3072 lds
  v_mfma_f32_16x16x32_bf16 v[244:247], v[124:127], v[88:91], v[244:247]
  v_mfma_f32_16x16x32_bf16 v[252:255], v[124:127], v[92:95], v[252:255]
  s_waitcnt lgkmcnt(4)
  v_mfma_f32_16x16x32_bf16 v[192:195], v[96:99], v[64:67], v[192:195]
  s_add_u32 m0, s86, 65536
  s_add_u32 s0, s72, 22528
  ds_read_b64_tr_b16 v[112:113], v27 offset:8192
  v_mfma_f32_16x16x32_bf16 v[200:203], v[96:99], v[68:71], v[200:203]
  ds_read_b64_tr_b16 v[114:115], v27 offset:12288
  buffer_load_dwordx4 v15, s[44:47], s0 offen offset:0 sc1 lds
  v_mfma_f32_16x16x32_bf16 v[224:227], v[96:99], v[72:75], v[224:227]
  ds_read_b128 v[80:83], v26 offset:1024
  v_mfma_f32_16x16x32_bf16 v[232:235], v[96:99], v[76:79], v[232:235]
  ds_read_b128 v[84:87], v26 offset:3072
  v_mfma_f32_16x16x32_bf16 v[196:199], v[100:103], v[64:67], v[196:199]
  ds_read_b128 v[88:91], v26 offset:5120
  buffer_load_dwordx4 v15, s[44:47], s0 offen offset:1024 sc1 lds
  v_mfma_f32_16x16x32_bf16 v[204:207], v[100:103], v[68:71], v[204:207]
  ds_read_b128 v[92:95], v26 offset:7168
  v_mfma_f32_16x16x32_bf16 v[228:231], v[100:103], v[72:75], v[228:231]
  ds_read_b64_tr_b16 v[116:117], v29 offset:8192
  v_mfma_f32_16x16x32_bf16 v[236:239], v[100:103], v[76:79], v[236:239]
  s_waitcnt lgkmcnt(7)
  ds_read_b64_tr_b16 v[118:119], v29 offset:12288
  v_mfma_f32_16x16x32_bf16 v[208:211], v[104:107], v[64:67], v[208:211]
  s_add_u32 s0, s72, 151552
  ds_read_b64_tr_b16 v[120:121], v27 offset:8448
  buffer_load_dwordx4 v15, s[44:47], s0 offen offset:2048 sc1 lds
  v_mfma_f32_16x16x32_bf16 v[216:219], v[104:107], v[68:71], v[216:219]
  ds_read_b64_tr_b16 v[122:123], v27 offset:12544
  v_mfma_f32_16x16x32_bf16 v[240:243], v[104:107], v[72:75], v[240:243]
  ds_read_b64_tr_b16 v[124:125], v29 offset:8448
  v_mfma_f32_16x16x32_bf16 v[248:251], v[104:107], v[76:79], v[248:251]
  ds_read_b64_tr_b16 v[126:127], v29 offset:12544
  v_mfma_f32_16x16x32_bf16 v[212:215], v[108:111], v[64:67], v[212:215]
  buffer_load_dwordx4 v15, s[44:47], s0 offen offset:3072 sc1 lds
  v_mfma_f32_16x16x32_bf16 v[220:223], v[108:111], v[68:71], v[220:223]
  v_mfma_f32_16x16x32_bf16 v[244:247], v[108:111], v[72:75], v[244:247]
  v_mfma_f32_16x16x32_bf16 v[252:255], v[108:111], v[76:79], v[252:255]
  s_waitcnt lgkmcnt(4)
  s_waitcnt vmcnt(16)
  s_barrier
  v_mfma_f32_16x16x32_bf16 v[192:195], v[112:115], v[80:83], v[192:195]
  ds_read_b64_tr_b16 v[96:97], v2 offset:0
  buffer_store_dword v52, v31, s[44:47], s88 offen sc1
  v_mfma_f32_16x16x32_bf16 v[200:203], v[112:115], v[84:87], v[200:203]
  s_add_u32 m0, s86, 114688
  s_add_u32 s0, s83, 786432
  ds_read_b64_tr_b16 v[98:99], v2 offset:4096
  v_mfma_f32_16x16x32_bf16 v[224:227], v[112:115], v[88:91], v[224:227]
  ds_read_b128 v[64:67], v24 offset:0
  buffer_load_dwordx4 v6, s[52:55], s0 offen offset:0 lds
  v_mfma_f32_16x16x32_bf16 v[232:235], v[112:115], v[92:95], v[232:235]
  ds_read_b128 v[68:71], v24 offset:2048
  v_mfma_f32_16x16x32_bf16 v[196:199], v[116:119], v[80:83], v[196:199]
  ds_read_b128 v[72:75], v24 offset:4096
  v_mfma_f32_16x16x32_bf16 v[204:207], v[116:119], v[84:87], v[204:207]
  ds_read_b128 v[76:79], v24 offset:6144
  buffer_load_dwordx4 v7, s[52:55], s0 offen offset:1024 lds
  v_mfma_f32_16x16x32_bf16 v[228:231], v[116:119], v[88:91], v[228:231]
  ds_read_b64_tr_b16 v[100:101], v3 offset:0
  v_mfma_f32_16x16x32_bf16 v[236:239], v[116:119], v[92:95], v[236:239]
  s_waitcnt lgkmcnt(7)
  ds_read_b64_tr_b16 v[102:103], v3 offset:4096
  v_mfma_f32_16x16x32_bf16 v[208:211], v[120:123], v[80:83], v[208:211]
  ds_read_b64_tr_b16 v[104:105], v2 offset:256
  v_mfma_f32_16x16x32_bf16 v[216:219], v[120:123], v[84:87], v[216:219]
  ds_read_b64_tr_b16 v[106:107], v2 offset:4352
  buffer_load_dwordx4 v8, s[52:55], s0 offen offset:2048 lds
  v_mfma_f32_16x16x32_bf16 v[240:243], v[120:123], v[88:91], v[240:243]
  ds_read_b64_tr_b16 v[108:109], v3 offset:256
  v_mfma_f32_16x16x32_bf16 v[248:251], v[120:123], v[92:95], v[248:251]
  ds_read_b64_tr_b16 v[110:111], v3 offset:4352
  v_mfma_f32_16x16x32_bf16 v[212:215], v[124:127], v[80:83], v[212:215]
  v_mfma_f32_16x16x32_bf16 v[220:223], v[124:127], v[84:87], v[220:223]
  buffer_load_dwordx4 v9, s[52:55], s0 offen offset:3072 lds
  v_mfma_f32_16x16x32_bf16 v[244:247], v[124:127], v[88:91], v[244:247]
  v_mfma_f32_16x16x32_bf16 v[252:255], v[124:127], v[92:95], v[252:255]
  s_waitcnt lgkmcnt(4)
  v_mfma_f32_16x16x32_bf16 v[192:195], v[96:99], v[64:67], v[192:195]
  s_add_u32 m0, s86, 98304
  s_add_u32 s0, s72, 24576
  ds_read_b64_tr_b16 v[112:113], v2 offset:8192
  v_mfma_f32_16x16x32_bf16 v[200:203], v[96:99], v[68:71], v[200:203]
  ds_read_b64_tr_b16 v[114:115], v2 offset:12288
  buffer_load_dwordx4 v15, s[44:47], s0 offen offset:0 sc1 lds
  v_mfma_f32_16x16x32_bf16 v[224:227], v[96:99], v[72:75], v[224:227]
  ds_read_b128 v[80:83], v24 offset:1024
  v_mfma_f32_16x16x32_bf16 v[232:235], v[96:99], v[76:79], v[232:235]
  ds_read_b128 v[84:87], v24 offset:3072
  v_mfma_f32_16x16x32_bf16 v[196:199], v[100:103], v[64:67], v[196:199]
  ds_read_b128 v[88:91], v24 offset:5120
  buffer_load_dwordx4 v15, s[44:47], s0 offen offset:1024 sc1 lds
  v_mfma_f32_16x16x32_bf16 v[204:207], v[100:103], v[68:71], v[204:207]
  ds_read_b128 v[92:95], v24 offset:7168
  v_mfma_f32_16x16x32_bf16 v[228:231], v[100:103], v[72:75], v[228:231]
  ds_read_b64_tr_b16 v[116:117], v3 offset:8192
  v_mfma_f32_16x16x32_bf16 v[236:239], v[100:103], v[76:79], v[236:239]
  s_waitcnt lgkmcnt(7)
  ds_read_b64_tr_b16 v[118:119], v3 offset:12288
  v_mfma_f32_16x16x32_bf16 v[208:211], v[104:107], v[64:67], v[208:211]
  s_add_u32 s0, s72, 153600
  ds_read_b64_tr_b16 v[120:121], v2 offset:8448
  buffer_load_dwordx4 v15, s[44:47], s0 offen offset:2048 sc1 lds
  v_mfma_f32_16x16x32_bf16 v[216:219], v[104:107], v[68:71], v[216:219]
  ds_read_b64_tr_b16 v[122:123], v2 offset:12544
  v_mfma_f32_16x16x32_bf16 v[240:243], v[104:107], v[72:75], v[240:243]
  ds_read_b64_tr_b16 v[124:125], v3 offset:8448
  v_mfma_f32_16x16x32_bf16 v[248:251], v[104:107], v[76:79], v[248:251]
  ds_read_b64_tr_b16 v[126:127], v3 offset:12544
  v_mfma_f32_16x16x32_bf16 v[212:215], v[108:111], v[64:67], v[212:215]
  buffer_load_dwordx4 v15, s[44:47], s0 offen offset:3072 sc1 lds
  v_mfma_f32_16x16x32_bf16 v[220:223], v[108:111], v[68:71], v[220:223]
  v_mfma_f32_16x16x32_bf16 v[244:247], v[108:111], v[72:75], v[244:247]
  v_mfma_f32_16x16x32_bf16 v[252:255], v[108:111], v[76:79], v[252:255]
  s_waitcnt lgkmcnt(4)
  s_waitcnt vmcnt(17)
  s_barrier
  v_mfma_f32_16x16x32_bf16 v[192:195], v[112:115], v[80:83], v[192:195]
  ds_read_b64_tr_b16 v[96:97], v2 offset:32768
  v_mfma_f32_16x16x32_bf16 v[200:203], v[112:115], v[84:87], v[200:203]
  s_add_u32 m0, s86, 147456
  s_add_u32 s0, s83, 851968
  ds_read_b64_tr_b16 v[98:99], v2 offset:36864
  v_mfma_f32_16x16x32_bf16 v[224:227], v[112:115], v[88:91], v[224:227]
  ds_read_b128 v[64:67], v24 offset:32768
  buffer_load_dwordx4 v6, s[52:55], s0 offen offset:0 lds
  v_mfma_f32_16x16x32_bf16 v[232:235], v[112:115], v[92:95], v[232:235]
  ds_read_b128 v[68:71], v24 offset:34816
  v_mfma_f32_16x16x32_bf16 v[196:199], v[116:119], v[80:83], v[196:199]
  ds_read_b128 v[72:75], v24 offset:36864
  v_mfma_f32_16x16x32_bf16 v[204:207], v[116:119], v[84:87], v[204:207]
  ds_read_b128 v[76:79], v24 offset:38912
  buffer_load_dwordx4 v7, s[52:55], s0 offen offset:1024 lds
  v_mfma_f32_16x16x32_bf16 v[228:231], v[116:119], v[88:91], v[228:231]
  ds_read_b64_tr_b16 v[100:101], v3 offset:32768
  v_mfma_f32_16x16x32_bf16 v[236:239], v[116:119], v[92:95], v[236:239]
  s_waitcnt lgkmcnt(7)
  ds_read_b64_tr_b16 v[102:103], v3 offset:36864
  v_mfma_f32_16x16x32_bf16 v[208:211], v[120:123], v[80:83], v[208:211]
  ds_read_b64_tr_b16 v[104:105], v2 offset:33024
  v_mfma_f32_16x16x32_bf16 v[216:219], v[120:123], v[84:87], v[216:219]
  ds_read_b64_tr_b16 v[106:107], v2 offset:37120
  buffer_load_dwordx4 v8, s[52:55], s0 offen offset:2048 lds
  v_mfma_f32_16x16x32_bf16 v[240:243], v[120:123], v[88:91], v[240:243]
  ds_read_b64_tr_b16 v[108:109], v3 offset:33024
  v_mfma_f32_16x16x32_bf16 v[248:251], v[120:123], v[92:95], v[248:251]
  ds_read_b64_tr_b16 v[110:111], v3 offset:37120
  v_mfma_f32_16x16x32_bf16 v[212:215], v[124:127], v[80:83], v[212:215]
  v_mfma_f32_16x16x32_bf16 v[220:223], v[124:127], v[84:87], v[220:223]
  buffer_load_dwordx4 v9, s[52:55], s0 offen offset:3072 lds
  v_mfma_f32_16x16x32_bf16 v[244:247], v[124:127], v[88:91], v[244:247]
  v_mfma_f32_16x16x32_bf16 v[252:255], v[124:127], v[92:95], v[252:255]
  s_waitcnt lgkmcnt(4)
  v_mfma_f32_16x16x32_bf16 v[192:195], v[96:99], v[64:67], v[192:195]
  s_add_u32 m0, s86, 131072
  s_add_u32 s0, s72, 26624
  ds_read_b64_tr_b16 v[112:113], v2 offset:40960
  v_mfma_f32_16x16x32_bf16 v[200:203], v[96:99], v[68:71], v[200:203]
  ds_read_b64_tr_b16 v[114:115], v2 offset:45056
  buffer_load_dwordx4 v15, s[44:47], s0 offen offset:0 sc1 lds
  v_mfma_f32_16x16x32_bf16 v[224:227], v[96:99], v[72:75], v[224:227]
  ds_read_b128 v[80:83], v24 offset:33792
  v_mfma_f32_16x16x32_bf16 v[232:235], v[96:99], v[76:79], v[232:235]
  ds_read_b128 v[84:87], v24 offset:35840
  v_mfma_f32_16x16x32_bf16 v[196:199], v[100:103], v[64:67], v[196:199]
  ds_read_b128 v[88:91], v24 offset:37888
  buffer_load_dwordx4 v15, s[44:47], s0 offen offset:1024 sc1 lds
  v_mfma_f32_16x16x32_bf16 v[204:207], v[100:103], v[68:71], v[204:207]
  ds_read_b128 v[92:95], v24 offset:39936
  v_mfma_f32_16x16x32_bf16 v[228:231], v[100:103], v[72:75], v[228:231]
  ds_read_b64_tr_b16 v[116:117], v3 offset:40960
  v_mfma_f32_16x16x32_bf16 v[236:239], v[100:103], v[76:79], v[236:239]
  s_waitcnt lgkmcnt(7)
  ds_read_b64_tr_b16 v[118:119], v3 offset:45056
  v_mfma_f32_16x16x32_bf16 v[208:211], v[104:107], v[64:67], v[208:211]
  s_add_u32 s0, s72, 155648
  ds_read_b64_tr_b16 v[120:121], v2 offset:41216
  buffer_load_dwordx4 v15, s[44:47], s0 offen offset:2048 sc1 lds
  v_mfma_f32_16x16x32_bf16 v[216:219], v[104:107], v[68:71], v[216:219]
  ds_read_b64_tr_b16 v[122:123], v2 offset:45312
  v_mfma_f32_16x16x32_bf16 v[240:243], v[104:107], v[72:75], v[240:243]
  ds_read_b64_tr_b16 v[124:125], v3 offset:41216
  v_mfma_f32_16x16x32_bf16 v[248:251], v[104:107], v[76:79], v[248:251]
  ds_read_b64_tr_b16 v[126:127], v3 offset:45312
  v_mfma_f32_16x16x32_bf16 v[212:215], v[108:111], v[64:67], v[212:215]
  buffer_load_dwordx4 v15, s[44:47], s0 offen offset:3072 sc1 lds
  v_mfma_f32_16x16x32_bf16 v[220:223], v[108:111], v[68:71], v[220:223]
  v_mfma_f32_16x16x32_bf16 v[244:247], v[108:111], v[72:75], v[244:247]
  v_mfma_f32_16x16x32_bf16 v[252:255], v[108:111], v[76:79], v[252:255]
  s_waitcnt lgkmcnt(4)
  s_waitcnt vmcnt(17)
  s_barrier
  v_mfma_f32_16x16x32_bf16 v[192:195], v[112:115], v[80:83], v[192:195]
  ds_read_b64_tr_b16 v[96:97], v4 offset:0
  v_mfma_f32_16x16x32_bf16 v[200:203], v[112:115], v[84:87], v[200:203]
  s_add_u32 m0, s86, 16384
  s_add_u32 s0, s83, 917504
  ds_read_b64_tr_b16 v[98:99], v4 offset:4096
  v_mfma_f32_16x16x32_bf16 v[224:227], v[112:115], v[88:91], v[224:227]
  ds_read_b128 v[64:67], v25 offset:0
  buffer_load_dwordx4 v6, s[52:55], s0 offen offset:0 lds
  v_mfma_f32_16x16x32_bf16 v[232:235], v[112:115], v[92:95], v[232:235]
  ds_read_b128 v[68:71], v25 offset:2048
  v_mfma_f32_16x16x32_bf16 v[196:199], v[116:119], v[80:83], v[196:199]
  ds_read_b128 v[72:75], v25 offset:4096
  v_mfma_f32_16x16x32_bf16 v[204:207], v[116:119], v[84:87], v[204:207]
  ds_read_b128 v[76:79], v25 offset:6144
  buffer_load_dwordx4 v7, s[52:55], s0 offen offset:1024 lds
  v_mfma_f32_16x16x32_bf16 v[228:231], v[116:119], v[88:91], v[228:231]
  ds_read_b64_tr_b16 v[100:101], v5 offset:0
  v_mfma_f32_16x16x32_bf16 v[236:239], v[116:119], v[92:95], v[236:239]
  s_waitcnt lgkmcnt(7)
  ds_read_b64_tr_b16 v[102:103], v5 offset:4096
  v_mfma_f32_16x16x32_bf16 v[208:211], v[120:123], v[80:83], v[208:211]
  ds_read_b64_tr_b16 v[104:105], v4 offset:256
  v_mfma_f32_16x16x32_bf16 v[216:219], v[120:123], v[84:87], v[216:219]
  ds_read_b64_tr_b16 v[106:107], v4 offset:4352
  buffer_load_dwordx4 v8, s[52:55], s0 offen offset:2048 lds
  v_mfma_f32_16x16x32_bf16 v[240:243], v[120:123], v[88:91], v[240:243]
  ds_read_b64_tr_b16 v[108:109], v5 offset:256
  v_mfma_f32_16x16x32_bf16 v[248:251], v[120:123], v[92:95], v[248:251]
  ds_read_b64_tr_b16 v[110:111], v5 offset:4352
  v_mfma_f32_16x16x32_bf16 v[212:215], v[124:127], v[80:83], v[212:215]
  v_mfma_f32_16x16x32_bf16 v[220:223], v[124:127], v[84:87], v[220:223]
  buffer_load_dwordx4 v9, s[52:55], s0 offen offset:3072 lds
  v_mfma_f32_16x16x32_bf16 v[244:247], v[124:127], v[88:91], v[244:247]
  v_mfma_f32_16x16x32_bf16 v[252:255], v[124:127], v[92:95], v[252:255]
  s_waitcnt lgkmcnt(4)
  v_mfma_f32_16x16x32_bf16 v[192:195], v[96:99], v[64:67], v[192:195]
  s_add_u32 m0, s86, 0
  s_add_u32 s0, s72, 28672
  ds_read_b64_tr_b16 v[112:113], v4 offset:8192
  v_mfma_f32_16x16x32_bf16 v[200:203], v[96:99], v[68:71], v[200:203]
  ds_read_b64_tr_b16 v[114:115], v4 offset:12288
  buffer_load_dwordx4 v15, s[44:47], s0 offen offset:0 sc1 lds
  v_mfma_f32_16x16x32_bf16 v[224:227], v[96:99], v[72:75], v[224:227]
  ds_read_b128 v[80:83], v25 offset:1024
  v_mfma_f32_16x16x32_bf16 v[232:235], v[96:99], v[76:79], v[232:235]
  ds_read_b128 v[84:87], v25 offset:3072
  v_mfma_f32_16x16x32_bf16 v[196:199], v[100:103], v[64:67], v[196:199]
  ds_read_b128 v[88:91], v25 offset:5120
  buffer_load_dwordx4 v15, s[44:47], s0 offen offset:1024 sc1 lds
  v_mfma_f32_16x16x32_bf16 v[204:207], v[100:103], v[68:71], v[204:207]
  ds_read_b128 v[92:95], v25 offset:7168
  v_mfma_f32_16x16x32_bf16 v[228:231], v[100:103], v[72:75], v[228:231]
  ds_read_b64_tr_b16 v[116:117], v5 offset:8192
  v_mfma_f32_16x16x32_bf16 v[236:239], v[100:103], v[76:79], v[236:239]
  s_waitcnt lgkmcnt(7)
  ds_read_b64_tr_b16 v[118:119], v5 offset:12288
  v_mfma_f32_16x16x32_bf16 v[208:211], v[104:107], v[64:67], v[208:211]
  s_add_u32 s0, s72, 157696
  ds_read_b64_tr_b16 v[120:121], v4 offset:8448
  buffer_load_dwordx4 v15, s[44:47], s0 offen offset:2048 sc1 lds
  v_mfma_f32_16x16x32_bf16 v[216:219], v[104:107], v[68:71], v[216:219]
  ds_read_b64_tr_b16 v[122:123], v4 offset:12544
  v_mfma_f32_16x16x32_bf16 v[240:243], v[104:107], v[72:75], v[240:243]
  ds_read_b64_tr_b16 v[124:125], v5 offset:8448
  v_mfma_f32_16x16x32_bf16 v[248:251], v[104:107], v[76:79], v[248:251]
  ds_read_b64_tr_b16 v[126:127], v5 offset:12544
  v_mfma_f32_16x16x32_bf16 v[212:215], v[108:111], v[64:67], v[212:215]
  buffer_load_dwordx4 v15, s[44:47], s0 offen offset:3072 sc1 lds
  v_mfma_f32_16x16x32_bf16 v[220:223], v[108:111], v[68:71], v[220:223]
  v_mfma_f32_16x16x32_bf16 v[244:247], v[108:111], v[72:75], v[244:247]
  v_mfma_f32_16x16x32_bf16 v[252:255], v[108:111], v[76:79], v[252:255]
  s_waitcnt lgkmcnt(4)
  s_waitcnt vmcnt(16)
  s_barrier
  v_mfma_f32_16x16x32_bf16 v[192:195], v[112:115], v[80:83], v[192:195]
  ds_read_b64_tr_b16 v[96:97], v4 offset:32768
  v_mfma_f32_16x16x32_bf16 v[200:203], v[112:115], v[84:87], v[200:203]
  s_add_u32 m0, s86, 49152
  s_add_u32 s0, s83, 983040
  ds_read_b64_tr_b16 v[98:99], v4 offset:36864
  v_mfma_f32_16x16x32_bf16 v[224:227], v[112:115], v[88:91], v[224:227]
  ds_read_b128 v[64:67], v25 offset:32768
  buffer_load_dwordx4 v6, s[52:55], s0 offen offset:0 lds
  v_mfma_f32_16x16x32_bf16 v[232:235], v[112:115], v[92:95], v[232:235]
  ds_read_b128 v[68:71], v25 offset:34816
  v_mfma_f32_16x16x32_bf16 v[196:199], v[116:119], v[80:83], v[196:199]
  ds_read_b128 v[72:75], v25 offset:36864
  buffer_load_dword v49, v50, s[44:47], 0 offen sc1
  v_mfma_f32_16x16x32_bf16 v[204:207], v[116:119], v[84:87], v[204:207]
  ds_read_b128 v[76:79], v25 offset:38912
  v_mfma_f32_16x16x32_bf16 v[228:231], v[116:119], v[88:91], v[228:231]
  ds_read_b64_tr_b16 v[100:101], v5 offset:32768
  buffer_load_dwordx4 v7, s[52:55], s0 offen offset:1024 lds
  v_mfma_f32_16x16x32_bf16 v[236:239], v[116:119], v[92:95], v[236:239]
  s_waitcnt lgkmcnt(7)
  ds_read_b64_tr_b16 v[102:103], v5 offset:36864
  v_mfma_f32_16x16x32_bf16 v[208:211], v[120:123], v[80:83], v[208:211]
  ds_read_b64_tr_b16 v[104:105], v4 offset:33024
  v_mfma_f32_16x16x32_bf16 v[216:219], v[120:123], v[84:87], v[216:219]
  ds_read_b64_tr_b16 v[106:107], v4 offset:37120
  buffer_load_dwordx4 v8, s[52:55], s0 offen offset:2048 lds
  v_mfma_f32_16x16x32_bf16 v[240:243], v[120:123], v[88:91], v[240:243]
  ds_read_b64_tr_b16 v[108:109], v5 offset:33024
  v_mfma_f32_16x16x32_bf16 v[248:251], v[120:123], v[92:95], v[248:251]
  ds_read_b64_tr_b16 v[110:111], v5 offset:37120
  v_mfma_f32_16x16x32_bf16 v[212:215], v[124:127], v[80:83], v[212:215]
  v_mfma_f32_16x16x32_bf16 v[220:223], v[124:127], v[84:87], v[220:223]
  buffer_load_dwordx4 v9, s[52:55], s0 offen offset:3072 lds
  v_mfma_f32_16x16x32_bf16 v[244:247], v[124:127], v[88:91], v[244:247]
  v_mfma_f32_16x16x32_bf16 v[252:255], v[124:127], v[92:95], v[252:255]
  s_waitcnt lgkmcnt(4)
  v_mfma_f32_16x16x32_bf16 v[192:195], v[96:99], v[64:67], v[192:195]
  s_add_u32 m0, s86, 32768
  s_add_u32 s0, s72, 30720
  ds_read_b64_tr_b16 v[112:113], v4 offset:40960
  v_mfma_f32_16x16x32_bf16 v[200:203], v[96:99], v[68:71], v[200:203]
  ds_read_b64_tr_b16 v[114:115], v4 offset:45056
  buffer_load_dwordx4 v15, s[44:47], s0 offen offset:0 sc1 lds
  v_mfma_f32_16x16x32_bf16 v[224:227], v[96:99], v[72:75], v[224:227]
  ds_read_b128 v[80:83], v25 offset:33792
  v_mfma_f32_16x16x32_bf16 v[232:235], v[96:99], v[76:79], v[232:235]
  ds_read_b128 v[84:87], v25 offset:35840
  v_mfma_f32_16x16x32_bf16 v[196:199], v[100:103], v[64:67], v[196:199]
  ds_read_b128 v[88:91], v25 offset:37888
  buffer_load_dwordx4 v15, s[44:47], s0 offen offset:1024 sc1 lds
  v_mfma_f32_16x16x32_bf16 v[204:207], v[100:103], v[68:71], v[204:207]
  ds_read_b128 v[92:95], v25 offset:39936
  v_mfma_f32_16x16x32_bf16 v[228:231], v[100:103], v[72:75], v[228:231]
  ds_read_b64_tr_b16 v[116:117], v5 offset:40960
  v_mfma_f32_16x16x32_bf16 v[236:239], v[100:103], v[76:79], v[236:239]
  s_waitcnt lgkmcnt(7)
  ds_read_b64_tr_b16 v[118:119], v5 offset:45056
  v_mfma_f32_16x16x32_bf16 v[208:211], v[104:107], v[64:67], v[208:211]
  s_add_u32 s0, s72, 159744
  ds_read_b64_tr_b16 v[120:121], v4 offset:41216
  buffer_load_dwordx4 v15, s[44:47], s0 offen offset:2048 sc1 lds
  v_mfma_f32_16x16x32_bf16 v[216:219], v[104:107], v[68:71], v[216:219]
  ds_read_b64_tr_b16 v[122:123], v4 offset:45312
  v_mfma_f32_16x16x32_bf16 v[240:243], v[104:107], v[72:75], v[240:243]
  ds_read_b64_tr_b16 v[124:125], v5 offset:41216
  v_mfma_f32_16x16x32_bf16 v[248:251], v[104:107], v[76:79], v[248:251]
  ds_read_b64_tr_b16 v[126:127], v5 offset:45312
  v_mfma_f32_16x16x32_bf16 v[212:215], v[108:111], v[64:67], v[212:215]
  buffer_load_dwordx4 v15, s[44:47], s0 offen offset:3072 sc1 lds
  v_mfma_f32_16x16x32_bf16 v[220:223], v[108:111], v[68:71], v[220:223]
  v_mfma_f32_16x16x32_bf16 v[244:247], v[108:111], v[72:75], v[244:247]
  v_mfma_f32_16x16x32_bf16 v[252:255], v[108:111], v[76:79], v[252:255]
  s_waitcnt lgkmcnt(4)
  s_waitcnt vmcnt(17)
  s_barrier
  v_mfma_f32_16x16x32_bf16 v[192:195], v[112:115], v[80:83], v[192:195]
  ds_read_b64_tr_b16 v[96:97], v27 offset:0
  v_mfma_f32_16x16x32_bf16 v[200:203], v[112:115], v[84:87], v[200:203]
  ds_read_b64_tr_b16 v[98:99], v27 offset:4096
  v_mfma_f32_16x16x32_bf16 v[224:227], v[112:115], v[88:91], v[224:227]
  ds_read_b128 v[64:67], v26 offset:0
  v_mfma_f32_16x16x32_bf16 v[232:235], v[112:115], v[92:95], v[232:235]
  ds_read_b128 v[68:71], v26 offset:2048
  v_mfma_f32_16x16x32_bf16 v[196:199], v[116:119], v[80:83], v[196:199]
  ds_read_b128 v[72:75], v26 offset:4096
  v_mfma_f32_16x16x32_bf16 v[204:207], v[116:119], v[84:87], v[204:207]
  ds_read_b128 v[76:79], v26 offset:6144
  v_mfma_f32_16x16x32_bf16 v[228:231], v[116:119], v[88:91], v[228:231]
  ds_read_b64_tr_b16 v[100:101], v29 offset:0
  v_mfma_f32_16x16x32_bf16 v[236:239], v[116:119], v[92:95], v[236:239]
  s_waitcnt lgkmcnt(7)
  ds_read_b64_tr_b16 v[102:103], v29 offset:4096
  v_mfma_f32_16x16x32_bf16 v[208:211], v[120:123], v[80:83], v[208:211]
  ds_read_b64_tr_b16 v[104:105], v27 offset:256
  s_waitcnt vmcnt(7)
  v_cmp_ne_u32 vcc, v52, v49
  s_cbranch_vccnz Lspin14
Lback14:
  v_mfma_f32_16x16x32_bf16 v[216:219], v[120:123], v[84:87], v[216:219]
  s_movk_i32 s1, 0x4000
  ds_read_b64_tr_b16 v[106:107], v27 offset:4352
  v_mfma_f32_16x16x32_bf16 v[240:243], v[120:123], v[88:91], v[240:243]
  s_xor_b32 s76, s84, 32768
  s_sub_u32 s76, s76, s84
  ds_read_b64_tr_b16 v[108:109], v29 offset:256
  v_mfma_f32_16x16x32_bf16 v[248:251], v[120:123], v[92:95], v[248:251]
  s_add_u32 s76, s76, s79
  s_add_u32 s76, s76, 0x800
  ds_read_b64_tr_b16 v[110:111], v29 offset:4352
  v_mfma_f32_16x16x32_bf16 v[212:215], v[124:127], v[80:83], v[212:215]
  buffer_load_dwordx4 v[144:147], v15, s[44:47], s76 offen offset:0 sc1
  v_mfma_f32_16x16x32_bf16 v[220:223], v[124:127], v[84:87], v[220:223]
  v_mfma_f32_16x16x32_bf16 v[244:247], v[124:127], v[88:91], v[244:247]
  buffer_load_dwordx4 v[148:151], v15, s[44:47], s76 offen offset:1024 sc1
  v_mfma_f32_16x16x32_bf16 v[252:255], v[124:127], v[92:95], v[252:255]
  s_waitcnt lgkmcnt(4)
  v_mfma_f32_16x16x32_bf16 v[192:195], v[96:99], v[64:67], v[192:195]
  s_xor_b32 s76, s84, 65536
  s_sub_u32 s76, s76, s84
  ds_read_b64_tr_b16 v[112:113], v27 offset:8192
  v_mfma_f32_16x16x32_bf16 v[200:203], v[96:99], v[68:71], v[200:203]
  s_add_u32 s76, s76, s79
  s_add_u32 s76, s76, 0x1000
  ds_read_b64_tr_b16 v[114:115], v27 offset:12288
  v_mfma_f32_16x16x32_bf16 v[224:227], v[96:99], v[72:75], v[224:227]
  ds_read_b128 v[80:83], v26 offset:1024
  buffer_load_dwordx4 v[160:163], v15, s[44:47], s76 offen offset:0 sc1
  v_mfma_f32_16x16x32_bf16 v[232:235], v[96:99], v[76:79], v[232:235]
  ds_read_b128 v[84:87], v26 offset:3072
  v_mfma_f32_16x16x32_bf16 v[196:199], v[100:103], v[64:67], v[196:199]
  ds_read_b128 v[88:91], v26 offset:5120
  buffer_load_dwordx4 v[164:167], v15, s[44:47], s76 offen offset:1024 sc1
  v_mfma_f32_16x16x32_bf16 v[204:207], v[100:103], v[68:71], v[204:207]
  ds_read_b128 v[92:95], v26 offset:7168
  v_mfma_f32_16x16x32_bf16 v[228:231], v[100:103], v[72:75], v[228:231]
  s_xor_b32 s76, s84, 98304
  s_sub_u32 s76, s76, s84
  ds_read_b64_tr_b16 v[116:117], v29 offset:8192
  v_mfma_f32_16x16x32_bf16 v[236:239], v[100:103], v[76:79], v[236:239]
  s_waitcnt lgkmcnt(7)
  s_add_u32 s76, s76, s79
  ds_read_b64_tr_b16 v[118:119], v29 offset:12288
  v_mfma_f32_16x16x32_bf16 v[208:211], v[104:107], v[64:67], v[208:211]
  s_add_u32 s76, s76, 0x1800
  ds_read_b64_tr_b16 v[120:121], v27 offset:8448
  buffer_load_dwordx4 v[176:179], v15, s[44:47], s76 offen offset:0 sc1
  v_mfma_f32_16x16x32_bf16 v[216:219], v[104:107], v[68:71], v[216:219]
  ds_read_b64_tr_b16 v[122:123], v27 offset:12544
  v_mfma_f32_16x16x32_bf16 v[240:243], v[104:107], v[72:75], v[240:243]
  ds_read_b64_tr_b16 v[124:125], v29 offset:8448
  buffer_load_dwordx4 v[180:183], v15, s[44:47], s76 offen offset:1024 sc1
  v_mfma_f32_16x16x32_bf16 v[248:251], v[104:107], v[76:79], v[248:251]
  ds_read_b64_tr_b16 v[126:127], v29 offset:12544
  v_mfma_f32_16x16x32_bf16 v[212:215], v[108:111], v[64:67], v[212:215]
  buffer_load_dwordx4 v[16:19], v53, s[48:51], 0 offen
  v_mfma_f32_16x16x32_bf16 v[220:223], v[108:111], v[68:71], v[220:223]
  v_mfma_f32_16x16x32_bf16 v[244:247], v[108:111], v[72:75], v[244:247]
  v_mfma_f32_16x16x32_bf16 v[252:255], v[108:111], v[76:79], v[252:255]
  s_waitcnt lgkmcnt(4)
  s_barrier
  v_mfma_f32_16x16x32_bf16 v[192:195], v[112:115], v[80:83], v[192:195]
  ds_read_b64_tr_b16 v[96:97], v2 offset:0
  buffer_load_dwordx4 v[20:23], v53, s[48:51], s1 offen
  v_mfma_f32_16x16x32_bf16 v[200:203], v[112:115], v[84:87], v[200:203]
  ds_read_b64_tr_b16 v[98:99], v2 offset:4096
  v_mfma_f32_16x16x32_bf16 v[224:227], v[112:115], v[88:91], v[224:227]
  ds_read_b128 v[64:67], v24 offset:0
  v_mfma_f32_16x16x32_bf16 v[232:235], v[112:115], v[92:95], v[232:235]
  ds_read_b128 v[68:71], v24 offset:2048
  v_mfma_f32_16x16x32_bf16 v[196:199], v[116:119], v[80:83], v[196:199]
  ds_read_b128 v[72:75], v24 offset:4096
  v_mfma_f32_16x16x32_bf16 v[204:207], v[116:119], v[84:87], v[204:207]
  ds_read_b128 v[76:79], v24 offset:6144
  v_mfma_f32_16x16x32_bf16 v[228:231], v[116:119], v[88:91], v[228:231]
  ds_read_b64_tr_b16 v[100:101], v3 offset:0
  v_mfma_f32_16x16x32_bf16 v[236:239], v[116:119], v[92:95], v[236:239]
  s_waitcnt lgkmcnt(7)
  ds_read_b64_tr_b16 v[102:103], v3 offset:4096
  v_mfma_f32_16x16x32_bf16 v[208:211], v[120:123], v[80:83], v[208:211]
  ds_read_b64_tr_b16 v[104:105], v2 offset:256
  v_mfma_f32_16x16x32_bf16 v[216:219], v[120:123], v[84:87], v[216:219]
  ds_read_b64_tr_b16 v[106:107], v2 offset:4352
  v_mfma_f32_16x16x32_bf16 v[240:243], v[120:123], v[88:91], v[240:243]
  ds_read_b64_tr_b16 v[108:109], v3 offset:256
  v_mfma_f32_16x16x32_bf16 v[248:251], v[120:123], v[92:95], v[248:251]
  ds_read_b64_tr_b16 v[110:111], v3 offset:4352
  v_mfma_f32_16x16x32_bf16 v[212:215], v[124:127], v[80:83], v[212:215]
  v_mfma_f32_16x16x32_bf16 v[220:223], v[124:127], v[84:87], v[220:223]
  v_mfma_f32_16x16x32_bf16 v[244:247], v[124:127], v[88:91], v[244:247]
  v_mfma_f32_16x16x32_bf16 v[252:255], v[124:127], v[92:95], v[252:255]
  s_waitcnt lgkmcnt(4)
  v_mfma_f32_16x16x32_bf16 v[192:195], v[96:99], v[64:67], v[192:195]
  ds_read_b64_tr_b16 v[112:113], v2 offset:8192
  v_mfma_f32_16x16x32_bf16 v[200:203], v[96:99], v[68:71], v[200:203]
  ds_read_b64_tr_b16 v[114:115], v2 offset:12288
  v_mfma_f32_16x16x32_bf16 v[224:227], v[96:99], v[72:75], v[224:227]
  ds_read_b128 v[80:83], v24 offset:1024
  v_mfma_f32_16x16x32_bf16 v[232:235], v[96:99], v[76:79], v[232:235]
  ds_read_b128 v[84:87], v24 offset:3072
  v_mfma_f32_16x16x32_bf16 v[196:199], v[100:103], v[64:67], v[196:199]
  ds_read_b128 v[88:91], v24 offset:5120
  v_mfma_f32_16x16x32_bf16 v[204:207], v[100:103], v[68:71], v[204:207]
  ds_read_b128 v[92:95], v24 offset:7168
  v_mfma_f32_16x16x32_bf16 v[228:231], v[100:103], v[72:75], v[228:231]
  ds_read_b64_tr_b16 v[116:117], v3 offset:8192
  v_mfma_f32_16x16x32_bf16 v[236:239], v[100:103], v[76:79], v[236:239]
  s_waitcnt lgkmcnt(7)
  ds_read_b64_tr_b16 v[118:119], v3 offset:12288
  v_mfma_f32_16x16x32_bf16 v[208:211], v[104:107], v[64:67], v[208:211]
  ds_read_b64_tr_b16 v[120:121], v2 offset:8448
  v_mfma_f32_16x16x32_bf16 v[216:219], v[104:107], v[68:71], v[216:219]
  ds_read_b64_tr_b16 v[122:123], v2 offset:12544
  v_mfma_f32_16x16x32_bf16 v[240:243], v[104:107], v[72:75], v[240:243]
  ds_read_b64_tr_b16 v[124:125], v3 offset:8448
  v_mfma_f32_16x16x32_bf16 v[248:251], v[104:107], v[76:79], v[248:251]
  ds_read_b64_tr_b16 v[126:127], v3 offset:12544
  v_mfma_f32_16x16x32_bf16 v[212:215], v[108:111], v[64:67], v[212:215]
  v_mfma_f32_16x16x32_bf16 v[220:223], v[108:111], v[68:71], v[220:223]
  v_mfma_f32_16x16x32_bf16 v[244:247], v[108:111], v[72:75], v[244:247]
  v_mfma_f32_16x16x32_bf16 v[252:255], v[108:111], v[76:79], v[252:255]
  s_waitcnt lgkmcnt(4)
  s_waitcnt vmcnt(8)
  s_barrier
  v_mfma_f32_16x16x32_bf16 v[192:195], v[112:115], v[80:83], v[192:195]
  ds_read_b64_tr_b16 v[96:97], v2 offset:32768
  v_mfma_f32_16x16x32_bf16 v[200:203], v[112:115], v[84:87], v[200:203]
  ds_read_b64_tr_b16 v[98:99], v2 offset:36864
  v_mfma_f32_16x16x32_bf16 v[224:227], v[112:115], v[88:91], v[224:227]
  ds_read_b128 v[64:67], v24 offset:32768
  v_mfma_f32_16x16x32_bf16 v[232:235], v[112:115], v[92:95], v[232:235]
  ds_read_b128 v[68:71], v24 offset:34816
  v_mfma_f32_16x16x32_bf16 v[196:199], v[116:119], v[80:83], v[196:199]
  ds_read_b128 v[72:75], v24 offset:36864
  v_mfma_f32_16x16x32_bf16 v[204:207], v[116:119], v[84:87], v[204:207]
  ds_read_b128 v[76:79], v24 offset:38912
  v_mfma_f32_16x16x32_bf16 v[228:231], v[116:119], v[88:91], v[228:231]
  ds_read_b64_tr_b16 v[100:101], v3 offset:32768
  v_mfma_f32_16x16x32_bf16 v[236:239], v[116:119], v[92:95], v[236:239]
  s_waitcnt lgkmcnt(7)
  ds_read_b64_tr_b16 v[102:103], v3 offset:36864
  v_mfma_f32_16x16x32_bf16 v[208:211], v[120:123], v[80:83], v[208:211]
  ds_read_b64_tr_b16 v[104:105], v2 offset:33024
  v_mfma_f32_16x16x32_bf16 v[216:219], v[120:123], v[84:87], v[216:219]
  ds_read_b64_tr_b16 v[106:107], v2 offset:37120
  v_mfma_f32_16x16x32_bf16 v[240:243], v[120:123], v[88:91], v[240:243]
  ds_read_b64_tr_b16 v[108:109], v3 offset:33024
  v_mfma_f32_16x16x32_bf16 v[248:251], v[120:123], v[92:95], v[248:251]
  ds_read_b64_tr_b16 v[110:111], v3 offset:37120
  v_mfma_f32_16x16x32_bf16 v[212:215], v[124:127], v[80:83], v[212:215]
  v_mfma_f32_16x16x32_bf16 v[220:223], v[124:127], v[84:87], v[220:223]
  v_mfma_f32_16x16x32_bf16 v[244:247], v[124:127], v[88:91], v[244:247]
  v_mfma_f32_16x16x32_bf16 v[252:255], v[124:127], v[92:95], v[252:255]
  s_waitcnt lgkmcnt(4)
  v_mfma_f32_16x16x32_bf16 v[192:195], v[96:99], v[64:67], v[192:195]
  ds_read_b64_tr_b16 v[112:113], v2 offset:40960
  v_mfma_f32_16x16x32_bf16 v[200:203], v[96:99], v[68:71], v[200:203]
  ds_read_b64_tr_b16 v[114:115], v2 offset:45056
  v_mfma_f32_16x16x32_bf16 v[224:227], v[96:99], v[72:75], v[224:227]
  ds_read_b128 v[80:83], v24 offset:33792
  v_mfma_f32_16x16x32_bf16 v[232:235], v[96:99], v[76:79], v[232:235]
  ds_read_b128 v[84:87], v24 offset:35840
  v_mfma_f32_16x16x32_bf16 v[196:199], v[100:103], v[64:67], v[196:199]
  ds_read_b128 v[88:91], v24 offset:37888
  v_mfma_f32_16x16x32_bf16 v[204:207], v[100:103], v[68:71], v[204:207]
  ds_read_b128 v[92:95], v24 offset:39936
  v_mfma_f32_16x16x32_bf16 v[228:231], v[100:103], v[72:75], v[228:231]
  ds_read_b64_tr_b16 v[116:117], v3 offset:40960
  v_mfma_f32_16x16x32_bf16 v[236:239], v[100:103], v[76:79], v[236:239]
  s_waitcnt lgkmcnt(7)
  ds_read_b64_tr_b16 v[118:119], v3 offset:45056
  v_mfma_f32_16x16x32_bf16 v[208:211], v[104:107], v[64:67], v[208:211]
  ds_read_b64_tr_b16 v[120:121], v2 offset:41216
  v_mfma_f32_16x16x32_bf16 v[216:219], v[104:107], v[68:71], v[216:219]
  ds_read_b64_tr_b16 v[122:123], v2 offset:45312
  v_mfma_f32_16x16x32_bf16 v[240:243], v[104:107], v[72:75], v[240:243]
  ds_read_b64_tr_b16 v[124:125], v3 offset:41216
  v_mfma_f32_16x16x32_bf16 v[248:251], v[104:107], v[76:79], v[248:251]
  ds_read_b64_tr_b16 v[126:127], v3 offset:45312
  v_mfma_f32_16x16x32_bf16 v[212:215], v[108:111], v[64:67], v[212:215]
  v_mfma_f32_16x16x32_bf16 v[220:223], v[108:111], v[68:71], v[220:223]
  v_mfma_f32_16x16x32_bf16 v[244:247], v[108:111], v[72:75], v[244:247]
  v_mfma_f32_16x16x32_bf16 v[252:255], v[108:111], v[76:79], v[252:255]
  s_waitcnt lgkmcnt(0)
  v_mfma_f32_16x16x32_bf16 v[208:211], v[120:123], v[80:83], v[208:211]
  v_mfma_f32_16x16x32_bf16 v[216:219], v[120:123], v[84:87], v[216:219]
  v_mfma_f32_16x16x32_bf16 v[212:215], v[124:127], v[80:83], v[212:215]
  v_mfma_f32_16x16x32_bf16 v[220:223], v[124:127], v[84:87], v[220:223]
  v_mfma_f32_16x16x32_bf16 v[224:227], v[112:115], v[88:91], v[224:227]
  v_mfma_f32_16x16x32_bf16 v[232:235], v[112:115], v[92:95], v[232:235]
  v_mfma_f32_16x16x32_bf16 v[228:231], v[116:119], v[88:91], v[228:231]
  v_mfma_f32_16x16x32_bf16 v[236:239], v[116:119], v[92:95], v[236:239]
  v_mfma_f32_16x16x32_bf16 v[240:243], v[120:123], v[88:91], v[240:243]
  v_cvt_pk_bf16_f32 v208, v208, v209
  v_cvt_pk_bf16_f32 v209, v210, v211
  v_mfma_f32_16x16x32_bf16 v[248:251], v[120:123], v[92:95], v[248:251]
  v_cvt_pk_bf16_f32 v210, v212, v213
  v_cvt_pk_bf16_f32 v211, v214, v215
  v_mfma_f32_16x16x32_bf16 v[244:247], v[124:127], v[88:91], v[244:247]
  v_cvt_pk_bf16_f32 v212, v216, v217
  v_cvt_pk_bf16_f32 v213, v218, v219
  v_mfma_f32_16x16x32_bf16 v[252:255], v[124:127], v[92:95], v[252:255]
  s_add_u32 s75, s79, 0x800000
  v_cvt_pk_bf16_f32 v214, v220, v221
  v_cvt_pk_bf16_f32 v215, v222, v223
  v_mfma_f32_16x16x32_bf16 v[192:195], v[112:115], v[80:83], v[192:195]
  buffer_store_dwordx4 v[208:211], v15, s[44:47], s75 offen offset:2048 sc1
  v_mfma_f32_16x16x32_bf16 v[200:203], v[112:115], v[84:87], v[200:203]
  v_mfma_f32_16x16x32_bf16 v[196:199], v[116:119], v[80:83], v[196:199]
  buffer_store_dwordx4 v[212:215], v15, s[44:47], s75 offen offset:3072 sc1
  v_mfma_f32_16x16x32_bf16 v[204:207], v[116:119], v[84:87], v[204:207]
  v_cvt_pk_bf16_f32 v224, v224, v225
  v_cvt_pk_bf16_f32 v225, v226, v227
  v_cvt_pk_bf16_f32 v226, v228, v229
  v_cvt_pk_bf16_f32 v227, v230, v231
  v_cvt_pk_bf16_f32 v228, v232, v233
  v_cvt_pk_bf16_f32 v229, v234, v235
  v_cvt_pk_bf16_f32 v230, v236, v237
  v_cvt_pk_bf16_f32 v231, v238, v239
  s_add_u32 s75, s79, 0x801000
  buffer_store_dwordx4 v[224:227], v15, s[44:47], s75 offen offset:0 sc1
  buffer_store_dwordx4 v[228:231], v15, s[44:47], s75 offen offset:1024 sc1
  v_cvt_pk_bf16_f32 v240, v240, v241
  v_cvt_pk_bf16_f32 v241, v242, v243
  v_cvt_pk_bf16_f32 v242, v244, v245
  v_cvt_pk_bf16_f32 v243, v246, v247
  v_cvt_pk_bf16_f32 v244, v248, v249
  v_cvt_pk_bf16_f32 v245, v250, v251
  v_cvt_pk_bf16_f32 v246, v252, v253
  v_cvt_pk_bf16_f32 v247, v254, v255
  buffer_store_dwordx4 v[240:243], v15, s[44:47], s75 offen offset:2048 sc1
  buffer_store_dwordx4 v[244:247], v15, s[44:47], s75 offen offset:3072 sc1
  s_waitcnt vmcnt(13)
  v_lshlrev_b32 v32, 16, v144
  v_and_b32 v33, 0xffff0000, v144
  v_lshlrev_b32 v34, 16, v145
  v_and_b32 v35, 0xffff0000, v145
  v_lshlrev_b32 v36, 16, v146
  v_and_b32 v37, 0xffff0000, v146
  v_lshlrev_b32 v38, 16, v147
  v_and_b32 v39, 0xffff0000, v147
  s_waitcnt vmcnt(12)
  v_lshlrev_b32 v40, 16, v148
  v_and_b32 v41, 0xffff0000, v148
  v_lshlrev_b32 v42, 16, v149
  v_and_b32 v43, 0xffff0000, v149
  v_lshlrev_b32 v44, 16, v150
  v_and_b32 v45, 0xffff0000, v150
  v_lshlrev_b32 v46, 16, v151
  v_and_b32 v47, 0xffff0000, v151
  v_pk_add_f32 v[128:129], v[128:129], v[32:33]
  v_pk_add_f32 v[130:131], v[130:131], v[34:35]
  v_pk_add_f32 v[132:133], v[132:133], v[36:37]
  v_pk_add_f32 v[134:135], v[134:135], v[38:39]
  v_pk_add_f32 v[136:137], v[136:137], v[40:41]
  v_pk_add_f32 v[138:139], v[138:139], v[42:43]
  v_pk_add_f32 v[140:141], v[140:141], v[44:45]
  v_pk_add_f32 v[142:143], v[142:143], v[46:47]
  s_waitcnt vmcnt(11)
  v_lshlrev_b32 v32, 16, v160
  v_and_b32 v33, 0xffff0000, v160
  v_lshlrev_b32 v34, 16, v161
  v_and_b32 v35, 0xffff0000, v161
  v_lshlrev_b32 v36, 16, v162
  v_and_b32 v37, 0xffff0000, v162
  v_lshlrev_b32 v38, 16, v163
  v_and_b32 v39, 0xffff0000, v163
  s_waitcnt vmcnt(10)
  v_lshlrev_b32 v40, 16, v164
  v_and_b32 v41, 0xffff0000, v164
  v_lshlrev_b32 v42, 16, v165
  v_and_b32 v43, 0xffff0000, v165
  v_lshlrev_b32 v44, 16, v166
  v_and_b32 v45, 0xffff0000, v166
  v_lshlrev_b32 v46, 16, v167
  v_and_b32 v47, 0xffff0000, v167
  v_pk_add_f32 v[128:129], v[128:129], v[32:33]
  v_pk_add_f32 v[130:131], v[130:131], v[34:35]
  v_pk_add_f32 v[132:133], v[132:133], v[36:37]
  v_pk_add_f32 v[134:135], v[134:135], v[38:39]
  v_pk_add_f32 v[136:137], v[136:137], v[40:41]
  v_pk_add_f32 v[138:139], v[138:139], v[42:43]
  v_pk_add_f32 v[140:141], v[140:141], v[44:45]
  v_pk_add_f32 v[142:143], v[142:143], v[46:47]
  s_waitcnt vmcnt(9)
  v_lshlrev_b32 v32, 16, v176
  v_and_b32 v33, 0xffff0000, v176
  v_lshlrev_b32 v34, 16, v177
  v_and_b32 v35, 0xffff0000, v177
  v_lshlrev_b32 v36, 16, v178
  v_and_b32 v37, 0xffff0000, v178
  v_lshlrev_b32 v38, 16, v179
  v_and_b32 v39, 0xffff0000, v179
  s_waitcnt vmcnt(8)
  v_lshlrev_b32 v40, 16, v180
  v_and_b32 v41, 0xffff0000, v180
  v_lshlrev_b32 v42, 16, v181
  v_and_b32 v43, 0xffff0000, v181
  v_lshlrev_b32 v44, 16, v182
  v_and_b32 v45, 0xffff0000, v182
  v_lshlrev_b32 v46, 16, v183
  v_and_b32 v47, 0xffff0000, v183
  v_pk_add_f32 v[128:129], v[128:129], v[32:33]
  v_pk_add_f32 v[130:131], v[130:131], v[34:35]
  v_pk_add_f32 v[132:133], v[132:133], v[36:37]
  v_pk_add_f32 v[134:135], v[134:135], v[38:39]
  v_pk_add_f32 v[136:137], v[136:137], v[40:41]
  v_pk_add_f32 v[138:139], v[138:139], v[42:43]
  v_pk_add_f32 v[140:141], v[140:141], v[44:45]
  v_pk_add_f32 v[142:143], v[142:143], v[46:47]
  v_cvt_pk_bf16_f32 v128, v128, v129
  v_and_b32 v129, 0xffff0000, v128
  v_lshlrev_b32 v128, 16, v128
  v_cvt_pk_bf16_f32 v130, v130, v131
  v_and_b32 v131, 0xffff0000, v130
  v_lshlrev_b32 v130, 16, v130
  v_cvt_pk_bf16_f32 v132, v132, v133
  v_and_b32 v133, 0xffff0000, v132
  v_lshlrev_b32 v132, 16, v132
  v_cvt_pk_bf16_f32 v134, v134, v135
  v_and_b32 v135, 0xffff0000, v134
  v_lshlrev_b32 v134, 16, v134
  v_cvt_pk_bf16_f32 v136, v136, v137
  v_and_b32 v137, 0xffff0000, v136
  v_lshlrev_b32 v136, 16, v136
  v_cvt_pk_bf16_f32 v138, v138, v139
  v_and_b32 v139, 0xffff0000, v138
  v_lshlrev_b32 v138, 16, v138
  v_cvt_pk_bf16_f32 v140, v140, v141
  v_and_b32 v141, 0xffff0000, v140
  v_lshlrev_b32 v140, 16, v140
  v_cvt_pk_bf16_f32 v142, v142, v143
  v_and_b32 v143, 0xffff0000, v142
  v_lshlrev_b32 v142, 16, v142
  s_mov_b32 s77, 0xbfb8aa3b
  v_mul_f32 v32, s77, v128
  v_mul_f32 v33, s77, v129
  v_mul_f32 v34, s77, v130
  v_mul_f32 v35, s77, v131
  v_mul_f32 v36, s77, v132
  v_mul_f32 v37, s77, v133
  v_mul_f32 v38, s77, v134
  v_mul_f32 v39, s77, v135
  v_mul_f32 v40, s77, v136
  v_mul_f32 v41, s77, v137
  v_mul_f32 v42, s77, v138
  v_mul_f32 v43, s77, v139
  v_mul_f32 v44, s77, v140
  v_mul_f32 v45, s77, v141
  v_mul_f32 v46, s77, v142
  v_mul_f32 v47, s77, v143
  v_exp_f32 v32, v32
  v_exp_f32 v33, v33
  v_exp_f32 v34, v34
  v_exp_f32 v35, v35
  v_exp_f32 v36, v36
  v_exp_f32 v37, v37
  v_exp_f32 v38, v38
  v_exp_f32 v39, v39
  v_exp_f32 v40, v40
  v_exp_f32 v41, v41
  v_exp_f32 v42, v42
  v_exp_f32 v43, v43
  v_exp_f32 v44, v44
  v_exp_f32 v45, v45
  v_exp_f32 v46, v46
  v_exp_f32 v47, v47
  v_add_f32 v32, 1.0, v32
  v_add_f32 v33, 1.0, v33
  v_add_f32 v34, 1.0, v34
  v_add_f32 v35, 1.0, v35
  v_add_f32 v36, 1.0, v36
  v_add_f32 v37, 1.0, v37
  v_add_f32 v38, 1.0, v38
  v_add_f32 v39, 1.0, v39
  v_add_f32 v40, 1.0, v40
  v_add_f32 v41, 1.0, v41
  v_add_f32 v42, 1.0, v42
  v_add_f32 v43, 1.0, v43
  v_add_f32 v44, 1.0, v44
  v_add_f32 v45, 1.0, v45
  v_add_f32 v46, 1.0, v46
  v_add_f32 v47, 1.0, v47
  v_rcp_f32 v32, v32
  v_rcp_f32 v33, v33
  v_rcp_f32 v34, v34
  v_rcp_f32 v35, v35
  v_rcp_f32 v36, v36
  v_rcp_f32 v37, v37
  v_rcp_f32 v38, v38
  v_rcp_f32 v39, v39
  v_rcp_f32 v40, v40
  v_rcp_f32 v41, v41
  v_rcp_f32 v42, v42
  v_rcp_f32 v43, v43
  v_rcp_f32 v44, v44
  v_rcp_f32 v45, v45
  v_rcp_f32 v46, v46
  v_rcp_f32 v47, v47
  v_pk_mul_f32 v[128:129], v[128:129], v[32:33]
  v_pk_mul_f32 v[130:131], v[130:131], v[34:35]
  v_pk_mul_f32 v[132:133], v[132:133], v[36:37]
  v_pk_mul_f32 v[134:135], v[134:135], v[38:39]
  v_pk_mul_f32 v[136:137], v[136:137], v[40:41]
  v_pk_mul_f32 v[138:139], v[138:139], v[42:43]
  v_pk_mul_f32 v[140:141], v[140:141], v[44:45]
  v_pk_mul_f32 v[142:143], v[142:143], v[46:47]
  v_cvt_pk_bf16_f32 v128, v128, v129
  v_and_b32 v129, 0xffff0000, v128
  v_lshlrev_b32 v128, 16, v128
  v_cvt_pk_bf16_f32 v130, v130, v131
  v_and_b32 v131, 0xffff0000, v130
  v_lshlrev_b32 v130, 16, v130
  v_cvt_pk_bf16_f32 v132, v132, v133
  v_and_b32 v133, 0xffff0000, v132
  v_lshlrev_b32 v132, 16, v132
  v_cvt_pk_bf16_f32 v134, v134, v135
  v_and_b32 v135, 0xffff0000, v134
  v_lshlrev_b32 v134, 16, v134
  v_cvt_pk_bf16_f32 v136, v136, v137
  v_and_b32 v137, 0xffff0000, v136
  v_lshlrev_b32 v136, 16, v136
  v_cvt_pk_bf16_f32 v138, v138, v139
  v_and_b32 v139, 0xffff0000, v138
  v_lshlrev_b32 v138, 16, v138
  v_cvt_pk_bf16_f32 v140, v140, v141
  v_and_b32 v141, 0xffff0000, v140
  v_lshlrev_b32 v140, 16, v140
  v_cvt_pk_bf16_f32 v142, v142, v143
  v_and_b32 v143, 0xffff0000, v142
  v_lshlrev_b32 v142, 16, v142
  s_waitcnt vmcnt(7)
  v_lshlrev_b32 v144, 16, v16
  v_and_b32 v145, 0xffff0000, v16
  v_lshlrev_b32 v146, 16, v17
  v_and_b32 v147, 0xffff0000, v17
  v_lshlrev_b32 v148, 16, v18
  v_and_b32 v149, 0xffff0000, v18
  v_lshlrev_b32 v150, 16, v19
  v_and_b32 v151, 0xffff0000, v19
  s_waitcnt vmcnt(6)
  v_lshlrev_b32 v152, 16, v20
  v_and_b32 v153, 0xffff0000, v20
  v_lshlrev_b32 v154, 16, v21
  v_and_b32 v155, 0xffff0000, v21
  v_lshlrev_b32 v156, 16, v22
  v_and_b32 v157, 0xffff0000, v22
  v_lshlrev_b32 v158, 16, v23
  v_and_b32 v159, 0xffff0000, v23
  s_waitcnt vmcnt(0)
  s_xor_b32 s76, s84, 32768
  s_sub_u32 s76, s76, s84
  s_add_u32 s76, s76, s79
  s_add_u32 s76, s76, 0x800800
  buffer_load_dwordx4 v[64:67], v15, s[44:47], s76 offen offset:0 sc1
  buffer_load_dwordx4 v[68:71], v15, s[44:47], s76 offen offset:1024 sc1
  s_xor_b32 s76, s84, 65536
  s_sub_u32 s76, s76, s84
  s_add_u32 s76, s76, s79
  s_add_u32 s76, s76, 0x801000
  buffer_load_dwordx4 v[72:75], v15, s[44:47], s76 offen offset:0 sc1
  buffer_load_dwordx4 v[76:79], v15, s[44:47], s76 offen offset:1024 sc1
  s_xor_b32 s76, s84, 98304
  s_sub_u32 s76, s76, s84
  s_add_u32 s76, s76, s79
  s_add_u32 s76, s76, 0x801800
  buffer_load_dwordx4 v[80:83], v15, s[44:47], s76 offen offset:0 sc1
  buffer_load_dwordx4 v[84:87], v15, s[44:47], s76 offen offset:1024 sc1
  s_waitcnt vmcnt(5)
  v_max3_u32 v112, v64, v65, v66
  s_waitcnt vmcnt(4)
  v_max3_u32 v112, v112, v67, v68
  v_max3_u32 v112, v112, v69, v70
  s_waitcnt vmcnt(3)
  v_max3_u32 v112, v112, v71, v72
  v_max3_u32 v112, v112, v73, v74
  s_waitcnt vmcnt(2)
  v_max3_u32 v112, v112, v75, v76
  v_max3_u32 v112, v112, v77, v78
  s_waitcnt vmcnt(1)
  v_max3_u32 v112, v112, v79, v80
  v_max3_u32 v112, v112, v81, v82
  s_waitcnt vmcnt(0)
  v_max3_u32 v112, v112, v83, v84
  v_max3_u32 v112, v112, v85, v86
  v_max_u32 v112, v112, v87
  v_cmp_eq_u32 vcc, -1, v112
  s_cbranch_vccnz Lspin15
Lback15:
  v_lshlrev_b32 v32, 16, v64
  v_and_b32 v33, 0xffff0000, v64
  v_lshlrev_b32 v34, 16, v65
  v_and_b32 v35, 0xffff0000, v65
  v_lshlrev_b32 v36, 16, v66
  v_and_b32 v37, 0xffff0000, v66
  v_lshlrev_b32 v38, 16, v67
  v_and_b32 v39, 0xffff0000, v67
  v_lshlrev_b32 v40, 16, v68
  v_and_b32 v41, 0xffff0000, v68
  v_lshlrev_b32 v42, 16, v69
  v_and_b32 v43, 0xffff0000, v69
  v_lshlrev_b32 v44, 16, v70
  v_and_b32 v45, 0xffff0000, v70
  v_lshlrev_b32 v46, 16, v71
  v_and_b32 v47, 0xffff0000, v71
  v_pk_add_f32 v[192:193], v[192:193], v[32:33]
  v_pk_add_f32 v[194:195], v[194:195], v[34:35]
  v_pk_add_f32 v[196:197], v[196:197], v[36:37]
  v_pk_add_f32 v[198:199], v[198:199], v[38:39]
  v_pk_add_f32 v[200:201], v[200:201], v[40:41]
  v_pk_add_f32 v[202:203], v[202:203], v[42:43]
  v_pk_add_f32 v[204:205], v[204:205], v[44:45]
  v_pk_add_f32 v[206:207], v[206:207], v[46:47]
  v_lshlrev_b32 v32, 16, v72
  v_and_b32 v33, 0xffff0000, v72
  v_lshlrev_b32 v34, 16, v73
  v_and_b32 v35, 0xffff0000, v73
  v_lshlrev_b32 v36, 16, v74
  v_and_b32 v37, 0xffff0000, v74
  v_lshlrev_b32 v38, 16, v75
  v_and_b32 v39, 0xffff0000, v75
  v_lshlrev_b32 v40, 16, v76
  v_and_b32 v41, 0xffff0000, v76
  v_lshlrev_b32 v42, 16, v77
  v_and_b32 v43, 0xffff0000, v77
  v_lshlrev_b32 v44, 16, v78
  v_and_b32 v45, 0xffff0000, v78
  v_lshlrev_b32 v46, 16, v79
  v_and_b32 v47, 0xffff0000, v79
  v_pk_add_f32 v[192:193], v[192:193], v[32:33]
  v_pk_add_f32 v[194:195], v[194:195], v[34:35]
  v_pk_add_f32 v[196:197], v[196:197], v[36:37]
  v_pk_add_f32 v[198:199], v[198:199], v[38:39]
  v_pk_add_f32 v[200:201], v[200:201], v[40:41]
  v_pk_add_f32 v[202:203], v[202:203], v[42:43]
  v_pk_add_f32 v[204:205], v[204:205], v[44:45]
  v_pk_add_f32 v[206:207], v[206:207], v[46:47]
  v_lshlrev_b32 v32, 16, v80
  v_and_b32 v33, 0xffff0000, v80
  v_lshlrev_b32 v34, 16, v81
  v_and_b32 v35, 0xffff0000, v81
  v_lshlrev_b32 v36, 16, v82
  v_and_b32 v37, 0xffff0000, v82
  v_lshlrev_b32 v38, 16, v83
  v_and_b32 v39, 0xffff0000, v83
  v_lshlrev_b32 v40, 16, v84
  v_and_b32 v41, 0xffff0000, v84
  v_lshlrev_b32 v42, 16, v85
  v_and_b32 v43, 0xffff0000, v85
  v_lshlrev_b32 v44, 16, v86
  v_and_b32 v45, 0xffff0000, v86
  v_lshlrev_b32 v46, 16, v87
  v_and_b32 v47, 0xffff0000, v87
  v_pk_add_f32 v[192:193], v[192:193], v[32:33]
  v_pk_add_f32 v[194:195], v[194:195], v[34:35]
  v_pk_add_f32 v[196:197], v[196:197], v[36:37]
  v_pk_add_f32 v[198:199], v[198:199], v[38:39]
  v_pk_add_f32 v[200:201], v[200:201], v[40:41]
  v_pk_add_f32 v[202:203], v[202:203], v[42:43]
  v_pk_add_f32 v[204:205], v[204:205], v[44:45]
  v_pk_add_f32 v[206:207], v[206:207], v[46:47]
  v_cvt_pk_bf16_f32 v192, v192, v193
  v_and_b32 v193, 0xffff0000, v192
  v_lshlrev_b32 v192, 16, v192
  v_cvt_pk_bf16_f32 v194, v194, v195
  v_and_b32 v195, 0xffff0000, v194
  v_lshlrev_b32 v194, 16, v194
  v_cvt_pk_bf16_f32 v196, v196, v197
  v_and_b32 v197, 0xffff0000, v196
  v_lshlrev_b32 v196, 16, v196
  v_cvt_pk_bf16_f32 v198, v198, v199
  v_and_b32 v199, 0xffff0000, v198
  v_lshlrev_b32 v198, 16, v198
  v_cvt_pk_bf16_f32 v200, v200, v201
  v_and_b32 v201, 0xffff0000, v200
  v_lshlrev_b32 v200, 16, v200
  v_cvt_pk_bf16_f32 v202, v202, v203
  v_and_b32 v203, 0xffff0000, v202
  v_lshlrev_b32 v202, 16, v202
  v_cvt_pk_bf16_f32 v204, v204, v205
  v_and_b32 v205, 0xffff0000, v204
  v_lshlrev_b32 v204, 16, v204
  v_cvt_pk_bf16_f32 v206, v206, v207
  v_and_b32 v207, 0xffff0000, v206
  v_lshlrev_b32 v206, 16, v206
  v_pk_mul_f32 v[128:129], v[128:129], v[192:193]
  v_pk_mul_f32 v[130:131], v[130:131], v[194:195]
  v_pk_mul_f32 v[132:133], v[132:133], v[196:197]
  v_pk_mul_f32 v[134:135], v[134:135], v[198:199]
  v_pk_mul_f32 v[136:137], v[136:137], v[200:201]
  v_pk_mul_f32 v[138:139], v[138:139], v[202:203]
  v_pk_mul_f32 v[140:141], v[140:141], v[204:205]
  v_pk_mul_f32 v[142:143], v[142:143], v[206:207]
  v_cvt_pk_bf16_f32 v192, v128, v129
  v_cvt_pk_bf16_f32 v193, v130, v131
  v_cvt_pk_bf16_f32 v194, v132, v133
  v_cvt_pk_bf16_f32 v195, v134, v135
  v_cvt_pk_bf16_f32 v196, v136, v137
  v_cvt_pk_bf16_f32 v197, v138, v139
  v_cvt_pk_bf16_f32 v198, v140, v141
  v_cvt_pk_bf16_f32 v199, v142, v143
  v_permlane16_swap_b32 v192, v194
  v_permlane16_swap_b32 v193, v195
  v_permlane16_swap_b32 v196, v198
  v_permlane16_swap_b32 v197, v199
  v_lshlrev_b32 v128, 16, v192
  v_and_b32 v129, 0xffff0000, v192
  v_lshlrev_b32 v130, 16, v193
  v_and_b32 v131, 0xffff0000, v193
  v_lshlrev_b32 v132, 16, v194
  v_and_b32 v133, 0xffff0000, v194
  v_lshlrev_b32 v134, 16, v195
  v_and_b32 v135, 0xffff0000, v195
  v_lshlrev_b32 v136, 16, v196
  v_and_b32 v137, 0xffff0000, v196
  v_lshlrev_b32 v138, 16, v197
  v_and_b32 v139, 0xffff0000, v197
  v_lshlrev_b32 v140, 16, v198
  v_and_b32 v141, 0xffff0000, v198
  v_lshlrev_b32 v142, 16, v199
  v_and_b32 v143, 0xffff0000, v199
  v_pk_add_f32 v[128:129], v[128:129], v[144:145]
  v_pk_add_f32 v[130:131], v[130:131], v[146:147]
  v_pk_add_f32 v[132:133], v[132:133], v[148:149]
  v_pk_add_f32 v[134:135], v[134:135], v[150:151]
  v_pk_add_f32 v[136:137], v[136:137], v[152:153]
  v_pk_add_f32 v[138:139], v[138:139], v[154:155]
  v_pk_add_f32 v[140:141], v[140:141], v[156:157]
  v_pk_add_f32 v[142:143], v[142:143], v[158:159]
  v_cvt_pk_bf16_f32 v192, v128, v129
  v_cvt_pk_bf16_f32 v193, v130, v131
  v_cvt_pk_bf16_f32 v194, v132, v133
  v_cvt_pk_bf16_f32 v195, v134, v135
  v_cvt_pk_bf16_f32 v196, v136, v137
  v_cvt_pk_bf16_f32 v197, v138, v139
  v_cvt_pk_bf16_f32 v198, v140, v141
  v_cvt_pk_bf16_f32 v199, v142, v143
  buffer_store_dwordx4 v[192:195], v53, s[60:63], 0 offen
  buffer_store_dwordx4 v[196:199], v53, s[60:63], s1 offen
  s_waitcnt vmcnt(0)
L_end:
  s_endpgm
L_diag0:
  s_nop 7
  v_mov_b32 v240, 0
  v_mov_b32 v241, 0
  v_mov_b32 v242, 0
  v_mov_b32 v243, 0
  v_mov_b32 v244, 0
  v_mov_b32 v245, 0
  v_mov_b32 v246, 0
  v_mov_b32 v247, 0
  s_mov_b32 s75, 0
  s_call_b64 s[98:99], Lmask
  v_add_f32 v144, v144, v240
  v_add_f32 v145, v145, v241
  v_add_f32 v146, v146, v242
  v_add_f32 v147, v147, v243
  v_add_f32 v148, v148, v244
  v_add_f32 v149, v149, v245
  v_add_f32 v150, v150, v246
  v_add_f32 v151, v151, v247
  s_branch L_diag0r
Lwb:
  buffer_wbl2 sc1
  s_waitcnt vmcnt(0)
  s_branch Lwbr
Lspin1:
  s_mov_b32 s80, 0
Lspinl1:
  s_sleep 2
  global_load_dword v52, v16, s[66:67] sc1
  s_waitcnt vmcnt(0)
  v_cmp_eq_u32 vcc, 0, v52
  s_cbranch_vccz Lback1
  s_add_u32 s80, s80, 1
  s_cmp_lt_u32 s80, 65536
  s_cbranch_scc1 Lspinl1
  s_branch Lback1
Lspin8:
  s_mov_b32 s80, 0
Lspinl8:
  s_sleep 2
  buffer_load_dword v49, v50, s[44:47], 0 offen sc1
  s_waitcnt vmcnt(0)
  v_cmp_ne_u32 vcc, v52, v49
  s_cbranch_vccz Lback8
  s_add_u32 s80, s80, 1
  s_cmp_lt_u32 s80, 65536
  s_cbranch_scc1 Lspinl8
  s_branch Lback8
Lspin9:
  s_mov_b32 s80, 0
Lspinl9:
  s_sleep 2
  buffer_load_dword v49, v50, s[44:47], 0 offen sc1
  s_waitcnt vmcnt(0)
  v_cmp_ne_u32 vcc, v52, v49
  s_cbranch_vccz Lback9
  s_add_u32 s80, s80, 1
  s_cmp_lt_u32 s80, 65536
  s_cbranch_scc1 Lspinl9
  s_branch Lback9
Lspin11:
  s_mov_b32 s80, 0
Lspinl11:
  s_sleep 2
  buffer_load_dword v49, v50, s[44:47], 0 offen sc1
  s_waitcnt vmcnt(0)
  v_cmp_ne_u32 vcc, v52, v49
  s_cbranch_vccz Lback11
  s_add_u32 s80, s80, 1
  s_cmp_lt_u32 s80, 65536
  s_cbranch_scc1 Lspinl11
  s_branch Lback11
LrealE:
  s_nop 15
  v_max3_f32 v36, v128, v129, v130
  v_max3_f32 v36, v36, v131, v132
  v_max3_f32 v36, v36, v133, v134
  v_max_f32 v36, v36, v135
  v_mov_b32 v62, v36
  s_nop 1
  v_permlane16_swap_b32 v36, v62
  v_max_f32 v36, v36, v62
  v_mov_b32 v62, v36
  s_nop 1
  v_permlane32_swap_b32 v36, v62
  v_max_f32 v36, v36, v62
  v_max_f32 v36, 0, v36
  v_sub_f32 v128, v128, v36
  v_sub_f32 v129, v129, v36
  v_sub_f32 v130, v130, v36
  v_sub_f32 v131, v131, v36
  v_sub_f32 v132, v132, v36
  v_sub_f32 v133, v133, v36
  v_sub_f32 v134, v134, v36
  v_sub_f32 v135, v135, v36
  v_sub_f32 v160, v160, v36
  v_sub_f32 v161, v161, v36
  v_sub_f32 v162, v162, v36
  v_sub_f32 v163, v163, v36
  v_sub_f32 v164, v164, v36
  v_sub_f32 v165, v165, v36
  v_sub_f32 v166, v166, v36
  v_sub_f32 v167, v167, v36
  v_sub_f32 v224, v224, v36
  v_sub_f32 v225, v225, v36
  v_sub_f32 v226, v226, v36
  v_sub_f32 v227, v227, v36
  v_sub_f32 v228, v228, v36
  v_sub_f32 v229, v229, v36
  v_sub_f32 v230, v230, v36
  v_sub_f32 v231, v231, v36
  v_sub_f32 v36, 0, v36
  v_exp_f32 v36, v36
  s_nop 0
  v_mul_f32 v56, v56, v36
  v_max3_f32 v37, v136, v137, v138
  v_max3_f32 v37, v37, v139, v140
  v_max3_f32 v37, v37, v141, v142
  v_max_f32 v37, v37, v143
  v_mov_b32 v62, v37
  s_nop 1
  v_permlane16_swap_b32 v37, v62
  v_max_f32 v37, v37, v62
  v_mov_b32 v62, v37
  s_nop 1
  v_permlane32_swap_b32 v37, v62
  v_max_f32 v37, v37, v62
  v_max_f32 v37, 0, v37
  v_sub_f32 v136, v136, v37
  v_sub_f32 v137, v137, v37
  v_sub_f32 v138, v138, v37
  v_sub_f32 v139, v139, v37
  v_sub_f32 v140, v140, v37
  v_sub_f32 v141, v141, v37
  v_sub_f32 v142, v142, v37
  v_sub_f32 v143, v143, v37
  v_sub_f32 v168, v168, v37
  v_sub_f32 v169, v169, v37
  v_sub_f32 v170, v170, v37
  v_sub_f32 v171, v171, v37
  v_sub_f32 v172, v172, v37
  v_sub_f32 v173, v173, v37
  v_sub_f32 v174, v174, v37
  v_sub_f32 v175, v175, v37
  v_sub_f32 v232, v232, v37
  v_sub_f32 v233, v233, v37
  v_sub_f32 v234, v234, v37
  v_sub_f32 v235, v235, v37
  v_sub_f32 v236, v236, v37
  v_sub_f32 v237, v237, v37
  v_sub_f32 v238, v238, v37
  v_sub_f32 v239, v239, v37
  v_sub_f32 v37, 0, v37
  v_exp_f32 v37, v37
  s_nop 0
  v_mul_f32 v57, v57, v37
  s_call_b64 s[98:99], Lscale0
  v_max3_f32 v36, v144, v145, v146
  v_max3_f32 v36, v36, v147, v148
  v_max3_f32 v36, v36, v149, v150
  v_max_f32 v36, v36, v151
  v_mov_b32 v62, v36
  s_nop 1
  v_permlane16_swap_b32 v36, v62
  v_max_f32 v36, v36, v62
  v_mov_b32 v62, v36
  s_nop 1
  v_permlane32_swap_b32 v36, v62
  v_max_f32 v36, v36, v62
  v_max_f32 v36, 0, v36
  v_sub_f32 v144, v144, v36
  v_sub_f32 v145, v145, v36
  v_sub_f32 v146, v146, v36
  v_sub_f32 v147, v147, v36
  v_sub_f32 v148, v148, v36
  v_sub_f32 v149, v149, v36
  v_sub_f32 v150, v150, v36
  v_sub_f32 v151, v151, v36
  v_sub_f32 v176, v176, v36
  v_sub_f32 v177, v177, v36
  v_sub_f32 v178, v178, v36
  v_sub_f32 v179, v179, v36
  v_sub_f32 v180, v180, v36
  v_sub_f32 v181, v181, v36
  v_sub_f32 v182, v182, v36
  v_sub_f32 v183, v183, v36
  v_sub_f32 v240, v240, v36
  v_sub_f32 v241, v241, v36
  v_sub_f32 v242, v242, v36
  v_sub_f32 v243, v243, v36
  v_sub_f32 v244, v244, v36
  v_sub_f32 v245, v245, v36
  v_sub_f32 v246, v246, v36
  v_sub_f32 v247, v247, v36
  v_sub_f32 v36, 0, v36
  v_exp_f32 v36, v36
  s_nop 0
  v_mul_f32 v58, v58, v36
  v_max3_f32 v37, v152, v153, v154
  v_max3_f32 v37, v37, v155, v156
  v_max3_f32 v37, v37, v157, v158
  v_max_f32 v37, v37, v159
  v_mov_b32 v62, v37
  s_nop 1
  v_permlane16_swap_b32 v37, v62
  v_max_f32 v37, v37, v62
  v_mov_b32 v62, v37
  s_nop 1
  v_permlane32_swap_b32 v37, v62
  v_max_f32 v37, v37, v62
  v_max_f32 v37, 0, v37
  v_sub_f32 v152, v152, v37
  v_sub_f32 v153, v153, v37
  v_sub_f32 v154, v154, v37
  v_sub_f32 v155, v155, v37
  v_sub_f32 v156, v156, v37
  v_sub_f32 v157, v157, v37
  v_sub_f32 v158, v158, v37
  v_sub_f32 v159, v159, v37
  v_sub_f32 v184, v184, v37
  v_sub_f32 v185, v185, v37
  v_sub_f32 v186, v186, v37
  v_sub_f32 v187, v187, v37
  v_sub_f32 v188, v188, v37
  v_sub_f32 v189, v189, v37
  v_sub_f32 v190, v190, v37
  v_sub_f32 v191, v191, v37
  v_sub_f32 v248, v248, v37
  v_sub_f32 v249, v249, v37
  v_sub_f32 v250, v250, v37
  v_sub_f32 v251, v251, v37
  v_sub_f32 v252, v252, v37
  v_sub_f32 v253, v253, v37
  v_sub_f32 v254, v254, v37
  v_sub_f32 v255, v255, v37
  v_sub_f32 v37, 0, v37
  v_exp_f32 v37, v37
  s_nop 0
  v_mul_f32 v59, v59, v37
  s_call_b64 s[98:99], Lscale1
  v_exp_f32 v32, v128
  v_exp_f32 v33, v129
  v_exp_f32 v34, v130
  v_exp_f32 v35, v131
  v_cvt_pk_bf16_f32 v192, v32, v33
  v_exp_f32 v36, v132
  v_exp_f32 v37, v133
  v_cvt_pk_bf16_f32 v193, v34, v35
  v_exp_f32 v38, v134
  v_exp_f32 v39, v135
  v_cvt_pk_bf16_f32 v194, v36, v37
  v_exp_f32 v32, v136
  v_exp_f32 v33, v137
  v_cvt_pk_bf16_f32 v195, v38, v39
  v_exp_f32 v34, v138
  v_exp_f32 v35, v139
  v_cvt_pk_bf16_f32 v196, v32, v33
  v_exp_f32 v36, v140
  v_exp_f32 v37, v141
  v_cvt_pk_bf16_f32 v197, v34, v35
  v_exp_f32 v38, v142
  v_exp_f32 v39, v143
  v_cvt_pk_bf16_f32 v198, v36, v37
  s_nop 0
  v_cvt_pk_bf16_f32 v199, v38, v39
  v_mfma_f32_16x16x32_bf16 v[40:43], a[192:195], v[192:195], 0
  s_nop 0
  v_mfma_f32_16x16x32_bf16 v[44:47], a[192:195], v[196:199], 0
  v_exp_f32 v32, v144
  v_exp_f32 v33, v145
  v_exp_f32 v34, v146
  v_exp_f32 v35, v147
  v_cvt_pk_bf16_f32 v200, v32, v33
  v_exp_f32 v36, v148
  v_exp_f32 v37, v149
  v_cvt_pk_bf16_f32 v201, v34, v35
  v_exp_f32 v38, v150
  v_exp_f32 v39, v151
  v_cvt_pk_bf16_f32 v202, v36, v37
  v_exp_f32 v32, v152
  v_exp_f32 v33, v153
  v_cvt_pk_bf16_f32 v203, v38, v39
  v_exp_f32 v34, v154
  v_exp_f32 v35, v155
  v_cvt_pk_bf16_f32 v204, v32, v33
  v_exp_f32 v36, v156
  v_exp_f32 v37, v157
  v_cvt_pk_bf16_f32 v205, v34, v35
  v_exp_f32 v38, v158
  v_exp_f32 v39, v159
  v_cvt_pk_bf16_f32 v206, v36, v37
  s_nop 0
  v_cvt_pk_bf16_f32 v207, v38, v39
  v_mfma_f32_16x16x32_bf16 v[16:19], a[192:195], v[200:203], 0
  s_nop 0
  v_mfma_f32_16x16x32_bf16 v[20:23], a[192:195], v[204:207], 0
  s_nop 7
  s_branch LretE
LrealO:
  s_nop 15
  v_max3_f32 v36, v160, v161, v162
  v_max3_f32 v36, v36, v163, v164
  v_max3_f32 v36, v36, v165, v166
  v_max_f32 v36, v36, v167
  v_mov_b32 v62, v36
  s_nop 1
  v_permlane16_swap_b32 v36, v62
  v_max_f32 v36, v36, v62
  v_mov_b32 v62, v36
  s_nop 1
  v_permlane32_swap_b32 v36, v62
  v_max_f32 v36, v36, v62
  v_max_f32 v36, 0, v36
  v_sub_f32 v160, v160, v36
  v_sub_f32 v161, v161, v36
  v_sub_f32 v162, v162, v36
  v_sub_f32 v163, v163, v36
  v_sub_f32 v164, v164, v36
  v_sub_f32 v165, v165, v36
  v_sub_f32 v166, v166, v36
  v_sub_f32 v167, v167, v36
  v_sub_f32 v128, v128, v36
  v_sub_f32 v129, v129, v36
  v_sub_f32 v130, v130, v36
  v_sub_f32 v131, v131, v36
  v_sub_f32 v132, v132, v36
  v_sub_f32 v133, v133, v36
  v_sub_f32 v134, v134, v36
  v_sub_f32 v135, v135, v36
  v_sub_f32 v224, v224, v36
  v_sub_f32 v225, v225, v36
  v_sub_f32 v226, v226, v36
  v_sub_f32 v227, v227, v36
  v_sub_f32 v228, v228, v36
  v_sub_f32 v229, v229, v36
  v_sub_f32 v230, v230, v36
  v_sub_f32 v231, v231, v36
  v_sub_f32 v36, 0, v36
  v_exp_f32 v36, v36
  s_nop 0
  v_mul_f32 v56, v56, v36
  v_max3_f32 v37, v168, v169, v170
  v_max3_f32 v37, v37, v171, v172
  v_max3_f32 v37, v37, v173, v174
  v_max_f32 v37, v37, v175
  v_mov_b32 v62, v37
  s_nop 1
  v_permlane16_swap_b32 v37, v62
  v_max_f32 v37, v37, v62
  v_mov_b32 v62, v37
  s_nop 1
  v_permlane32_swap_b32 v37, v62
  v_max_f32 v37, v37, v62
  v_max_f32 v37, 0, v37
  v_sub_f32 v168, v168, v37
  v_sub_f32 v169, v169, v37
  v_sub_f32 v170, v170, v37
  v_sub_f32 v171, v171, v37
  v_sub_f32 v172, v172, v37
  v_sub_f32 v173, v173, v37
  v_sub_f32 v174, v174, v37
  v_sub_f32 v175, v175, v37
  v_sub_f32 v136, v136, v37
  v_sub_f32 v137, v137, v37
  v_sub_f32 v138, v138, v37
  v_sub_f32 v139, v139, v37
  v_sub_f32 v140, v140, v37
  v_sub_f32 v141, v141, v37
  v_sub_f32 v142, v142, v37
  v_sub_f32 v143, v143, v37
  v_sub_f32 v232, v232, v37
  v_sub_f32 v233, v233, v37
  v_sub_f32 v234, v234, v37
  v_sub_f32 v235, v235, v37
  v_sub_f32 v236, v236, v37
  v_sub_f32 v237, v237, v37
  v_sub_f32 v238, v238, v37
  v_sub_f32 v239, v239, v37
  v_sub_f32 v37, 0, v37
  v_exp_f32 v37, v37
  s_nop 0
  v_mul_f32 v57, v57, v37
  s_call_b64 s[98:99], Lscale0
  v_max3_f32 v36, v176, v177, v178
  v_max3_f32 v36, v36, v179, v180
  v_max3_f32 v36, v36, v181, v182
  v_max_f32 v36, v36, v183
  v_mov_b32 v62, v36
  s_nop 1
  v_permlane16_swap_b32 v36, v62
  v_max_f32 v36, v36, v62
  v_mov_b32 v62, v36
  s_nop 1
  v_permlane32_swap_b32 v36, v62
  v_max_f32 v36, v36, v62
  v_max_f32 v36, 0, v36
  v_sub_f32 v176, v176, v36
  v_sub_f32 v177, v177, v36
  v_sub_f32 v178, v178, v36
  v_sub_f32 v179, v179, v36
  v_sub_f32 v180, v180, v36
  v_sub_f32 v181, v181, v36
  v_sub_f32 v182, v182, v36
  v_sub_f32 v183, v183, v36
  v_sub_f32 v144, v144, v36
  v_sub_f32 v145, v145, v36
  v_sub_f32 v146, v146, v36
  v_sub_f32 v147, v147, v36
  v_sub_f32 v148, v148, v36
  v_sub_f32 v149, v149, v36
  v_sub_f32 v150, v150, v36
  v_sub_f32 v151, v151, v36
  v_sub_f32 v240, v240, v36
  v_sub_f32 v241, v241, v36
  v_sub_f32 v242, v242, v36
  v_sub_f32 v243, v243, v36
  v_sub_f32 v244, v244, v36
  v_sub_f32 v245, v245, v36
  v_sub_f32 v246, v246, v36
  v_sub_f32 v247, v247, v36
  v_sub_f32 v36, 0, v36
  v_exp_f32 v36, v36
  s_nop 0
  v_mul_f32 v58, v58, v36
  v_max3_f32 v37, v184, v185, v186
  v_max3_f32 v37, v37, v187, v188
  v_max3_f32 v37, v37, v189, v190
  v_max_f32 v37, v37, v191
  v_mov_b32 v62, v37
  s_nop 1
  v_permlane16_swap_b32 v37, v62
  v_max_f32 v37, v37, v62
  v_mov_b32 v62, v37
  s_nop 1
  v_permlane32_swap_b32 v37, v62
  v_max_f32 v37, v37, v62
  v_max_f32 v37, 0, v37
  v_sub_f32 v184, v184, v37
  v_sub_f32 v185, v185, v37
  v_sub_f32 v186, v186, v37
  v_sub_f32 v187, v187, v37
  v_sub_f32 v188, v188, v37
  v_sub_f32 v189, v189, v37
  v_sub_f32 v190, v190, v37
  v_sub_f32 v191, v191, v37
  v_sub_f32 v152, v152, v37
  v_sub_f32 v153, v153, v37
  v_sub_f32 v154, v154, v37
  v_sub_f32 v155, v155, v37
  v_sub_f32 v156, v156, v37
  v_sub_f32 v157, v157, v37
  v_sub_f32 v158, v158, v37
  v_sub_f32 v159, v159, v37
  v_sub_f32 v248, v248, v37
  v_sub_f32 v249, v249, v37
  v_sub_f32 v250, v250, v37
  v_sub_f32 v251, v251, v37
  v_sub_f32 v252, v252, v37
  v_sub_f32 v253, v253, v37
  v_sub_f32 v254, v254, v37
  v_sub_f32 v255, v255, v37
  v_sub_f32 v37, 0, v37
  v_exp_f32 v37, v37
  s_nop 0
  v_mul_f32 v59, v59, v37
  s_call_b64 s[98:99], Lscale1
  v_exp_f32 v32, v160
  v_exp_f32 v33, v161
  v_exp_f32 v34, v162
  v_exp_f32 v35, v163
  v_cvt_pk_bf16_f32 v208, v32, v33
  v_exp_f32 v36, v164
  v_exp_f32 v37, v165
  v_cvt_pk_bf16_f32 v209, v34, v35
  v_exp_f32 v38, v166
  v_exp_f32 v39, v167
  v_cvt_pk_bf16_f32 v210, v36, v37
  v_exp_f32 v32, v168
  v_exp_f32 v33, v169
  v_cvt_pk_bf16_f32 v211, v38, v39
  v_exp_f32 v34, v170
  v_exp_f32 v35, v171
  v_cvt_pk_bf16_f32 v212, v32, v33
  v_exp_f32 v36, v172
  v_exp_f32 v37, v173
  v_cvt_pk_bf16_f32 v213, v34, v35
  v_exp_f32 v38, v174
  v_exp_f32 v39, v175
  v_cvt_pk_bf16_f32 v214, v36, v37
  s_nop 0
  v_cvt_pk_bf16_f32 v215, v38, v39
  v_mfma_f32_16x16x32_bf16 v[40:43], a[192:195], v[208:211], 0
  s_nop 0
  v_mfma_f32_16x16x32_bf16 v[44:47], a[192:195], v[212:215], 0
  v_exp_f32 v32, v176
  v_exp_f32 v33, v177
  v_exp_f32 v34, v178
  v_exp_f32 v35, v179
  v_cvt_pk_bf16_f32 v216, v32, v33
  v_exp_f32 v36, v180
  v_exp_f32 v37, v181
  v_cvt_pk_bf16_f32 v217, v34, v35
  v_exp_f32 v38, v182
  v_exp_f32 v39, v183
  v_cvt_pk_bf16_f32 v218, v36, v37
  v_exp_f32 v32, v184
  v_exp_f32 v33, v185
  v_cvt_pk_bf16_f32 v219, v38, v39
  v_exp_f32 v34, v186
  v_exp_f32 v35, v187
  v_cvt_pk_bf16_f32 v220, v32, v33
  v_exp_f32 v36, v188
  v_exp_f32 v37, v189
  v_cvt_pk_bf16_f32 v221, v34, v35
  v_exp_f32 v38, v190
  v_exp_f32 v39, v191
  v_cvt_pk_bf16_f32 v222, v36, v37
  s_nop 0
  v_cvt_pk_bf16_f32 v223, v38, v39
  v_mfma_f32_16x16x32_bf16 v[16:19], a[192:195], v[216:219], 0
  s_nop 0
  v_mfma_f32_16x16x32_bf16 v[20:23], a[192:195], v[220:223], 0
  s_nop 7
  s_branch LretO
LrealOL:
  s_nop 15
  v_max3_f32 v36, v160, v161, v162
  v_max3_f32 v36, v36, v163, v164
  v_max3_f32 v36, v36, v165, v166
  v_max_f32 v36, v36, v167
  v_mov_b32 v62, v36
  s_nop 1
  v_permlane16_swap_b32 v36, v62
  v_max_f32 v36, v36, v62
  v_mov_b32 v62, v36
  s_nop 1
  v_permlane32_swap_b32 v36, v62
  v_max_f32 v36, v36, v62
  v_max_f32 v36, 0, v36
  v_sub_f32 v160, v160, v36
  v_sub_f32 v161, v161, v36
  v_sub_f32 v162, v162, v36
  v_sub_f32 v163, v163, v36
  v_sub_f32 v164, v164, v36
  v_sub_f32 v165, v165, v36
  v_sub_f32 v166, v166, v36
  v_sub_f32 v167, v167, v36
  v_sub_f32 v128, v128, v36
  v_sub_f32 v129, v129, v36
  v_sub_f32 v130, v130, v36
  v_sub_f32 v131, v131, v36
  v_sub_f32 v132, v132, v36
  v_sub_f32 v133, v133, v36
  v_sub_f32 v134, v134, v36
  v_sub_f32 v135, v135, v36
  v_sub_f32 v224, v224, v36
  v_sub_f32 v225, v225, v36
  v_sub_f32 v226, v226, v36
  v_sub_f32 v227, v227, v36
  v_sub_f32 v228, v228, v36
  v_sub_f32 v229, v229, v36
  v_sub_f32 v230, v230, v36
  v_sub_f32 v231, v231, v36
  v_sub_f32 v36, 0, v36
  v_exp_f32 v36, v36
  s_nop 0
  v_mul_f32 v56, v56, v36
  v_max3_f32 v37, v168, v169, v170
  v_max3_f32 v37, v37, v171, v172
  v_max3_f32 v37, v37, v173, v174
  v_max_f32 v37, v37, v175
  v_mov_b32 v62, v37
  s_nop 1
  v_permlane16_swap_b32 v37, v62
  v_max_f32 v37, v37, v62
  v_mov_b32 v62, v37
  s_nop 1
  v_permlane32_swap_b32 v37, v62
  v_max_f32 v37, v37, v62
  v_max_f32 v37, 0, v37
  v_sub_f32 v168, v168, v37
  v_sub_f32 v169, v169, v37
  v_sub_f32 v170, v170, v37
  v_sub_f32 v171, v171, v37
  v_sub_f32 v172, v172, v37
  v_sub_f32 v173, v173, v37
  v_sub_f32 v174, v174, v37
  v_sub_f32 v175, v175, v37
  v_sub_f32 v136, v136, v37
  v_sub_f32 v137, v137, v37
  v_sub_f32 v138, v138, v37
  v_sub_f32 v139, v139, v37
  v_sub_f32 v140, v140, v37
  v_sub_f32 v141, v141, v37
  v_sub_f32 v142, v142, v37
  v_sub_f32 v143, v143, v37
  v_sub_f32 v232, v232, v37
  v_sub_f32 v233, v233, v37
  v_sub_f32 v234, v234, v37
  v_sub_f32 v235, v235, v37
  v_sub_f32 v236, v236, v37
  v_sub_f32 v237, v237, v37
  v_sub_f32 v238, v238, v37
  v_sub_f32 v239, v239, v37
  v_sub_f32 v37, 0, v37
  v_exp_f32 v37, v37
  s_nop 0
  v_mul_f32 v57, v57, v37
  s_call_b64 s[98:99], Lscale0
  v_max3_f32 v36, v176, v177, v178
  v_max3_f32 v36, v36, v179, v180
  v_max3_f32 v36, v36, v181, v182
  v_max_f32 v36, v36, v183
  v_mov_b32 v62, v36
  s_nop 1
  v_permlane16_swap_b32 v36, v62
  v_max_f32 v36, v36, v62
  v_mov_b32 v62, v36
  s_nop 1
  v_permlane32_swap_b32 v36, v62
  v_max_f32 v36, v36, v62
  v_max_f32 v36, 0, v36
  v_sub_f32 v176, v176, v36
  v_sub_f32 v177, v177, v36
  v_sub_f32 v178, v178, v36
  v_sub_f32 v179, v179, v36
  v_sub_f32 v180, v180, v36
  v_sub_f32 v181, v181, v36
  v_sub_f32 v182, v182, v36
  v_sub_f32 v183, v183, v36
  v_sub_f32 v36, 0, v36
  v_exp_f32 v36, v36
  s_nop 0
  v_mul_f32 v58, v58, v36
  v_max3_f32 v37, v184, v185, v186
  v_max3_f32 v37, v37, v187, v188
  v_max3_f32 v37, v37, v189, v190
  v_max_f32 v37, v37, v191
  v_mov_b32 v62, v37
  s_nop 1
  v_permlane16_swap_b32 v37, v62
  v_max_f32 v37, v37, v62
  v_mov_b32 v62, v37
  s_nop 1
  v_permlane32_swap_b32 v37, v62
  v_max_f32 v37, v37, v62
  v_max_f32 v37, 0, v37
  v_sub_f32 v184, v184, v37
  v_sub_f32 v185, v185, v37
  v_sub_f32 v186, v186, v37
  v_sub_f32 v187, v187, v37
  v_sub_f32 v188, v188, v37
  v_sub_f32 v189, v189, v37
  v_sub_f32 v190, v190, v37
  v_sub_f32 v191, v191, v37
  v_sub_f32 v152, v152, v37
  v_sub_f32 v153, v153, v37
  v_sub_f32 v154, v154, v37
  v_sub_f32 v155, v155, v37
  v_sub_f32 v156, v156, v37
  v_sub_f32 v157, v157, v37
  v_sub_f32 v158, v158, v37
  v_sub_f32 v159, v159, v37
  v_sub_f32 v248, v248, v37
  v_sub_f32 v249, v249, v37
  v_sub_f32 v250, v250, v37
  v_sub_f32 v251, v251, v37
  v_sub_f32 v252, v252, v37
  v_sub_f32 v253, v253, v37
  v_sub_f32 v254, v254, v37
  v_sub_f32 v255, v255, v37
  v_sub_f32 v37, 0, v37
  v_exp_f32 v37, v37
  s_nop 0
  v_mul_f32 v59, v59, v37
  s_call_b64 s[98:99], Lscale1
  v_exp_f32 v32, v160
  v_exp_f32 v33, v161
  v_exp_f32 v34, v162
  v_exp_f32 v35, v163
  v_cvt_pk_bf16_f32 v208, v32, v33
  v_exp_f32 v36, v164
  v_exp_f32 v37, v165
  v_cvt_pk_bf16_f32 v209, v34, v35
  v_exp_f32 v38, v166
  v_exp_f32 v39, v167
  v_cvt_pk_bf16_f32 v210, v36, v37
  v_exp_f32 v32, v168
  v_exp_f32 v33, v169
  v_cvt_pk_bf16_f32 v211, v38, v39
  v_exp_f32 v34, v170
  v_exp_f32 v35, v171
  v_cvt_pk_bf16_f32 v212, v32, v33
  v_exp_f32 v36, v172
  v_exp_f32 v37, v173
  v_cvt_pk_bf16_f32 v213, v34, v35
  v_exp_f32 v38, v174
  v_exp_f32 v39, v175
  v_cvt_pk_bf16_f32 v214, v36, v37
  s_nop 0
  v_cvt_pk_bf16_f32 v215, v38, v39
  v_mfma_f32_16x16x32_bf16 v[40:43], a[192:195], v[208:211], 0
  s_nop 0
  v_mfma_f32_16x16x32_bf16 v[44:47], a[192:195], v[212:215], 0
  v_exp_f32 v32, v176
  v_exp_f32 v33, v177
  v_exp_f32 v34, v178
  v_exp_f32 v35, v179
  v_cvt_pk_bf16_f32 v216, v32, v33
  v_exp_f32 v36, v180
  v_exp_f32 v37, v181
  v_cvt_pk_bf16_f32 v217, v34, v35
  v_exp_f32 v38, v182
  v_exp_f32 v39, v183
  v_cvt_pk_bf16_f32 v218, v36, v37
  v_exp_f32 v32, v184
  v_exp_f32 v33, v185
  v_cvt_pk_bf16_f32 v219, v38, v39
  v_exp_f32 v34, v186
  v_exp_f32 v35, v187
  v_cvt_pk_bf16_f32 v220, v32, v33
  v_exp_f32 v36, v188
  v_exp_f32 v37, v189
  v_cvt_pk_bf16_f32 v221, v34, v35
  v_exp_f32 v38, v190
  v_exp_f32 v39, v191
  v_cvt_pk_bf16_f32 v222, v36, v37
  s_nop 0
  v_cvt_pk_bf16_f32 v223, v38, v39
  v_mfma_f32_16x16x32_bf16 v[16:19], a[192:195], v[216:219], 0
  s_nop 0
  v_mfma_f32_16x16x32_bf16 v[20:23], a[192:195], v[220:223], 0
  s_nop 7
  s_branch LretOL
LrealEM:
  s_nop 15
  v_max3_f32 v36, v128, v129, v130
  v_max3_f32 v36, v36, v131, v132
  v_max3_f32 v36, v36, v133, v134
  v_max_f32 v36, v36, v135
  v_mov_b32 v62, v36
  s_nop 1
  v_permlane16_swap_b32 v36, v62
  v_max_f32 v36, v36, v62
  v_mov_b32 v62, v36
  s_nop 1
  v_permlane32_swap_b32 v36, v62
  v_max_f32 v36, v36, v62
  v_max_f32 v36, 0, v36
  v_sub_f32 v128, v128, v36
  v_sub_f32 v129, v129, v36
  v_sub_f32 v130, v130, v36
  v_sub_f32 v131, v131, v36
  v_sub_f32 v132, v132, v36
  v_sub_f32 v133, v133, v36
  v_sub_f32 v134, v134, v36
  v_sub_f32 v135, v135, v36
  v_sub_f32 v160, v160, v36
  v_sub_f32 v161, v161, v36
  v_sub_f32 v162, v162, v36
  v_sub_f32 v163, v163, v36
  v_sub_f32 v164, v164, v36
  v_sub_f32 v165, v165, v36
  v_sub_f32 v166, v166, v36
  v_sub_f32 v167, v167, v36
  v_sub_f32 v224, v224, v36
  v_sub_f32 v225, v225, v36
  v_sub_f32 v226, v226, v36
  v_sub_f32 v227, v227, v36
  v_sub_f32 v228, v228, v36
  v_sub_f32 v229, v229, v36
  v_sub_f32 v230, v230, v36
  v_sub_f32 v231, v231, v36
  v_sub_f32 v36, 0, v36
  v_exp_f32 v36, v36
  s_nop 0
  v_mul_f32 v56, v56, v36
  v_max3_f32 v37, v136, v137, v138
  v_max3_f32 v37, v37, v139, v140
  v_max3_f32 v37, v37, v141, v142
  v_max_f32 v37, v37, v143
  v_mov_b32 v62, v37
  s_nop 1
  v_permlane16_swap_b32 v37, v62
  v_max_f32 v37, v37, v62
  v_mov_b32 v62, v37
  s_nop 1
  v_permlane32_swap_b32 v37, v62
  v_max_f32 v37, v37, v62
  v_max_f32 v37, 0, v37
  v_sub_f32 v136, v136, v37
  v_sub_f32 v137, v137, v37
  v_sub_f32 v138, v138, v37
  v_sub_f32 v139, v139, v37
  v_sub_f32 v140, v140, v37
  v_sub_f32 v141, v141, v37
  v_sub_f32 v142, v142, v37
  v_sub_f32 v143, v143, v37
  v_sub_f32 v168, v168, v37
  v_sub_f32 v169, v169, v37
  v_sub_f32 v170, v170, v37
  v_sub_f32 v171, v171, v37
  v_sub_f32 v172, v172, v37
  v_sub_f32 v173, v173, v37
  v_sub_f32 v174, v174, v37
  v_sub_f32 v175, v175, v37
  v_sub_f32 v232, v232, v37
  v_sub_f32 v233, v233, v37
  v_sub_f32 v234, v234, v37
  v_sub_f32 v235, v235, v37
  v_sub_f32 v236, v236, v37
  v_sub_f32 v237, v237, v37
  v_sub_f32 v238, v238, v37
  v_sub_f32 v239, v239, v37
  v_sub_f32 v37, 0, v37
  v_exp_f32 v37, v37
  s_nop 0
  v_mul_f32 v57, v57, v37
  s_call_b64 s[98:99], Lscale0
  v_mov_b32 v36, 1.0
  v_max3_f32 v37, v152, v153, v154
  v_max3_f32 v37, v37, v155, v156
  v_max3_f32 v37, v37, v157, v158
  v_max_f32 v37, v37, v159
  v_mov_b32 v62, v37
  s_nop 1
  v_permlane16_swap_b32 v37, v62
  v_max_f32 v37, v37, v62
  v_mov_b32 v62, v37
  s_nop 1
  v_permlane32_swap_b32 v37, v62
  v_max_f32 v37, v37, v62
  v_max_f32 v37, 0, v37
  v_sub_f32 v152, v152, v37
  v_sub_f32 v153, v153, v37
  v_sub_f32 v154, v154, v37
  v_sub_f32 v155, v155, v37
  v_sub_f32 v156, v156, v37
  v_sub_f32 v157, v157, v37
  v_sub_f32 v158, v158, v37
  v_sub_f32 v159, v159, v37
  v_sub_f32 v184, v184, v37
  v_sub_f32 v185, v185, v37
  v_sub_f32 v186, v186, v37
  v_sub_f32 v187, v187, v37
  v_sub_f32 v188, v188, v37
  v_sub_f32 v189, v189, v37
  v_sub_f32 v190, v190, v37
  v_sub_f32 v191, v191, v37
  v_sub_f32 v248, v248, v37
  v_sub_f32 v249, v249, v37
  v_sub_f32 v250, v250, v37
  v_sub_f32 v251, v251, v37
  v_sub_f32 v252, v252, v37
  v_sub_f32 v253, v253, v37
  v_sub_f32 v254, v254, v37
  v_sub_f32 v255, v255, v37
  v_sub_f32 v37, 0, v37
  v_exp_f32 v37, v37
  s_nop 0
  v_mul_f32 v59, v59, v37
  s_call_b64 s[98:99], Lscale1
  v_exp_f32 v32, v128
  v_exp_f32 v33, v129
  v_exp_f32 v34, v130
  v_exp_f32 v35, v131
  v_cvt_pk_bf16_f32 v192, v32, v33
  v_exp_f32 v36, v132
  v_exp_f32 v37, v133
  v_cvt_pk_bf16_f32 v193, v34, v35
  v_exp_f32 v38, v134
  v_exp_f32 v39, v135
  v_cvt_pk_bf16_f32 v194, v36, v37
  v_exp_f32 v32, v136
  v_exp_f32 v33, v137
  v_cvt_pk_bf16_f32 v195, v38, v39
  v_exp_f32 v34, v138
  v_exp_f32 v35, v139
  v_cvt_pk_bf16_f32 v196, v32, v33
  v_exp_f32 v36, v140
  v_exp_f32 v37, v141
  v_cvt_pk_bf16_f32 v197, v34, v35
  v_exp_f32 v38, v142
  v_exp_f32 v39, v143
  v_cvt_pk_bf16_f32 v198, v36, v37
  s_nop 0
  v_cvt_pk_bf16_f32 v199, v38, v39
  v_mfma_f32_16x16x32_bf16 v[40:43], a[192:195], v[192:195], 0
  s_nop 0
  v_mfma_f32_16x16x32_bf16 v[44:47], a[192:195], v[196:199], 0
  v_exp_f32 v32, v152
  v_exp_f32 v33, v153
  v_exp_f32 v34, v154
  v_exp_f32 v35, v155
  v_cvt_pk_bf16_f32 v204, v32, v33
  v_exp_f32 v36, v156
  v_exp_f32 v37, v157
  v_cvt_pk_bf16_f32 v205, v34, v35
  v_exp_f32 v38, v158
  v_exp_f32 v39, v159
  v_cvt_pk_bf16_f32 v206, v36, v37
  s_nop 0
  v_cvt_pk_bf16_f32 v207, v38, v39
  s_nop 1
  v_mfma_f32_16x16x32_bf16 v[20:23], a[192:195], v[204:207], 0
  s_nop 7
  s_branch LretEM
LrealT:
  s_nop 15
  v_max3_f32 v36, v160, v161, v162
  v_max3_f32 v36, v36, v163, v164
  v_max3_f32 v36, v36, v165, v166
  v_max_f32 v36, v36, v167
  v_mov_b32 v62, v36
  s_nop 1
  v_permlane16_swap_b32 v36, v62
  v_max_f32 v36, v36, v62
  v_mov_b32 v62, v36
  s_nop 1
  v_permlane32_swap_b32 v36, v62
  v_max_f32 v36, v36, v62
  v_max_f32 v36, 0, v36
  v_sub_f32 v160, v160, v36
  v_sub_f32 v161, v161, v36
  v_sub_f32 v162, v162, v36
  v_sub_f32 v163, v163, v36
  v_sub_f32 v164, v164, v36
  v_sub_f32 v165, v165, v36
  v_sub_f32 v166, v166, v36
  v_sub_f32 v167, v167, v36
  v_sub_f32 v128, v128, v36
  v_sub_f32 v129, v129, v36
  v_sub_f32 v130, v130, v36
  v_sub_f32 v131, v131, v36
  v_sub_f32 v132, v132, v36
  v_sub_f32 v133, v133, v36
  v_sub_f32 v134, v134, v36
  v_sub_f32 v135, v135, v36
  v_sub_f32 v224, v224, v36
  v_sub_f32 v225, v225, v36
  v_sub_f32 v226, v226, v36
  v_sub_f32 v227, v227, v36
  v_sub_f32 v228, v228, v36
  v_sub_f32 v229, v229, v36
  v_sub_f32 v230, v230, v36
  v_sub_f32 v231, v231, v36
  v_sub_f32 v144, v144, v36
  v_sub_f32 v145, v145, v36
  v_sub_f32 v146, v146, v36
  v_sub_f32 v147, v147, v36
  v_sub_f32 v148, v148, v36
  v_sub_f32 v149, v149, v36
  v_sub_f32 v150, v150, v36
  v_sub_f32 v151, v151, v36
  v_sub_f32 v240, v240, v36
  v_sub_f32 v241, v241, v36
  v_sub_f32 v242, v242, v36
  v_sub_f32 v243, v243, v36
  v_sub_f32 v244, v244, v36
  v_sub_f32 v245, v245, v36
  v_sub_f32 v246, v246, v36
  v_sub_f32 v247, v247, v36
  v_sub_f32 v36, 0, v36
  v_exp_f32 v36, v36
  s_nop 0
  v_mul_f32 v56, v56, v36
  v_max3_f32 v37, v168, v169, v170
  v_max3_f32 v37, v37, v171, v172
  v_max3_f32 v37, v37, v173, v174
  v_max_f32 v37, v37, v175
  v_mov_b32 v62, v37
  s_nop 1
  v_permlane16_swap_b32 v37, v62
  v_max_f32 v37, v37, v62
  v_mov_b32 v62, v37
  s_nop 1
  v_permlane32_swap_b32 v37, v62
  v_max_f32 v37, v37, v62
  v_max_f32 v37, 0, v37
  v_sub_f32 v168, v168, v37
  v_sub_f32 v169, v169, v37
  v_sub_f32 v170, v170, v37
  v_sub_f32 v171, v171, v37
  v_sub_f32 v172, v172, v37
  v_sub_f32 v173, v173, v37
  v_sub_f32 v174, v174, v37
  v_sub_f32 v175, v175, v37
  v_sub_f32 v136, v136, v37
  v_sub_f32 v137, v137, v37
  v_sub_f32 v138, v138, v37
  v_sub_f32 v139, v139, v37
  v_sub_f32 v140, v140, v37
  v_sub_f32 v141, v141, v37
  v_sub_f32 v142, v142, v37
  v_sub_f32 v143, v143, v37
  v_sub_f32 v232, v232, v37
  v_sub_f32 v233, v233, v37
  v_sub_f32 v234, v234, v37
  v_sub_f32 v235, v235, v37
  v_sub_f32 v236, v236, v37
  v_sub_f32 v237, v237, v37
  v_sub_f32 v238, v238, v37
  v_sub_f32 v239, v239, v37
  v_sub_f32 v152, v152, v37
  v_sub_f32 v153, v153, v37
  v_sub_f32 v154, v154, v37
  v_sub_f32 v155, v155, v37
  v_sub_f32 v156, v156, v37
  v_sub_f32 v157, v157, v37
  v_sub_f32 v158, v158, v37
  v_sub_f32 v159, v159, v37
  v_sub_f32 v248, v248, v37
  v_sub_f32 v249, v249, v37
  v_sub_f32 v250, v250, v37
  v_sub_f32 v251, v251, v37
  v_sub_f32 v252, v252, v37
  v_sub_f32 v253, v253, v37
  v_sub_f32 v254, v254, v37
  v_sub_f32 v255, v255, v37
  v_sub_f32 v37, 0, v37
  v_exp_f32 v37, v37
  s_nop 0
  v_mul_f32 v57, v57, v37
  s_call_b64 s[98:99], Lscale0
  v_mov_b32 v36, 1.0
  v_max3_f32 v37, v184, v185, v186
  v_max3_f32 v37, v37, v187, v188
  v_max3_f32 v37, v37, v189, v190
  v_max_f32 v37, v37, v191
  v_mov_b32 v62, v37
  s_nop 1
  v_permlane16_swap_b32 v37, v62
  v_max_f32 v37, v37, v62
  v_mov_b32 v62, v37
  s_nop 1
  v_permlane32_swap_b32 v37, v62
  v_max_f32 v37, v37, v62
  v_max_f32 v37, 0, v37
  v_sub_f32 v184, v184, v37
  v_sub_f32 v185, v185, v37
  v_sub_f32 v186, v186, v37
  v_sub_f32 v187, v187, v37
  v_sub_f32 v188, v188, v37
  v_sub_f32 v189, v189, v37
  v_sub_f32 v190, v190, v37
  v_sub_f32 v191, v191, v37
  v_sub_f32 v37, 0, v37
  v_exp_f32 v37, v37
  s_nop 0
  v_mul_f32 v59, v59, v37
  s_call_b64 s[98:99], Lscale1
  v_exp_f32 v32, v160
  v_exp_f32 v33, v161
  v_exp_f32 v34, v162
  v_exp_f32 v35, v163
  v_cvt_pk_bf16_f32 v208, v32, v33
  v_exp_f32 v36, v164
  v_exp_f32 v37, v165
  v_cvt_pk_bf16_f32 v209, v34, v35
  v_exp_f32 v38, v166
  v_exp_f32 v39, v167
  v_cvt_pk_bf16_f32 v210, v36, v37
  v_exp_f32 v32, v168
  v_exp_f32 v33, v169
  v_cvt_pk_bf16_f32 v211, v38, v39
  v_exp_f32 v34, v170
  v_exp_f32 v35, v171
  v_cvt_pk_bf16_f32 v212, v32, v33
  v_exp_f32 v36, v172
  v_exp_f32 v37, v173
  v_cvt_pk_bf16_f32 v213, v34, v35
  v_exp_f32 v38, v174
  v_exp_f32 v39, v175
  v_cvt_pk_bf16_f32 v214, v36, v37
  s_nop 0
  v_cvt_pk_bf16_f32 v215, v38, v39
  v_mfma_f32_16x16x32_bf16 v[40:43], a[192:195], v[208:211], 0
  s_nop 0
  v_mfma_f32_16x16x32_bf16 v[44:47], a[192:195], v[212:215], 0
  v_exp_f32 v32, v184
  v_exp_f32 v33, v185
  v_exp_f32 v34, v186
  v_exp_f32 v35, v187
  v_cvt_pk_bf16_f32 v220, v32, v33
  v_exp_f32 v36, v188
  v_exp_f32 v37, v189
  v_cvt_pk_bf16_f32 v221, v34, v35
  v_exp_f32 v38, v190
  v_exp_f32 v39, v191
  v_cvt_pk_bf16_f32 v222, v36, v37
  s_nop 0
  v_cvt_pk_bf16_f32 v223, v38, v39
  s_nop 1
  v_mfma_f32_16x16x32_bf16 v[20:23], a[192:195], v[220:223], 0
  v_exp_f32 v32, v128
  v_exp_f32 v33, v129
  v_exp_f32 v34, v130
  v_exp_f32 v35, v131
  s_nop 7
  s_branch LretT
LrealE2:
  s_nop 15
  v_max3_f32 v36, v128, v129, v130
  v_max3_f32 v36, v36, v131, v132
  v_max3_f32 v36, v36, v133, v134
  v_max3_f32 v36, v36, v135, v144
  v_max3_f32 v36, v36, v145, v146
  v_max3_f32 v36, v36, v147, v148
  v_max3_f32 v36, v36, v149, v150
  v_max_f32 v36, v36, v151
  v_mov_b32 v62, v36
  s_nop 1
  v_permlane16_swap_b32 v36, v62
  v_max_f32 v36, v36, v62
  v_mov_b32 v62, v36
  s_nop 1
  v_permlane32_swap_b32 v36, v62
  v_max_f32 v36, v36, v62
  v_max_f32 v36, 0, v36
  v_sub_f32 v128, v128, v36
  v_sub_f32 v129, v129, v36
  v_sub_f32 v130, v130, v36
  v_sub_f32 v131, v131, v36
  v_sub_f32 v132, v132, v36
  v_sub_f32 v133, v133, v36
  v_sub_f32 v134, v134, v36
  v_sub_f32 v135, v135, v36
  v_sub_f32 v144, v144, v36
  v_sub_f32 v145, v145, v36
  v_sub_f32 v146, v146, v36
  v_sub_f32 v147, v147, v36
  v_sub_f32 v148, v148, v36
  v_sub_f32 v149, v149, v36
  v_sub_f32 v150, v150, v36
  v_sub_f32 v151, v151, v36
  v_sub_f32 v160, v160, v36
  v_sub_f32 v161, v161, v36
  v_sub_f32 v162, v162, v36
  v_sub_f32 v163, v163, v36
  v_sub_f32 v164, v164, v36
  v_sub_f32 v165, v165, v36
  v_sub_f32 v166, v166, v36
  v_sub_f32 v167, v167, v36
  v_sub_f32 v224, v224, v36
  v_sub_f32 v225, v225, v36
  v_sub_f32 v226, v226, v36
  v_sub_f32 v227, v227, v36
  v_sub_f32 v228, v228, v36
  v_sub_f32 v229, v229, v36
  v_sub_f32 v230, v230, v36
  v_sub_f32 v231, v231, v36
  v_sub_f32 v176, v176, v36
  v_sub_f32 v177, v177, v36
  v_sub_f32 v178, v178, v36
  v_sub_f32 v179, v179, v36
  v_sub_f32 v180, v180, v36
  v_sub_f32 v181, v181, v36
  v_sub_f32 v182, v182, v36
  v_sub_f32 v183, v183, v36
  v_sub_f32 v240, v240, v36
  v_sub_f32 v241, v241, v36
  v_sub_f32 v242, v242, v36
  v_sub_f32 v243, v243, v36
  v_sub_f32 v244, v244, v36
  v_sub_f32 v245, v245, v36
  v_sub_f32 v246, v246, v36
  v_sub_f32 v247, v247, v36
  v_sub_f32 v36, 0, v36
  v_exp_f32 v36, v36
  s_nop 0
  v_mul_f32 v56, v56, v36
  v_max3_f32 v37, v136, v137, v138
  v_max3_f32 v37, v37, v139, v140
  v_max3_f32 v37, v37, v141, v142
  v_max3_f32 v37, v37, v143, v152
  v_max3_f32 v37, v37, v153, v154
  v_max3_f32 v37, v37, v155, v156
  v_max3_f32 v37, v37, v157, v158
  v_max_f32 v37, v37, v159
  v_mov_b32 v62, v37
  s_nop 1
  v_permlane16_swap_b32 v37, v62
  v_max_f32 v37, v37, v62
  v_mov_b32 v62, v37
  s_nop 1
  v_permlane32_swap_b32 v37, v62
  v_max_f32 v37, v37, v62
  v_max_f32 v37, 0, v37
  v_sub_f32 v136, v136, v37
  v_sub_f32 v137, v137, v37
  v_sub_f32 v138, v138, v37
  v_sub_f32 v139, v139, v37
  v_sub_f32 v140, v140, v37
  v_sub_f32 v141, v141, v37
  v_sub_f32 v142, v142, v37
  v_sub_f32 v143, v143, v37
  v_sub_f32 v152, v152, v37
  v_sub_f32 v153, v153, v37
  v_sub_f32 v154, v154, v37
  v_sub_f32 v155, v155, v37
  v_sub_f32 v156, v156, v37
  v_sub_f32 v157, v157, v37
  v_sub_f32 v158, v158, v37
  v_sub_f32 v159, v159, v37
  v_sub_f32 v168, v168, v37
  v_sub_f32 v169, v169, v37
  v_sub_f32 v170, v170, v37
  v_sub_f32 v171, v171, v37
  v_sub_f32 v172, v172, v37
  v_sub_f32 v173, v173, v37
  v_sub_f32 v174, v174, v37
  v_sub_f32 v175, v175, v37
  v_sub_f32 v232, v232, v37
  v_sub_f32 v233, v233, v37
  v_sub_f32 v234, v234, v37
  v_sub_f32 v235, v235, v37
  v_sub_f32 v236, v236, v37
  v_sub_f32 v237, v237, v37
  v_sub_f32 v238, v238, v37
  v_sub_f32 v239, v239, v37
  v_sub_f32 v184, v184, v37
  v_sub_f32 v185, v185, v37
  v_sub_f32 v186, v186, v37
  v_sub_f32 v187, v187, v37
  v_sub_f32 v188, v188, v37
  v_sub_f32 v189, v189, v37
  v_sub_f32 v190, v190, v37
  v_sub_f32 v191, v191, v37
  v_sub_f32 v248, v248, v37
  v_sub_f32 v249, v249, v37
  v_sub_f32 v250, v250, v37
  v_sub_f32 v251, v251, v37
  v_sub_f32 v252, v252, v37
  v_sub_f32 v253, v253, v37
  v_sub_f32 v254, v254, v37
  v_sub_f32 v255, v255, v37
  v_sub_f32 v37, 0, v37
  v_exp_f32 v37, v37
  s_nop 0
  v_mul_f32 v57, v57, v37
  s_call_b64 s[98:99], Lscale0
  v_exp_f32 v32, v128
  v_exp_f32 v33, v129
  v_exp_f32 v34, v130
  v_exp_f32 v35, v131
  v_cvt_pk_bf16_f32 v192, v32, v33
  v_exp_f32 v36, v132
  v_exp_f32 v37, v133
  v_cvt_pk_bf16_f32 v193, v34, v35
  v_exp_f32 v38, v134
  v_exp_f32 v39, v135
  v_cvt_pk_bf16_f32 v194, v36, v37
  v_exp_f32 v32, v136
  v_exp_f32 v33, v137
  v_cvt_pk_bf16_f32 v195, v38, v39
  v_exp_f32 v34, v138
  v_exp_f32 v35, v139
  v_cvt_pk_bf16_f32 v196, v32, v33
  v_exp_f32 v36, v140
  v_exp_f32 v37, v141
  v_cvt_pk_bf16_f32 v197, v34, v35
  v_exp_f32 v38, v142
  v_exp_f32 v39, v143
  v_cvt_pk_bf16_f32 v198, v36, v37
  s_nop 0
  v_cvt_pk_bf16_f32 v199, v38, v39
  v_mfma_f32_16x16x32_bf16 v[40:43], a[192:195], v[192:195], 0
  s_nop 0
  v_mfma_f32_16x16x32_bf16 v[44:47], a[192:195], v[196:199], 0
  v_exp_f32 v32, v144
  v_exp_f32 v33, v145
  v_exp_f32 v34, v146
  v_exp_f32 v35, v147
  v_cvt_pk_bf16_f32 v200, v32, v33
  v_exp_f32 v36, v148
  v_exp_f32 v37, v149
  v_cvt_pk_bf16_f32 v201, v34, v35
  v_exp_f32 v38, v150
  v_exp_f32 v39, v151
  v_cvt_pk_bf16_f32 v202, v36, v37
  v_exp_f32 v32, v152
  v_exp_f32 v33, v153
  v_cvt_pk_bf16_f32 v203, v38, v39
  v_exp_f32 v34, v154
  v_exp_f32 v35, v155
  v_cvt_pk_bf16_f32 v204, v32, v33
  v_exp_f32 v36, v156
  v_exp_f32 v37, v157
  v_cvt_pk_bf16_f32 v205, v34, v35
  v_exp_f32 v38, v158
  v_exp_f32 v39, v159
  v_cvt_pk_bf16_f32 v206, v36, v37
  s_nop 0
  v_cvt_pk_bf16_f32 v207, v38, v39
  v_mfma_f32_16x16x32_bf16 v[40:43], a[192:195], v[200:203], v[40:43]
  s_nop 0
  v_mfma_f32_16x16x32_bf16 v[44:47], a[192:195], v[204:207], v[44:47]
  v_exp_f32 v32, v160
  v_exp_f32 v33, v161
  v_exp_f32 v34, v162
  v_exp_f32 v35, v163
  s_nop 7
  s_branch LretE2
LrealO2:
  s_nop 15
  v_max3_f32 v36, v160, v161, v162
  v_max3_f32 v36, v36, v163, v164
  v_max3_f32 v36, v36, v165, v166
  v_max3_f32 v36, v36, v167, v176
  v_max3_f32 v36, v36, v177, v178
  v_max3_f32 v36, v36, v179, v180
  v_max3_f32 v36, v36, v181, v182
  v_max_f32 v36, v36, v183
  v_mov_b32 v62, v36
  s_nop 1
  v_permlane16_swap_b32 v36, v62
  v_max_f32 v36, v36, v62
  v_mov_b32 v62, v36
  s_nop 1
  v_permlane32_swap_b32 v36, v62
  v_max_f32 v36, v36, v62
  v_max_f32 v36, 0, v36
  v_sub_f32 v160, v160, v36
  v_sub_f32 v161, v161, v36
  v_sub_f32 v162, v162, v36
  v_sub_f32 v163, v163, v36
  v_sub_f32 v164, v164, v36
  v_sub_f32 v165, v165, v36
  v_sub_f32 v166, v166, v36
  v_sub_f32 v167, v167, v36
  v_sub_f32 v176, v176, v36
  v_sub_f32 v177, v177, v36
  v_sub_f32 v178, v178, v36
  v_sub_f32 v179, v179, v36
  v_sub_f32 v180, v180, v36
  v_sub_f32 v181, v181, v36
  v_sub_f32 v182, v182, v36
  v_sub_f32 v183, v183, v36
  v_sub_f32 v128, v128, v36
  v_sub_f32 v129, v129, v36
  v_sub_f32 v130, v130, v36
  v_sub_f32 v131, v131, v36
  v_sub_f32 v132, v132, v36
  v_sub_f32 v133, v133, v36
  v_sub_f32 v134, v134, v36
  v_sub_f32 v135, v135, v36
  v_sub_f32 v224, v224, v36
  v_sub_f32 v225, v225, v36
  v_sub_f32 v226, v226, v36
  v_sub_f32 v227, v227, v36
  v_sub_f32 v228, v228, v36
  v_sub_f32 v229, v229, v36
  v_sub_f32 v230, v230, v36
  v_sub_f32 v231, v231, v36
  v_sub_f32 v144, v144, v36
  v_sub_f32 v145, v145, v36
  v_sub_f32 v146, v146, v36
  v_sub_f32 v147, v147, v36
  v_sub_f32 v148, v148, v36
  v_sub_f32 v149, v149, v36
  v_sub_f32 v150, v150, v36
  v_sub_f32 v151, v151, v36
  v_sub_f32 v240, v240, v36
  v_sub_f32 v241, v241, v36
  v_sub_f32 v242, v242, v36
  v_sub_f32 v243, v243, v36
  v_sub_f32 v244, v244, v36
  v_sub_f32 v245, v245, v36
  v_sub_f32 v246, v246, v36
  v_sub_f32 v247, v247, v36
  v_sub_f32 v36, 0, v36
  v_exp_f32 v36, v36
  s_nop 0
  v_mul_f32 v56, v56, v36
  v_max3_f32 v37, v168, v169, v170
  v_max3_f32 v37, v37, v171, v172
  v_max3_f32 v37, v37, v173, v174
  v_max3_f32 v37, v37, v175, v184
  v_max3_f32 v37, v37, v185, v186
  v_max3_f32 v37, v37, v187, v188
  v_max3_f32 v37, v37, v189, v190
  v_max_f32 v37, v37, v191
  v_mov_b32 v62, v37
  s_nop 1
  v_permlane16_swap_b32 v37, v62
  v_max_f32 v37, v37, v62
  v_mov_b32 v62, v37
  s_nop 1
  v_permlane32_swap_b32 v37, v62
  v_max_f32 v37, v37, v62
  v_max_f32 v37, 0, v37
  v_sub_f32 v168, v168, v37
  v_sub_f32 v169, v169, v37
  v_sub_f32 v170, v170, v37
  v_sub_f32 v171, v171, v37
  v_sub_f32 v172, v172, v37
  v_sub_f32 v173, v173, v37
  v_sub_f32 v174, v174, v37
  v_sub_f32 v175, v175, v37
  v_sub_f32 v184, v184, v37
  v_sub_f32 v185, v185, v37
  v_sub_f32 v186, v186, v37
  v_sub_f32 v187, v187, v37
  v_sub_f32 v188, v188, v37
  v_sub_f32 v189, v189, v37
  v_sub_f32 v190, v190, v37
  v_sub_f32 v191, v191, v37
  v_sub_f32 v136, v136, v37
  v_sub_f32 v137, v137, v37
  v_sub_f32 v138, v138, v37
  v_sub_f32 v139, v139, v37
  v_sub_f32 v140, v140, v37
  v_sub_f32 v141, v141, v37
  v_sub_f32 v142, v142, v37
  v_sub_f32 v143, v143, v37
  v_sub_f32 v232, v232, v37
  v_sub_f32 v233, v233, v37
  v_sub_f32 v234, v234, v37
  v_sub_f32 v235, v235, v37
  v_sub_f32 v236, v236, v37
  v_sub_f32 v237, v237, v37
  v_sub_f32 v238, v238, v37
  v_sub_f32 v239, v239, v37
  v_sub_f32 v152, v152, v37
  v_sub_f32 v153, v153, v37
  v_sub_f32 v154, v154, v37
  v_sub_f32 v155, v155, v37
  v_sub_f32 v156, v156, v37
  v_sub_f32 v157, v157, v37
  v_sub_f32 v158, v158, v37
  v_sub_f32 v159, v159, v37
  v_sub_f32 v248, v248, v37
  v_sub_f32 v249, v249, v37
  v_sub_f32 v250, v250, v37
  v_sub_f32 v251, v251, v37
  v_sub_f32 v252, v252, v37
  v_sub_f32 v253, v253, v37
  v_sub_f32 v254, v254, v37
  v_sub_f32 v255, v255, v37
  v_sub_f32 v37, 0, v37
  v_exp_f32 v37, v37
  s_nop 0
  v_mul_f32 v57, v57, v37
  s_call_b64 s[98:99], Lscale0
  v_exp_f32 v32, v160
  v_exp_f32 v33, v161
  v_exp_f32 v34, v162
  v_exp_f32 v35, v163
  v_cvt_pk_bf16_f32 v208, v32, v33
  v_exp_f32 v36, v164
  v_exp_f32 v37, v165
  v_cvt_pk_bf16_f32 v209, v34, v35
  v_exp_f32 v38, v166
  v_exp_f32 v39, v167
  v_cvt_pk_bf16_f32 v210, v36, v37
  v_exp_f32 v32, v168
  v_exp_f32 v33, v169
  v_cvt_pk_bf16_f32 v211, v38, v39
  v_exp_f32 v34, v170
  v_exp_f32 v35, v171
  v_cvt_pk_bf16_f32 v212, v32, v33
  v_exp_f32 v36, v172
  v_exp_f32 v37, v173
  v_cvt_pk_bf16_f32 v213, v34, v35
  v_exp_f32 v38, v174
  v_exp_f32 v39, v175
  v_cvt_pk_bf16_f32 v214, v36, v37
  s_nop 0
  v_cvt_pk_bf16_f32 v215, v38, v39
  v_mfma_f32_16x16x32_bf16 v[40:43], a[192:195], v[208:211], 0
  s_nop 0
  v_mfma_f32_16x16x32_bf16 v[44:47], a[192:195], v[212:215], 0
  v_exp_f32 v32, v176
  v_exp_f32 v33, v177
  v_exp_f32 v34, v178
  v_exp_f32 v35, v179
  v_cvt_pk_bf16_f32 v216, v32, v33
  v_exp_f32 v36, v180
  v_exp_f32 v37, v181
  v_cvt_pk_bf16_f32 v217, v34, v35
  v_exp_f32 v38, v182
  v_exp_f32 v39, v183
  v_cvt_pk_bf16_f32 v218, v36, v37
  v_exp_f32 v32, v184
  v_exp_f32 v33, v185
  v_cvt_pk_bf16_f32 v219, v38, v39
  v_exp_f32 v34, v186
  v_exp_f32 v35, v187
  v_cvt_pk_bf16_f32 v220, v32, v33
  v_exp_f32 v36, v188
  v_exp_f32 v37, v189
  v_cvt_pk_bf16_f32 v221, v34, v35
  v_exp_f32 v38, v190
  v_exp_f32 v39, v191
  v_cvt_pk_bf16_f32 v222, v36, v37
  s_nop 0
  v_cvt_pk_bf16_f32 v223, v38, v39
  v_mfma_f32_16x16x32_bf16 v[40:43], a[192:195], v[216:219], v[40:43]
  s_nop 0
  v_mfma_f32_16x16x32_bf16 v[44:47], a[192:195], v[220:223], v[44:47]
  v_exp_f32 v32, v128
  v_exp_f32 v33, v129
  v_exp_f32 v34, v130
  v_exp_f32 v35, v131
  s_nop 7
  s_branch LretO2
LrealEL:
  s_nop 15
  v_max3_f32 v36, v128, v129, v130
  v_max3_f32 v36, v36, v131, v132
  v_max3_f32 v36, v36, v133, v134
  v_max3_f32 v36, v36, v135, v144
  v_max3_f32 v36, v36, v145, v146
  v_max3_f32 v36, v36, v147, v148
  v_max3_f32 v36, v36, v149, v150
  v_max_f32 v36, v36, v151
  v_mov_b32 v62, v36
  s_nop 1
  v_permlane16_swap_b32 v36, v62
  v_max_f32 v36, v36, v62
  v_mov_b32 v62, v36
  s_nop 1
  v_permlane32_swap_b32 v36, v62
  v_max_f32 v36, v36, v62
  v_max_f32 v36, 0, v36
  v_sub_f32 v128, v128, v36
  v_sub_f32 v129, v129, v36
  v_sub_f32 v130, v130, v36
  v_sub_f32 v131, v131, v36
  v_sub_f32 v132, v132, v36
  v_sub_f32 v133, v133, v36
  v_sub_f32 v134, v134, v36
  v_sub_f32 v135, v135, v36
  v_sub_f32 v144, v144, v36
  v_sub_f32 v145, v145, v36
  v_sub_f32 v146, v146, v36
  v_sub_f32 v147, v147, v36
  v_sub_f32 v148, v148, v36
  v_sub_f32 v149, v149, v36
  v_sub_f32 v150, v150, v36
  v_sub_f32 v151, v151, v36
  v_sub_f32 v36, 0, v36
  v_exp_f32 v36, v36
  s_nop 0
  v_mul_f32 v56, v56, v36
  v_max3_f32 v37, v136, v137, v138
  v_max3_f32 v37, v37, v139, v140
  v_max3_f32 v37, v37, v141, v142
  v_max3_f32 v37, v37, v143, v152
  v_max3_f32 v37, v37, v153, v154
  v_max3_f32 v37, v37, v155, v156
  v_max3_f32 v37, v37, v157, v158
  v_max_f32 v37, v37, v159
  v_mov_b32 v62, v37
  s_nop 1
  v_permlane16_swap_b32 v37, v62
  v_max_f32 v37, v37, v62
  v_mov_b32 v62, v37
  s_nop 1
  v_permlane32_swap_b32 v37, v62
  v_max_f32 v37, v37, v62
  v_max_f32 v37, 0, v37
  v_sub_f32 v136, v136, v37
  v_sub_f32 v137, v137, v37
  v_sub_f32 v138, v138, v37
  v_sub_f32 v139, v139, v37
  v_sub_f32 v140, v140, v37
  v_sub_f32 v141, v141, v37
  v_sub_f32 v142, v142, v37
  v_sub_f32 v143, v143, v37
  v_sub_f32 v152, v152, v37
  v_sub_f32 v153, v153, v37
  v_sub_f32 v154, v154, v37
  v_sub_f32 v155, v155, v37
  v_sub_f32 v156, v156, v37
  v_sub_f32 v157, v157, v37
  v_sub_f32 v158, v158, v37
  v_sub_f32 v159, v159, v37
  v_sub_f32 v168, v168, v37
  v_sub_f32 v169, v169, v37
  v_sub_f32 v170, v170, v37
  v_sub_f32 v171, v171, v37
  v_sub_f32 v172, v172, v37
  v_sub_f32 v173, v173, v37
  v_sub_f32 v174, v174, v37
  v_sub_f32 v175, v175, v37
  v_sub_f32 v232, v232, v37
  v_sub_f32 v233, v233, v37
  v_sub_f32 v234, v234, v37
  v_sub_f32 v235, v235, v37
  v_sub_f32 v236, v236, v37
  v_sub_f32 v237, v237, v37
  v_sub_f32 v238, v238, v37
  v_sub_f32 v239, v239, v37
  v_sub_f32 v184, v184, v37
  v_sub_f32 v185, v185, v37
  v_sub_f32 v186, v186, v37
  v_sub_f32 v187, v187, v37
  v_sub_f32 v188, v188, v37
  v_sub_f32 v189, v189, v37
  v_sub_f32 v190, v190, v37
  v_sub_f32 v191, v191, v37
  v_sub_f32 v248, v248, v37
  v_sub_f32 v249, v249, v37
  v_sub_f32 v250, v250, v37
  v_sub_f32 v251, v251, v37
  v_sub_f32 v252, v252, v37
  v_sub_f32 v253, v253, v37
  v_sub_f32 v254, v254, v37
  v_sub_f32 v255, v255, v37
  v_sub_f32 v37, 0, v37
  v_exp_f32 v37, v37
  s_nop 0
  v_mul_f32 v57, v57, v37
  s_call_b64 s[98:99], Lscale0
  v_exp_f32 v32, v128
  v_exp_f32 v33, v129
  v_exp_f32 v34, v130
  v_exp_f32 v35, v131
  v_cvt_pk_bf16_f32 v192, v32, v33
  v_exp_f32 v36, v132
  v_exp_f32 v37, v133
  v_cvt_pk_bf16_f32 v193, v34, v35
  v_exp_f32 v38, v134
  v_exp_f32 v39, v135
  v_cvt_pk_bf16_f32 v194, v36, v37
  v_exp_f32 v32, v136
  v_exp_f32 v33, v137
  v_cvt_pk_bf16_f32 v195, v38, v39
  v_exp_f32 v34, v138
  v_exp_f32 v35, v139
  v_cvt_pk_bf16_f32 v196, v32, v33
  v_exp_f32 v36, v140
  v_exp_f32 v37, v141
  v_cvt_pk_bf16_f32 v197, v34, v35
  v_exp_f32 v38, v142
  v_exp_f32 v39, v143
  v_cvt_pk_bf16_f32 v198, v36, v37
  s_nop 0
  v_cvt_pk_bf16_f32 v199, v38, v39
  v_mfma_f32_16x16x32_bf16 v[40:43], a[192:195], v[192:195], 0
  s_nop 0
  v_mfma_f32_16x16x32_bf16 v[44:47], a[192:195], v[196:199], 0
  v_exp_f32 v32, v144
  v_exp_f32 v33, v145
  v_exp_f32 v34, v146
  v_exp_f32 v35, v147
  v_cvt_pk_bf16_f32 v200, v32, v33
  v_exp_f32 v36, v148
  v_exp_f32 v37, v149
  v_cvt_pk_bf16_f32 v201, v34, v35
  v_exp_f32 v38, v150
  v_exp_f32 v39, v151
  v_cvt_pk_bf16_f32 v202, v36, v37
  v_exp_f32 v32, v152
  v_exp_f32 v33, v153
  v_cvt_pk_bf16_f32 v203, v38, v39
  v_exp_f32 v34, v154
  v_exp_f32 v35, v155
  v_cvt_pk_bf16_f32 v204, v32, v33
  v_exp_f32 v36, v156
  v_exp_f32 v37, v157
  v_cvt_pk_bf16_f32 v205, v34, v35
  v_exp_f32 v38, v158
  v_exp_f32 v39, v159
  v_cvt_pk_bf16_f32 v206, v36, v37
  s_nop 0
  v_cvt_pk_bf16_f32 v207, v38, v39
  v_mfma_f32_16x16x32_bf16 v[40:43], a[192:195], v[200:203], v[40:43]
  s_nop 0
  v_mfma_f32_16x16x32_bf16 v[44:47], a[192:195], v[204:207], v[44:47]
  s_nop 7
  s_branch LretEL
LrealF:
  s_nop 15
  v_mov_b32 v36, 1.0
  v_max3_f32 v37, v168, v169, v170
  v_max3_f32 v37, v37, v171, v172
  v_max3_f32 v37, v37, v173, v174
  v_max3_f32 v37, v37, v175, v184
  v_max3_f32 v37, v37, v185, v186
  v_max3_f32 v37, v37, v187, v188
  v_max3_f32 v37, v37, v189, v190
  v_max_f32 v37, v37, v191
  v_mov_b32 v62, v37
  s_nop 1
  v_permlane16_swap_b32 v37, v62
  v_max_f32 v37, v37, v62
  v_mov_b32 v62, v37
  s_nop 1
  v_permlane32_swap_b32 v37, v62
  v_max_f32 v37, v37, v62
  v_max_f32 v37, 0, v37
  v_sub_f32 v168, v168, v37
  v_sub_f32 v169, v169, v37
  v_sub_f32 v170, v170, v37
  v_sub_f32 v171, v171, v37
  v_sub_f32 v172, v172, v37
  v_sub_f32 v173, v173, v37
  v_sub_f32 v174, v174, v37
  v_sub_f32 v175, v175, v37
  v_sub_f32 v184, v184, v37
  v_sub_f32 v185, v185, v37
  v_sub_f32 v186, v186, v37
  v_sub_f32 v187, v187, v37
  v_sub_f32 v188, v188, v37
  v_sub_f32 v189, v189, v37
  v_sub_f32 v190, v190, v37
  v_sub_f32 v191, v191, v37
  v_sub_f32 v37, 0, v37
  v_exp_f32 v37, v37
  s_nop 0
  v_mul_f32 v57, v57, v37
  s_call_b64 s[98:99], Lscale0
  v_exp_f32 v32, v168
  v_exp_f32 v33, v169
  v_exp_f32 v34, v170
  v_exp_f32 v35, v171
  v_cvt_pk_bf16_f32 v212, v32, v33
  v_exp_f32 v36, v172
  v_exp_f32 v37, v173
  v_cvt_pk_bf16_f32 v213, v34, v35
  v_exp_f32 v38, v174
  v_exp_f32 v39, v175
  v_cvt_pk_bf16_f32 v214, v36, v37
  s_nop 0
  v_cvt_pk_bf16_f32 v215, v38, v39
  s_nop 1
  v_mfma_f32_16x16x32_bf16 v[44:47], a[192:195], v[212:215], 0
  v_exp_f32 v32, v184
  v_exp_f32 v33, v185
  v_exp_f32 v34, v186
  v_exp_f32 v35, v187
  v_cvt_pk_bf16_f32 v220, v32, v33
  v_exp_f32 v36, v188
  v_exp_f32 v37, v189
  v_cvt_pk_bf16_f32 v221, v34, v35
  v_exp_f32 v38, v190
  v_exp_f32 v39, v191
  v_cvt_pk_bf16_f32 v222, v36, v37
  s_nop 0
  v_cvt_pk_bf16_f32 v223, v38, v39
  s_nop 1
  v_mfma_f32_16x16x32_bf16 v[44:47], a[192:195], v[220:223], v[44:47]
  s_nop 7
  s_branch LretF
Lscale0:
  v_accvgpr_read_b32 v32, a0
  v_accvgpr_read_b32 v33, a1
  v_accvgpr_read_b32 v34, a2
  v_accvgpr_read_b32 v35, a3
  v_mul_f32 v32, v32, v36
  v_mul_f32 v33, v33, v36
  v_mul_f32 v34, v34, v36
  v_mul_f32 v35, v35, v36
  v_accvgpr_write_b32 a0, v32
  v_accvgpr_write_b32 a1, v33
  v_accvgpr_write_b32 a2, v34
  v_accvgpr_write_b32 a3, v35
  v_accvgpr_read_b32 v32, a4
  v_accvgpr_read_b32 v33, a5
  v_accvgpr_read_b32 v34, a6
  v_accvgpr_read_b32 v35, a7
  v_mul_f32 v32, v32, v36
  v_mul_f32 v33, v33, v36
  v_mul_f32 v34, v34, v36
  v_mul_f32 v35, v35, v36
  v_accvgpr_write_b32 a4, v32
  v_accvgpr_write_b32 a5, v33
  v_accvgpr_write_b32 a6, v34
  v_accvgpr_write_b32 a7, v35
  v_accvgpr_read_b32 v32, a8
  v_accvgpr_read_b32 v33, a9
  v_accvgpr_read_b32 v34, a10
  v_accvgpr_read_b32 v35, a11
  v_mul_f32 v32, v32, v36
  v_mul_f32 v33, v33, v36
  v_mul_f32 v34, v34, v36
  v_mul_f32 v35, v35, v36
  v_accvgpr_write_b32 a8, v32
  v_accvgpr_write_b32 a9, v33
  v_accvgpr_write_b32 a10, v34
  v_accvgpr_write_b32 a11, v35
  v_accvgpr_read_b32 v32, a12
  v_accvgpr_read_b32 v33, a13
  v_accvgpr_read_b32 v34, a14
  v_accvgpr_read_b32 v35, a15
  v_mul_f32 v32, v32, v36
  v_mul_f32 v33, v33, v36
  v_mul_f32 v34, v34, v36
  v_mul_f32 v35, v35, v36
  v_accvgpr_write_b32 a12, v32
  v_accvgpr_write_b32 a13, v33
  v_accvgpr_write_b32 a14, v34
  v_accvgpr_write_b32 a15, v35
  v_accvgpr_read_b32 v32, a16
  v_accvgpr_read_b32 v33, a17
  v_accvgpr_read_b32 v34, a18
  v_accvgpr_read_b32 v35, a19
  v_mul_f32 v32, v32, v36
  v_mul_f32 v33, v33, v36
  v_mul_f32 v34, v34, v36
  v_mul_f32 v35, v35, v36
  v_accvgpr_write_b32 a16, v32
  v_accvgpr_write_b32 a17, v33
  v_accvgpr_write_b32 a18, v34
  v_accvgpr_write_b32 a19, v35
  v_accvgpr_read_b32 v32, a20
  v_accvgpr_read_b32 v33, a21
  v_accvgpr_read_b32 v34, a22
  v_accvgpr_read_b32 v35, a23
  v_mul_f32 v32, v32, v36
  v_mul_f32 v33, v33, v36
  v_mul_f32 v34, v34, v36
  v_mul_f32 v35, v35, v36
  v_accvgpr_write_b32 a20, v32
  v_accvgpr_write_b32 a21, v33
  v_accvgpr_write_b32 a22, v34
  v_accvgpr_write_b32 a23, v35
  v_accvgpr_read_b32 v32, a24
  v_accvgpr_read_b32 v33, a25
  v_accvgpr_read_b32 v34, a26
  v_accvgpr_read_b32 v35, a27
  v_mul_f32 v32, v32, v36
  v_mul_f32 v33, v33, v36
  v_mul_f32 v34, v34, v36
  v_mul_f32 v35, v35, v36
  v_accvgpr_write_b32 a24, v32
  v_accvgpr_write_b32 a25, v33
  v_accvgpr_write_b32 a26, v34
  v_accvgpr_write_b32 a27, v35
  v_accvgpr_read_b32 v32, a28
  v_accvgpr_read_b32 v33, a29
  v_accvgpr_read_b32 v34, a30
  v_accvgpr_read_b32 v35, a31
  v_mul_f32 v32, v32, v36
  v_mul_f32 v33, v33, v36
  v_mul_f32 v34, v34, v36
  v_mul_f32 v35, v35, v36
  v_accvgpr_write_b32 a28, v32
  v_accvgpr_write_b32 a29, v33
  v_accvgpr_write_b32 a30, v34
  v_accvgpr_write_b32 a31, v35
  v_accvgpr_read_b32 v32, a32
  v_accvgpr_read_b32 v33, a33
  v_accvgpr_read_b32 v34, a34
  v_accvgpr_read_b32 v35, a35
  v_mul_f32 v32, v32, v37
  v_mul_f32 v33, v33, v37
  v_mul_f32 v34, v34, v37
  v_mul_f32 v35, v35, v37
  v_accvgpr_write_b32 a32, v32
  v_accvgpr_write_b32 a33, v33
  v_accvgpr_write_b32 a34, v34
  v_accvgpr_write_b32 a35, v35
  v_accvgpr_read_b32 v32, a36
  v_accvgpr_read_b32 v33, a37
  v_accvgpr_read_b32 v34, a38
  v_accvgpr_read_b32 v35, a39
  v_mul_f32 v32, v32, v37
  v_mul_f32 v33, v33, v37
  v_mul_f32 v34, v34, v37
  v_mul_f32 v35, v35, v37
  v_accvgpr_write_b32 a36, v32
  v_accvgpr_write_b32 a37, v33
  v_accvgpr_write_b32 a38, v34
  v_accvgpr_write_b32 a39, v35
  v_accvgpr_read_b32 v32, a40
  v_accvgpr_read_b32 v33, a41
  v_accvgpr_read_b32 v34, a42
  v_accvgpr_read_b32 v35, a43
  v_mul_f32 v32, v32, v37
  v_mul_f32 v33, v33, v37
  v_mul_f32 v34, v34, v37
  v_mul_f32 v35, v35, v37
  v_accvgpr_write_b32 a40, v32
  v_accvgpr_write_b32 a41, v33
  v_accvgpr_write_b32 a42, v34
  v_accvgpr_write_b32 a43, v35
  v_accvgpr_read_b32 v32, a44
  v_accvgpr_read_b32 v33, a45
  v_accvgpr_read_b32 v34, a46
  v_accvgpr_read_b32 v35, a47
  v_mul_f32 v32, v32, v37
  v_mul_f32 v33, v33, v37
  v_mul_f32 v34, v34, v37
  v_mul_f32 v35, v35, v37
  v_accvgpr_write_b32 a44, v32
  v_accvgpr_write_b32 a45, v33
  v_accvgpr_write_b32 a46, v34
  v_accvgpr_write_b32 a47, v35
  v_accvgpr_read_b32 v32, a48
  v_accvgpr_read_b32 v33, a49
  v_accvgpr_read_b32 v34, a50
  v_accvgpr_read_b32 v35, a51
  v_mul_f32 v32, v32, v37
  v_mul_f32 v33, v33, v37
  v_mul_f32 v34, v34, v37
  v_mul_f32 v35, v35, v37
  v_accvgpr_write_b32 a48, v32
  v_accvgpr_write_b32 a49, v33
  v_accvgpr_write_b32 a50, v34
  v_accvgpr_write_b32 a51, v35
  v_accvgpr_read_b32 v32, a52
  v_accvgpr_read_b32 v33, a53
  v_accvgpr_read_b32 v34, a54
  v_accvgpr_read_b32 v35, a55
  v_mul_f32 v32, v32, v37
  v_mul_f32 v33, v33, v37
  v_mul_f32 v34, v34, v37
  v_mul_f32 v35, v35, v37
  v_accvgpr_write_b32 a52, v32
  v_accvgpr_write_b32 a53, v33
  v_accvgpr_write_b32 a54, v34
  v_accvgpr_write_b32 a55, v35
  v_accvgpr_read_b32 v32, a56
  v_accvgpr_read_b32 v33, a57
  v_accvgpr_read_b32 v34, a58
  v_accvgpr_read_b32 v35, a59
  v_mul_f32 v32, v32, v37
  v_mul_f32 v33, v33, v37
  v_mul_f32 v34, v34, v37
  v_mul_f32 v35, v35, v37
  v_accvgpr_write_b32 a56, v32
  v_accvgpr_write_b32 a57, v33
  v_accvgpr_write_b32 a58, v34
  v_accvgpr_write_b32 a59, v35
  v_accvgpr_read_b32 v32, a60
  v_accvgpr_read_b32 v33, a61
  v_accvgpr_read_b32 v34, a62
  v_accvgpr_read_b32 v35, a63
  v_mul_f32 v32, v32, v37
  v_mul_f32 v33, v33, v37
  v_mul_f32 v34, v34, v37
  v_mul_f32 v35, v35, v37
  v_accvgpr_write_b32 a60, v32
  v_accvgpr_write_b32 a61, v33
  v_accvgpr_write_b32 a62, v34
  v_accvgpr_write_b32 a63, v35
  s_setpc_b64 s[98:99]
Lscale1:
  v_accvgpr_read_b32 v32, a64
  v_accvgpr_read_b32 v33, a65
  v_accvgpr_read_b32 v34, a66
  v_accvgpr_read_b32 v35, a67
  v_mul_f32 v32, v32, v36
  v_mul_f32 v33, v33, v36
  v_mul_f32 v34, v34, v36
  v_mul_f32 v35, v35, v36
  v_accvgpr_write_b32 a64, v32
  v_accvgpr_write_b32 a65, v33
  v_accvgpr_write_b32 a66, v34
  v_accvgpr_write_b32 a67, v35
  v_accvgpr_read_b32 v32, a68
  v_accvgpr_read_b32 v33, a69
  v_accvgpr_read_b32 v34, a70
  v_accvgpr_read_b32 v35, a71
  v_mul_f32 v32, v32, v36
  v_mul_f32 v33, v33, v36
  v_mul_f32 v34, v34, v36
  v_mul_f32 v35, v35, v36
  v_accvgpr_write_b32 a68, v32
  v_accvgpr_write_b32 a69, v33
  v_accvgpr_write_b32 a70, v34
  v_accvgpr_write_b32 a71, v35
  v_accvgpr_read_b32 v32, a72
  v_accvgpr_read_b32 v33, a73
  v_accvgpr_read_b32 v34, a74
  v_accvgpr_read_b32 v35, a75
  v_mul_f32 v32, v32, v36
  v_mul_f32 v33, v33, v36
  v_mul_f32 v34, v34, v36
  v_mul_f32 v35, v35, v36
  v_accvgpr_write_b32 a72, v32
  v_accvgpr_write_b32 a73, v33
  v_accvgpr_write_b32 a74, v34
  v_accvgpr_write_b32 a75, v35
  v_accvgpr_read_b32 v32, a76
  v_accvgpr_read_b32 v33, a77
  v_accvgpr_read_b32 v34, a78
  v_accvgpr_read_b32 v35, a79
  v_mul_f32 v32, v32, v36
  v_mul_f32 v33, v33, v36
  v_mul_f32 v34, v34, v36
  v_mul_f32 v35, v35, v36
  v_accvgpr_write_b32 a76, v32
  v_accvgpr_write_b32 a77, v33
  v_accvgpr_write_b32 a78, v34
  v_accvgpr_write_b32 a79, v35
  v_accvgpr_read_b32 v32, a80
  v_accvgpr_read_b32 v33, a81
  v_accvgpr_read_b32 v34, a82
  v_accvgpr_read_b32 v35, a83
  v_mul_f32 v32, v32, v36
  v_mul_f32 v33, v33, v36
  v_mul_f32 v34, v34, v36
  v_mul_f32 v35, v35, v36
  v_accvgpr_write_b32 a80, v32
  v_accvgpr_write_b32 a81, v33
  v_accvgpr_write_b32 a82, v34
  v_accvgpr_write_b32 a83, v35
  v_accvgpr_read_b32 v32, a84
  v_accvgpr_read_b32 v33, a85
  v_accvgpr_read_b32 v34, a86
  v_accvgpr_read_b32 v35, a87
  v_mul_f32 v32, v32, v36
  v_mul_f32 v33, v33, v36
  v_mul_f32 v34, v34, v36
  v_mul_f32 v35, v35, v36
  v_accvgpr_write_b32 a84, v32
  v_accvgpr_write_b32 a85, v33
  v_accvgpr_write_b32 a86, v34
  v_accvgpr_write_b32 a87, v35
  v_accvgpr_read_b32 v32, a88
  v_accvgpr_read_b32 v33, a89
  v_accvgpr_read_b32 v34, a90
  v_accvgpr_read_b32 v35, a91
  v_mul_f32 v32, v32, v36
  v_mul_f32 v33, v33, v36
  v_mul_f32 v34, v34, v36
  v_mul_f32 v35, v35, v36
  v_accvgpr_write_b32 a88, v32
  v_accvgpr_write_b32 a89, v33
  v_accvgpr_write_b32 a90, v34
  v_accvgpr_write_b32 a91, v35
  v_accvgpr_read_b32 v32, a92
  v_accvgpr_read_b32 v33, a93
  v_accvgpr_read_b32 v34, a94
  v_accvgpr_read_b32 v35, a95
  v_mul_f32 v32, v32, v36
  v_mul_f32 v33, v33, v36
  v_mul_f32 v34, v34, v36
  v_mul_f32 v35, v35, v36
  v_accvgpr_write_b32 a92, v32
  v_accvgpr_write_b32 a93, v33
  v_accvgpr_write_b32 a94, v34
  v_accvgpr_write_b32 a95, v35
  v_accvgpr_read_b32 v32, a96
  v_accvgpr_read_b32 v33, a97
  v_accvgpr_read_b32 v34, a98
  v_accvgpr_read_b32 v35, a99
  v_mul_f32 v32, v32, v37
  v_mul_f32 v33, v33, v37
  v_mul_f32 v34, v34, v37
  v_mul_f32 v35, v35, v37
  v_accvgpr_write_b32 a96, v32
  v_accvgpr_write_b32 a97, v33
  v_accvgpr_write_b32 a98, v34
  v_accvgpr_write_b32 a99, v35
  v_accvgpr_read_b32 v32, a100
  v_accvgpr_read_b32 v33, a101
  v_accvgpr_read_b32 v34, a102
  v_accvgpr_read_b32 v35, a103
  v_mul_f32 v32, v32, v37
  v_mul_f32 v33, v33, v37
  v_mul_f32 v34, v34, v37
  v_mul_f32 v35, v35, v37
  v_accvgpr_write_b32 a100, v32
  v_accvgpr_write_b32 a101, v33
  v_accvgpr_write_b32 a102, v34
  v_accvgpr_write_b32 a103, v35
  v_accvgpr_read_b32 v32, a104
  v_accvgpr_read_b32 v33, a105
  v_accvgpr_read_b32 v34, a106
  v_accvgpr_read_b32 v35, a107
  v_mul_f32 v32, v32, v37
  v_mul_f32 v33, v33, v37
  v_mul_f32 v34, v34, v37
  v_mul_f32 v35, v35, v37
  v_accvgpr_write_b32 a104, v32
  v_accvgpr_write_b32 a105, v33
  v_accvgpr_write_b32 a106, v34
  v_accvgpr_write_b32 a107, v35
  v_accvgpr_read_b32 v32, a108
  v_accvgpr_read_b32 v33, a109
  v_accvgpr_read_b32 v34, a110
  v_accvgpr_read_b32 v35, a111
  v_mul_f32 v32, v32, v37
  v_mul_f32 v33, v33, v37
  v_mul_f32 v34, v34, v37
  v_mul_f32 v35, v35, v37
  v_accvgpr_write_b32 a108, v32
  v_accvgpr_write_b32 a109, v33
  v_accvgpr_write_b32 a110, v34
  v_accvgpr_write_b32 a111, v35
  v_accvgpr_read_b32 v32, a112
  v_accvgpr_read_b32 v33, a113
  v_accvgpr_read_b32 v34, a114
  v_accvgpr_read_b32 v35, a115
  v_mul_f32 v32, v32, v37
  v_mul_f32 v33, v33, v37
  v_mul_f32 v34, v34, v37
  v_mul_f32 v35, v35, v37
  v_accvgpr_write_b32 a112, v32
  v_accvgpr_write_b32 a113, v33
  v_accvgpr_write_b32 a114, v34
  v_accvgpr_write_b32 a115, v35
  v_accvgpr_read_b32 v32, a116
  v_accvgpr_read_b32 v33, a117
  v_accvgpr_read_b32 v34, a118
  v_accvgpr_read_b32 v35, a119
  v_mul_f32 v32, v32, v37
  v_mul_f32 v33, v33, v37
  v_mul_f32 v34, v34, v37
  v_mul_f32 v35, v35, v37
  v_accvgpr_write_b32 a116, v32
  v_accvgpr_write_b32 a117, v33
  v_accvgpr_write_b32 a118, v34
  v_accvgpr_write_b32 a119, v35
  v_accvgpr_read_b32 v32, a120
  v_accvgpr_read_b32 v33, a121
  v_accvgpr_read_b32 v34, a122
  v_accvgpr_read_b32 v35, a123
  v_mul_f32 v32, v32, v37
  v_mul_f32 v33, v33, v37
  v_mul_f32 v34, v34, v37
  v_mul_f32 v35, v35, v37
  v_accvgpr_write_b32 a120, v32
  v_accvgpr_write_b32 a121, v33
  v_accvgpr_write_b32 a122, v34
  v_accvgpr_write_b32 a123, v35
  v_accvgpr_read_b32 v32, a124
  v_accvgpr_read_b32 v33, a125
  v_accvgpr_read_b32 v34, a126
  v_accvgpr_read_b32 v35, a127
  v_mul_f32 v32, v32, v37
  v_mul_f32 v33, v33, v37
  v_mul_f32 v34, v34, v37
  v_mul_f32 v35, v35, v37
  v_accvgpr_write_b32 a124, v32
  v_accvgpr_write_b32 a125, v33
  v_accvgpr_write_b32 a126, v34
  v_accvgpr_write_b32 a127, v35
  s_setpc_b64 s[98:99]
Lspin13:
  s_mov_b32 s80, 0
Lspinl13:
  s_sleep 2
  buffer_load_dword v49, v50, s[44:47], 0 offen sc1
  s_waitcnt vmcnt(0)
  v_cmp_ne_u32 vcc, v52, v49
  s_cbranch_vccz Lback13
  s_add_u32 s80, s80, 1
  s_cmp_lt_u32 s80, 65536
  s_cbranch_scc1 Lspinl13
  s_branch Lback13
Lspin14:
  s_mov_b32 s80, 0
Lspinl14:
  s_sleep 2
  buffer_load_dword v49, v50, s[44:47], 0 offen sc1
  s_waitcnt vmcnt(0)
  v_cmp_ne_u32 vcc, v52, v49
  s_cbranch_vccz Lback14
  s_add_u32 s80, s80, 1
  s_cmp_lt_u32 s80, 65536
  s_cbranch_scc1 Lspinl14
  s_branch Lback14
Lspin15:
  s_mov_b32 s80, 0
Lspinl15:
  s_sleep 2
  s_xor_b32 s76, s84, 32768
  s_sub_u32 s76, s76, s84
  s_add_u32 s76, s76, s79
  s_add_u32 s76, s76, 0x800800
  buffer_load_dwordx4 v[64:67], v15, s[44:47], s76 offen offset:0 sc1
  buffer_load_dwordx4 v[68:71], v15, s[44:47], s76 offen offset:1024 sc1
  s_xor_b32 s76, s84, 65536
  s_sub_u32 s76, s76, s84
  s_add_u32 s76, s76, s79
  s_add_u32 s76, s76, 0x801000
  buffer_load_dwordx4 v[72:75], v15, s[44:47], s76 offen offset:0 sc1
  buffer_load_dwordx4 v[76:79], v15, s[44:47], s76 offen offset:1024 sc1
  s_xor_b32 s76, s84, 98304
  s_sub_u32 s76, s76, s84
  s_add_u32 s76, s76, s79
  s_add_u32 s76, s76, 0x801800
  buffer_load_dwordx4 v[80:83], v15, s[44:47], s76 offen offset:0 sc1
  buffer_load_dwordx4 v[84:87], v15, s[44:47], s76 offen offset:1024 sc1
  s_waitcnt vmcnt(0)
  v_max3_u32 v112, v64, v65, v66
  v_max3_u32 v112, v112, v67, v68
  v_max3_u32 v112, v112, v69, v70
  v_max3_u32 v112, v112, v71, v72
  v_max3_u32 v112, v112, v73, v74
  v_max3_u32 v112, v112, v75, v76
  v_max3_u32 v112, v112, v77, v78
  v_max3_u32 v112, v112, v79, v80
  v_max3_u32 v112, v112, v81, v82
  v_max3_u32 v112, v112, v83, v84
  v_max3_u32 v112, v112, v85, v86
  v_max_u32 v112, v112, v87
  v_cmp_eq_u32 vcc, -1, v112
  s_cbranch_vccz Lback15
  s_add_u32 s80, s80, 1
  s_cmp_lt_u32 s80, 65536
  s_cbranch_scc1 Lspinl15
  s_branch Lback15
L_code_end:
.section .rodata,"a"
.p2align 6
.amdhsa_kernel recurrent_scan__compressed_kv_cla__glu_gated_bilinear__prompt_kernel
  .amdhsa_next_free_vgpr 512
  .amdhsa_next_free_sgpr 102
  .amdhsa_accum_offset 256
  .amdhsa_group_segment_fixed_size 0
  .amdhsa_kernarg_size 104
  .amdhsa_user_sgpr_count 2
  .amdhsa_user_sgpr_kernarg_segment_ptr 1
  .amdhsa_system_sgpr_workgroup_id_x 1
  .amdhsa_float_denorm_mode_32 3
  .amdhsa_ieee_mode 0
.end_amdhsa_kernel
```
